```python
import torch

def _softmax(x, axis=-1):
    return torch.softmax(x, dim=axis)
def _gelu(x):
    return torch.nn.functional.gelu(x, approximate="tanh")
def _silu(x):
    return torch.nn.functional.silu(x)
def _sigmoid(x):
    return torch.sigmoid(x)
def _layernorm(x, axis=-1, eps=1e-5):
    m = x.mean(dim=axis, keepdim=True)
    v = x.var(dim=axis, keepdim=True, unbiased=False)
    return (x - m) / torch.sqrt(v + eps)
def _scatter_add(tgt, idx, src, axis=0):
    return tgt.clone().index_add_(axis, idx, src)
def _segment_sum(src, seg, n):
    out = torch.zeros((n,) + src.shape[1:], dtype=src.dtype)
    return out.index_add_(0, seg, src)
def _pad(x, pw):
    flat = tuple(v for pair in reversed(pw) for v in pair)
    return torch.nn.functional.pad(x, flat)

kernel_name = 'sequential_preLN__compressed_kv_cla__glu_gated_reglu__prompt'

def setup_inputs():

    _w = (lambda a: (lambda t: t.to(torch.bfloat16) if t.is_floating_point() else t)(torch.as_tensor(a)))
    def _A_setup():
        B, H, Sq, Sk, D, M = 1, 16, 2048, 2048, 256, 448
        Dc = 4 * D
        return {
            "x": _w((lambda *s: torch.randn(*s, dtype=torch.bfloat16) * 0.05)(B, Sq, M)),
            "c_kv": _w((lambda *s: torch.randn(*s, dtype=torch.bfloat16) * 0.4)(B, Sk, Dc)),
            "w_q": _w((lambda *s: torch.randn(*s, dtype=torch.bfloat16) * 1.6)(M, H, D) * (M ** -0.5)),
            "w_uk": _w((lambda *s: torch.randn(*s, dtype=torch.bfloat16) * 1.6)(Dc, H, D) * (Dc ** -0.5)),
            "w_uv": _w((lambda *s: torch.randn(*s, dtype=torch.bfloat16) * 0.4)(Dc, H, D) * (Dc ** -0.5)),
            "w_o": _w((lambda *s: torch.randn(*s, dtype=torch.bfloat16) * 0.4)(H, D, M) * ((H * D) ** -0.5)),
        }
    _A_in = _A_setup()

    def _B_setup():
        B, S, D, F = 1, 2048, 448, 1792
        return {
            "x": _w((lambda *s: torch.randn(*s, dtype=torch.bfloat16) * 0.05)(B, S, D)),
            "W_gate": _w((lambda *s: torch.randn(*s, dtype=torch.bfloat16) * 0.2)(D, F) * (2.0 / D) ** 0.5),
            "W_up": _w((lambda *s: torch.randn(*s, dtype=torch.bfloat16) * 0.2)(D, F) * (2.0 / D) ** 0.5),
            "W_down": _w((lambda *s: torch.randn(*s, dtype=torch.bfloat16) * 0.2)(F, D) * (1.0 / F) ** 0.5),
        }
    _B_in = _B_setup()

    return {
        "A_x": _A_in["x"],
        "A_c_kv": _A_in["c_kv"],
        "A_w_q": _A_in["w_q"],
        "A_w_uk": _A_in["w_uk"],
        "A_w_uv": _A_in["w_uv"],
        "A_w_o": _A_in["w_o"],
        "B_x": _B_in["x"],
        "B_W_gate": _B_in["W_gate"],
        "B_W_up": _B_in["W_up"],
        "B_W_down": _B_in["W_down"],
    }

def reference(A_x, A_c_kv, A_w_q, A_w_uk, A_w_uv, A_w_o, B_x, B_W_gate, B_W_up, B_W_down):
    def _A_ref(x, c_kv, w_q, w_uk, w_uv, w_o):
        B, Sq, M = x.shape[0], x.shape[1], x.shape[2]
        Sk = c_kv.shape[1]
        H, D = w_q.shape[1], w_q.shape[2]
        q = torch.einsum("bqm,mhd->bhqd", x, w_q)
        k = torch.einsum("bkc,chd->bhkd", c_kv, w_uk)
        v = torch.einsum("bkc,chd->bhkd", c_kv, w_uv)
        scores = torch.einsum("bhqd,bhkd->bhqk", q, k) * (D ** -0.5)
        off = Sk - Sq
        qi = torch.arange(Sq)[:, None]
        kj = torch.arange(Sk)[None, :]
        cmask = kj <= (qi + off)
        scores = torch.where(cmask[None, None], scores, -1e9)
        p = _softmax(scores, axis=-1)
        ctx = torch.einsum("bhqk,bhkd->bhqd", p, v)
        return torch.einsum("bhqd,hdm->bqm", ctx, w_o)

    def _B_ref(x, W_gate, W_up, W_down):
        gate = torch.einsum("bsd,df->bsf", x, W_gate)
        up = torch.einsum("bsd,df->bsf", x, W_up)
        gate = gate * (lambda x, dt: x.to(dt))(gate > 0, gate.dtype)
        h = gate * up
        return torch.einsum("bsf,fd->bsd", h, W_down)

    x = A_x
    h = x + _A_ref(_layernorm(x, axis=-1), A_c_kv, A_w_q, A_w_uk, A_w_uv, A_w_o)
    h2 = h + _B_ref(_layernorm(h, axis=-1), B_W_gate, B_W_up, B_W_down)
    return h2
```

```asm
; @launch grid=(256,1,1) block=(256,1,1) lds=163840
.amdgcn_target "amdgcn-amd-amdhsa--gfx950"
.text
.globl sequential_preLN__compressed_kv_cla__glu_gated_reglu__prompt_kernel
.p2align 8
.type sequential_preLN__compressed_kv_cla__glu_gated_reglu__prompt_kernel,@function
sequential_preLN__compressed_kv_cla__glu_gated_reglu__prompt_kernel:
s_cmp_ge_u32 s2, 256
s_cbranch_scc1 K2_end
s_getpc_b64 s[58:59]
CT0:
s_sub_u32 s58, s58, (CT0 - sequential_preLN__compressed_kv_cla__glu_gated_reglu__prompt_kernel)
s_subb_u32 s59, s59, 0
v_and_b32 v250, 63, v0
v_lshrrev_b32 v251, 6, v0
v_mov_b32 v248, s2
v_lshrrev_b32 v248, 3, v248
v_lshl_add_u32 v251, v248, 2, v251
v_mul_u32_u24 v251, 6, v251
v_add_u32 v251, v251, v250
v_cmp_gt_u32 vcc, 6, v250
s_nop 1
v_cndmask_b32 v251, 0, v251, vcc
v_min_u32 v251, ((KALL_code_end - sequential_preLN__compressed_kv_cla__glu_gated_reglu__prompt_kernel) / 128) - 1, v251
v_lshlrev_b32 v251, 7, v251
v_mov_b32 v249, s59
v_add_co_u32 v248, vcc, s58, v251
s_nop 1
v_addc_co_u32 v249, vcc, 0, v249, vcc
global_load_dword v250, v[248:249], off
s_load_dwordx2 s[72:73], s[0:1], 88
s_load_dwordx2 s[74:75], s[0:1], 16
s_load_dwordx2 s[62:63], s[0:1], 40
s_load_dwordx4 s[64:67], s[0:1], 56
s_load_dwordx4 s[68:71], s[0:1], 72
s_load_dwordx4 s[40:43], s[0:1], 0
s_load_dwordx4 s[44:47], s[0:1], 24
s_load_dwordx2 s[48:49], s[0:1], 96
v_and_b32 v1, 63, v0
v_lshrrev_b32 v2, 6, v0
s_nop 0
v_readfirstlane_b32 s20, v2
s_and_b32 s3, s2, 7
s_lshr_b32 s4, s2, 3
s_and_b32 s5, s4, 3
s_lshr_b32 s6, s4, 2
s_and_b32 s7, s5, 1
s_lshl_b32 s31, s3, 1
s_add_u32 s7, s7, s31
s_lshr_b32 s21, s20, 1
s_and_b32 s22, s20, 1
s_lshl_b32 s28, s20, 12
s_lshl_b32 s31, s2, 3
s_lshl_b32 s33, s20, 1
s_add_u32 s31, s31, s33
s_mul_i32 s33, s31, 896
v_lshlrev_b32 v2, 4, v1
v_add_u32 v2, s33, v2
v_add_u32 v3, 896, v2
v_cmp_gt_u32 s[56:57], 56, v1
v_mov_b32 v4, 0x80000000
s_nop 0
v_cndmask_b32 v28, v4, v2, s[56:57]
v_cndmask_b32 v29, v4, v3, s[56:57]
s_lshr_b32 s33, s31, 4
s_mul_i32 s33, s33, 14336
s_and_b32 s31, s31, 15
s_lshl_b32 s31, s31, 4
s_add_u32 s33, s33, s31
v_lshrrev_b32 v2, 2, v1
v_lshlrev_b32 v2, 10, v2
v_and_b32 v3, 3, v1
v_lshl_add_u32 v2, v3, 8, v2
v_add_u32 v2, s33, v2
v_add_u32 v3, 16, v2
v_cndmask_b32 v30, v4, v2, s[56:57]
v_cndmask_b32 v31, v4, v3, s[56:57]
v_lshrrev_b32 v2, 3, v1
v_lshrrev_b32 v3, 2, v2
v_lshlrev_b32 v3, 3, v3
v_and_b32 v2, 3, v2
v_add_u32 v2, v2, v3
s_mov_b32 s30, 8192
v_mul_lo_u32 v2, v2, s30
v_and_b32 v3, 7, v1
v_lshrrev_b32 v3, 1, v3
v_lshrrev_b32 v4, 4, v1
v_xor_b32 v3, v3, v4
v_lshlrev_b32 v3, 5, v3
v_and_b32 v4, 1, v1
v_lshlrev_b32 v4, 4, v4
v_add3_u32 v2, v2, v3, v4
s_lshl_b32 s30, s20, 7
v_add_u32 v2, s30, v2
v_add_u32 v12, 0, v2
v_add_u32 v13, 31744, v2
v_add_u32 v14, 129024, v2
v_add_u32 v15, 160768, v2
v_and_b32 v2, 15, v1
v_lshrrev_b32 v2, 2, v2
v_lshrrev_b32 v3, 4, v1
v_and_b32 v4, 1, v3
v_lshrrev_b32 v3, 1, v3
v_lshlrev_b32 v3, 4, v3
v_lshl_add_u32 v3, v4, 2, v3
v_add_u32 v3, v3, v2
v_lshlrev_b32 v3, 7, v3
v_lshrrev_b32 v2, 1, v2
v_lshl_add_u32 v2, v4, 1, v2
v_and_b32 v4, 3, v1
v_lshl_add_u32 v3, v4, 3, v3
s_lshl_b32 s30, s22, 13
v_add_u32 v3, s30, v3
v_xor_b32 v4, 0, v2
v_lshl_add_u32 v20, v4, 5, v3
v_xor_b32 v4, 1, v2
v_lshl_add_u32 v21, v4, 5, v3
v_xor_b32 v4, 2, v2
v_lshl_add_u32 v22, v4, 5, v3
v_xor_b32 v4, 3, v2
v_lshl_add_u32 v23, v4, 5, v3
v_lshrrev_b32 v2, 3, v1
s_mul_i32 s30, s20, 64
v_add_u32 v2, s30, v2
s_mov_b32 s30, 2048
v_mul_lo_u32 v2, v2, s30
v_lshrrev_b32 v3, 4, v1
v_and_b32 v4, 7, v1
v_xor_b32 v5, 0, v3
v_xor_b32 v5, v5, v4
v_lshlrev_b32 v5, 4, v5
v_add_u32 v5, v5, v2
v_add_u32 v8, 0, v5
v_xor_b32 v5, 4, v3
v_xor_b32 v5, v5, v4
v_lshlrev_b32 v5, 4, v5
v_add_u32 v5, v5, v2
v_add_u32 v9, 15360, v5
v_xor_b32 v5, 0, v3
v_xor_b32 v5, v5, v4
v_lshlrev_b32 v5, 4, v5
v_add_u32 v5, v5, v2
v_add_u32 v10, 30720, v5
v_xor_b32 v5, 4, v3
v_xor_b32 v5, v5, v4
v_lshlrev_b32 v5, 4, v5
v_add_u32 v5, v5, v2
v_add_u32 v11, 46080, v5
v_and_b32 v2, 15, v1
v_lshrrev_b32 v3, 4, v1
v_lshrrev_b32 v4, 1, v2
v_xor_b32 v4, v4, v3
v_lshlrev_b32 v2, 7, v2
s_mul_i32 s30, s21, 16384
v_add_u32 v2, s30, v2
v_xor_b32 v5, 0, v4
v_lshlrev_b32 v5, 4, v5
v_add_u32 v16, v5, v2
v_xor_b32 v5, 4, v4
v_lshlrev_b32 v5, 4, v5
v_add_u32 v17, v5, v2
s_lshl_b32 s29, s20, 13
s_add_u32 s29, s29, 65536
s_waitcnt lgkmcnt(0)
s_lshl_b32 s31, s7, 9
s_add_u32 s92, s74, s31
s_addc_u32 s93, s75, 0
s_sub_u32 s94, 3670016, s31
s_mov_b32 s95, 0x20000
s_lshr_b32 s33, s4, 1
s_mul_i32 s33, s33, 28
s_mul_i32 s31, s20, 7
s_add_u32 s33, s33, s31
v_lshrrev_b32 v245, 2, v1
v_add_u32 v245, s33, v245
v_lshlrev_b32 v245, 13, v245
v_and_b32 v246, 3, v1
v_lshl_add_u32 v245, v246, 7, v245
v_cmp_gt_u32 vcc, 28, v1
v_mov_b32 v246, 0x80000000
s_nop 0
v_cndmask_b32 v245, v246, v245, vcc
s_mov_b32 s52, s48
s_mov_b32 s53, s49
s_mov_b32 s54, 134217728
s_mov_b32 s55, 0x20000
s_lshr_b32 s31, s2, 3
s_lshl_b32 s31, s31, 2
s_add_u32 s31, s31, s20
s_lshl_b32 s33, s31, 21
v_lshlrev_b32 v252, 27, v1
v_add_u32 v253, s33, v252
buffer_load_dword v254, v253, s[52:55], 0 offen
s_lshl_b32 s33, s31, 20
v_add_u32 v253, s33, v252
s_mov_b32 s52, s74
s_mov_b32 s53, s75
s_mov_b32 s54, 3670016
s_mov_b32 s55, 0x20000
buffer_load_dword v208, v253, s[52:55], 0 offen
s_mov_b32 s52, s62
s_mov_b32 s53, s63
s_mov_b32 s54, 3670016
s_mov_b32 s55, 0x20000
buffer_load_dword v209, v253, s[52:55], 0 offen
s_mov_b32 s52, s64
s_mov_b32 s53, s65
s_mov_b32 s54, 1605632
s_mov_b32 s55, 0x20000
buffer_load_dword v210, v253, s[52:55], 0 offen
s_mov_b32 s52, s66
s_mov_b32 s53, s67
s_mov_b32 s54, 1605632
s_mov_b32 s55, 0x20000
buffer_load_dword v211, v253, s[52:55], 0 offen
s_mov_b32 s52, s68
s_mov_b32 s53, s69
s_mov_b32 s54, 1605632
s_mov_b32 s55, 0x20000
buffer_load_dword v212, v253, s[52:55], 0 offen
s_mov_b32 s52, s70
s_mov_b32 s53, s71
s_mov_b32 s54, 1835008
s_mov_b32 s55, 0x20000
buffer_load_dword v213, v253, s[52:55], 0 offen
s_mov_b32 s52, s40
s_mov_b32 s53, s41
s_mov_b32 s54, 1835008
s_mov_b32 s55, 0x20000
buffer_load_dwordx4 v[200:203], v28, s[52:55], 0 offen
buffer_load_dwordx4 v[204:207], v29, s[52:55], 0 offen
s_lshl_b32 s31, s6, 19
s_add_u32 s8, s42, s31
s_addc_u32 s9, s43, 0
s_sub_u32 s10, 0x400000, s31
s_mov_b32 s11, 0x20000
s_lshr_b32 s32, s5, 1
s_cmp_eq_u32 s32, 0
s_cselect_b32 s36, s44, s46
s_cselect_b32 s37, s45, s47
s_lshl_b32 s31, s7, 9
s_add_u32 s12, s36, s31
s_addc_u32 s13, s37, 0
s_sub_u32 s14, 0x800000, s31
s_mov_b32 s15, 0x20000
s_mul_i32 s31, s32, 16777216
s_lshl_b32 s33, s7, 20
s_add_u32 s31, s31, s33
s_add_u32 s31, s31, 2097152
s_add_u32 s16, s48, s31
s_addc_u32 s17, s49, 0
s_mov_b32 s18, 0x100000
s_mov_b32 s19, 0x20000
s_mov_b32 s23, 0
s_mov_b32 s24, 0
s_mov_b32 s25, 0
s_mov_b32 s26, 65536
s_add_u32 m0, s29, s25
s_nop 0
buffer_load_dwordx4 v8, s[8:11], s24 offen offset:0 lds
buffer_load_dwordx4 v9, s[8:11], s24 offen offset:1024 lds
buffer_load_dwordx4 v10, s[8:11], s24 offen offset:2048 lds
buffer_load_dwordx4 v11, s[8:11], s24 offen offset:3072 lds
s_add_u32 s30, s24, 65536
s_add_u32 m0, s29, s25
s_add_u32 m0, m0, 4096
s_nop 0
buffer_load_dwordx4 v8, s[8:11], s30 offen offset:0 lds
buffer_load_dwordx4 v9, s[8:11], s30 offen offset:1024 lds
buffer_load_dwordx4 v10, s[8:11], s30 offen offset:2048 lds
buffer_load_dwordx4 v11, s[8:11], s30 offen offset:3072 lds
s_add_u32 s24, s24, 128
s_add_u32 s25, s25, 32768
s_cmp_eq_u32 s25, 98304
s_cselect_b32 s25, 0, s25
s_add_u32 m0, s28, 0
s_nop 0
buffer_load_dwordx4 v12, s[12:15], s23 offen offset:0 lds
buffer_load_dwordx4 v13, s[12:15], s23 offen offset:1024 lds
buffer_load_dwordx4 v14, s[12:15], s23 offen offset:2048 lds
buffer_load_dwordx4 v15, s[12:15], s23 offen offset:3072 lds
s_add_u32 s23, s23, 262144
s_add_u32 m0, s28, 16384
s_nop 0
buffer_load_dwordx4 v12, s[12:15], s23 offen offset:0 lds
buffer_load_dwordx4 v13, s[12:15], s23 offen offset:1024 lds
buffer_load_dwordx4 v14, s[12:15], s23 offen offset:2048 lds
buffer_load_dwordx4 v15, s[12:15], s23 offen offset:3072 lds
s_add_u32 s23, s23, 262144
v_accvgpr_write_b32 a0, 0
v_accvgpr_write_b32 a1, 0
v_accvgpr_write_b32 a2, 0
v_accvgpr_write_b32 a3, 0
v_accvgpr_write_b32 a4, 0
v_accvgpr_write_b32 a5, 0
v_accvgpr_write_b32 a6, 0
v_accvgpr_write_b32 a7, 0
v_accvgpr_write_b32 a8, 0
v_accvgpr_write_b32 a9, 0
v_accvgpr_write_b32 a10, 0
v_accvgpr_write_b32 a11, 0
v_accvgpr_write_b32 a12, 0
v_accvgpr_write_b32 a13, 0
v_accvgpr_write_b32 a14, 0
v_accvgpr_write_b32 a15, 0
v_accvgpr_write_b32 a16, 0
v_accvgpr_write_b32 a17, 0
v_accvgpr_write_b32 a18, 0
v_accvgpr_write_b32 a19, 0
v_accvgpr_write_b32 a20, 0
v_accvgpr_write_b32 a21, 0
v_accvgpr_write_b32 a22, 0
v_accvgpr_write_b32 a23, 0
v_accvgpr_write_b32 a24, 0
v_accvgpr_write_b32 a25, 0
v_accvgpr_write_b32 a26, 0
v_accvgpr_write_b32 a27, 0
v_accvgpr_write_b32 a28, 0
v_accvgpr_write_b32 a29, 0
v_accvgpr_write_b32 a30, 0
v_accvgpr_write_b32 a31, 0
v_accvgpr_write_b32 a32, 0
v_accvgpr_write_b32 a33, 0
v_accvgpr_write_b32 a34, 0
v_accvgpr_write_b32 a35, 0
v_accvgpr_write_b32 a36, 0
v_accvgpr_write_b32 a37, 0
v_accvgpr_write_b32 a38, 0
v_accvgpr_write_b32 a39, 0
v_accvgpr_write_b32 a40, 0
v_accvgpr_write_b32 a41, 0
v_accvgpr_write_b32 a42, 0
v_accvgpr_write_b32 a43, 0
v_accvgpr_write_b32 a44, 0
v_accvgpr_write_b32 a45, 0
v_accvgpr_write_b32 a46, 0
v_accvgpr_write_b32 a47, 0
v_accvgpr_write_b32 a48, 0
v_accvgpr_write_b32 a49, 0
v_accvgpr_write_b32 a50, 0
v_accvgpr_write_b32 a51, 0
v_accvgpr_write_b32 a52, 0
v_accvgpr_write_b32 a53, 0
v_accvgpr_write_b32 a54, 0
v_accvgpr_write_b32 a55, 0
v_accvgpr_write_b32 a56, 0
v_accvgpr_write_b32 a57, 0
v_accvgpr_write_b32 a58, 0
v_accvgpr_write_b32 a59, 0
v_accvgpr_write_b32 a60, 0
v_accvgpr_write_b32 a61, 0
v_accvgpr_write_b32 a62, 0
v_accvgpr_write_b32 a63, 0
v_accvgpr_write_b32 a64, 0
v_accvgpr_write_b32 a65, 0
v_accvgpr_write_b32 a66, 0
v_accvgpr_write_b32 a67, 0
v_accvgpr_write_b32 a68, 0
v_accvgpr_write_b32 a69, 0
v_accvgpr_write_b32 a70, 0
v_accvgpr_write_b32 a71, 0
v_accvgpr_write_b32 a72, 0
v_accvgpr_write_b32 a73, 0
v_accvgpr_write_b32 a74, 0
v_accvgpr_write_b32 a75, 0
v_accvgpr_write_b32 a76, 0
v_accvgpr_write_b32 a77, 0
v_accvgpr_write_b32 a78, 0
v_accvgpr_write_b32 a79, 0
v_accvgpr_write_b32 a80, 0
v_accvgpr_write_b32 a81, 0
v_accvgpr_write_b32 a82, 0
v_accvgpr_write_b32 a83, 0
v_accvgpr_write_b32 a84, 0
v_accvgpr_write_b32 a85, 0
v_accvgpr_write_b32 a86, 0
v_accvgpr_write_b32 a87, 0
v_accvgpr_write_b32 a88, 0
v_accvgpr_write_b32 a89, 0
v_accvgpr_write_b32 a90, 0
v_accvgpr_write_b32 a91, 0
v_accvgpr_write_b32 a92, 0
v_accvgpr_write_b32 a93, 0
v_accvgpr_write_b32 a94, 0
v_accvgpr_write_b32 a95, 0
v_accvgpr_write_b32 a96, 0
v_accvgpr_write_b32 a97, 0
v_accvgpr_write_b32 a98, 0
v_accvgpr_write_b32 a99, 0
v_accvgpr_write_b32 a100, 0
v_accvgpr_write_b32 a101, 0
v_accvgpr_write_b32 a102, 0
v_accvgpr_write_b32 a103, 0
v_accvgpr_write_b32 a104, 0
v_accvgpr_write_b32 a105, 0
v_accvgpr_write_b32 a106, 0
v_accvgpr_write_b32 a107, 0
v_accvgpr_write_b32 a108, 0
v_accvgpr_write_b32 a109, 0
v_accvgpr_write_b32 a110, 0
v_accvgpr_write_b32 a111, 0
v_accvgpr_write_b32 a112, 0
v_accvgpr_write_b32 a113, 0
v_accvgpr_write_b32 a114, 0
v_accvgpr_write_b32 a115, 0
v_accvgpr_write_b32 a116, 0
v_accvgpr_write_b32 a117, 0
v_accvgpr_write_b32 a118, 0
v_accvgpr_write_b32 a119, 0
v_accvgpr_write_b32 a120, 0
v_accvgpr_write_b32 a121, 0
v_accvgpr_write_b32 a122, 0
v_accvgpr_write_b32 a123, 0
v_accvgpr_write_b32 a124, 0
v_accvgpr_write_b32 a125, 0
v_accvgpr_write_b32 a126, 0
v_accvgpr_write_b32 a127, 0
v_accvgpr_write_b32 a128, 0
v_accvgpr_write_b32 a129, 0
v_accvgpr_write_b32 a130, 0
v_accvgpr_write_b32 a131, 0
v_accvgpr_write_b32 a132, 0
v_accvgpr_write_b32 a133, 0
v_accvgpr_write_b32 a134, 0
v_accvgpr_write_b32 a135, 0
v_accvgpr_write_b32 a136, 0
v_accvgpr_write_b32 a137, 0
v_accvgpr_write_b32 a138, 0
v_accvgpr_write_b32 a139, 0
v_accvgpr_write_b32 a140, 0
v_accvgpr_write_b32 a141, 0
v_accvgpr_write_b32 a142, 0
v_accvgpr_write_b32 a143, 0
v_accvgpr_write_b32 a144, 0
v_accvgpr_write_b32 a145, 0
v_accvgpr_write_b32 a146, 0
v_accvgpr_write_b32 a147, 0
v_accvgpr_write_b32 a148, 0
v_accvgpr_write_b32 a149, 0
v_accvgpr_write_b32 a150, 0
v_accvgpr_write_b32 a151, 0
v_accvgpr_write_b32 a152, 0
v_accvgpr_write_b32 a153, 0
v_accvgpr_write_b32 a154, 0
v_accvgpr_write_b32 a155, 0
v_accvgpr_write_b32 a156, 0
v_accvgpr_write_b32 a157, 0
v_accvgpr_write_b32 a158, 0
v_accvgpr_write_b32 a159, 0
v_accvgpr_write_b32 a160, 0
v_accvgpr_write_b32 a161, 0
v_accvgpr_write_b32 a162, 0
v_accvgpr_write_b32 a163, 0
v_accvgpr_write_b32 a164, 0
v_accvgpr_write_b32 a165, 0
v_accvgpr_write_b32 a166, 0
v_accvgpr_write_b32 a167, 0
v_accvgpr_write_b32 a168, 0
v_accvgpr_write_b32 a169, 0
v_accvgpr_write_b32 a170, 0
v_accvgpr_write_b32 a171, 0
v_accvgpr_write_b32 a172, 0
v_accvgpr_write_b32 a173, 0
v_accvgpr_write_b32 a174, 0
v_accvgpr_write_b32 a175, 0
v_accvgpr_write_b32 a176, 0
v_accvgpr_write_b32 a177, 0
v_accvgpr_write_b32 a178, 0
v_accvgpr_write_b32 a179, 0
v_accvgpr_write_b32 a180, 0
v_accvgpr_write_b32 a181, 0
v_accvgpr_write_b32 a182, 0
v_accvgpr_write_b32 a183, 0
v_accvgpr_write_b32 a184, 0
v_accvgpr_write_b32 a185, 0
v_accvgpr_write_b32 a186, 0
v_accvgpr_write_b32 a187, 0
v_accvgpr_write_b32 a188, 0
v_accvgpr_write_b32 a189, 0
v_accvgpr_write_b32 a190, 0
v_accvgpr_write_b32 a191, 0
v_accvgpr_write_b32 a192, 0
v_accvgpr_write_b32 a193, 0
v_accvgpr_write_b32 a194, 0
v_accvgpr_write_b32 a195, 0
v_accvgpr_write_b32 a196, 0
v_accvgpr_write_b32 a197, 0
v_accvgpr_write_b32 a198, 0
v_accvgpr_write_b32 a199, 0
v_accvgpr_write_b32 a200, 0
v_accvgpr_write_b32 a201, 0
v_accvgpr_write_b32 a202, 0
v_accvgpr_write_b32 a203, 0
v_accvgpr_write_b32 a204, 0
v_accvgpr_write_b32 a205, 0
v_accvgpr_write_b32 a206, 0
v_accvgpr_write_b32 a207, 0
v_accvgpr_write_b32 a208, 0
v_accvgpr_write_b32 a209, 0
v_accvgpr_write_b32 a210, 0
v_accvgpr_write_b32 a211, 0
v_accvgpr_write_b32 a212, 0
v_accvgpr_write_b32 a213, 0
v_accvgpr_write_b32 a214, 0
v_accvgpr_write_b32 a215, 0
v_accvgpr_write_b32 a216, 0
v_accvgpr_write_b32 a217, 0
v_accvgpr_write_b32 a218, 0
v_accvgpr_write_b32 a219, 0
v_accvgpr_write_b32 a220, 0
v_accvgpr_write_b32 a221, 0
v_accvgpr_write_b32 a222, 0
v_accvgpr_write_b32 a223, 0
v_accvgpr_write_b32 a224, 0
v_accvgpr_write_b32 a225, 0
v_accvgpr_write_b32 a226, 0
v_accvgpr_write_b32 a227, 0
v_accvgpr_write_b32 a228, 0
v_accvgpr_write_b32 a229, 0
v_accvgpr_write_b32 a230, 0
v_accvgpr_write_b32 a231, 0
v_accvgpr_write_b32 a232, 0
v_accvgpr_write_b32 a233, 0
v_accvgpr_write_b32 a234, 0
v_accvgpr_write_b32 a235, 0
v_accvgpr_write_b32 a236, 0
v_accvgpr_write_b32 a237, 0
v_accvgpr_write_b32 a238, 0
v_accvgpr_write_b32 a239, 0
v_accvgpr_write_b32 a240, 0
v_accvgpr_write_b32 a241, 0
v_accvgpr_write_b32 a242, 0
v_accvgpr_write_b32 a243, 0
v_accvgpr_write_b32 a244, 0
v_accvgpr_write_b32 a245, 0
v_accvgpr_write_b32 a246, 0
v_accvgpr_write_b32 a247, 0
v_accvgpr_write_b32 a248, 0
v_accvgpr_write_b32 a249, 0
v_accvgpr_write_b32 a250, 0
v_accvgpr_write_b32 a251, 0
v_accvgpr_write_b32 a252, 0
v_accvgpr_write_b32 a253, 0
v_accvgpr_write_b32 a254, 0
v_accvgpr_write_b32 a255, 0
s_waitcnt vmcnt(16)
v_lshlrev_b32 v208, 16, v200
v_and_b32 v209, 0xffff0000, v200
v_lshlrev_b32 v210, 16, v201
v_and_b32 v211, 0xffff0000, v201
v_lshlrev_b32 v212, 16, v202
v_and_b32 v213, 0xffff0000, v202
v_lshlrev_b32 v214, 16, v203
v_and_b32 v215, 0xffff0000, v203
v_lshlrev_b32 v216, 16, v204
v_and_b32 v217, 0xffff0000, v204
v_lshlrev_b32 v218, 16, v205
v_and_b32 v219, 0xffff0000, v205
v_lshlrev_b32 v220, 16, v206
v_and_b32 v221, 0xffff0000, v206
v_lshlrev_b32 v222, 16, v207
v_and_b32 v223, 0xffff0000, v207
v_add_f32 v224, v208, v209
v_add_f32 v224, v224, v210
v_add_f32 v224, v224, v211
v_add_f32 v224, v224, v212
v_add_f32 v224, v224, v213
v_add_f32 v224, v224, v214
v_add_f32 v224, v224, v215
v_add_f32 v225, v216, v217
v_add_f32 v225, v225, v218
v_add_f32 v225, v225, v219
v_add_f32 v225, v225, v220
v_add_f32 v225, v225, v221
v_add_f32 v225, v225, v222
v_add_f32 v225, v225, v223
s_nop 1
v_add_f32_dpp v224, v224, v224 row_ror:8 row_mask:0xf bank_mask:0xf
v_add_f32_dpp v225, v225, v225 row_ror:8 row_mask:0xf bank_mask:0xf
s_nop 1
v_add_f32_dpp v224, v224, v224 row_ror:4 row_mask:0xf bank_mask:0xf
v_add_f32_dpp v225, v225, v225 row_ror:4 row_mask:0xf bank_mask:0xf
s_nop 1
v_add_f32_dpp v224, v224, v224 row_ror:2 row_mask:0xf bank_mask:0xf
v_add_f32_dpp v225, v225, v225 row_ror:2 row_mask:0xf bank_mask:0xf
s_nop 1
v_add_f32_dpp v224, v224, v224 row_ror:1 row_mask:0xf bank_mask:0xf
v_add_f32_dpp v225, v225, v225 row_ror:1 row_mask:0xf bank_mask:0xf
v_mov_b32 v226, v224
v_mov_b32 v227, v225
s_nop 1
v_permlane16_swap_b32 v224, v226
v_permlane16_swap_b32 v225, v227
s_nop 1
v_add_f32 v224, v224, v226
v_add_f32 v225, v225, v227
v_mov_b32 v226, v224
v_mov_b32 v227, v225
s_nop 1
v_permlane32_swap_b32 v224, v226
v_permlane32_swap_b32 v225, v227
s_nop 1
v_add_f32 v224, v224, v226
v_add_f32 v225, v225, v227
s_mov_b32 s58, 0x3b124925
v_mul_f32 v224, s58, v224
v_mul_f32 v225, s58, v225
v_sub_f32 v208, v208, v224
v_sub_f32 v209, v209, v224
v_sub_f32 v210, v210, v224
v_sub_f32 v211, v211, v224
v_sub_f32 v212, v212, v224
v_sub_f32 v213, v213, v224
v_sub_f32 v214, v214, v224
v_sub_f32 v215, v215, v224
v_sub_f32 v216, v216, v225
v_sub_f32 v217, v217, v225
v_sub_f32 v218, v218, v225
v_sub_f32 v219, v219, v225
v_sub_f32 v220, v220, v225
v_sub_f32 v221, v221, v225
v_sub_f32 v222, v222, v225
v_sub_f32 v223, v223, v225
v_mov_b32 v230, 0
v_mul_f32 v228, v208, v208
v_fmac_f32 v228, v209, v209
v_fmac_f32 v228, v210, v210
v_fmac_f32 v228, v211, v211
v_fmac_f32 v228, v212, v212
v_fmac_f32 v228, v213, v213
v_fmac_f32 v228, v214, v214
v_fmac_f32 v228, v215, v215
v_cndmask_b32 v228, v230, v228, s[56:57]
v_mul_f32 v229, v216, v216
v_fmac_f32 v229, v217, v217
v_fmac_f32 v229, v218, v218
v_fmac_f32 v229, v219, v219
v_fmac_f32 v229, v220, v220
v_fmac_f32 v229, v221, v221
v_fmac_f32 v229, v222, v222
v_fmac_f32 v229, v223, v223
v_cndmask_b32 v229, v230, v229, s[56:57]
s_nop 1
v_add_f32_dpp v228, v228, v228 row_ror:8 row_mask:0xf bank_mask:0xf
v_add_f32_dpp v229, v229, v229 row_ror:8 row_mask:0xf bank_mask:0xf
s_nop 1
v_add_f32_dpp v228, v228, v228 row_ror:4 row_mask:0xf bank_mask:0xf
v_add_f32_dpp v229, v229, v229 row_ror:4 row_mask:0xf bank_mask:0xf
s_nop 1
v_add_f32_dpp v228, v228, v228 row_ror:2 row_mask:0xf bank_mask:0xf
v_add_f32_dpp v229, v229, v229 row_ror:2 row_mask:0xf bank_mask:0xf
s_nop 1
v_add_f32_dpp v228, v228, v228 row_ror:1 row_mask:0xf bank_mask:0xf
v_add_f32_dpp v229, v229, v229 row_ror:1 row_mask:0xf bank_mask:0xf
v_mov_b32 v226, v228
v_mov_b32 v227, v229
s_nop 1
v_permlane16_swap_b32 v228, v226
v_permlane16_swap_b32 v229, v227
s_nop 1
v_add_f32 v228, v228, v226
v_add_f32 v229, v229, v227
v_mov_b32 v226, v228
v_mov_b32 v227, v229
s_nop 1
v_permlane32_swap_b32 v228, v226
v_permlane32_swap_b32 v229, v227
s_nop 1
v_add_f32 v228, v228, v226
v_add_f32 v229, v229, v227
s_mov_b32 s59, 0x3727c5ac
v_mov_b32 v231, s59
v_fmac_f32 v231, s58, v228
v_rsq_f32 v228, v231
v_mov_b32 v231, s59
v_fmac_f32 v231, s58, v229
v_rsq_f32 v229, v231
s_nop 0
s_mov_b32 s59, 0x3db8aa3b
v_mul_f32 v228, s59, v228
v_mul_f32 v229, s59, v229
v_mul_f32 v208, v208, v228
v_mul_f32 v209, v209, v228
v_mul_f32 v210, v210, v228
v_mul_f32 v211, v211, v228
v_mul_f32 v212, v212, v228
v_mul_f32 v213, v213, v228
v_mul_f32 v214, v214, v228
v_mul_f32 v215, v215, v228
v_cvt_pk_bf16_f32 v200, v208, v209
v_cvt_pk_bf16_f32 v201, v210, v211
v_cvt_pk_bf16_f32 v202, v212, v213
v_cvt_pk_bf16_f32 v203, v214, v215
v_mul_f32 v216, v216, v229
v_mul_f32 v217, v217, v229
v_mul_f32 v218, v218, v229
v_mul_f32 v219, v219, v229
v_mul_f32 v220, v220, v229
v_mul_f32 v221, v221, v229
v_mul_f32 v222, v222, v229
v_mul_f32 v223, v223, v229
v_cvt_pk_bf16_f32 v204, v216, v217
v_cvt_pk_bf16_f32 v205, v218, v219
v_cvt_pk_bf16_f32 v206, v220, v221
v_cvt_pk_bf16_f32 v207, v222, v223
s_mov_b32 s52, s48
s_mov_b32 s53, s49
s_mov_b32 s54, 1835008
s_mov_b32 s55, 0x20000
s_mov_b32 s96, s52
s_mov_b32 s97, s53
s_mov_b32 s98, s54
s_mov_b32 s99, 0x20000
s_lshr_b32 s31, s20, 1
s_lshl_b32 s31, s31, 13
s_and_b32 s33, s20, 1
s_lshl_b32 s33, s33, 11
s_add_u32 s31, s31, s33
s_add_u32 s31, s31, 135168
v_lshlrev_b32 v2, 4, v1
v_add_u32 v2, s31, v2
ds_write_b128 v2, v[200:203]
ds_write_b128 v2, v[204:207] offset:1024
v_and_b32 v3, 7, v1
v_lshrrev_b32 v4, 2, v3
v_lshlrev_b32 v4, 13, v4
v_and_b32 v5, 3, v3
v_lshl_add_u32 v4, v5, 10, v4
v_lshrrev_b32 v5, 3, v1
s_lshl_b32 s31, s20, 3
v_add_u32 v5, s31, v5
v_lshl_add_u32 v4, v5, 4, v4
v_add_u32 v232, 135168, v4
s_lshr_b32 s31, s2, 1
s_mul_i32 s31, s31, 14336
s_and_b32 s33, s2, 1
s_lshl_b32 s33, s33, 7
s_add_u32 s31, s31, s33
v_lshrrev_b32 v4, 2, v5
v_lshlrev_b32 v4, 10, v4
v_and_b32 v5, 3, v5
v_lshl_add_u32 v4, v5, 8, v4
v_lshl_add_u32 v4, v3, 4, v4
v_add_u32 v30, s31, v4
v_add_u32 v31, 8192, v30
s_cmp_eq_u32 s20, 3
s_cselect_b32 s31, 0x7f000000, 0
v_add_u32 v31, s31, v31
s_lshl_b32 s31, s2, 7
s_lshl_b32 s33, s20, 20
s_add_u32 s31, s31, s33
v_lshlrev_b32 v2, 20, v1
v_add_u32 v2, s31, v2
v_mov_b32 v3, 0
s_add_u32 s52, s48, 125829120
s_addc_u32 s53, s49, 0
s_mov_b32 s54, 12288
s_mov_b32 s55, 0x20000
v_mov_b32 v243, v2
v_mov_b32 v244, 0
s_mov_b32 s76, s72
s_mov_b32 s77, s73
s_mov_b32 s78, 256
s_mov_b32 s79, 0x20000
s_lshr_b32 s39, s2, 3
s_and_b32 s39, s39, 3
s_add_u32 s39, s39, 3
s_lshr_b32 s33, s2, 4
s_lshl_b32 s33, s33, 2
s_add_u32 s33, s33, 64
v_mov_b32 v236, s33
v_mov_b32 v237, 128
s_add_u32 m0, s29, s25
s_nop 0
buffer_load_dwordx4 v8, s[8:11], s24 offen offset:0 lds
buffer_load_dwordx4 v9, s[8:11], s24 offen offset:1024 lds
buffer_load_dwordx4 v10, s[8:11], s24 offen offset:2048 lds
buffer_load_dwordx4 v11, s[8:11], s24 offen offset:3072 lds
s_add_u32 s30, s24, 65536
s_add_u32 m0, s29, s25
s_add_u32 m0, m0, 4096
s_nop 0
buffer_load_dwordx4 v8, s[8:11], s30 offen offset:0 lds
buffer_load_dwordx4 v9, s[8:11], s30 offen offset:1024 lds
buffer_load_dwordx4 v10, s[8:11], s30 offen offset:2048 lds
buffer_load_dwordx4 v11, s[8:11], s30 offen offset:3072 lds
s_add_u32 s24, s24, 128
s_add_u32 s25, s25, 32768
s_cmp_eq_u32 s25, 98304
s_cselect_b32 s25, 0, s25
s_add_u32 m0, s28, 32768
s_nop 0
buffer_load_dwordx4 v12, s[12:15], s23 offen offset:0 lds
buffer_load_dwordx4 v13, s[12:15], s23 offen offset:1024 lds
buffer_load_dwordx4 v14, s[12:15], s23 offen offset:2048 lds
buffer_load_dwordx4 v15, s[12:15], s23 offen offset:3072 lds
s_add_u32 s23, s23, 262144
s_add_u32 m0, s28, 49152
s_nop 0
buffer_load_dwordx4 v12, s[12:15], s23 offen offset:0 lds
buffer_load_dwordx4 v13, s[12:15], s23 offen offset:1024 lds
buffer_load_dwordx4 v14, s[12:15], s23 offen offset:2048 lds
buffer_load_dwordx4 v15, s[12:15], s23 offen offset:3072 lds
s_add_u32 s23, s23, 262144
s_add_u32 m0, s29, s25
s_nop 0
buffer_load_dwordx4 v8, s[8:11], s24 offen offset:0 lds
buffer_load_dwordx4 v9, s[8:11], s24 offen offset:1024 lds
buffer_load_dwordx4 v10, s[8:11], s24 offen offset:2048 lds
buffer_load_dwordx4 v11, s[8:11], s24 offen offset:3072 lds
s_waitcnt vmcnt(24) lgkmcnt(0)
s_barrier
ds_read_b128 v[200:203], v232
ds_read_b128 v[204:207], v232 offset:512
v_add_u32 v18, s26, v16
v_add_u32 v19, s26, v17
s_add_u32 s26, s26, 32768
s_cmp_eq_u32 s26, 163840
s_cselect_b32 s26, 65536, s26
s_nop 0
ds_read_b128 v[64:67], v18 offset:0
ds_read_b64_tr_b16 v[96:97], v20 offset:0
ds_read_b64_tr_b16 v[98:99], v20 offset:1024
ds_read_b64_tr_b16 v[100:101], v21 offset:0
ds_read_b64_tr_b16 v[102:103], v21 offset:1024
ds_read_b64_tr_b16 v[104:105], v22 offset:0
ds_read_b64_tr_b16 v[106:107], v22 offset:1024
ds_read_b64_tr_b16 v[108:109], v23 offset:0
ds_read_b64_tr_b16 v[110:111], v23 offset:1024
ds_read_b64_tr_b16 v[112:113], v20 offset:4096
ds_read_b64_tr_b16 v[114:115], v20 offset:5120
ds_read_b64_tr_b16 v[116:117], v21 offset:4096
ds_read_b64_tr_b16 v[118:119], v21 offset:5120
ds_read_b64_tr_b16 v[120:121], v22 offset:4096
ds_read_b64_tr_b16 v[122:123], v22 offset:5120
ds_read_b64_tr_b16 v[124:125], v23 offset:4096
ds_read_b64_tr_b16 v[126:127], v23 offset:5120
ds_read_b128 v[68:71], v18 offset:2048
ds_read_b128 v[72:75], v18 offset:4096
ds_read_b128 v[76:79], v18 offset:6144
ds_read_b128 v[80:83], v18 offset:8192
ds_read_b128 v[84:87], v18 offset:10240
ds_read_b128 v[88:91], v18 offset:12288
ds_read_b128 v[92:95], v18 offset:14336
s_waitcnt vmcnt(20) lgkmcnt(0)
s_barrier
s_cmp_eq_u32 s32, 0
s_cbranch_scc0 K1_V
s_mov_b32 s27, 0
K1K_loop:
s_cmp_lg_u32 s27, 1
s_cbranch_scc1 K1K_h3
buffer_store_dwordx4 v[200:203], v30, s[96:99], 0 offen sc1
buffer_store_dwordx4 v[204:207], v31, s[96:99], 0 offen sc1
buffer_store_dword v244, v243, s[52:55], 0 offen sc1
K1K_h3:
s_cmp_lg_u32 s27, 5
s_cbranch_scc1 K1K_h4
buffer_load_dword v246, v245, s[92:95], 0 offen
K1K_h4:
s_cmp_lg_u32 s27, s39
s_cbranch_scc1 K1K_h1
s_cmp_lg_u32 s20, 0
s_cbranch_scc1 K1K_h1
s_lshr_b32 s31, s2, 4
s_lshl_b32 s31, s31, 2
s_add_u32 s31, s31, 64
v_mov_b32 v240, s31
v_mov_b32 v241, 1
v_mov_b32 v242, 128
v_cmp_eq_u32 vcc, 0, v1
s_and_saveexec_b64 s[56:57], vcc
buffer_atomic_add v241, v240, s[76:79], 0 offen sc1
s_cmp_ge_u32 s2, 96
s_cbranch_scc1 K1K_h0
buffer_atomic_add v241, v242, s[76:79], 0 offen sc1
K1K_h0:
s_mov_b64 exec, s[56:57]
s_nop 4
K1K_h1:
s_cmp_lg_u32 s27, 7
s_cbranch_scc1 K1K_h2
buffer_load_dword v251, v236, s[76:79], 0 offen sc1
buffer_load_dword v252, v237, s[76:79], 0 offen sc1
s_mov_b32 s12, s92
s_mov_b32 s13, s93
s_mov_b32 s14, s94
s_mov_b32 s23, 0
K1K_h2:
v_mfma_f32_16x16x32_bf16 a[0:3], v[96:99], v[64:67], a[0:3]
s_add_u32 m0, s28, 0
ds_read_b128 v[128:131], v19 offset:0
s_nop 0
v_mfma_f32_16x16x32_bf16 a[4:7], v[100:103], v[64:67], a[4:7]
ds_read_b64_tr_b16 v[160:161], v20 offset:16384
v_mfma_f32_16x16x32_bf16 a[8:11], v[104:107], v[64:67], a[8:11]
buffer_load_dwordx4 v12, s[12:15], s23 offen offset:0 lds
v_mfma_f32_16x16x32_bf16 a[12:15], v[108:111], v[64:67], a[12:15]
ds_read_b64_tr_b16 v[162:163], v20 offset:17408
v_mfma_f32_16x16x32_bf16 a[16:19], v[112:115], v[64:67], a[16:19]
ds_read_b64_tr_b16 v[164:165], v21 offset:16384
v_mfma_f32_16x16x32_bf16 a[20:23], v[116:119], v[64:67], a[20:23]
v_mfma_f32_16x16x32_bf16 a[24:27], v[120:123], v[64:67], a[24:27]
ds_read_b64_tr_b16 v[166:167], v21 offset:17408
v_mfma_f32_16x16x32_bf16 a[28:31], v[124:127], v[64:67], a[28:31]
v_mfma_f32_16x16x32_bf16 a[32:35], v[96:99], v[68:71], a[32:35]
buffer_load_dwordx4 v13, s[12:15], s23 offen offset:1024 lds
v_mfma_f32_16x16x32_bf16 a[36:39], v[100:103], v[68:71], a[36:39]
ds_read_b64_tr_b16 v[168:169], v22 offset:16384
v_mfma_f32_16x16x32_bf16 a[40:43], v[104:107], v[68:71], a[40:43]
v_mfma_f32_16x16x32_bf16 a[44:47], v[108:111], v[68:71], a[44:47]
ds_read_b64_tr_b16 v[170:171], v22 offset:17408
v_mfma_f32_16x16x32_bf16 a[48:51], v[112:115], v[68:71], a[48:51]
v_mfma_f32_16x16x32_bf16 a[52:55], v[116:119], v[68:71], a[52:55]
ds_read_b64_tr_b16 v[172:173], v23 offset:16384
v_mfma_f32_16x16x32_bf16 a[56:59], v[120:123], v[68:71], a[56:59]
v_mfma_f32_16x16x32_bf16 a[60:63], v[124:127], v[68:71], a[60:63]
buffer_load_dwordx4 v14, s[12:15], s23 offen offset:2048 lds
v_mfma_f32_16x16x32_bf16 a[64:67], v[96:99], v[72:75], a[64:67]
ds_read_b64_tr_b16 v[174:175], v23 offset:17408
v_mfma_f32_16x16x32_bf16 a[68:71], v[100:103], v[72:75], a[68:71]
ds_read_b64_tr_b16 v[176:177], v20 offset:20480
v_mfma_f32_16x16x32_bf16 a[72:75], v[104:107], v[72:75], a[72:75]
v_mfma_f32_16x16x32_bf16 a[76:79], v[108:111], v[72:75], a[76:79]
ds_read_b64_tr_b16 v[178:179], v20 offset:21504
v_mfma_f32_16x16x32_bf16 a[80:83], v[112:115], v[72:75], a[80:83]
v_mfma_f32_16x16x32_bf16 a[84:87], v[116:119], v[72:75], a[84:87]
ds_read_b64_tr_b16 v[180:181], v21 offset:20480
v_mfma_f32_16x16x32_bf16 a[88:91], v[120:123], v[72:75], a[88:91]
buffer_load_dwordx4 v15, s[12:15], s23 offen offset:3072 lds
v_mfma_f32_16x16x32_bf16 a[92:95], v[124:127], v[72:75], a[92:95]
v_mfma_f32_16x16x32_bf16 a[96:99], v[96:99], v[76:79], a[96:99]
ds_read_b64_tr_b16 v[182:183], v21 offset:21504
v_mfma_f32_16x16x32_bf16 a[100:103], v[100:103], v[76:79], a[100:103]
v_mfma_f32_16x16x32_bf16 a[104:107], v[104:107], v[76:79], a[104:107]
s_add_u32 s23, s23, 262144
ds_read_b64_tr_b16 v[184:185], v22 offset:20480
s_add_u32 s30, s24, 65536
v_mfma_f32_16x16x32_bf16 a[108:111], v[108:111], v[76:79], a[108:111]
s_add_u32 m0, s29, s25
v_mfma_f32_16x16x32_bf16 a[112:115], v[112:115], v[76:79], a[112:115]
s_add_u32 m0, m0, 4096
ds_read_b64_tr_b16 v[186:187], v22 offset:21504
s_nop 0
v_mfma_f32_16x16x32_bf16 a[116:119], v[116:119], v[76:79], a[116:119]
buffer_load_dwordx4 v8, s[8:11], s30 offen offset:0 lds
v_mfma_f32_16x16x32_bf16 a[120:123], v[120:123], v[76:79], a[120:123]
ds_read_b64_tr_b16 v[188:189], v23 offset:20480
v_mfma_f32_16x16x32_bf16 a[124:127], v[124:127], v[76:79], a[124:127]
v_mfma_f32_16x16x32_bf16 a[128:131], v[96:99], v[80:83], a[128:131]
ds_read_b64_tr_b16 v[190:191], v23 offset:21504
v_mfma_f32_16x16x32_bf16 a[132:135], v[100:103], v[80:83], a[132:135]
v_mfma_f32_16x16x32_bf16 a[136:139], v[104:107], v[80:83], a[136:139]
ds_read_b128 v[132:135], v19 offset:2048
v_mfma_f32_16x16x32_bf16 a[140:143], v[108:111], v[80:83], a[140:143]
v_mfma_f32_16x16x32_bf16 a[144:147], v[112:115], v[80:83], a[144:147]
buffer_load_dwordx4 v9, s[8:11], s30 offen offset:1024 lds
v_mfma_f32_16x16x32_bf16 a[148:151], v[116:119], v[80:83], a[148:151]
ds_read_b128 v[136:139], v19 offset:4096
v_mfma_f32_16x16x32_bf16 a[152:155], v[120:123], v[80:83], a[152:155]
v_mfma_f32_16x16x32_bf16 a[156:159], v[124:127], v[80:83], a[156:159]
ds_read_b128 v[140:143], v19 offset:6144
v_mfma_f32_16x16x32_bf16 a[160:163], v[96:99], v[84:87], a[160:163]
v_mfma_f32_16x16x32_bf16 a[164:167], v[100:103], v[84:87], a[164:167]
ds_read_b128 v[144:147], v19 offset:8192
v_mfma_f32_16x16x32_bf16 a[168:171], v[104:107], v[84:87], a[168:171]
v_mfma_f32_16x16x32_bf16 a[172:175], v[108:111], v[84:87], a[172:175]
buffer_load_dwordx4 v10, s[8:11], s30 offen offset:2048 lds
v_mfma_f32_16x16x32_bf16 a[176:179], v[112:115], v[84:87], a[176:179]
ds_read_b128 v[148:151], v19 offset:10240
v_mfma_f32_16x16x32_bf16 a[180:183], v[116:119], v[84:87], a[180:183]
ds_read_b128 v[152:155], v19 offset:12288
v_mfma_f32_16x16x32_bf16 a[184:187], v[120:123], v[84:87], a[184:187]
v_mfma_f32_16x16x32_bf16 a[188:191], v[124:127], v[84:87], a[188:191]
ds_read_b128 v[156:159], v19 offset:14336
v_mfma_f32_16x16x32_bf16 a[192:195], v[96:99], v[88:91], a[192:195]
v_mfma_f32_16x16x32_bf16 a[196:199], v[100:103], v[88:91], a[196:199]
v_mfma_f32_16x16x32_bf16 a[200:203], v[104:107], v[88:91], a[200:203]
buffer_load_dwordx4 v11, s[8:11], s30 offen offset:3072 lds
v_mfma_f32_16x16x32_bf16 a[204:207], v[108:111], v[88:91], a[204:207]
v_mfma_f32_16x16x32_bf16 a[208:211], v[112:115], v[88:91], a[208:211]
v_mfma_f32_16x16x32_bf16 a[212:215], v[116:119], v[88:91], a[212:215]
v_mfma_f32_16x16x32_bf16 a[216:219], v[120:123], v[88:91], a[216:219]
v_mfma_f32_16x16x32_bf16 a[220:223], v[124:127], v[88:91], a[220:223]
s_add_u32 s24, s24, 128
v_mfma_f32_16x16x32_bf16 a[224:227], v[96:99], v[92:95], a[224:227]
s_add_u32 s25, s25, 32768
v_mfma_f32_16x16x32_bf16 a[228:231], v[100:103], v[92:95], a[228:231]
s_cmp_eq_u32 s25, 98304
s_cselect_b32 s25, 0, s25
v_mfma_f32_16x16x32_bf16 a[232:235], v[104:107], v[92:95], a[232:235]
v_mfma_f32_16x16x32_bf16 a[236:239], v[108:111], v[92:95], a[236:239]
s_waitcnt vmcnt(16) lgkmcnt(0)
v_mfma_f32_16x16x32_bf16 a[240:243], v[112:115], v[92:95], a[240:243]
s_barrier
v_mfma_f32_16x16x32_bf16 a[244:247], v[116:119], v[92:95], a[244:247]
v_mfma_f32_16x16x32_bf16 a[248:251], v[120:123], v[92:95], a[248:251]
v_mfma_f32_16x16x32_bf16 a[252:255], v[124:127], v[92:95], a[252:255]
v_mfma_f32_16x16x32_bf16 a[0:3], v[160:163], v[128:131], a[0:3]
s_add_u32 m0, s28, 16384
ds_read_b64_tr_b16 v[96:97], v20 offset:32768
v_add_u32 v18, s26, v16
v_mfma_f32_16x16x32_bf16 a[4:7], v[164:167], v[128:131], a[4:7]
s_nop 0
ds_read_b64_tr_b16 v[98:99], v20 offset:33792
v_add_u32 v19, s26, v17
v_mfma_f32_16x16x32_bf16 a[8:11], v[168:171], v[128:131], a[8:11]
s_add_u32 s26, s26, 32768
s_cmp_eq_u32 s26, 163840
s_cselect_b32 s26, 65536, s26
ds_read_b64_tr_b16 v[100:101], v21 offset:32768
v_mfma_f32_16x16x32_bf16 a[12:15], v[172:175], v[128:131], a[12:15]
buffer_load_dwordx4 v12, s[12:15], s23 offen offset:0 lds
v_mfma_f32_16x16x32_bf16 a[16:19], v[176:179], v[128:131], a[16:19]
ds_read_b64_tr_b16 v[102:103], v21 offset:33792
v_mfma_f32_16x16x32_bf16 a[20:23], v[180:183], v[128:131], a[20:23]
v_mfma_f32_16x16x32_bf16 a[24:27], v[184:187], v[128:131], a[24:27]
ds_read_b128 v[64:67], v18 offset:0
v_mfma_f32_16x16x32_bf16 a[28:31], v[188:191], v[128:131], a[28:31]
v_mfma_f32_16x16x32_bf16 a[32:35], v[160:163], v[132:135], a[32:35]
buffer_load_dwordx4 v13, s[12:15], s23 offen offset:1024 lds
v_mfma_f32_16x16x32_bf16 a[36:39], v[164:167], v[132:135], a[36:39]
ds_read_b64_tr_b16 v[104:105], v22 offset:32768
v_mfma_f32_16x16x32_bf16 a[40:43], v[168:171], v[132:135], a[40:43]
v_mfma_f32_16x16x32_bf16 a[44:47], v[172:175], v[132:135], a[44:47]
ds_read_b64_tr_b16 v[106:107], v22 offset:33792
v_mfma_f32_16x16x32_bf16 a[48:51], v[176:179], v[132:135], a[48:51]
v_mfma_f32_16x16x32_bf16 a[52:55], v[180:183], v[132:135], a[52:55]
ds_read_b64_tr_b16 v[108:109], v23 offset:32768
v_mfma_f32_16x16x32_bf16 a[56:59], v[184:187], v[132:135], a[56:59]
v_mfma_f32_16x16x32_bf16 a[60:63], v[188:191], v[132:135], a[60:63]
buffer_load_dwordx4 v14, s[12:15], s23 offen offset:2048 lds
v_mfma_f32_16x16x32_bf16 a[64:67], v[160:163], v[136:139], a[64:67]
ds_read_b64_tr_b16 v[110:111], v23 offset:33792
v_mfma_f32_16x16x32_bf16 a[68:71], v[164:167], v[136:139], a[68:71]
ds_read_b64_tr_b16 v[112:113], v20 offset:36864
v_mfma_f32_16x16x32_bf16 a[72:75], v[168:171], v[136:139], a[72:75]
v_mfma_f32_16x16x32_bf16 a[76:79], v[172:175], v[136:139], a[76:79]
ds_read_b64_tr_b16 v[114:115], v20 offset:37888
v_mfma_f32_16x16x32_bf16 a[80:83], v[176:179], v[136:139], a[80:83]
v_mfma_f32_16x16x32_bf16 a[84:87], v[180:183], v[136:139], a[84:87]
ds_read_b64_tr_b16 v[116:117], v21 offset:36864
v_mfma_f32_16x16x32_bf16 a[88:91], v[184:187], v[136:139], a[88:91]
buffer_load_dwordx4 v15, s[12:15], s23 offen offset:3072 lds
v_mfma_f32_16x16x32_bf16 a[92:95], v[188:191], v[136:139], a[92:95]
v_mfma_f32_16x16x32_bf16 a[96:99], v[160:163], v[140:143], a[96:99]
ds_read_b64_tr_b16 v[118:119], v21 offset:37888
v_mfma_f32_16x16x32_bf16 a[100:103], v[164:167], v[140:143], a[100:103]
v_mfma_f32_16x16x32_bf16 a[104:107], v[168:171], v[140:143], a[104:107]
s_add_u32 s23, s23, 262144
ds_read_b64_tr_b16 v[120:121], v22 offset:36864
s_add_u32 m0, s29, s25
v_mfma_f32_16x16x32_bf16 a[108:111], v[172:175], v[140:143], a[108:111]
s_nop 0
v_mfma_f32_16x16x32_bf16 a[112:115], v[176:179], v[140:143], a[112:115]
ds_read_b64_tr_b16 v[122:123], v22 offset:37888
v_mfma_f32_16x16x32_bf16 a[116:119], v[180:183], v[140:143], a[116:119]
buffer_load_dwordx4 v8, s[8:11], s24 offen offset:0 lds
v_mfma_f32_16x16x32_bf16 a[120:123], v[184:187], v[140:143], a[120:123]
ds_read_b64_tr_b16 v[124:125], v23 offset:36864
v_mfma_f32_16x16x32_bf16 a[124:127], v[188:191], v[140:143], a[124:127]
v_mfma_f32_16x16x32_bf16 a[128:131], v[160:163], v[144:147], a[128:131]
ds_read_b64_tr_b16 v[126:127], v23 offset:37888
v_mfma_f32_16x16x32_bf16 a[132:135], v[164:167], v[144:147], a[132:135]
v_mfma_f32_16x16x32_bf16 a[136:139], v[168:171], v[144:147], a[136:139]
ds_read_b128 v[68:71], v18 offset:2048
v_mfma_f32_16x16x32_bf16 a[140:143], v[172:175], v[144:147], a[140:143]
v_mfma_f32_16x16x32_bf16 a[144:147], v[176:179], v[144:147], a[144:147]
buffer_load_dwordx4 v9, s[8:11], s24 offen offset:1024 lds
v_mfma_f32_16x16x32_bf16 a[148:151], v[180:183], v[144:147], a[148:151]
ds_read_b128 v[72:75], v18 offset:4096
v_mfma_f32_16x16x32_bf16 a[152:155], v[184:187], v[144:147], a[152:155]
v_mfma_f32_16x16x32_bf16 a[156:159], v[188:191], v[144:147], a[156:159]
ds_read_b128 v[76:79], v18 offset:6144
v_mfma_f32_16x16x32_bf16 a[160:163], v[160:163], v[148:151], a[160:163]
v_mfma_f32_16x16x32_bf16 a[164:167], v[164:167], v[148:151], a[164:167]
ds_read_b128 v[80:83], v18 offset:8192
v_mfma_f32_16x16x32_bf16 a[168:171], v[168:171], v[148:151], a[168:171]
v_mfma_f32_16x16x32_bf16 a[172:175], v[172:175], v[148:151], a[172:175]
buffer_load_dwordx4 v10, s[8:11], s24 offen offset:2048 lds
v_mfma_f32_16x16x32_bf16 a[176:179], v[176:179], v[148:151], a[176:179]
ds_read_b128 v[84:87], v18 offset:10240
v_mfma_f32_16x16x32_bf16 a[180:183], v[180:183], v[148:151], a[180:183]
ds_read_b128 v[88:91], v18 offset:12288
v_mfma_f32_16x16x32_bf16 a[184:187], v[184:187], v[148:151], a[184:187]
v_mfma_f32_16x16x32_bf16 a[188:191], v[188:191], v[148:151], a[188:191]
ds_read_b128 v[92:95], v18 offset:14336
v_mfma_f32_16x16x32_bf16 a[192:195], v[160:163], v[152:155], a[192:195]
v_mfma_f32_16x16x32_bf16 a[196:199], v[164:167], v[152:155], a[196:199]
v_mfma_f32_16x16x32_bf16 a[200:203], v[168:171], v[152:155], a[200:203]
buffer_load_dwordx4 v11, s[8:11], s24 offen offset:3072 lds
v_mfma_f32_16x16x32_bf16 a[204:207], v[172:175], v[152:155], a[204:207]
v_mfma_f32_16x16x32_bf16 a[208:211], v[176:179], v[152:155], a[208:211]
v_mfma_f32_16x16x32_bf16 a[212:215], v[180:183], v[152:155], a[212:215]
v_mfma_f32_16x16x32_bf16 a[216:219], v[184:187], v[152:155], a[216:219]
v_mfma_f32_16x16x32_bf16 a[220:223], v[188:191], v[152:155], a[220:223]
v_mfma_f32_16x16x32_bf16 a[224:227], v[160:163], v[156:159], a[224:227]
v_mfma_f32_16x16x32_bf16 a[228:231], v[164:167], v[156:159], a[228:231]
v_mfma_f32_16x16x32_bf16 a[232:235], v[168:171], v[156:159], a[232:235]
v_mfma_f32_16x16x32_bf16 a[236:239], v[172:175], v[156:159], a[236:239]
s_waitcnt vmcnt(16) lgkmcnt(0)
v_mfma_f32_16x16x32_bf16 a[240:243], v[176:179], v[156:159], a[240:243]
s_barrier
v_mfma_f32_16x16x32_bf16 a[244:247], v[180:183], v[156:159], a[244:247]
v_mfma_f32_16x16x32_bf16 a[248:251], v[184:187], v[156:159], a[248:251]
v_mfma_f32_16x16x32_bf16 a[252:255], v[188:191], v[156:159], a[252:255]
v_mfma_f32_16x16x32_bf16 a[0:3], v[96:99], v[64:67], a[0:3]
s_add_u32 m0, s28, 32768
ds_read_b128 v[128:131], v19 offset:0
s_nop 0
v_mfma_f32_16x16x32_bf16 a[4:7], v[100:103], v[64:67], a[4:7]
ds_read_b64_tr_b16 v[160:161], v20 offset:49152
v_mfma_f32_16x16x32_bf16 a[8:11], v[104:107], v[64:67], a[8:11]
buffer_load_dwordx4 v12, s[12:15], s23 offen offset:0 lds
v_mfma_f32_16x16x32_bf16 a[12:15], v[108:111], v[64:67], a[12:15]
ds_read_b64_tr_b16 v[162:163], v20 offset:50176
v_mfma_f32_16x16x32_bf16 a[16:19], v[112:115], v[64:67], a[16:19]
ds_read_b64_tr_b16 v[164:165], v21 offset:49152
v_mfma_f32_16x16x32_bf16 a[20:23], v[116:119], v[64:67], a[20:23]
v_mfma_f32_16x16x32_bf16 a[24:27], v[120:123], v[64:67], a[24:27]
ds_read_b64_tr_b16 v[166:167], v21 offset:50176
v_mfma_f32_16x16x32_bf16 a[28:31], v[124:127], v[64:67], a[28:31]
v_mfma_f32_16x16x32_bf16 a[32:35], v[96:99], v[68:71], a[32:35]
buffer_load_dwordx4 v13, s[12:15], s23 offen offset:1024 lds
v_mfma_f32_16x16x32_bf16 a[36:39], v[100:103], v[68:71], a[36:39]
ds_read_b64_tr_b16 v[168:169], v22 offset:49152
v_mfma_f32_16x16x32_bf16 a[40:43], v[104:107], v[68:71], a[40:43]
v_mfma_f32_16x16x32_bf16 a[44:47], v[108:111], v[68:71], a[44:47]
ds_read_b64_tr_b16 v[170:171], v22 offset:50176
v_mfma_f32_16x16x32_bf16 a[48:51], v[112:115], v[68:71], a[48:51]
v_mfma_f32_16x16x32_bf16 a[52:55], v[116:119], v[68:71], a[52:55]
ds_read_b64_tr_b16 v[172:173], v23 offset:49152
v_mfma_f32_16x16x32_bf16 a[56:59], v[120:123], v[68:71], a[56:59]
v_mfma_f32_16x16x32_bf16 a[60:63], v[124:127], v[68:71], a[60:63]
buffer_load_dwordx4 v14, s[12:15], s23 offen offset:2048 lds
v_mfma_f32_16x16x32_bf16 a[64:67], v[96:99], v[72:75], a[64:67]
ds_read_b64_tr_b16 v[174:175], v23 offset:50176
v_mfma_f32_16x16x32_bf16 a[68:71], v[100:103], v[72:75], a[68:71]
ds_read_b64_tr_b16 v[176:177], v20 offset:53248
v_mfma_f32_16x16x32_bf16 a[72:75], v[104:107], v[72:75], a[72:75]
v_mfma_f32_16x16x32_bf16 a[76:79], v[108:111], v[72:75], a[76:79]
ds_read_b64_tr_b16 v[178:179], v20 offset:54272
v_mfma_f32_16x16x32_bf16 a[80:83], v[112:115], v[72:75], a[80:83]
v_mfma_f32_16x16x32_bf16 a[84:87], v[116:119], v[72:75], a[84:87]
ds_read_b64_tr_b16 v[180:181], v21 offset:53248
v_mfma_f32_16x16x32_bf16 a[88:91], v[120:123], v[72:75], a[88:91]
buffer_load_dwordx4 v15, s[12:15], s23 offen offset:3072 lds
v_mfma_f32_16x16x32_bf16 a[92:95], v[124:127], v[72:75], a[92:95]
v_mfma_f32_16x16x32_bf16 a[96:99], v[96:99], v[76:79], a[96:99]
ds_read_b64_tr_b16 v[182:183], v21 offset:54272
v_mfma_f32_16x16x32_bf16 a[100:103], v[100:103], v[76:79], a[100:103]
v_mfma_f32_16x16x32_bf16 a[104:107], v[104:107], v[76:79], a[104:107]
s_add_u32 s23, s23, 262144
ds_read_b64_tr_b16 v[184:185], v22 offset:53248
s_add_u32 s30, s24, 65536
v_mfma_f32_16x16x32_bf16 a[108:111], v[108:111], v[76:79], a[108:111]
s_add_u32 m0, s29, s25
v_mfma_f32_16x16x32_bf16 a[112:115], v[112:115], v[76:79], a[112:115]
s_add_u32 m0, m0, 4096
ds_read_b64_tr_b16 v[186:187], v22 offset:54272
s_nop 0
v_mfma_f32_16x16x32_bf16 a[116:119], v[116:119], v[76:79], a[116:119]
buffer_load_dwordx4 v8, s[8:11], s30 offen offset:0 lds
v_mfma_f32_16x16x32_bf16 a[120:123], v[120:123], v[76:79], a[120:123]
ds_read_b64_tr_b16 v[188:189], v23 offset:53248
v_mfma_f32_16x16x32_bf16 a[124:127], v[124:127], v[76:79], a[124:127]
v_mfma_f32_16x16x32_bf16 a[128:131], v[96:99], v[80:83], a[128:131]
ds_read_b64_tr_b16 v[190:191], v23 offset:54272
v_mfma_f32_16x16x32_bf16 a[132:135], v[100:103], v[80:83], a[132:135]
v_mfma_f32_16x16x32_bf16 a[136:139], v[104:107], v[80:83], a[136:139]
ds_read_b128 v[132:135], v19 offset:2048
v_mfma_f32_16x16x32_bf16 a[140:143], v[108:111], v[80:83], a[140:143]
v_mfma_f32_16x16x32_bf16 a[144:147], v[112:115], v[80:83], a[144:147]
buffer_load_dwordx4 v9, s[8:11], s30 offen offset:1024 lds
v_mfma_f32_16x16x32_bf16 a[148:151], v[116:119], v[80:83], a[148:151]
ds_read_b128 v[136:139], v19 offset:4096
v_mfma_f32_16x16x32_bf16 a[152:155], v[120:123], v[80:83], a[152:155]
v_mfma_f32_16x16x32_bf16 a[156:159], v[124:127], v[80:83], a[156:159]
ds_read_b128 v[140:143], v19 offset:6144
v_mfma_f32_16x16x32_bf16 a[160:163], v[96:99], v[84:87], a[160:163]
v_mfma_f32_16x16x32_bf16 a[164:167], v[100:103], v[84:87], a[164:167]
ds_read_b128 v[144:147], v19 offset:8192
v_mfma_f32_16x16x32_bf16 a[168:171], v[104:107], v[84:87], a[168:171]
v_mfma_f32_16x16x32_bf16 a[172:175], v[108:111], v[84:87], a[172:175]
buffer_load_dwordx4 v10, s[8:11], s30 offen offset:2048 lds
v_mfma_f32_16x16x32_bf16 a[176:179], v[112:115], v[84:87], a[176:179]
ds_read_b128 v[148:151], v19 offset:10240
v_mfma_f32_16x16x32_bf16 a[180:183], v[116:119], v[84:87], a[180:183]
ds_read_b128 v[152:155], v19 offset:12288
v_mfma_f32_16x16x32_bf16 a[184:187], v[120:123], v[84:87], a[184:187]
v_mfma_f32_16x16x32_bf16 a[188:191], v[124:127], v[84:87], a[188:191]
ds_read_b128 v[156:159], v19 offset:14336
v_mfma_f32_16x16x32_bf16 a[192:195], v[96:99], v[88:91], a[192:195]
v_mfma_f32_16x16x32_bf16 a[196:199], v[100:103], v[88:91], a[196:199]
v_mfma_f32_16x16x32_bf16 a[200:203], v[104:107], v[88:91], a[200:203]
buffer_load_dwordx4 v11, s[8:11], s30 offen offset:3072 lds
v_mfma_f32_16x16x32_bf16 a[204:207], v[108:111], v[88:91], a[204:207]
v_mfma_f32_16x16x32_bf16 a[208:211], v[112:115], v[88:91], a[208:211]
v_mfma_f32_16x16x32_bf16 a[212:215], v[116:119], v[88:91], a[212:215]
v_mfma_f32_16x16x32_bf16 a[216:219], v[120:123], v[88:91], a[216:219]
v_mfma_f32_16x16x32_bf16 a[220:223], v[124:127], v[88:91], a[220:223]
s_add_u32 s24, s24, 128
v_mfma_f32_16x16x32_bf16 a[224:227], v[96:99], v[92:95], a[224:227]
s_add_u32 s25, s25, 32768
v_mfma_f32_16x16x32_bf16 a[228:231], v[100:103], v[92:95], a[228:231]
s_cmp_eq_u32 s25, 98304
s_cselect_b32 s25, 0, s25
v_mfma_f32_16x16x32_bf16 a[232:235], v[104:107], v[92:95], a[232:235]
v_mfma_f32_16x16x32_bf16 a[236:239], v[108:111], v[92:95], a[236:239]
s_waitcnt vmcnt(16) lgkmcnt(0)
v_mfma_f32_16x16x32_bf16 a[240:243], v[112:115], v[92:95], a[240:243]
s_barrier
v_mfma_f32_16x16x32_bf16 a[244:247], v[116:119], v[92:95], a[244:247]
v_mfma_f32_16x16x32_bf16 a[248:251], v[120:123], v[92:95], a[248:251]
v_mfma_f32_16x16x32_bf16 a[252:255], v[124:127], v[92:95], a[252:255]
v_mfma_f32_16x16x32_bf16 a[0:3], v[160:163], v[128:131], a[0:3]
s_add_u32 m0, s28, 49152
ds_read_b64_tr_b16 v[96:97], v20 offset:0
v_add_u32 v18, s26, v16
v_mfma_f32_16x16x32_bf16 a[4:7], v[164:167], v[128:131], a[4:7]
s_nop 0
ds_read_b64_tr_b16 v[98:99], v20 offset:1024
v_add_u32 v19, s26, v17
v_mfma_f32_16x16x32_bf16 a[8:11], v[168:171], v[128:131], a[8:11]
s_add_u32 s26, s26, 32768
s_cmp_eq_u32 s26, 163840
s_cselect_b32 s26, 65536, s26
ds_read_b64_tr_b16 v[100:101], v21 offset:0
v_mfma_f32_16x16x32_bf16 a[12:15], v[172:175], v[128:131], a[12:15]
buffer_load_dwordx4 v12, s[12:15], s23 offen offset:0 lds
v_mfma_f32_16x16x32_bf16 a[16:19], v[176:179], v[128:131], a[16:19]
ds_read_b64_tr_b16 v[102:103], v21 offset:1024
v_mfma_f32_16x16x32_bf16 a[20:23], v[180:183], v[128:131], a[20:23]
v_mfma_f32_16x16x32_bf16 a[24:27], v[184:187], v[128:131], a[24:27]
ds_read_b128 v[64:67], v18 offset:0
v_mfma_f32_16x16x32_bf16 a[28:31], v[188:191], v[128:131], a[28:31]
v_mfma_f32_16x16x32_bf16 a[32:35], v[160:163], v[132:135], a[32:35]
buffer_load_dwordx4 v13, s[12:15], s23 offen offset:1024 lds
v_mfma_f32_16x16x32_bf16 a[36:39], v[164:167], v[132:135], a[36:39]
ds_read_b64_tr_b16 v[104:105], v22 offset:0
v_mfma_f32_16x16x32_bf16 a[40:43], v[168:171], v[132:135], a[40:43]
v_mfma_f32_16x16x32_bf16 a[44:47], v[172:175], v[132:135], a[44:47]
ds_read_b64_tr_b16 v[106:107], v22 offset:1024
v_mfma_f32_16x16x32_bf16 a[48:51], v[176:179], v[132:135], a[48:51]
v_mfma_f32_16x16x32_bf16 a[52:55], v[180:183], v[132:135], a[52:55]
ds_read_b64_tr_b16 v[108:109], v23 offset:0
v_mfma_f32_16x16x32_bf16 a[56:59], v[184:187], v[132:135], a[56:59]
v_mfma_f32_16x16x32_bf16 a[60:63], v[188:191], v[132:135], a[60:63]
buffer_load_dwordx4 v14, s[12:15], s23 offen offset:2048 lds
v_mfma_f32_16x16x32_bf16 a[64:67], v[160:163], v[136:139], a[64:67]
ds_read_b64_tr_b16 v[110:111], v23 offset:1024
v_mfma_f32_16x16x32_bf16 a[68:71], v[164:167], v[136:139], a[68:71]
ds_read_b64_tr_b16 v[112:113], v20 offset:4096
v_mfma_f32_16x16x32_bf16 a[72:75], v[168:171], v[136:139], a[72:75]
v_mfma_f32_16x16x32_bf16 a[76:79], v[172:175], v[136:139], a[76:79]
ds_read_b64_tr_b16 v[114:115], v20 offset:5120
v_mfma_f32_16x16x32_bf16 a[80:83], v[176:179], v[136:139], a[80:83]
v_mfma_f32_16x16x32_bf16 a[84:87], v[180:183], v[136:139], a[84:87]
ds_read_b64_tr_b16 v[116:117], v21 offset:4096
v_mfma_f32_16x16x32_bf16 a[88:91], v[184:187], v[136:139], a[88:91]
buffer_load_dwordx4 v15, s[12:15], s23 offen offset:3072 lds
v_mfma_f32_16x16x32_bf16 a[92:95], v[188:191], v[136:139], a[92:95]
v_mfma_f32_16x16x32_bf16 a[96:99], v[160:163], v[140:143], a[96:99]
ds_read_b64_tr_b16 v[118:119], v21 offset:5120
v_mfma_f32_16x16x32_bf16 a[100:103], v[164:167], v[140:143], a[100:103]
v_mfma_f32_16x16x32_bf16 a[104:107], v[168:171], v[140:143], a[104:107]
s_add_u32 s23, s23, 262144
ds_read_b64_tr_b16 v[120:121], v22 offset:4096
s_add_u32 m0, s29, s25
v_mfma_f32_16x16x32_bf16 a[108:111], v[172:175], v[140:143], a[108:111]
s_nop 0
v_mfma_f32_16x16x32_bf16 a[112:115], v[176:179], v[140:143], a[112:115]
ds_read_b64_tr_b16 v[122:123], v22 offset:5120
v_mfma_f32_16x16x32_bf16 a[116:119], v[180:183], v[140:143], a[116:119]
buffer_load_dwordx4 v8, s[8:11], s24 offen offset:0 lds
v_mfma_f32_16x16x32_bf16 a[120:123], v[184:187], v[140:143], a[120:123]
ds_read_b64_tr_b16 v[124:125], v23 offset:4096
v_mfma_f32_16x16x32_bf16 a[124:127], v[188:191], v[140:143], a[124:127]
v_mfma_f32_16x16x32_bf16 a[128:131], v[160:163], v[144:147], a[128:131]
ds_read_b64_tr_b16 v[126:127], v23 offset:5120
v_mfma_f32_16x16x32_bf16 a[132:135], v[164:167], v[144:147], a[132:135]
v_mfma_f32_16x16x32_bf16 a[136:139], v[168:171], v[144:147], a[136:139]
ds_read_b128 v[68:71], v18 offset:2048
v_mfma_f32_16x16x32_bf16 a[140:143], v[172:175], v[144:147], a[140:143]
v_mfma_f32_16x16x32_bf16 a[144:147], v[176:179], v[144:147], a[144:147]
buffer_load_dwordx4 v9, s[8:11], s24 offen offset:1024 lds
v_mfma_f32_16x16x32_bf16 a[148:151], v[180:183], v[144:147], a[148:151]
ds_read_b128 v[72:75], v18 offset:4096
v_mfma_f32_16x16x32_bf16 a[152:155], v[184:187], v[144:147], a[152:155]
v_mfma_f32_16x16x32_bf16 a[156:159], v[188:191], v[144:147], a[156:159]
ds_read_b128 v[76:79], v18 offset:6144
v_mfma_f32_16x16x32_bf16 a[160:163], v[160:163], v[148:151], a[160:163]
v_mfma_f32_16x16x32_bf16 a[164:167], v[164:167], v[148:151], a[164:167]
ds_read_b128 v[80:83], v18 offset:8192
v_mfma_f32_16x16x32_bf16 a[168:171], v[168:171], v[148:151], a[168:171]
v_mfma_f32_16x16x32_bf16 a[172:175], v[172:175], v[148:151], a[172:175]
buffer_load_dwordx4 v10, s[8:11], s24 offen offset:2048 lds
v_mfma_f32_16x16x32_bf16 a[176:179], v[176:179], v[148:151], a[176:179]
ds_read_b128 v[84:87], v18 offset:10240
v_mfma_f32_16x16x32_bf16 a[180:183], v[180:183], v[148:151], a[180:183]
ds_read_b128 v[88:91], v18 offset:12288
v_mfma_f32_16x16x32_bf16 a[184:187], v[184:187], v[148:151], a[184:187]
v_mfma_f32_16x16x32_bf16 a[188:191], v[188:191], v[148:151], a[188:191]
ds_read_b128 v[92:95], v18 offset:14336
v_mfma_f32_16x16x32_bf16 a[192:195], v[160:163], v[152:155], a[192:195]
v_mfma_f32_16x16x32_bf16 a[196:199], v[164:167], v[152:155], a[196:199]
v_mfma_f32_16x16x32_bf16 a[200:203], v[168:171], v[152:155], a[200:203]
buffer_load_dwordx4 v11, s[8:11], s24 offen offset:3072 lds
v_mfma_f32_16x16x32_bf16 a[204:207], v[172:175], v[152:155], a[204:207]
v_mfma_f32_16x16x32_bf16 a[208:211], v[176:179], v[152:155], a[208:211]
v_mfma_f32_16x16x32_bf16 a[212:215], v[180:183], v[152:155], a[212:215]
v_mfma_f32_16x16x32_bf16 a[216:219], v[184:187], v[152:155], a[216:219]
v_mfma_f32_16x16x32_bf16 a[220:223], v[188:191], v[152:155], a[220:223]
v_mfma_f32_16x16x32_bf16 a[224:227], v[160:163], v[156:159], a[224:227]
v_mfma_f32_16x16x32_bf16 a[228:231], v[164:167], v[156:159], a[228:231]
v_mfma_f32_16x16x32_bf16 a[232:235], v[168:171], v[156:159], a[232:235]
v_mfma_f32_16x16x32_bf16 a[236:239], v[172:175], v[156:159], a[236:239]
s_waitcnt vmcnt(16) lgkmcnt(0)
v_mfma_f32_16x16x32_bf16 a[240:243], v[176:179], v[156:159], a[240:243]
s_barrier
v_mfma_f32_16x16x32_bf16 a[244:247], v[180:183], v[156:159], a[244:247]
v_mfma_f32_16x16x32_bf16 a[248:251], v[184:187], v[156:159], a[248:251]
v_mfma_f32_16x16x32_bf16 a[252:255], v[188:191], v[156:159], a[252:255]
s_add_u32 s27, s27, 1
s_cmp_lt_u32 s27, 8
s_cbranch_scc1 K1K_loop
s_lshl_b32 s50, s6, 17
s_lshl_b32 s31, s21, 16
s_add_u32 s50, s50, s31
s_lshl_b32 s31, s22, 12
s_add_u32 s50, s50, s31
s_movk_i32 s51, 8192
s_movk_i32 s37, 8192
s_branch K1_E
K1_V:
s_mov_b32 s27, 0
K1V_loop:
s_cmp_lg_u32 s27, 1
s_cbranch_scc1 K1V_h3
buffer_store_dwordx4 v[200:203], v30, s[96:99], 0 offen sc1
buffer_store_dwordx4 v[204:207], v31, s[96:99], 0 offen sc1
buffer_store_dword v244, v243, s[52:55], 0 offen sc1
K1V_h3:
s_cmp_lg_u32 s27, 5
s_cbranch_scc1 K1V_h4
buffer_load_dword v246, v245, s[92:95], 0 offen
K1V_h4:
s_cmp_lg_u32 s27, s39
s_cbranch_scc1 K1V_h1
s_cmp_lg_u32 s20, 0
s_cbranch_scc1 K1V_h1
s_lshr_b32 s31, s2, 4
s_lshl_b32 s31, s31, 2
s_add_u32 s31, s31, 64
v_mov_b32 v240, s31
v_mov_b32 v241, 1
v_mov_b32 v242, 128
v_cmp_eq_u32 vcc, 0, v1
s_and_saveexec_b64 s[56:57], vcc
buffer_atomic_add v241, v240, s[76:79], 0 offen sc1
s_cmp_ge_u32 s2, 96
s_cbranch_scc1 K1V_h0
buffer_atomic_add v241, v242, s[76:79], 0 offen sc1
K1V_h0:
s_mov_b64 exec, s[56:57]
s_nop 4
K1V_h1:
s_cmp_lg_u32 s27, 7
s_cbranch_scc1 K1V_h2
buffer_load_dword v251, v236, s[76:79], 0 offen sc1
buffer_load_dword v252, v237, s[76:79], 0 offen sc1
s_mov_b32 s12, s92
s_mov_b32 s13, s93
s_mov_b32 s14, s94
s_mov_b32 s23, 0
K1V_h2:
v_mfma_f32_16x16x32_bf16 a[0:3], v[64:67], v[96:99], a[0:3]
s_add_u32 m0, s28, 0
ds_read_b128 v[128:131], v19 offset:0
s_nop 0
v_mfma_f32_16x16x32_bf16 a[8:11], v[64:67], v[100:103], a[8:11]
ds_read_b64_tr_b16 v[160:161], v20 offset:16384
v_mfma_f32_16x16x32_bf16 a[16:19], v[64:67], v[104:107], a[16:19]
buffer_load_dwordx4 v12, s[12:15], s23 offen offset:0 lds
v_mfma_f32_16x16x32_bf16 a[24:27], v[64:67], v[108:111], a[24:27]
ds_read_b64_tr_b16 v[162:163], v20 offset:17408
v_mfma_f32_16x16x32_bf16 a[32:35], v[64:67], v[112:115], a[32:35]
ds_read_b64_tr_b16 v[164:165], v21 offset:16384
v_mfma_f32_16x16x32_bf16 a[40:43], v[64:67], v[116:119], a[40:43]
v_mfma_f32_16x16x32_bf16 a[48:51], v[64:67], v[120:123], a[48:51]
ds_read_b64_tr_b16 v[166:167], v21 offset:17408
v_mfma_f32_16x16x32_bf16 a[56:59], v[64:67], v[124:127], a[56:59]
v_mfma_f32_16x16x32_bf16 a[4:7], v[68:71], v[96:99], a[4:7]
buffer_load_dwordx4 v13, s[12:15], s23 offen offset:1024 lds
v_mfma_f32_16x16x32_bf16 a[12:15], v[68:71], v[100:103], a[12:15]
ds_read_b64_tr_b16 v[168:169], v22 offset:16384
v_mfma_f32_16x16x32_bf16 a[20:23], v[68:71], v[104:107], a[20:23]
v_mfma_f32_16x16x32_bf16 a[28:31], v[68:71], v[108:111], a[28:31]
ds_read_b64_tr_b16 v[170:171], v22 offset:17408
v_mfma_f32_16x16x32_bf16 a[36:39], v[68:71], v[112:115], a[36:39]
v_mfma_f32_16x16x32_bf16 a[44:47], v[68:71], v[116:119], a[44:47]
ds_read_b64_tr_b16 v[172:173], v23 offset:16384
v_mfma_f32_16x16x32_bf16 a[52:55], v[68:71], v[120:123], a[52:55]
v_mfma_f32_16x16x32_bf16 a[60:63], v[68:71], v[124:127], a[60:63]
buffer_load_dwordx4 v14, s[12:15], s23 offen offset:2048 lds
v_mfma_f32_16x16x32_bf16 a[64:67], v[72:75], v[96:99], a[64:67]
ds_read_b64_tr_b16 v[174:175], v23 offset:17408
v_mfma_f32_16x16x32_bf16 a[72:75], v[72:75], v[100:103], a[72:75]
ds_read_b64_tr_b16 v[176:177], v20 offset:20480
v_mfma_f32_16x16x32_bf16 a[80:83], v[72:75], v[104:107], a[80:83]
v_mfma_f32_16x16x32_bf16 a[88:91], v[72:75], v[108:111], a[88:91]
ds_read_b64_tr_b16 v[178:179], v20 offset:21504
v_mfma_f32_16x16x32_bf16 a[96:99], v[72:75], v[112:115], a[96:99]
v_mfma_f32_16x16x32_bf16 a[104:107], v[72:75], v[116:119], a[104:107]
ds_read_b64_tr_b16 v[180:181], v21 offset:20480
v_mfma_f32_16x16x32_bf16 a[112:115], v[72:75], v[120:123], a[112:115]
buffer_load_dwordx4 v15, s[12:15], s23 offen offset:3072 lds
v_mfma_f32_16x16x32_bf16 a[120:123], v[72:75], v[124:127], a[120:123]
v_mfma_f32_16x16x32_bf16 a[68:71], v[76:79], v[96:99], a[68:71]
ds_read_b64_tr_b16 v[182:183], v21 offset:21504
v_mfma_f32_16x16x32_bf16 a[76:79], v[76:79], v[100:103], a[76:79]
v_mfma_f32_16x16x32_bf16 a[84:87], v[76:79], v[104:107], a[84:87]
s_add_u32 s23, s23, 262144
ds_read_b64_tr_b16 v[184:185], v22 offset:20480
s_add_u32 s30, s24, 65536
v_mfma_f32_16x16x32_bf16 a[92:95], v[76:79], v[108:111], a[92:95]
s_add_u32 m0, s29, s25
v_mfma_f32_16x16x32_bf16 a[100:103], v[76:79], v[112:115], a[100:103]
s_add_u32 m0, m0, 4096
ds_read_b64_tr_b16 v[186:187], v22 offset:21504
s_nop 0
v_mfma_f32_16x16x32_bf16 a[108:111], v[76:79], v[116:119], a[108:111]
buffer_load_dwordx4 v8, s[8:11], s30 offen offset:0 lds
v_mfma_f32_16x16x32_bf16 a[116:119], v[76:79], v[120:123], a[116:119]
ds_read_b64_tr_b16 v[188:189], v23 offset:20480
v_mfma_f32_16x16x32_bf16 a[124:127], v[76:79], v[124:127], a[124:127]
v_mfma_f32_16x16x32_bf16 a[128:131], v[80:83], v[96:99], a[128:131]
ds_read_b64_tr_b16 v[190:191], v23 offset:21504
v_mfma_f32_16x16x32_bf16 a[136:139], v[80:83], v[100:103], a[136:139]
v_mfma_f32_16x16x32_bf16 a[144:147], v[80:83], v[104:107], a[144:147]
ds_read_b128 v[132:135], v19 offset:2048
v_mfma_f32_16x16x32_bf16 a[152:155], v[80:83], v[108:111], a[152:155]
v_mfma_f32_16x16x32_bf16 a[160:163], v[80:83], v[112:115], a[160:163]
buffer_load_dwordx4 v9, s[8:11], s30 offen offset:1024 lds
v_mfma_f32_16x16x32_bf16 a[168:171], v[80:83], v[116:119], a[168:171]
ds_read_b128 v[136:139], v19 offset:4096
v_mfma_f32_16x16x32_bf16 a[176:179], v[80:83], v[120:123], a[176:179]
v_mfma_f32_16x16x32_bf16 a[184:187], v[80:83], v[124:127], a[184:187]
ds_read_b128 v[140:143], v19 offset:6144
v_mfma_f32_16x16x32_bf16 a[132:135], v[84:87], v[96:99], a[132:135]
v_mfma_f32_16x16x32_bf16 a[140:143], v[84:87], v[100:103], a[140:143]
ds_read_b128 v[144:147], v19 offset:8192
v_mfma_f32_16x16x32_bf16 a[148:151], v[84:87], v[104:107], a[148:151]
v_mfma_f32_16x16x32_bf16 a[156:159], v[84:87], v[108:111], a[156:159]
buffer_load_dwordx4 v10, s[8:11], s30 offen offset:2048 lds
v_mfma_f32_16x16x32_bf16 a[164:167], v[84:87], v[112:115], a[164:167]
ds_read_b128 v[148:151], v19 offset:10240
v_mfma_f32_16x16x32_bf16 a[172:175], v[84:87], v[116:119], a[172:175]
ds_read_b128 v[152:155], v19 offset:12288
v_mfma_f32_16x16x32_bf16 a[180:183], v[84:87], v[120:123], a[180:183]
v_mfma_f32_16x16x32_bf16 a[188:191], v[84:87], v[124:127], a[188:191]
ds_read_b128 v[156:159], v19 offset:14336
v_mfma_f32_16x16x32_bf16 a[192:195], v[88:91], v[96:99], a[192:195]
v_mfma_f32_16x16x32_bf16 a[200:203], v[88:91], v[100:103], a[200:203]
v_mfma_f32_16x16x32_bf16 a[208:211], v[88:91], v[104:107], a[208:211]
buffer_load_dwordx4 v11, s[8:11], s30 offen offset:3072 lds
v_mfma_f32_16x16x32_bf16 a[216:219], v[88:91], v[108:111], a[216:219]
v_mfma_f32_16x16x32_bf16 a[224:227], v[88:91], v[112:115], a[224:227]
v_mfma_f32_16x16x32_bf16 a[232:235], v[88:91], v[116:119], a[232:235]
v_mfma_f32_16x16x32_bf16 a[240:243], v[88:91], v[120:123], a[240:243]
v_mfma_f32_16x16x32_bf16 a[248:251], v[88:91], v[124:127], a[248:251]
s_add_u32 s24, s24, 128
v_mfma_f32_16x16x32_bf16 a[196:199], v[92:95], v[96:99], a[196:199]
s_add_u32 s25, s25, 32768
v_mfma_f32_16x16x32_bf16 a[204:207], v[92:95], v[100:103], a[204:207]
s_cmp_eq_u32 s25, 98304
s_cselect_b32 s25, 0, s25
v_mfma_f32_16x16x32_bf16 a[212:215], v[92:95], v[104:107], a[212:215]
v_mfma_f32_16x16x32_bf16 a[220:223], v[92:95], v[108:111], a[220:223]
s_waitcnt vmcnt(16) lgkmcnt(0)
v_mfma_f32_16x16x32_bf16 a[228:231], v[92:95], v[112:115], a[228:231]
s_barrier
v_mfma_f32_16x16x32_bf16 a[236:239], v[92:95], v[116:119], a[236:239]
v_mfma_f32_16x16x32_bf16 a[244:247], v[92:95], v[120:123], a[244:247]
v_mfma_f32_16x16x32_bf16 a[252:255], v[92:95], v[124:127], a[252:255]
v_mfma_f32_16x16x32_bf16 a[0:3], v[128:131], v[160:163], a[0:3]
s_add_u32 m0, s28, 16384
ds_read_b64_tr_b16 v[96:97], v20 offset:32768
v_add_u32 v18, s26, v16
v_mfma_f32_16x16x32_bf16 a[8:11], v[128:131], v[164:167], a[8:11]
s_nop 0
ds_read_b64_tr_b16 v[98:99], v20 offset:33792
v_add_u32 v19, s26, v17
v_mfma_f32_16x16x32_bf16 a[16:19], v[128:131], v[168:171], a[16:19]
s_add_u32 s26, s26, 32768
s_cmp_eq_u32 s26, 163840
s_cselect_b32 s26, 65536, s26
ds_read_b64_tr_b16 v[100:101], v21 offset:32768
v_mfma_f32_16x16x32_bf16 a[24:27], v[128:131], v[172:175], a[24:27]
buffer_load_dwordx4 v12, s[12:15], s23 offen offset:0 lds
v_mfma_f32_16x16x32_bf16 a[32:35], v[128:131], v[176:179], a[32:35]
ds_read_b64_tr_b16 v[102:103], v21 offset:33792
v_mfma_f32_16x16x32_bf16 a[40:43], v[128:131], v[180:183], a[40:43]
v_mfma_f32_16x16x32_bf16 a[48:51], v[128:131], v[184:187], a[48:51]
ds_read_b128 v[64:67], v18 offset:0
v_mfma_f32_16x16x32_bf16 a[56:59], v[128:131], v[188:191], a[56:59]
v_mfma_f32_16x16x32_bf16 a[4:7], v[132:135], v[160:163], a[4:7]
buffer_load_dwordx4 v13, s[12:15], s23 offen offset:1024 lds
v_mfma_f32_16x16x32_bf16 a[12:15], v[132:135], v[164:167], a[12:15]
ds_read_b64_tr_b16 v[104:105], v22 offset:32768
v_mfma_f32_16x16x32_bf16 a[20:23], v[132:135], v[168:171], a[20:23]
v_mfma_f32_16x16x32_bf16 a[28:31], v[132:135], v[172:175], a[28:31]
ds_read_b64_tr_b16 v[106:107], v22 offset:33792
v_mfma_f32_16x16x32_bf16 a[36:39], v[132:135], v[176:179], a[36:39]
v_mfma_f32_16x16x32_bf16 a[44:47], v[132:135], v[180:183], a[44:47]
ds_read_b64_tr_b16 v[108:109], v23 offset:32768
v_mfma_f32_16x16x32_bf16 a[52:55], v[132:135], v[184:187], a[52:55]
v_mfma_f32_16x16x32_bf16 a[60:63], v[132:135], v[188:191], a[60:63]
buffer_load_dwordx4 v14, s[12:15], s23 offen offset:2048 lds
v_mfma_f32_16x16x32_bf16 a[64:67], v[136:139], v[160:163], a[64:67]
ds_read_b64_tr_b16 v[110:111], v23 offset:33792
v_mfma_f32_16x16x32_bf16 a[72:75], v[136:139], v[164:167], a[72:75]
ds_read_b64_tr_b16 v[112:113], v20 offset:36864
v_mfma_f32_16x16x32_bf16 a[80:83], v[136:139], v[168:171], a[80:83]
v_mfma_f32_16x16x32_bf16 a[88:91], v[136:139], v[172:175], a[88:91]
ds_read_b64_tr_b16 v[114:115], v20 offset:37888
v_mfma_f32_16x16x32_bf16 a[96:99], v[136:139], v[176:179], a[96:99]
v_mfma_f32_16x16x32_bf16 a[104:107], v[136:139], v[180:183], a[104:107]
ds_read_b64_tr_b16 v[116:117], v21 offset:36864
v_mfma_f32_16x16x32_bf16 a[112:115], v[136:139], v[184:187], a[112:115]
buffer_load_dwordx4 v15, s[12:15], s23 offen offset:3072 lds
v_mfma_f32_16x16x32_bf16 a[120:123], v[136:139], v[188:191], a[120:123]
v_mfma_f32_16x16x32_bf16 a[68:71], v[140:143], v[160:163], a[68:71]
ds_read_b64_tr_b16 v[118:119], v21 offset:37888
v_mfma_f32_16x16x32_bf16 a[76:79], v[140:143], v[164:167], a[76:79]
v_mfma_f32_16x16x32_bf16 a[84:87], v[140:143], v[168:171], a[84:87]
s_add_u32 s23, s23, 262144
ds_read_b64_tr_b16 v[120:121], v22 offset:36864
s_add_u32 m0, s29, s25
v_mfma_f32_16x16x32_bf16 a[92:95], v[140:143], v[172:175], a[92:95]
s_nop 0
v_mfma_f32_16x16x32_bf16 a[100:103], v[140:143], v[176:179], a[100:103]
ds_read_b64_tr_b16 v[122:123], v22 offset:37888
v_mfma_f32_16x16x32_bf16 a[108:111], v[140:143], v[180:183], a[108:111]
buffer_load_dwordx4 v8, s[8:11], s24 offen offset:0 lds
v_mfma_f32_16x16x32_bf16 a[116:119], v[140:143], v[184:187], a[116:119]
ds_read_b64_tr_b16 v[124:125], v23 offset:36864
v_mfma_f32_16x16x32_bf16 a[124:127], v[140:143], v[188:191], a[124:127]
v_mfma_f32_16x16x32_bf16 a[128:131], v[144:147], v[160:163], a[128:131]
ds_read_b64_tr_b16 v[126:127], v23 offset:37888
v_mfma_f32_16x16x32_bf16 a[136:139], v[144:147], v[164:167], a[136:139]
v_mfma_f32_16x16x32_bf16 a[144:147], v[144:147], v[168:171], a[144:147]
ds_read_b128 v[68:71], v18 offset:2048
v_mfma_f32_16x16x32_bf16 a[152:155], v[144:147], v[172:175], a[152:155]
v_mfma_f32_16x16x32_bf16 a[160:163], v[144:147], v[176:179], a[160:163]
buffer_load_dwordx4 v9, s[8:11], s24 offen offset:1024 lds
v_mfma_f32_16x16x32_bf16 a[168:171], v[144:147], v[180:183], a[168:171]
ds_read_b128 v[72:75], v18 offset:4096
v_mfma_f32_16x16x32_bf16 a[176:179], v[144:147], v[184:187], a[176:179]
v_mfma_f32_16x16x32_bf16 a[184:187], v[144:147], v[188:191], a[184:187]
ds_read_b128 v[76:79], v18 offset:6144
v_mfma_f32_16x16x32_bf16 a[132:135], v[148:151], v[160:163], a[132:135]
v_mfma_f32_16x16x32_bf16 a[140:143], v[148:151], v[164:167], a[140:143]
ds_read_b128 v[80:83], v18 offset:8192
v_mfma_f32_16x16x32_bf16 a[148:151], v[148:151], v[168:171], a[148:151]
v_mfma_f32_16x16x32_bf16 a[156:159], v[148:151], v[172:175], a[156:159]
buffer_load_dwordx4 v10, s[8:11], s24 offen offset:2048 lds
v_mfma_f32_16x16x32_bf16 a[164:167], v[148:151], v[176:179], a[164:167]
ds_read_b128 v[84:87], v18 offset:10240
v_mfma_f32_16x16x32_bf16 a[172:175], v[148:151], v[180:183], a[172:175]
ds_read_b128 v[88:91], v18 offset:12288
v_mfma_f32_16x16x32_bf16 a[180:183], v[148:151], v[184:187], a[180:183]
v_mfma_f32_16x16x32_bf16 a[188:191], v[148:151], v[188:191], a[188:191]
ds_read_b128 v[92:95], v18 offset:14336
v_mfma_f32_16x16x32_bf16 a[192:195], v[152:155], v[160:163], a[192:195]
v_mfma_f32_16x16x32_bf16 a[200:203], v[152:155], v[164:167], a[200:203]
v_mfma_f32_16x16x32_bf16 a[208:211], v[152:155], v[168:171], a[208:211]
buffer_load_dwordx4 v11, s[8:11], s24 offen offset:3072 lds
v_mfma_f32_16x16x32_bf16 a[216:219], v[152:155], v[172:175], a[216:219]
v_mfma_f32_16x16x32_bf16 a[224:227], v[152:155], v[176:179], a[224:227]
v_mfma_f32_16x16x32_bf16 a[232:235], v[152:155], v[180:183], a[232:235]
v_mfma_f32_16x16x32_bf16 a[240:243], v[152:155], v[184:187], a[240:243]
v_mfma_f32_16x16x32_bf16 a[248:251], v[152:155], v[188:191], a[248:251]
v_mfma_f32_16x16x32_bf16 a[196:199], v[156:159], v[160:163], a[196:199]
v_mfma_f32_16x16x32_bf16 a[204:207], v[156:159], v[164:167], a[204:207]
v_mfma_f32_16x16x32_bf16 a[212:215], v[156:159], v[168:171], a[212:215]
v_mfma_f32_16x16x32_bf16 a[220:223], v[156:159], v[172:175], a[220:223]
s_waitcnt vmcnt(16) lgkmcnt(0)
v_mfma_f32_16x16x32_bf16 a[228:231], v[156:159], v[176:179], a[228:231]
s_barrier
v_mfma_f32_16x16x32_bf16 a[236:239], v[156:159], v[180:183], a[236:239]
v_mfma_f32_16x16x32_bf16 a[244:247], v[156:159], v[184:187], a[244:247]
v_mfma_f32_16x16x32_bf16 a[252:255], v[156:159], v[188:191], a[252:255]
v_mfma_f32_16x16x32_bf16 a[0:3], v[64:67], v[96:99], a[0:3]
s_add_u32 m0, s28, 32768
ds_read_b128 v[128:131], v19 offset:0
s_nop 0
v_mfma_f32_16x16x32_bf16 a[8:11], v[64:67], v[100:103], a[8:11]
ds_read_b64_tr_b16 v[160:161], v20 offset:49152
v_mfma_f32_16x16x32_bf16 a[16:19], v[64:67], v[104:107], a[16:19]
buffer_load_dwordx4 v12, s[12:15], s23 offen offset:0 lds
v_mfma_f32_16x16x32_bf16 a[24:27], v[64:67], v[108:111], a[24:27]
ds_read_b64_tr_b16 v[162:163], v20 offset:50176
v_mfma_f32_16x16x32_bf16 a[32:35], v[64:67], v[112:115], a[32:35]
ds_read_b64_tr_b16 v[164:165], v21 offset:49152
v_mfma_f32_16x16x32_bf16 a[40:43], v[64:67], v[116:119], a[40:43]
v_mfma_f32_16x16x32_bf16 a[48:51], v[64:67], v[120:123], a[48:51]
ds_read_b64_tr_b16 v[166:167], v21 offset:50176
v_mfma_f32_16x16x32_bf16 a[56:59], v[64:67], v[124:127], a[56:59]
v_mfma_f32_16x16x32_bf16 a[4:7], v[68:71], v[96:99], a[4:7]
buffer_load_dwordx4 v13, s[12:15], s23 offen offset:1024 lds
v_mfma_f32_16x16x32_bf16 a[12:15], v[68:71], v[100:103], a[12:15]
ds_read_b64_tr_b16 v[168:169], v22 offset:49152
v_mfma_f32_16x16x32_bf16 a[20:23], v[68:71], v[104:107], a[20:23]
v_mfma_f32_16x16x32_bf16 a[28:31], v[68:71], v[108:111], a[28:31]
ds_read_b64_tr_b16 v[170:171], v22 offset:50176
v_mfma_f32_16x16x32_bf16 a[36:39], v[68:71], v[112:115], a[36:39]
v_mfma_f32_16x16x32_bf16 a[44:47], v[68:71], v[116:119], a[44:47]
ds_read_b64_tr_b16 v[172:173], v23 offset:49152
v_mfma_f32_16x16x32_bf16 a[52:55], v[68:71], v[120:123], a[52:55]
v_mfma_f32_16x16x32_bf16 a[60:63], v[68:71], v[124:127], a[60:63]
buffer_load_dwordx4 v14, s[12:15], s23 offen offset:2048 lds
v_mfma_f32_16x16x32_bf16 a[64:67], v[72:75], v[96:99], a[64:67]
ds_read_b64_tr_b16 v[174:175], v23 offset:50176
v_mfma_f32_16x16x32_bf16 a[72:75], v[72:75], v[100:103], a[72:75]
ds_read_b64_tr_b16 v[176:177], v20 offset:53248
v_mfma_f32_16x16x32_bf16 a[80:83], v[72:75], v[104:107], a[80:83]
v_mfma_f32_16x16x32_bf16 a[88:91], v[72:75], v[108:111], a[88:91]
ds_read_b64_tr_b16 v[178:179], v20 offset:54272
v_mfma_f32_16x16x32_bf16 a[96:99], v[72:75], v[112:115], a[96:99]
v_mfma_f32_16x16x32_bf16 a[104:107], v[72:75], v[116:119], a[104:107]
ds_read_b64_tr_b16 v[180:181], v21 offset:53248
v_mfma_f32_16x16x32_bf16 a[112:115], v[72:75], v[120:123], a[112:115]
buffer_load_dwordx4 v15, s[12:15], s23 offen offset:3072 lds
v_mfma_f32_16x16x32_bf16 a[120:123], v[72:75], v[124:127], a[120:123]
v_mfma_f32_16x16x32_bf16 a[68:71], v[76:79], v[96:99], a[68:71]
ds_read_b64_tr_b16 v[182:183], v21 offset:54272
v_mfma_f32_16x16x32_bf16 a[76:79], v[76:79], v[100:103], a[76:79]
v_mfma_f32_16x16x32_bf16 a[84:87], v[76:79], v[104:107], a[84:87]
s_add_u32 s23, s23, 262144
ds_read_b64_tr_b16 v[184:185], v22 offset:53248
s_add_u32 s30, s24, 65536
v_mfma_f32_16x16x32_bf16 a[92:95], v[76:79], v[108:111], a[92:95]
s_add_u32 m0, s29, s25
v_mfma_f32_16x16x32_bf16 a[100:103], v[76:79], v[112:115], a[100:103]
s_add_u32 m0, m0, 4096
ds_read_b64_tr_b16 v[186:187], v22 offset:54272
s_nop 0
v_mfma_f32_16x16x32_bf16 a[108:111], v[76:79], v[116:119], a[108:111]
buffer_load_dwordx4 v8, s[8:11], s30 offen offset:0 lds
v_mfma_f32_16x16x32_bf16 a[116:119], v[76:79], v[120:123], a[116:119]
ds_read_b64_tr_b16 v[188:189], v23 offset:53248
v_mfma_f32_16x16x32_bf16 a[124:127], v[76:79], v[124:127], a[124:127]
v_mfma_f32_16x16x32_bf16 a[128:131], v[80:83], v[96:99], a[128:131]
ds_read_b64_tr_b16 v[190:191], v23 offset:54272
v_mfma_f32_16x16x32_bf16 a[136:139], v[80:83], v[100:103], a[136:139]
v_mfma_f32_16x16x32_bf16 a[144:147], v[80:83], v[104:107], a[144:147]
ds_read_b128 v[132:135], v19 offset:2048
v_mfma_f32_16x16x32_bf16 a[152:155], v[80:83], v[108:111], a[152:155]
v_mfma_f32_16x16x32_bf16 a[160:163], v[80:83], v[112:115], a[160:163]
buffer_load_dwordx4 v9, s[8:11], s30 offen offset:1024 lds
v_mfma_f32_16x16x32_bf16 a[168:171], v[80:83], v[116:119], a[168:171]
ds_read_b128 v[136:139], v19 offset:4096
v_mfma_f32_16x16x32_bf16 a[176:179], v[80:83], v[120:123], a[176:179]
v_mfma_f32_16x16x32_bf16 a[184:187], v[80:83], v[124:127], a[184:187]
ds_read_b128 v[140:143], v19 offset:6144
v_mfma_f32_16x16x32_bf16 a[132:135], v[84:87], v[96:99], a[132:135]
v_mfma_f32_16x16x32_bf16 a[140:143], v[84:87], v[100:103], a[140:143]
ds_read_b128 v[144:147], v19 offset:8192
v_mfma_f32_16x16x32_bf16 a[148:151], v[84:87], v[104:107], a[148:151]
v_mfma_f32_16x16x32_bf16 a[156:159], v[84:87], v[108:111], a[156:159]
buffer_load_dwordx4 v10, s[8:11], s30 offen offset:2048 lds
v_mfma_f32_16x16x32_bf16 a[164:167], v[84:87], v[112:115], a[164:167]
ds_read_b128 v[148:151], v19 offset:10240
v_mfma_f32_16x16x32_bf16 a[172:175], v[84:87], v[116:119], a[172:175]
ds_read_b128 v[152:155], v19 offset:12288
v_mfma_f32_16x16x32_bf16 a[180:183], v[84:87], v[120:123], a[180:183]
v_mfma_f32_16x16x32_bf16 a[188:191], v[84:87], v[124:127], a[188:191]
ds_read_b128 v[156:159], v19 offset:14336
v_mfma_f32_16x16x32_bf16 a[192:195], v[88:91], v[96:99], a[192:195]
v_mfma_f32_16x16x32_bf16 a[200:203], v[88:91], v[100:103], a[200:203]
v_mfma_f32_16x16x32_bf16 a[208:211], v[88:91], v[104:107], a[208:211]
buffer_load_dwordx4 v11, s[8:11], s30 offen offset:3072 lds
v_mfma_f32_16x16x32_bf16 a[216:219], v[88:91], v[108:111], a[216:219]
v_mfma_f32_16x16x32_bf16 a[224:227], v[88:91], v[112:115], a[224:227]
v_mfma_f32_16x16x32_bf16 a[232:235], v[88:91], v[116:119], a[232:235]
v_mfma_f32_16x16x32_bf16 a[240:243], v[88:91], v[120:123], a[240:243]
v_mfma_f32_16x16x32_bf16 a[248:251], v[88:91], v[124:127], a[248:251]
s_add_u32 s24, s24, 128
v_mfma_f32_16x16x32_bf16 a[196:199], v[92:95], v[96:99], a[196:199]
s_add_u32 s25, s25, 32768
v_mfma_f32_16x16x32_bf16 a[204:207], v[92:95], v[100:103], a[204:207]
s_cmp_eq_u32 s25, 98304
s_cselect_b32 s25, 0, s25
v_mfma_f32_16x16x32_bf16 a[212:215], v[92:95], v[104:107], a[212:215]
v_mfma_f32_16x16x32_bf16 a[220:223], v[92:95], v[108:111], a[220:223]
s_waitcnt vmcnt(16) lgkmcnt(0)
v_mfma_f32_16x16x32_bf16 a[228:231], v[92:95], v[112:115], a[228:231]
s_barrier
v_mfma_f32_16x16x32_bf16 a[236:239], v[92:95], v[116:119], a[236:239]
v_mfma_f32_16x16x32_bf16 a[244:247], v[92:95], v[120:123], a[244:247]
v_mfma_f32_16x16x32_bf16 a[252:255], v[92:95], v[124:127], a[252:255]
v_mfma_f32_16x16x32_bf16 a[0:3], v[128:131], v[160:163], a[0:3]
s_add_u32 m0, s28, 49152
ds_read_b64_tr_b16 v[96:97], v20 offset:0
v_add_u32 v18, s26, v16
v_mfma_f32_16x16x32_bf16 a[8:11], v[128:131], v[164:167], a[8:11]
s_nop 0
ds_read_b64_tr_b16 v[98:99], v20 offset:1024
v_add_u32 v19, s26, v17
v_mfma_f32_16x16x32_bf16 a[16:19], v[128:131], v[168:171], a[16:19]
s_add_u32 s26, s26, 32768
s_cmp_eq_u32 s26, 163840
s_cselect_b32 s26, 65536, s26
ds_read_b64_tr_b16 v[100:101], v21 offset:0
v_mfma_f32_16x16x32_bf16 a[24:27], v[128:131], v[172:175], a[24:27]
buffer_load_dwordx4 v12, s[12:15], s23 offen offset:0 lds
v_mfma_f32_16x16x32_bf16 a[32:35], v[128:131], v[176:179], a[32:35]
ds_read_b64_tr_b16 v[102:103], v21 offset:1024
v_mfma_f32_16x16x32_bf16 a[40:43], v[128:131], v[180:183], a[40:43]
v_mfma_f32_16x16x32_bf16 a[48:51], v[128:131], v[184:187], a[48:51]
ds_read_b128 v[64:67], v18 offset:0
v_mfma_f32_16x16x32_bf16 a[56:59], v[128:131], v[188:191], a[56:59]
v_mfma_f32_16x16x32_bf16 a[4:7], v[132:135], v[160:163], a[4:7]
buffer_load_dwordx4 v13, s[12:15], s23 offen offset:1024 lds
v_mfma_f32_16x16x32_bf16 a[12:15], v[132:135], v[164:167], a[12:15]
ds_read_b64_tr_b16 v[104:105], v22 offset:0
v_mfma_f32_16x16x32_bf16 a[20:23], v[132:135], v[168:171], a[20:23]
v_mfma_f32_16x16x32_bf16 a[28:31], v[132:135], v[172:175], a[28:31]
ds_read_b64_tr_b16 v[106:107], v22 offset:1024
v_mfma_f32_16x16x32_bf16 a[36:39], v[132:135], v[176:179], a[36:39]
v_mfma_f32_16x16x32_bf16 a[44:47], v[132:135], v[180:183], a[44:47]
ds_read_b64_tr_b16 v[108:109], v23 offset:0
v_mfma_f32_16x16x32_bf16 a[52:55], v[132:135], v[184:187], a[52:55]
v_mfma_f32_16x16x32_bf16 a[60:63], v[132:135], v[188:191], a[60:63]
buffer_load_dwordx4 v14, s[12:15], s23 offen offset:2048 lds
v_mfma_f32_16x16x32_bf16 a[64:67], v[136:139], v[160:163], a[64:67]
ds_read_b64_tr_b16 v[110:111], v23 offset:1024
v_mfma_f32_16x16x32_bf16 a[72:75], v[136:139], v[164:167], a[72:75]
ds_read_b64_tr_b16 v[112:113], v20 offset:4096
v_mfma_f32_16x16x32_bf16 a[80:83], v[136:139], v[168:171], a[80:83]
v_mfma_f32_16x16x32_bf16 a[88:91], v[136:139], v[172:175], a[88:91]
ds_read_b64_tr_b16 v[114:115], v20 offset:5120
v_mfma_f32_16x16x32_bf16 a[96:99], v[136:139], v[176:179], a[96:99]
v_mfma_f32_16x16x32_bf16 a[104:107], v[136:139], v[180:183], a[104:107]
ds_read_b64_tr_b16 v[116:117], v21 offset:4096
v_mfma_f32_16x16x32_bf16 a[112:115], v[136:139], v[184:187], a[112:115]
buffer_load_dwordx4 v15, s[12:15], s23 offen offset:3072 lds
v_mfma_f32_16x16x32_bf16 a[120:123], v[136:139], v[188:191], a[120:123]
v_mfma_f32_16x16x32_bf16 a[68:71], v[140:143], v[160:163], a[68:71]
ds_read_b64_tr_b16 v[118:119], v21 offset:5120
v_mfma_f32_16x16x32_bf16 a[76:79], v[140:143], v[164:167], a[76:79]
v_mfma_f32_16x16x32_bf16 a[84:87], v[140:143], v[168:171], a[84:87]
s_add_u32 s23, s23, 262144
ds_read_b64_tr_b16 v[120:121], v22 offset:4096
s_add_u32 m0, s29, s25
v_mfma_f32_16x16x32_bf16 a[92:95], v[140:143], v[172:175], a[92:95]
s_nop 0
v_mfma_f32_16x16x32_bf16 a[100:103], v[140:143], v[176:179], a[100:103]
ds_read_b64_tr_b16 v[122:123], v22 offset:5120
v_mfma_f32_16x16x32_bf16 a[108:111], v[140:143], v[180:183], a[108:111]
buffer_load_dwordx4 v8, s[8:11], s24 offen offset:0 lds
v_mfma_f32_16x16x32_bf16 a[116:119], v[140:143], v[184:187], a[116:119]
ds_read_b64_tr_b16 v[124:125], v23 offset:4096
v_mfma_f32_16x16x32_bf16 a[124:127], v[140:143], v[188:191], a[124:127]
v_mfma_f32_16x16x32_bf16 a[128:131], v[144:147], v[160:163], a[128:131]
ds_read_b64_tr_b16 v[126:127], v23 offset:5120
v_mfma_f32_16x16x32_bf16 a[136:139], v[144:147], v[164:167], a[136:139]
v_mfma_f32_16x16x32_bf16 a[144:147], v[144:147], v[168:171], a[144:147]
ds_read_b128 v[68:71], v18 offset:2048
v_mfma_f32_16x16x32_bf16 a[152:155], v[144:147], v[172:175], a[152:155]
v_mfma_f32_16x16x32_bf16 a[160:163], v[144:147], v[176:179], a[160:163]
buffer_load_dwordx4 v9, s[8:11], s24 offen offset:1024 lds
v_mfma_f32_16x16x32_bf16 a[168:171], v[144:147], v[180:183], a[168:171]
ds_read_b128 v[72:75], v18 offset:4096
v_mfma_f32_16x16x32_bf16 a[176:179], v[144:147], v[184:187], a[176:179]
v_mfma_f32_16x16x32_bf16 a[184:187], v[144:147], v[188:191], a[184:187]
ds_read_b128 v[76:79], v18 offset:6144
v_mfma_f32_16x16x32_bf16 a[132:135], v[148:151], v[160:163], a[132:135]
v_mfma_f32_16x16x32_bf16 a[140:143], v[148:151], v[164:167], a[140:143]
ds_read_b128 v[80:83], v18 offset:8192
v_mfma_f32_16x16x32_bf16 a[148:151], v[148:151], v[168:171], a[148:151]
v_mfma_f32_16x16x32_bf16 a[156:159], v[148:151], v[172:175], a[156:159]
buffer_load_dwordx4 v10, s[8:11], s24 offen offset:2048 lds
v_mfma_f32_16x16x32_bf16 a[164:167], v[148:151], v[176:179], a[164:167]
ds_read_b128 v[84:87], v18 offset:10240
v_mfma_f32_16x16x32_bf16 a[172:175], v[148:151], v[180:183], a[172:175]
ds_read_b128 v[88:91], v18 offset:12288
v_mfma_f32_16x16x32_bf16 a[180:183], v[148:151], v[184:187], a[180:183]
v_mfma_f32_16x16x32_bf16 a[188:191], v[148:151], v[188:191], a[188:191]
ds_read_b128 v[92:95], v18 offset:14336
v_mfma_f32_16x16x32_bf16 a[192:195], v[152:155], v[160:163], a[192:195]
v_mfma_f32_16x16x32_bf16 a[200:203], v[152:155], v[164:167], a[200:203]
v_mfma_f32_16x16x32_bf16 a[208:211], v[152:155], v[168:171], a[208:211]
buffer_load_dwordx4 v11, s[8:11], s24 offen offset:3072 lds
v_mfma_f32_16x16x32_bf16 a[216:219], v[152:155], v[172:175], a[216:219]
v_mfma_f32_16x16x32_bf16 a[224:227], v[152:155], v[176:179], a[224:227]
v_mfma_f32_16x16x32_bf16 a[232:235], v[152:155], v[180:183], a[232:235]
v_mfma_f32_16x16x32_bf16 a[240:243], v[152:155], v[184:187], a[240:243]
v_mfma_f32_16x16x32_bf16 a[248:251], v[152:155], v[188:191], a[248:251]
v_mfma_f32_16x16x32_bf16 a[196:199], v[156:159], v[160:163], a[196:199]
v_mfma_f32_16x16x32_bf16 a[204:207], v[156:159], v[164:167], a[204:207]
v_mfma_f32_16x16x32_bf16 a[212:215], v[156:159], v[168:171], a[212:215]
v_mfma_f32_16x16x32_bf16 a[220:223], v[156:159], v[172:175], a[220:223]
s_waitcnt vmcnt(16) lgkmcnt(0)
v_mfma_f32_16x16x32_bf16 a[228:231], v[156:159], v[176:179], a[228:231]
s_barrier
v_mfma_f32_16x16x32_bf16 a[236:239], v[156:159], v[180:183], a[236:239]
v_mfma_f32_16x16x32_bf16 a[244:247], v[156:159], v[184:187], a[244:247]
v_mfma_f32_16x16x32_bf16 a[252:255], v[156:159], v[188:191], a[252:255]
s_add_u32 s27, s27, 1
s_cmp_lt_u32 s27, 8
s_cbranch_scc1 K1V_loop
s_lshl_b32 s50, s6, 17
s_lshl_b32 s31, s21, 16
s_add_u32 s50, s50, s31
s_lshl_b32 s31, s22, 13
s_add_u32 s50, s50, s31
s_movk_i32 s51, 4096
s_movk_i32 s37, 12288
K1_E:
s_mov_b32 s84, s16
s_mov_b32 s85, s17
s_mov_b32 s86, s18
s_mov_b32 s87, 0x20000
s_mov_b32 s88, s50
s_mov_b32 s89, s51
s_mov_b32 s90, s37
s_load_dwordx2 s[40:41], s[0:1], 16
s_load_dwordx2 s[42:43], s[0:1], 40
s_load_dwordx4 s[48:51], s[0:1], 88
s_load_dwordx2 s[98:99], s[0:1], 0
v_and_b32 v6, 63, v0
v_lshlrev_b32 v1, 4, v6
v_lshrrev_b32 v7, 6, v0
s_nop 0
v_readfirstlane_b32 s20, v7
v_lshrrev_b32 v7, 4, v6
v_lshlrev_b32 v7, 2, v7
v_and_b32 v8, 15, v6
v_sub_u32 v5, v7, v8
s_lshl_b32 s29, s20, 13
v_add_u32 v4, s29, v1
s_lshl_b32 s39, s20, 12
s_mov_b32 s92, 0
v_lshrrev_b32 v7, 3, v6
v_lshrrev_b32 v8, 2, v7
v_lshlrev_b32 v8, 3, v8
v_and_b32 v9, 3, v7
v_add_u32 v8, v8, v9
v_lshlrev_b32 v8, 13, v8
v_and_b32 v9, 7, v6
v_lshrrev_b32 v9, 1, v9
v_lshrrev_b32 v10, 4, v6
v_xor_b32 v9, v9, v10
v_lshlrev_b32 v9, 5, v9
v_and_b32 v10, 1, v6
v_lshlrev_b32 v10, 4, v10
v_add_u32 v11, v9, v10
s_lshl_b32 s30, s20, 7
v_add3_u32 v8, v8, v11, s30
v_add_u32 v196, 0, v8
v_add_u32 v197, 31744, v8
v_add_u32 v198, 129024, v8
v_add_u32 v199, 160768, v8
s_movk_i32 s30, 896
v_mul_lo_u32 v7, v7, s30
v_add_u32 v7, v7, v11
s_mul_i32 s4, s20, 57344
v_add_u32 v7, s4, v7
v_add_u32 v200, 0, v7
v_add_u32 v201, 6144, v7
v_add_u32 v202, 12288, v7
v_add_u32 v203, 18432, v7
v_and_b32 v7, 15, v6
v_lshrrev_b32 v7, 2, v7
v_lshrrev_b32 v8, 4, v6
v_and_b32 v9, 3, v6
v_lshlrev_b32 v9, 3, v9
v_and_b32 v10, 1, v8
v_lshrrev_b32 v11, 1, v8
v_lshlrev_b32 v11, 4, v11
v_lshl_add_u32 v11, v10, 2, v11
v_add_u32 v11, v11, v7
v_lshl_add_u32 v11, v11, 7, v9
v_lshrrev_b32 v12, 1, v7
v_lshl_add_u32 v12, v10, 1, v12
v_xor_b32 v13, 0, v12
v_lshl_add_u32 v208, v13, 5, v11
v_xor_b32 v13, 1, v12
v_lshl_add_u32 v209, v13, 5, v11
v_xor_b32 v13, 2, v12
v_lshl_add_u32 v210, v13, 5, v11
v_xor_b32 v13, 3, v12
v_lshl_add_u32 v211, v13, 5, v11
v_lshl_add_u32 v11, v8, 2, v7
v_lshl_add_u32 v11, v11, 7, v9
v_lshrrev_b32 v12, 1, v7
v_lshl_add_u32 v12, v8, 1, v12
v_and_b32 v12, 3, v12
v_xor_b32 v13, 0, v12
v_lshl_add_u32 v212, v13, 5, v11
v_xor_b32 v13, 1, v12
v_lshl_add_u32 v213, v13, 5, v11
v_xor_b32 v13, 2, v12
v_lshl_add_u32 v214, v13, 5, v11
v_xor_b32 v13, 3, v12
v_lshl_add_u32 v215, v13, 5, v11
v_and_b32 v10, 15, v6
v_lshrrev_b32 v11, 3, v10
v_mul_u32_u24 v11, 7168, v11
v_and_b32 v10, 7, v10
v_lshl_add_u32 v10, v8, 3, v10
v_lshl_add_u32 v14, v10, 4, v11
v_mov_b32 v192, 0x3f803f80
v_mov_b32 v193, 0x3f803f80
v_mov_b32 v194, 0x3f803f80
v_mov_b32 v195, 0x3f803f80
s_and_b32 s3, s2, 7
s_lshr_b32 s4, s2, 3
s_and_b32 s5, s4, 1
s_lshl_b32 s21, s3, 1
s_add_u32 s21, s21, s5
s_lshr_b32 s33, s4, 1
s_mov_b32 s36, 0x41800000
s_waitcnt lgkmcnt(0)
s_lshl_b32 s6, s21, 20
s_add_u32 s7, s6, 2097152
s_add_u32 s8, s50, s7
s_addc_u32 s9, s51, 0
s_mov_b32 s10, 17825792
s_mov_b32 s11, 0x20000
s_mov_b32 s12, s50
s_mov_b32 s13, s51
s_mov_b32 s14, 1835008
s_mov_b32 s15, 0x20000
s_add_u32 s16, s50, 46137344
s_addc_u32 s17, s51, 0
s_mov_b32 s18, 29360128
s_mov_b32 s19, 0x20000
s_lshl_b32 s6, s21, 9
s_add_u32 s76, s40, s6
s_addc_u32 s77, s41, 0
s_sub_u32 s78, 3670016, s6
s_mov_b32 s79, 0x20000
s_mul_i32 s6, s21, 229376
s_add_u32 s4, s42, s6
s_addc_u32 s81, s43, 0
s_mov_b32 s80, s4
s_mov_b32 s82, 229376
s_mov_b32 s83, 0x20000
s_mov_b32 s42, 0x3db8aa3b
s_mov_b32 s43, 0x3db8aa3b
s_sub_u32 s7, 15, s33
s_cmp_ge_u32 s33, 8
s_cselect_b32 s22, s33, s7
s_lshl_b32 s34, s21, 3
s_add_u32 s34, s34, s22
s_sub_u32 s34, s34, 8
s_lshl_b32 s7, s34, 16
s_lshl_b32 s6, s20, 14
s_add_u32 s7, s7, s6
s_add_u32 s7, s7, 35651584
s_add_u32 s44, s50, s7
s_addc_u32 s45, s51, 0
s_mov_b32 s46, 16384
s_mov_b32 s47, 0x20000
s_lshl_b32 s7, s34, 12
s_lshl_b32 s6, s20, 10
s_add_u32 s7, s7, s6
s_add_u32 s7, s7, 45088768
s_add_u32 s52, s50, s7
s_addc_u32 s53, s51, 0
s_mov_b32 s54, 1024
s_mov_b32 s55, 0x20000
s_mov_b32 s56, s48
s_mov_b32 s57, s49
s_mov_b32 s58, 256
s_mov_b32 s59, 0x20000
v_mov_b32 v13, 128
s_add_u32 s92, s50, 125829120
s_addc_u32 s93, s51, 0
s_mov_b32 s94, 12288
s_mov_b32 s95, 0x20000
s_lshl_b32 s35, s22, 1
s_sub_i32 s35, s35, 18
s_max_i32 s35, s35, 0
s_cmp_ge_u32 s33, 8
s_cbranch_scc1 K2_A
s_cmp_eq_u32 s35, 0
s_cbranch_scc1 K2_B2f
s_mov_b32 s23, 0
s_mov_b32 s24, s35
s_mov_b32 s37, 0
s_branch K2_first
K2_A:
s_mov_b32 s23, s35
s_lshl_b32 s24, s22, 1
s_sub_u32 s24, s24, s35
s_cmp_eq_u32 s35, 0
s_cselect_b32 s37, 1, 2
s_branch K2_first
K2_B2f:
s_mov_b32 s22, s33
s_mov_b32 s23, 0
s_lshl_b32 s24, s33, 1
s_mov_b32 s37, 1
K2_first:
s_waitcnt vmcnt(0) lgkmcnt(0)
s_barrier
s_mov_b32 s27, 65536
s_mov_b32 s28, 0
s_mov_b32 s38, 1048576
s_lshl_b32 s4, s33, 3
s_lshl_b32 s40, s20, 1
s_add_u32 s4, s4, s40
s_mul_i32 s4, s4, 14336
s_add_u32 s5, s4, 14336
s_lshl_b32 s25, s23, 15
s_add_u32 s26, s25, 16777216
s_cmp_lg_u32 s20, 0
s_cbranch_scc1 K2_x_got
v_mov_b32 v10, v251
v_mov_b32 v12, v252
s_mov_b32 s41, 0
s_lshl_b32 s40, s33, 2
s_add_u32 s40, s40, 64
v_mov_b32 v11, s40
s_branch K2_x_chk
K2_x_spin:
buffer_load_dword v10, v11, s[56:59], 0 offen sc1
buffer_load_dword v12, v13, s[56:59], 0 offen sc1
s_waitcnt vmcnt(0)
K2_x_chk:
v_readfirstlane_b32 s6, v10
v_readfirstlane_b32 s7, v12
s_nop 3
s_cmp_ge_u32 s6, 16
s_cselect_b32 s6, 1, 0
s_cmp_ge_u32 s7, 96
s_cselect_b32 s7, 1, 0
s_and_b32 s6, s6, s7
s_cbranch_scc1 K2_x_ok
s_add_u32 s41, s41, 1
s_cmp_lt_u32 s41, 0x40000
s_cbranch_scc0 K2_x_ok
s_sleep 2
s_branch K2_x_spin
K2_x_ok:
K2_x_got:
s_barrier
v_add_u32 v216, s28, v208
v_add_u32 v217, s28, v209
v_add_u32 v218, s28, v210
v_add_u32 v219, s28, v211
s_add_u32 s28, s28, 32768
s_cmp_eq_u32 s28, 163840
s_cselect_b32 s28, 0, s28
v_add_u32 v220, s28, v208
v_add_u32 v221, s28, v209
v_add_u32 v222, s28, v210
v_add_u32 v223, s28, v211
s_add_u32 s28, s28, 32768
s_cmp_eq_u32 s28, 163840
s_cselect_b32 s28, 0, s28
buffer_load_dwordx4 v[16:19], v1, s[12:15], s4 offen
buffer_load_dwordx4 v[72:75], v1, s[12:15], s5 offen
buffer_load_dwordx4 v[20:23], v1, s[12:15], s4 offen offset:1024
buffer_load_dwordx4 v[76:79], v1, s[12:15], s5 offen offset:1024
s_add_u32 s4, s4, 2048
s_add_u32 s5, s5, 2048
buffer_load_dwordx4 v[24:27], v1, s[12:15], s4 offen
buffer_load_dwordx4 v[80:83], v1, s[12:15], s5 offen
buffer_load_dwordx4 v[28:31], v1, s[12:15], s4 offen offset:1024
buffer_load_dwordx4 v[84:87], v1, s[12:15], s5 offen offset:1024
s_add_u32 s4, s4, 2048
s_add_u32 s5, s5, 2048
s_add_u32 m0, s39, s27
s_add_u32 s31, s38, 262144
buffer_load_dwordx4 v196, s[76:79], s38 offen lds
buffer_load_dwordx4 v197, s[76:79], s38 offen offset:1024 lds
buffer_load_dwordx4 v198, s[76:79], s38 offen offset:2048 lds
buffer_load_dwordx4 v199, s[76:79], s38 offen offset:3072 lds
s_add_u32 m0, m0, 16384
s_add_u32 s38, s38, 524288
buffer_load_dwordx4 v196, s[76:79], s31 offen lds
buffer_load_dwordx4 v197, s[76:79], s31 offen offset:1024 lds
buffer_load_dwordx4 v198, s[76:79], s31 offen offset:2048 lds
buffer_load_dwordx4 v199, s[76:79], s31 offen offset:3072 lds
s_add_u32 s27, s27, 32768
s_cmp_eq_u32 s27, 163840
s_cselect_b32 s27, 0, s27
buffer_load_dwordx4 v[32:35], v1, s[12:15], s4 offen
buffer_load_dwordx4 v[88:91], v1, s[12:15], s5 offen
buffer_load_dwordx4 v[36:39], v1, s[12:15], s4 offen offset:1024
buffer_load_dwordx4 v[92:95], v1, s[12:15], s5 offen offset:1024
s_add_u32 s4, s4, 2048
s_add_u32 s5, s5, 2048
s_add_u32 m0, s39, s27
s_add_u32 s31, s38, 262144
buffer_load_dwordx4 v196, s[76:79], s38 offen lds
buffer_load_dwordx4 v197, s[76:79], s38 offen offset:1024 lds
buffer_load_dwordx4 v198, s[76:79], s38 offen offset:2048 lds
buffer_load_dwordx4 v199, s[76:79], s38 offen offset:3072 lds
s_add_u32 m0, m0, 16384
s_add_u32 s38, s38, 524288
buffer_load_dwordx4 v196, s[76:79], s31 offen lds
buffer_load_dwordx4 v197, s[76:79], s31 offen offset:1024 lds
buffer_load_dwordx4 v198, s[76:79], s31 offen offset:2048 lds
buffer_load_dwordx4 v199, s[76:79], s31 offen offset:3072 lds
s_add_u32 s27, s27, 32768
s_cmp_eq_u32 s27, 163840
s_cselect_b32 s27, 0, s27
s_add_u32 s91, s88, 32768
v_accvgpr_read_b32 v224, a0
v_accvgpr_read_b32 v225, a1
v_accvgpr_read_b32 v226, a2
v_accvgpr_read_b32 v227, a3
v_accvgpr_read_b32 v228, a4
v_accvgpr_read_b32 v229, a5
v_accvgpr_read_b32 v230, a6
v_accvgpr_read_b32 v231, a7
v_cvt_pk_bf16_f32 v224, v224, v225
v_cvt_pk_bf16_f32 v225, v226, v227
v_cvt_pk_bf16_f32 v226, v228, v229
v_cvt_pk_bf16_f32 v227, v230, v231
buffer_store_dwordx4 v[224:227], v1, s[84:87], s88 offen offset:0 sc1
v_accvgpr_read_b32 v232, a8
v_accvgpr_read_b32 v233, a9
v_accvgpr_read_b32 v234, a10
v_accvgpr_read_b32 v235, a11
v_accvgpr_read_b32 v236, a12
v_accvgpr_read_b32 v237, a13
v_accvgpr_read_b32 v238, a14
v_accvgpr_read_b32 v239, a15
v_cvt_pk_bf16_f32 v232, v232, v233
v_cvt_pk_bf16_f32 v233, v234, v235
v_cvt_pk_bf16_f32 v234, v236, v237
v_cvt_pk_bf16_f32 v235, v238, v239
buffer_store_dwordx4 v[232:235], v1, s[84:87], s88 offen offset:1024 sc1
v_accvgpr_read_b32 v240, a16
v_accvgpr_read_b32 v241, a17
v_accvgpr_read_b32 v242, a18
v_accvgpr_read_b32 v243, a19
v_accvgpr_read_b32 v244, a20
v_accvgpr_read_b32 v245, a21
v_accvgpr_read_b32 v246, a22
v_accvgpr_read_b32 v247, a23
v_cvt_pk_bf16_f32 v240, v240, v241
v_cvt_pk_bf16_f32 v241, v242, v243
v_cvt_pk_bf16_f32 v242, v244, v245
v_cvt_pk_bf16_f32 v243, v246, v247
buffer_store_dwordx4 v[240:243], v1, s[84:87], s88 offen offset:2048 sc1
v_accvgpr_read_b32 v248, a24
v_accvgpr_read_b32 v249, a25
v_accvgpr_read_b32 v250, a26
v_accvgpr_read_b32 v251, a27
v_accvgpr_read_b32 v252, a28
v_accvgpr_read_b32 v253, a29
v_accvgpr_read_b32 v254, a30
v_accvgpr_read_b32 v255, a31
v_cvt_pk_bf16_f32 v248, v248, v249
v_cvt_pk_bf16_f32 v249, v250, v251
v_cvt_pk_bf16_f32 v250, v252, v253
v_cvt_pk_bf16_f32 v251, v254, v255
buffer_store_dwordx4 v[248:251], v1, s[84:87], s88 offen offset:3072 sc1
s_add_u32 s88, s88, s89
v_accvgpr_read_b32 v224, a32
v_accvgpr_read_b32 v225, a33
v_accvgpr_read_b32 v226, a34
v_accvgpr_read_b32 v227, a35
v_accvgpr_read_b32 v228, a36
v_accvgpr_read_b32 v229, a37
v_accvgpr_read_b32 v230, a38
v_accvgpr_read_b32 v231, a39
v_cvt_pk_bf16_f32 v224, v224, v225
v_cvt_pk_bf16_f32 v225, v226, v227
v_cvt_pk_bf16_f32 v226, v228, v229
v_cvt_pk_bf16_f32 v227, v230, v231
buffer_store_dwordx4 v[224:227], v1, s[84:87], s88 offen offset:0 sc1
v_accvgpr_read_b32 v232, a40
v_accvgpr_read_b32 v233, a41
v_accvgpr_read_b32 v234, a42
v_accvgpr_read_b32 v235, a43
v_accvgpr_read_b32 v236, a44
v_accvgpr_read_b32 v237, a45
v_accvgpr_read_b32 v238, a46
v_accvgpr_read_b32 v239, a47
v_cvt_pk_bf16_f32 v232, v232, v233
v_cvt_pk_bf16_f32 v233, v234, v235
v_cvt_pk_bf16_f32 v234, v236, v237
v_cvt_pk_bf16_f32 v235, v238, v239
buffer_store_dwordx4 v[232:235], v1, s[84:87], s88 offen offset:1024 sc1
v_accvgpr_read_b32 v240, a48
v_accvgpr_read_b32 v241, a49
v_accvgpr_read_b32 v242, a50
v_accvgpr_read_b32 v243, a51
v_accvgpr_read_b32 v244, a52
v_accvgpr_read_b32 v245, a53
v_accvgpr_read_b32 v246, a54
v_accvgpr_read_b32 v247, a55
v_cvt_pk_bf16_f32 v240, v240, v241
v_cvt_pk_bf16_f32 v241, v242, v243
v_cvt_pk_bf16_f32 v242, v244, v245
v_cvt_pk_bf16_f32 v243, v246, v247
buffer_store_dwordx4 v[240:243], v1, s[84:87], s88 offen offset:2048 sc1
v_accvgpr_read_b32 v248, a56
v_accvgpr_read_b32 v249, a57
v_accvgpr_read_b32 v250, a58
v_accvgpr_read_b32 v251, a59
v_accvgpr_read_b32 v252, a60
v_accvgpr_read_b32 v253, a61
v_accvgpr_read_b32 v254, a62
v_accvgpr_read_b32 v255, a63
v_cvt_pk_bf16_f32 v248, v248, v249
v_cvt_pk_bf16_f32 v249, v250, v251
v_cvt_pk_bf16_f32 v250, v252, v253
v_cvt_pk_bf16_f32 v251, v254, v255
buffer_store_dwordx4 v[248:251], v1, s[84:87], s88 offen offset:3072 sc1
s_add_u32 s88, s88, s90
v_accvgpr_read_b32 v224, a64
v_accvgpr_read_b32 v225, a65
v_accvgpr_read_b32 v226, a66
v_accvgpr_read_b32 v227, a67
v_accvgpr_read_b32 v228, a68
v_accvgpr_read_b32 v229, a69
v_accvgpr_read_b32 v230, a70
v_accvgpr_read_b32 v231, a71
v_cvt_pk_bf16_f32 v224, v224, v225
v_cvt_pk_bf16_f32 v225, v226, v227
v_cvt_pk_bf16_f32 v226, v228, v229
v_cvt_pk_bf16_f32 v227, v230, v231
buffer_store_dwordx4 v[224:227], v1, s[84:87], s88 offen offset:0 sc1
v_accvgpr_read_b32 v232, a72
v_accvgpr_read_b32 v233, a73
v_accvgpr_read_b32 v234, a74
v_accvgpr_read_b32 v235, a75
v_accvgpr_read_b32 v236, a76
v_accvgpr_read_b32 v237, a77
v_accvgpr_read_b32 v238, a78
v_accvgpr_read_b32 v239, a79
v_cvt_pk_bf16_f32 v232, v232, v233
v_cvt_pk_bf16_f32 v233, v234, v235
v_cvt_pk_bf16_f32 v234, v236, v237
v_cvt_pk_bf16_f32 v235, v238, v239
buffer_store_dwordx4 v[232:235], v1, s[84:87], s88 offen offset:1024 sc1
v_accvgpr_read_b32 v240, a80
v_accvgpr_read_b32 v241, a81
v_accvgpr_read_b32 v242, a82
v_accvgpr_read_b32 v243, a83
v_accvgpr_read_b32 v244, a84
v_accvgpr_read_b32 v245, a85
v_accvgpr_read_b32 v246, a86
v_accvgpr_read_b32 v247, a87
v_cvt_pk_bf16_f32 v240, v240, v241
v_cvt_pk_bf16_f32 v241, v242, v243
v_cvt_pk_bf16_f32 v242, v244, v245
v_cvt_pk_bf16_f32 v243, v246, v247
buffer_store_dwordx4 v[240:243], v1, s[84:87], s88 offen offset:2048 sc1
v_accvgpr_read_b32 v248, a88
v_accvgpr_read_b32 v249, a89
v_accvgpr_read_b32 v250, a90
v_accvgpr_read_b32 v251, a91
v_accvgpr_read_b32 v252, a92
v_accvgpr_read_b32 v253, a93
v_accvgpr_read_b32 v254, a94
v_accvgpr_read_b32 v255, a95
v_cvt_pk_bf16_f32 v248, v248, v249
v_cvt_pk_bf16_f32 v249, v250, v251
v_cvt_pk_bf16_f32 v250, v252, v253
v_cvt_pk_bf16_f32 v251, v254, v255
buffer_store_dwordx4 v[248:251], v1, s[84:87], s88 offen offset:3072 sc1
s_add_u32 s88, s88, s89
v_accvgpr_read_b32 v224, a96
v_accvgpr_read_b32 v225, a97
v_accvgpr_read_b32 v226, a98
v_accvgpr_read_b32 v227, a99
v_accvgpr_read_b32 v228, a100
v_accvgpr_read_b32 v229, a101
v_accvgpr_read_b32 v230, a102
v_accvgpr_read_b32 v231, a103
v_cvt_pk_bf16_f32 v224, v224, v225
v_cvt_pk_bf16_f32 v225, v226, v227
v_cvt_pk_bf16_f32 v226, v228, v229
v_cvt_pk_bf16_f32 v227, v230, v231
buffer_store_dwordx4 v[224:227], v1, s[84:87], s88 offen offset:0 sc1
v_accvgpr_read_b32 v232, a104
v_accvgpr_read_b32 v233, a105
v_accvgpr_read_b32 v234, a106
v_accvgpr_read_b32 v235, a107
v_accvgpr_read_b32 v236, a108
v_accvgpr_read_b32 v237, a109
v_accvgpr_read_b32 v238, a110
v_accvgpr_read_b32 v239, a111
v_cvt_pk_bf16_f32 v232, v232, v233
v_cvt_pk_bf16_f32 v233, v234, v235
v_cvt_pk_bf16_f32 v234, v236, v237
v_cvt_pk_bf16_f32 v235, v238, v239
buffer_store_dwordx4 v[232:235], v1, s[84:87], s88 offen offset:1024 sc1
v_accvgpr_read_b32 v240, a112
v_accvgpr_read_b32 v241, a113
v_accvgpr_read_b32 v242, a114
v_accvgpr_read_b32 v243, a115
v_accvgpr_read_b32 v244, a116
v_accvgpr_read_b32 v245, a117
v_accvgpr_read_b32 v246, a118
v_accvgpr_read_b32 v247, a119
v_cvt_pk_bf16_f32 v240, v240, v241
v_cvt_pk_bf16_f32 v241, v242, v243
v_cvt_pk_bf16_f32 v242, v244, v245
v_cvt_pk_bf16_f32 v243, v246, v247
buffer_store_dwordx4 v[240:243], v1, s[84:87], s88 offen offset:2048 sc1
v_accvgpr_read_b32 v248, a120
v_accvgpr_read_b32 v249, a121
v_accvgpr_read_b32 v250, a122
v_accvgpr_read_b32 v251, a123
v_accvgpr_read_b32 v252, a124
v_accvgpr_read_b32 v253, a125
v_accvgpr_read_b32 v254, a126
v_accvgpr_read_b32 v255, a127
v_cvt_pk_bf16_f32 v248, v248, v249
v_cvt_pk_bf16_f32 v249, v250, v251
v_cvt_pk_bf16_f32 v250, v252, v253
v_cvt_pk_bf16_f32 v251, v254, v255
buffer_store_dwordx4 v[248:251], v1, s[84:87], s88 offen offset:3072 sc1
s_add_u32 s88, s88, s90
ds_read_b64_tr_b16 v[128:129], v216 offset:0
ds_read_b64_tr_b16 v[130:131], v216 offset:1024
ds_read_b64_tr_b16 v[132:133], v217 offset:0
ds_read_b64_tr_b16 v[134:135], v217 offset:1024
ds_read_b64_tr_b16 v[136:137], v218 offset:0
ds_read_b64_tr_b16 v[138:139], v218 offset:1024
ds_read_b64_tr_b16 v[140:141], v219 offset:0
ds_read_b64_tr_b16 v[142:143], v219 offset:1024
ds_read_b64_tr_b16 v[144:145], v216 offset:4096
ds_read_b64_tr_b16 v[146:147], v216 offset:5120
ds_read_b64_tr_b16 v[148:149], v217 offset:4096
ds_read_b64_tr_b16 v[150:151], v217 offset:5120
s_waitcnt vmcnt(40)
s_waitcnt lgkmcnt(8)
v_mfma_f32_16x16x32_bf16 a[0:3], v[128:131], v[16:19], 0
ds_read_b64_tr_b16 v[152:153], v218 offset:4096
v_mfma_f32_16x16x32_bf16 a[4:7], v[128:131], v[72:75], 0
ds_read_b64_tr_b16 v[154:155], v218 offset:5120
v_mfma_f32_16x16x32_bf16 a[8:11], v[132:135], v[16:19], 0
ds_read_b64_tr_b16 v[156:157], v219 offset:4096
v_mfma_f32_16x16x32_bf16 a[12:15], v[132:135], v[72:75], 0
s_waitcnt lgkmcnt(7)
ds_read_b64_tr_b16 v[158:159], v219 offset:5120
v_mfma_f32_16x16x32_bf16 a[16:19], v[136:139], v[16:19], 0
buffer_load_dwordx4 v[40:43], v1, s[12:15], s4 offen
v_mfma_f32_16x16x32_bf16 a[20:23], v[136:139], v[72:75], 0
ds_read_b64_tr_b16 v[160:161], v216 offset:8192
v_mfma_f32_16x16x32_bf16 a[24:27], v[140:143], v[16:19], 0
ds_read_b64_tr_b16 v[162:163], v216 offset:9216
v_mfma_f32_16x16x32_bf16 a[28:31], v[140:143], v[72:75], 0
s_waitcnt lgkmcnt(6)
ds_read_b64_tr_b16 v[164:165], v217 offset:8192
v_mfma_f32_16x16x32_bf16 a[32:35], v[144:147], v[16:19], 0
ds_read_b64_tr_b16 v[166:167], v217 offset:9216
v_mfma_f32_16x16x32_bf16 a[36:39], v[144:147], v[72:75], 0
buffer_load_dwordx4 v[96:99], v1, s[12:15], s5 offen
v_mfma_f32_16x16x32_bf16 a[40:43], v[148:151], v[16:19], 0
ds_read_b64_tr_b16 v[168:169], v218 offset:8192
v_mfma_f32_16x16x32_bf16 a[44:47], v[148:151], v[72:75], 0
s_waitcnt lgkmcnt(5)
ds_read_b64_tr_b16 v[170:171], v218 offset:9216
v_mfma_f32_16x16x32_bf16 a[48:51], v[152:155], v[16:19], 0
ds_read_b64_tr_b16 v[172:173], v219 offset:8192
ds_read_b64_tr_b16 v[174:175], v219 offset:9216
v_mfma_f32_16x16x32_bf16 a[52:55], v[152:155], v[72:75], 0
buffer_load_dwordx4 v[44:47], v1, s[12:15], s4 offen offset:1024
v_mfma_f32_16x16x32_bf16 a[56:59], v[156:159], v[16:19], 0
ds_read_b64_tr_b16 v[176:177], v216 offset:12288
v_mfma_f32_16x16x32_bf16 a[60:63], v[156:159], v[72:75], 0
s_waitcnt lgkmcnt(5)
ds_read_b64_tr_b16 v[178:179], v216 offset:13312
v_mfma_f32_16x16x32_bf16 a[64:67], v[160:163], v[16:19], 0
ds_read_b64_tr_b16 v[180:181], v217 offset:12288
ds_read_b64_tr_b16 v[182:183], v217 offset:13312
v_mfma_f32_16x16x32_bf16 a[68:71], v[160:163], v[72:75], 0
ds_read_b64_tr_b16 v[184:185], v218 offset:12288
v_mfma_f32_16x16x32_bf16 a[72:75], v[164:167], v[16:19], 0
ds_read_b64_tr_b16 v[186:187], v218 offset:13312
v_mfma_f32_16x16x32_bf16 a[76:79], v[164:167], v[72:75], 0
s_waitcnt lgkmcnt(6)
ds_read_b64_tr_b16 v[188:189], v219 offset:12288
v_mfma_f32_16x16x32_bf16 a[80:83], v[168:171], v[16:19], 0
ds_read_b64_tr_b16 v[190:191], v219 offset:13312
buffer_load_dwordx4 v[100:103], v1, s[12:15], s5 offen offset:1024
v_mfma_f32_16x16x32_bf16 a[84:87], v[168:171], v[72:75], 0
s_add_u32 s4, s4, 2048
ds_read_b64_tr_b16 v[128:129], v216 offset:16384
s_add_u32 s5, s5, 2048
v_mfma_f32_16x16x32_bf16 a[88:91], v[172:175], v[16:19], 0
s_add_u32 m0, s39, s27
ds_read_b64_tr_b16 v[130:131], v216 offset:17408
s_add_u32 s31, s38, 262144
v_mfma_f32_16x16x32_bf16 a[92:95], v[172:175], v[72:75], 0
s_waitcnt lgkmcnt(6)
ds_read_b64_tr_b16 v[132:133], v217 offset:16384
v_mfma_f32_16x16x32_bf16 a[96:99], v[176:179], v[16:19], 0
ds_read_b64_tr_b16 v[134:135], v217 offset:17408
v_mfma_f32_16x16x32_bf16 a[100:103], v[176:179], v[72:75], 0
buffer_load_dwordx4 v196, s[76:79], s38 offen lds
v_mfma_f32_16x16x32_bf16 a[104:107], v[180:183], v[16:19], 0
ds_read_b64_tr_b16 v[136:137], v218 offset:16384
v_mfma_f32_16x16x32_bf16 a[108:111], v[180:183], v[72:75], 0
s_waitcnt lgkmcnt(5)
ds_read_b64_tr_b16 v[138:139], v218 offset:17408
v_mfma_f32_16x16x32_bf16 a[112:115], v[184:187], v[16:19], 0
ds_read_b64_tr_b16 v[140:141], v219 offset:16384
ds_read_b64_tr_b16 v[142:143], v219 offset:17408
v_mfma_f32_16x16x32_bf16 a[116:119], v[184:187], v[72:75], 0
buffer_load_dwordx4 v197, s[76:79], s38 offen offset:1024 lds
v_mfma_f32_16x16x32_bf16 a[120:123], v[188:191], v[16:19], 0
ds_read_b64_tr_b16 v[144:145], v216 offset:20480
v_mfma_f32_16x16x32_bf16 a[124:127], v[188:191], v[72:75], 0
s_waitcnt lgkmcnt(5)
ds_read_b64_tr_b16 v[146:147], v216 offset:21504
v_mfma_f32_16x16x32_bf16 a[0:3], v[128:131], v[20:23], a[0:3]
ds_read_b64_tr_b16 v[148:149], v217 offset:20480
ds_read_b64_tr_b16 v[150:151], v217 offset:21504
v_mfma_f32_16x16x32_bf16 a[4:7], v[128:131], v[76:79], a[4:7]
buffer_load_dwordx4 v198, s[76:79], s38 offen offset:2048 lds
v_mfma_f32_16x16x32_bf16 a[8:11], v[132:135], v[20:23], a[8:11]
ds_read_b64_tr_b16 v[152:153], v218 offset:20480
v_mfma_f32_16x16x32_bf16 a[12:15], v[132:135], v[76:79], a[12:15]
s_waitcnt lgkmcnt(5)
ds_read_b64_tr_b16 v[154:155], v218 offset:21504
v_mfma_f32_16x16x32_bf16 a[16:19], v[136:139], v[20:23], a[16:19]
ds_read_b64_tr_b16 v[156:157], v219 offset:20480
ds_read_b64_tr_b16 v[158:159], v219 offset:21504
v_mfma_f32_16x16x32_bf16 a[20:23], v[136:139], v[76:79], a[20:23]
buffer_load_dwordx4 v199, s[76:79], s38 offen offset:3072 lds
v_mfma_f32_16x16x32_bf16 a[24:27], v[140:143], v[20:23], a[24:27]
s_add_u32 m0, m0, 16384
ds_read_b64_tr_b16 v[160:161], v216 offset:24576
s_add_u32 s38, s38, 524288
v_mfma_f32_16x16x32_bf16 a[28:31], v[140:143], v[76:79], a[28:31]
s_waitcnt lgkmcnt(5)
ds_read_b64_tr_b16 v[162:163], v216 offset:25600
v_mfma_f32_16x16x32_bf16 a[32:35], v[144:147], v[20:23], a[32:35]
ds_read_b64_tr_b16 v[164:165], v217 offset:24576
ds_read_b64_tr_b16 v[166:167], v217 offset:25600
v_mfma_f32_16x16x32_bf16 a[36:39], v[144:147], v[76:79], a[36:39]
ds_read_b64_tr_b16 v[168:169], v218 offset:24576
v_mfma_f32_16x16x32_bf16 a[40:43], v[148:151], v[20:23], a[40:43]
ds_read_b64_tr_b16 v[170:171], v218 offset:25600
v_mfma_f32_16x16x32_bf16 a[44:47], v[148:151], v[76:79], a[44:47]
s_waitcnt lgkmcnt(6)
ds_read_b64_tr_b16 v[172:173], v219 offset:24576
v_mfma_f32_16x16x32_bf16 a[48:51], v[152:155], v[20:23], a[48:51]
ds_read_b64_tr_b16 v[174:175], v219 offset:25600
buffer_load_dwordx4 v196, s[76:79], s31 offen lds
v_mfma_f32_16x16x32_bf16 a[52:55], v[152:155], v[76:79], a[52:55]
ds_read_b64_tr_b16 v[176:177], v216 offset:28672
v_mfma_f32_16x16x32_bf16 a[56:59], v[156:159], v[20:23], a[56:59]
ds_read_b64_tr_b16 v[178:179], v216 offset:29696
v_mfma_f32_16x16x32_bf16 a[60:63], v[156:159], v[76:79], a[60:63]
s_waitcnt lgkmcnt(6)
ds_read_b64_tr_b16 v[180:181], v217 offset:28672
v_mfma_f32_16x16x32_bf16 a[64:67], v[160:163], v[20:23], a[64:67]
ds_read_b64_tr_b16 v[182:183], v217 offset:29696
buffer_load_dwordx4 v197, s[76:79], s31 offen offset:1024 lds
v_mfma_f32_16x16x32_bf16 a[68:71], v[160:163], v[76:79], a[68:71]
ds_read_b64_tr_b16 v[184:185], v218 offset:28672
v_mfma_f32_16x16x32_bf16 a[72:75], v[164:167], v[20:23], a[72:75]
ds_read_b64_tr_b16 v[186:187], v218 offset:29696
v_mfma_f32_16x16x32_bf16 a[76:79], v[164:167], v[76:79], a[76:79]
s_waitcnt lgkmcnt(6)
ds_read_b64_tr_b16 v[188:189], v219 offset:28672
v_mfma_f32_16x16x32_bf16 a[80:83], v[168:171], v[20:23], a[80:83]
ds_read_b64_tr_b16 v[190:191], v219 offset:29696
v_mfma_f32_16x16x32_bf16 a[84:87], v[168:171], v[76:79], a[84:87]
buffer_load_dwordx4 v198, s[76:79], s31 offen offset:2048 lds
v_mfma_f32_16x16x32_bf16 a[88:91], v[172:175], v[20:23], a[88:91]
ds_read_b64_tr_b16 v[128:129], v220 offset:0
v_add_u32 v216, s28, v208
v_mfma_f32_16x16x32_bf16 a[92:95], v[172:175], v[76:79], a[92:95]
s_waitcnt lgkmcnt(5)
ds_read_b64_tr_b16 v[130:131], v220 offset:1024
v_add_u32 v217, s28, v209
v_mfma_f32_16x16x32_bf16 a[96:99], v[176:179], v[20:23], a[96:99]
ds_read_b64_tr_b16 v[132:133], v221 offset:0
ds_read_b64_tr_b16 v[134:135], v221 offset:1024
v_mfma_f32_16x16x32_bf16 a[100:103], v[176:179], v[76:79], a[100:103]
buffer_load_dwordx4 v199, s[76:79], s31 offen offset:3072 lds
s_add_u32 s27, s27, 32768
s_cmp_eq_u32 s27, 163840
s_cselect_b32 s27, 0, s27
v_mfma_f32_16x16x32_bf16 a[104:107], v[180:183], v[20:23], a[104:107]
ds_read_b64_tr_b16 v[136:137], v222 offset:0
v_add_u32 v218, s28, v210
v_mfma_f32_16x16x32_bf16 a[108:111], v[180:183], v[76:79], a[108:111]
s_waitcnt vmcnt(40) lgkmcnt(5)
ds_read_b64_tr_b16 v[138:139], v222 offset:1024
v_add_u32 v219, s28, v211
v_mfma_f32_16x16x32_bf16 a[112:115], v[184:187], v[20:23], a[112:115]
s_barrier
ds_read_b64_tr_b16 v[140:141], v223 offset:0
ds_read_b64_tr_b16 v[142:143], v223 offset:1024
v_mfma_f32_16x16x32_bf16 a[116:119], v[184:187], v[76:79], a[116:119]
s_add_u32 s28, s28, 32768
ds_read_b64_tr_b16 v[144:145], v220 offset:4096
s_cmp_eq_u32 s28, 163840
s_cselect_b32 s28, 0, s28
v_mfma_f32_16x16x32_bf16 a[120:123], v[188:191], v[20:23], a[120:123]
ds_read_b64_tr_b16 v[146:147], v220 offset:5120
v_mfma_f32_16x16x32_bf16 a[124:127], v[188:191], v[76:79], a[124:127]
ds_read_b64_tr_b16 v[148:149], v221 offset:4096
ds_read_b64_tr_b16 v[150:151], v221 offset:5120
s_waitcnt lgkmcnt(8)
v_mfma_f32_16x16x32_bf16 a[0:3], v[128:131], v[24:27], a[0:3]
ds_read_b64_tr_b16 v[152:153], v222 offset:4096
v_mfma_f32_16x16x32_bf16 a[4:7], v[128:131], v[80:83], a[4:7]
ds_read_b64_tr_b16 v[154:155], v222 offset:5120
v_mfma_f32_16x16x32_bf16 a[8:11], v[132:135], v[24:27], a[8:11]
ds_read_b64_tr_b16 v[156:157], v223 offset:4096
v_mfma_f32_16x16x32_bf16 a[12:15], v[132:135], v[80:83], a[12:15]
s_waitcnt lgkmcnt(7)
ds_read_b64_tr_b16 v[158:159], v223 offset:5120
v_mfma_f32_16x16x32_bf16 a[16:19], v[136:139], v[24:27], a[16:19]
buffer_load_dwordx4 v[48:51], v1, s[12:15], s4 offen
v_mfma_f32_16x16x32_bf16 a[20:23], v[136:139], v[80:83], a[20:23]
ds_read_b64_tr_b16 v[160:161], v220 offset:8192
v_mfma_f32_16x16x32_bf16 a[24:27], v[140:143], v[24:27], a[24:27]
ds_read_b64_tr_b16 v[162:163], v220 offset:9216
v_mfma_f32_16x16x32_bf16 a[28:31], v[140:143], v[80:83], a[28:31]
s_waitcnt lgkmcnt(6)
ds_read_b64_tr_b16 v[164:165], v221 offset:8192
v_mfma_f32_16x16x32_bf16 a[32:35], v[144:147], v[24:27], a[32:35]
ds_read_b64_tr_b16 v[166:167], v221 offset:9216
v_mfma_f32_16x16x32_bf16 a[36:39], v[144:147], v[80:83], a[36:39]
buffer_load_dwordx4 v[104:107], v1, s[12:15], s5 offen
v_mfma_f32_16x16x32_bf16 a[40:43], v[148:151], v[24:27], a[40:43]
ds_read_b64_tr_b16 v[168:169], v222 offset:8192
v_mfma_f32_16x16x32_bf16 a[44:47], v[148:151], v[80:83], a[44:47]
s_waitcnt lgkmcnt(5)
ds_read_b64_tr_b16 v[170:171], v222 offset:9216
v_mfma_f32_16x16x32_bf16 a[48:51], v[152:155], v[24:27], a[48:51]
ds_read_b64_tr_b16 v[172:173], v223 offset:8192
ds_read_b64_tr_b16 v[174:175], v223 offset:9216
v_mfma_f32_16x16x32_bf16 a[52:55], v[152:155], v[80:83], a[52:55]
buffer_load_dwordx4 v[52:55], v1, s[12:15], s4 offen offset:1024
v_mfma_f32_16x16x32_bf16 a[56:59], v[156:159], v[24:27], a[56:59]
ds_read_b64_tr_b16 v[176:177], v220 offset:12288
v_mfma_f32_16x16x32_bf16 a[60:63], v[156:159], v[80:83], a[60:63]
s_waitcnt lgkmcnt(5)
ds_read_b64_tr_b16 v[178:179], v220 offset:13312
v_mfma_f32_16x16x32_bf16 a[64:67], v[160:163], v[24:27], a[64:67]
ds_read_b64_tr_b16 v[180:181], v221 offset:12288
ds_read_b64_tr_b16 v[182:183], v221 offset:13312
v_mfma_f32_16x16x32_bf16 a[68:71], v[160:163], v[80:83], a[68:71]
ds_read_b64_tr_b16 v[184:185], v222 offset:12288
v_mfma_f32_16x16x32_bf16 a[72:75], v[164:167], v[24:27], a[72:75]
ds_read_b64_tr_b16 v[186:187], v222 offset:13312
v_mfma_f32_16x16x32_bf16 a[76:79], v[164:167], v[80:83], a[76:79]
s_waitcnt lgkmcnt(6)
ds_read_b64_tr_b16 v[188:189], v223 offset:12288
v_mfma_f32_16x16x32_bf16 a[80:83], v[168:171], v[24:27], a[80:83]
ds_read_b64_tr_b16 v[190:191], v223 offset:13312
buffer_load_dwordx4 v[108:111], v1, s[12:15], s5 offen offset:1024
v_mfma_f32_16x16x32_bf16 a[84:87], v[168:171], v[80:83], a[84:87]
s_add_u32 s4, s4, 2048
ds_read_b64_tr_b16 v[128:129], v220 offset:16384
s_add_u32 s5, s5, 2048
v_mfma_f32_16x16x32_bf16 a[88:91], v[172:175], v[24:27], a[88:91]
s_add_u32 m0, s39, s27
ds_read_b64_tr_b16 v[130:131], v220 offset:17408
s_add_u32 s31, s38, 262144
v_mfma_f32_16x16x32_bf16 a[92:95], v[172:175], v[80:83], a[92:95]
s_waitcnt lgkmcnt(6)
ds_read_b64_tr_b16 v[132:133], v221 offset:16384
v_mfma_f32_16x16x32_bf16 a[96:99], v[176:179], v[24:27], a[96:99]
ds_read_b64_tr_b16 v[134:135], v221 offset:17408
v_mfma_f32_16x16x32_bf16 a[100:103], v[176:179], v[80:83], a[100:103]
buffer_load_dwordx4 v196, s[76:79], s38 offen lds
v_mfma_f32_16x16x32_bf16 a[104:107], v[180:183], v[24:27], a[104:107]
ds_read_b64_tr_b16 v[136:137], v222 offset:16384
v_mfma_f32_16x16x32_bf16 a[108:111], v[180:183], v[80:83], a[108:111]
s_waitcnt lgkmcnt(5)
ds_read_b64_tr_b16 v[138:139], v222 offset:17408
v_mfma_f32_16x16x32_bf16 a[112:115], v[184:187], v[24:27], a[112:115]
ds_read_b64_tr_b16 v[140:141], v223 offset:16384
ds_read_b64_tr_b16 v[142:143], v223 offset:17408
v_mfma_f32_16x16x32_bf16 a[116:119], v[184:187], v[80:83], a[116:119]
buffer_load_dwordx4 v197, s[76:79], s38 offen offset:1024 lds
v_mfma_f32_16x16x32_bf16 a[120:123], v[188:191], v[24:27], a[120:123]
ds_read_b64_tr_b16 v[144:145], v220 offset:20480
v_mfma_f32_16x16x32_bf16 a[124:127], v[188:191], v[80:83], a[124:127]
s_waitcnt lgkmcnt(5)
ds_read_b64_tr_b16 v[146:147], v220 offset:21504
v_mfma_f32_16x16x32_bf16 a[0:3], v[128:131], v[28:31], a[0:3]
ds_read_b64_tr_b16 v[148:149], v221 offset:20480
ds_read_b64_tr_b16 v[150:151], v221 offset:21504
v_mfma_f32_16x16x32_bf16 a[4:7], v[128:131], v[84:87], a[4:7]
buffer_load_dwordx4 v198, s[76:79], s38 offen offset:2048 lds
v_mfma_f32_16x16x32_bf16 a[8:11], v[132:135], v[28:31], a[8:11]
ds_read_b64_tr_b16 v[152:153], v222 offset:20480
v_mfma_f32_16x16x32_bf16 a[12:15], v[132:135], v[84:87], a[12:15]
s_waitcnt lgkmcnt(5)
ds_read_b64_tr_b16 v[154:155], v222 offset:21504
v_mfma_f32_16x16x32_bf16 a[16:19], v[136:139], v[28:31], a[16:19]
ds_read_b64_tr_b16 v[156:157], v223 offset:20480
ds_read_b64_tr_b16 v[158:159], v223 offset:21504
v_mfma_f32_16x16x32_bf16 a[20:23], v[136:139], v[84:87], a[20:23]
buffer_load_dwordx4 v199, s[76:79], s38 offen offset:3072 lds
v_mfma_f32_16x16x32_bf16 a[24:27], v[140:143], v[28:31], a[24:27]
s_add_u32 m0, m0, 16384
ds_read_b64_tr_b16 v[160:161], v220 offset:24576
s_add_u32 s38, s38, 524288
v_mfma_f32_16x16x32_bf16 a[28:31], v[140:143], v[84:87], a[28:31]
s_waitcnt lgkmcnt(5)
ds_read_b64_tr_b16 v[162:163], v220 offset:25600
v_mfma_f32_16x16x32_bf16 a[32:35], v[144:147], v[28:31], a[32:35]
ds_read_b64_tr_b16 v[164:165], v221 offset:24576
ds_read_b64_tr_b16 v[166:167], v221 offset:25600
v_mfma_f32_16x16x32_bf16 a[36:39], v[144:147], v[84:87], a[36:39]
ds_read_b64_tr_b16 v[168:169], v222 offset:24576
v_mfma_f32_16x16x32_bf16 a[40:43], v[148:151], v[28:31], a[40:43]
ds_read_b64_tr_b16 v[170:171], v222 offset:25600
v_mfma_f32_16x16x32_bf16 a[44:47], v[148:151], v[84:87], a[44:47]
s_waitcnt lgkmcnt(6)
ds_read_b64_tr_b16 v[172:173], v223 offset:24576
v_mfma_f32_16x16x32_bf16 a[48:51], v[152:155], v[28:31], a[48:51]
ds_read_b64_tr_b16 v[174:175], v223 offset:25600
buffer_load_dwordx4 v196, s[76:79], s31 offen lds
v_mfma_f32_16x16x32_bf16 a[52:55], v[152:155], v[84:87], a[52:55]
ds_read_b64_tr_b16 v[176:177], v220 offset:28672
v_mfma_f32_16x16x32_bf16 a[56:59], v[156:159], v[28:31], a[56:59]
ds_read_b64_tr_b16 v[178:179], v220 offset:29696
v_mfma_f32_16x16x32_bf16 a[60:63], v[156:159], v[84:87], a[60:63]
s_waitcnt lgkmcnt(6)
ds_read_b64_tr_b16 v[180:181], v221 offset:28672
v_mfma_f32_16x16x32_bf16 a[64:67], v[160:163], v[28:31], a[64:67]
ds_read_b64_tr_b16 v[182:183], v221 offset:29696
buffer_load_dwordx4 v197, s[76:79], s31 offen offset:1024 lds
v_mfma_f32_16x16x32_bf16 a[68:71], v[160:163], v[84:87], a[68:71]
ds_read_b64_tr_b16 v[184:185], v222 offset:28672
v_mfma_f32_16x16x32_bf16 a[72:75], v[164:167], v[28:31], a[72:75]
ds_read_b64_tr_b16 v[186:187], v222 offset:29696
v_mfma_f32_16x16x32_bf16 a[76:79], v[164:167], v[84:87], a[76:79]
s_waitcnt lgkmcnt(6)
ds_read_b64_tr_b16 v[188:189], v223 offset:28672
v_mfma_f32_16x16x32_bf16 a[80:83], v[168:171], v[28:31], a[80:83]
ds_read_b64_tr_b16 v[190:191], v223 offset:29696
v_mfma_f32_16x16x32_bf16 a[84:87], v[168:171], v[84:87], a[84:87]
buffer_load_dwordx4 v198, s[76:79], s31 offen offset:2048 lds
v_mfma_f32_16x16x32_bf16 a[88:91], v[172:175], v[28:31], a[88:91]
ds_read_b64_tr_b16 v[128:129], v216 offset:0
v_add_u32 v220, s28, v208
v_mfma_f32_16x16x32_bf16 a[92:95], v[172:175], v[84:87], a[92:95]
s_waitcnt lgkmcnt(5)
ds_read_b64_tr_b16 v[130:131], v216 offset:1024
v_add_u32 v221, s28, v209
v_mfma_f32_16x16x32_bf16 a[96:99], v[176:179], v[28:31], a[96:99]
ds_read_b64_tr_b16 v[132:133], v217 offset:0
ds_read_b64_tr_b16 v[134:135], v217 offset:1024
v_mfma_f32_16x16x32_bf16 a[100:103], v[176:179], v[84:87], a[100:103]
buffer_load_dwordx4 v199, s[76:79], s31 offen offset:3072 lds
s_add_u32 s27, s27, 32768
s_cmp_eq_u32 s27, 163840
s_cselect_b32 s27, 0, s27
v_mfma_f32_16x16x32_bf16 a[104:107], v[180:183], v[28:31], a[104:107]
ds_read_b64_tr_b16 v[136:137], v218 offset:0
v_add_u32 v222, s28, v210
v_mfma_f32_16x16x32_bf16 a[108:111], v[180:183], v[84:87], a[108:111]
s_waitcnt vmcnt(40) lgkmcnt(5)
ds_read_b64_tr_b16 v[138:139], v218 offset:1024
v_add_u32 v223, s28, v211
v_mfma_f32_16x16x32_bf16 a[112:115], v[184:187], v[28:31], a[112:115]
s_barrier
ds_read_b64_tr_b16 v[140:141], v219 offset:0
ds_read_b64_tr_b16 v[142:143], v219 offset:1024
v_mfma_f32_16x16x32_bf16 a[116:119], v[184:187], v[84:87], a[116:119]
s_add_u32 s28, s28, 32768
ds_read_b64_tr_b16 v[144:145], v216 offset:4096
s_cmp_eq_u32 s28, 163840
s_cselect_b32 s28, 0, s28
v_mfma_f32_16x16x32_bf16 a[120:123], v[188:191], v[28:31], a[120:123]
ds_read_b64_tr_b16 v[146:147], v216 offset:5120
v_mfma_f32_16x16x32_bf16 a[124:127], v[188:191], v[84:87], a[124:127]
ds_read_b64_tr_b16 v[148:149], v217 offset:4096
ds_read_b64_tr_b16 v[150:151], v217 offset:5120
s_waitcnt lgkmcnt(8)
v_mfma_f32_16x16x32_bf16 a[0:3], v[128:131], v[32:35], a[0:3]
ds_read_b64_tr_b16 v[152:153], v218 offset:4096
v_mfma_f32_16x16x32_bf16 a[4:7], v[128:131], v[88:91], a[4:7]
ds_read_b64_tr_b16 v[154:155], v218 offset:5120
v_mfma_f32_16x16x32_bf16 a[8:11], v[132:135], v[32:35], a[8:11]
ds_read_b64_tr_b16 v[156:157], v219 offset:4096
v_accvgpr_read_b32 v224, a128
v_mfma_f32_16x16x32_bf16 a[12:15], v[132:135], v[88:91], a[12:15]
s_waitcnt lgkmcnt(7)
ds_read_b64_tr_b16 v[158:159], v219 offset:5120
v_accvgpr_read_b32 v225, a129
v_mfma_f32_16x16x32_bf16 a[16:19], v[136:139], v[32:35], a[16:19]
buffer_load_dwordx4 v[56:59], v1, s[12:15], s4 offen
v_mfma_f32_16x16x32_bf16 a[20:23], v[136:139], v[88:91], a[20:23]
ds_read_b64_tr_b16 v[160:161], v216 offset:8192
v_accvgpr_read_b32 v226, a130
v_mfma_f32_16x16x32_bf16 a[24:27], v[140:143], v[32:35], a[24:27]
ds_read_b64_tr_b16 v[162:163], v216 offset:9216
v_accvgpr_read_b32 v227, a131
v_mfma_f32_16x16x32_bf16 a[28:31], v[140:143], v[88:91], a[28:31]
s_waitcnt lgkmcnt(6)
ds_read_b64_tr_b16 v[164:165], v217 offset:8192
v_accvgpr_read_b32 v228, a132
v_mfma_f32_16x16x32_bf16 a[32:35], v[144:147], v[32:35], a[32:35]
ds_read_b64_tr_b16 v[166:167], v217 offset:9216
v_accvgpr_read_b32 v229, a133
v_mfma_f32_16x16x32_bf16 a[36:39], v[144:147], v[88:91], a[36:39]
buffer_load_dwordx4 v[112:115], v1, s[12:15], s5 offen
v_mfma_f32_16x16x32_bf16 a[40:43], v[148:151], v[32:35], a[40:43]
ds_read_b64_tr_b16 v[168:169], v218 offset:8192
v_accvgpr_read_b32 v230, a134
v_mfma_f32_16x16x32_bf16 a[44:47], v[148:151], v[88:91], a[44:47]
s_waitcnt lgkmcnt(5)
ds_read_b64_tr_b16 v[170:171], v218 offset:9216
v_accvgpr_read_b32 v231, a135
v_mfma_f32_16x16x32_bf16 a[48:51], v[152:155], v[32:35], a[48:51]
ds_read_b64_tr_b16 v[172:173], v219 offset:8192
ds_read_b64_tr_b16 v[174:175], v219 offset:9216
v_mfma_f32_16x16x32_bf16 a[52:55], v[152:155], v[88:91], a[52:55]
buffer_load_dwordx4 v[60:63], v1, s[12:15], s4 offen offset:1024
v_mfma_f32_16x16x32_bf16 a[56:59], v[156:159], v[32:35], a[56:59]
v_cvt_pk_bf16_f32 v224, v224, v225
v_cvt_pk_bf16_f32 v225, v226, v227
v_mfma_f32_16x16x32_bf16 a[60:63], v[156:159], v[88:91], a[60:63]
s_waitcnt lgkmcnt(4)
ds_read_b64_tr_b16 v[176:177], v216 offset:12288
v_cvt_pk_bf16_f32 v226, v228, v229
v_mfma_f32_16x16x32_bf16 a[64:67], v[160:163], v[32:35], a[64:67]
ds_read_b64_tr_b16 v[178:179], v216 offset:13312
ds_read_b64_tr_b16 v[180:181], v217 offset:12288
ds_read_b64_tr_b16 v[182:183], v217 offset:13312
buffer_load_dwordx4 v[116:119], v1, s[12:15], s5 offen offset:1024
v_mfma_f32_16x16x32_bf16 a[68:71], v[160:163], v[88:91], a[68:71]
s_add_u32 s4, s4, 2048
v_cvt_pk_bf16_f32 v227, v230, v231
s_add_u32 s5, s5, 2048
v_mfma_f32_16x16x32_bf16 a[72:75], v[164:167], v[32:35], a[72:75]
buffer_store_dwordx4 v[224:227], v1, s[84:87], s91 offen offset:0 sc1
v_mfma_f32_16x16x32_bf16 a[76:79], v[164:167], v[88:91], a[76:79]
s_waitcnt lgkmcnt(4)
v_accvgpr_read_b32 v232, a136
v_accvgpr_read_b32 v233, a137
v_mfma_f32_16x16x32_bf16 a[80:83], v[168:171], v[32:35], a[80:83]
ds_read_b64_tr_b16 v[184:185], v218 offset:12288
ds_read_b64_tr_b16 v[186:187], v218 offset:13312
ds_read_b64_tr_b16 v[188:189], v219 offset:12288
ds_read_b64_tr_b16 v[190:191], v219 offset:13312
buffer_load_dwordx4 v[64:67], v1, s[12:15], s4 offen
v_mfma_f32_16x16x32_bf16 a[84:87], v[168:171], v[88:91], a[84:87]
v_accvgpr_read_b32 v234, a138
v_accvgpr_read_b32 v235, a139
v_mfma_f32_16x16x32_bf16 a[88:91], v[172:175], v[32:35], a[88:91]
buffer_load_dwordx4 v[120:123], v1, s[12:15], s5 offen
v_mfma_f32_16x16x32_bf16 a[92:95], v[172:175], v[88:91], a[92:95]
s_waitcnt lgkmcnt(4)
v_accvgpr_read_b32 v236, a140
v_accvgpr_read_b32 v237, a141
v_mfma_f32_16x16x32_bf16 a[96:99], v[176:179], v[32:35], a[96:99]
ds_read_b64_tr_b16 v[128:129], v216 offset:16384
ds_read_b64_tr_b16 v[130:131], v216 offset:17408
ds_read_b64_tr_b16 v[132:133], v217 offset:16384
ds_read_b64_tr_b16 v[134:135], v217 offset:17408
v_mfma_f32_16x16x32_bf16 a[100:103], v[176:179], v[88:91], a[100:103]
v_accvgpr_read_b32 v238, a142
v_accvgpr_read_b32 v239, a143
v_mfma_f32_16x16x32_bf16 a[104:107], v[180:183], v[32:35], a[104:107]
buffer_load_dwordx4 v[68:71], v1, s[12:15], s4 offen offset:1024
v_mfma_f32_16x16x32_bf16 a[108:111], v[180:183], v[88:91], a[108:111]
s_waitcnt lgkmcnt(4)
v_cvt_pk_bf16_f32 v232, v232, v233
v_cvt_pk_bf16_f32 v233, v234, v235
v_mfma_f32_16x16x32_bf16 a[112:115], v[184:187], v[32:35], a[112:115]
ds_read_b64_tr_b16 v[136:137], v218 offset:16384
ds_read_b64_tr_b16 v[138:139], v218 offset:17408
ds_read_b64_tr_b16 v[140:141], v219 offset:16384
ds_read_b64_tr_b16 v[142:143], v219 offset:17408
v_mfma_f32_16x16x32_bf16 a[116:119], v[184:187], v[88:91], a[116:119]
v_cvt_pk_bf16_f32 v234, v236, v237
v_cvt_pk_bf16_f32 v235, v238, v239
v_mfma_f32_16x16x32_bf16 a[120:123], v[188:191], v[32:35], a[120:123]
buffer_load_dwordx4 v[124:127], v1, s[12:15], s5 offen offset:1024
v_mfma_f32_16x16x32_bf16 a[124:127], v[188:191], v[88:91], a[124:127]
s_waitcnt lgkmcnt(4)
buffer_store_dwordx4 v[232:235], v1, s[84:87], s91 offen offset:1024 sc1
v_mfma_f32_16x16x32_bf16 a[0:3], v[128:131], v[36:39], a[0:3]
s_add_u32 s4, s4, 2048
ds_read_b64_tr_b16 v[144:145], v216 offset:20480
ds_read_b64_tr_b16 v[146:147], v216 offset:21504
ds_read_b64_tr_b16 v[148:149], v217 offset:20480
ds_read_b64_tr_b16 v[150:151], v217 offset:21504
v_accvgpr_read_b32 v240, a144
v_mfma_f32_16x16x32_bf16 a[4:7], v[128:131], v[92:95], a[4:7]
s_add_u32 s5, s5, 2048
v_accvgpr_read_b32 v241, a145
v_accvgpr_read_b32 v242, a146
v_mfma_f32_16x16x32_bf16 a[8:11], v[132:135], v[36:39], a[8:11]
s_add_u32 m0, s39, s27
s_add_u32 s31, s38, 262144
buffer_load_dwordx4 v196, s[76:79], s38 offen lds
v_mfma_f32_16x16x32_bf16 a[12:15], v[132:135], v[92:95], a[12:15]
s_waitcnt lgkmcnt(4)
v_accvgpr_read_b32 v243, a147
v_accvgpr_read_b32 v244, a148
v_mfma_f32_16x16x32_bf16 a[16:19], v[136:139], v[36:39], a[16:19]
ds_read_b64_tr_b16 v[152:153], v218 offset:20480
ds_read_b64_tr_b16 v[154:155], v218 offset:21504
ds_read_b64_tr_b16 v[156:157], v219 offset:20480
ds_read_b64_tr_b16 v[158:159], v219 offset:21504
v_mfma_f32_16x16x32_bf16 a[20:23], v[136:139], v[92:95], a[20:23]
v_accvgpr_read_b32 v245, a149
v_accvgpr_read_b32 v246, a150
v_mfma_f32_16x16x32_bf16 a[24:27], v[140:143], v[36:39], a[24:27]
buffer_load_dwordx4 v197, s[76:79], s38 offen offset:1024 lds
v_mfma_f32_16x16x32_bf16 a[28:31], v[140:143], v[92:95], a[28:31]
s_waitcnt lgkmcnt(4)
v_accvgpr_read_b32 v247, a151
v_cvt_pk_bf16_f32 v240, v240, v241
v_mfma_f32_16x16x32_bf16 a[32:35], v[144:147], v[36:39], a[32:35]
ds_read_b64_tr_b16 v[160:161], v216 offset:24576
ds_read_b64_tr_b16 v[162:163], v216 offset:25600
ds_read_b64_tr_b16 v[164:165], v217 offset:24576
ds_read_b64_tr_b16 v[166:167], v217 offset:25600
v_mfma_f32_16x16x32_bf16 a[36:39], v[144:147], v[92:95], a[36:39]
buffer_load_dwordx4 v198, s[76:79], s38 offen offset:2048 lds
v_cvt_pk_bf16_f32 v241, v242, v243
v_mfma_f32_16x16x32_bf16 a[40:43], v[148:151], v[36:39], a[40:43]
v_cvt_pk_bf16_f32 v242, v244, v245
v_cvt_pk_bf16_f32 v243, v246, v247
v_mfma_f32_16x16x32_bf16 a[44:47], v[148:151], v[92:95], a[44:47]
s_waitcnt lgkmcnt(4)
ds_read_b64_tr_b16 v[168:169], v218 offset:24576
v_mfma_f32_16x16x32_bf16 a[48:51], v[152:155], v[36:39], a[48:51]
ds_read_b64_tr_b16 v[170:171], v218 offset:25600
ds_read_b64_tr_b16 v[172:173], v219 offset:24576
ds_read_b64_tr_b16 v[174:175], v219 offset:25600
buffer_store_dwordx4 v[240:243], v1, s[84:87], s91 offen offset:2048 sc1
v_mfma_f32_16x16x32_bf16 a[52:55], v[152:155], v[92:95], a[52:55]
buffer_load_dwordx4 v199, s[76:79], s38 offen offset:3072 lds
v_accvgpr_read_b32 v248, a152
v_mfma_f32_16x16x32_bf16 a[56:59], v[156:159], v[36:39], a[56:59]
s_add_u32 m0, m0, 16384
v_accvgpr_read_b32 v249, a153
v_accvgpr_read_b32 v250, a154
v_mfma_f32_16x16x32_bf16 a[60:63], v[156:159], v[92:95], a[60:63]
s_waitcnt lgkmcnt(4)
ds_read_b64_tr_b16 v[176:177], v216 offset:28672
v_accvgpr_read_b32 v251, a155
v_mfma_f32_16x16x32_bf16 a[64:67], v[160:163], v[36:39], a[64:67]
s_add_u32 s38, s38, 524288
ds_read_b64_tr_b16 v[178:179], v216 offset:29696
ds_read_b64_tr_b16 v[180:181], v217 offset:28672
ds_read_b64_tr_b16 v[182:183], v217 offset:29696
buffer_load_dwordx4 v196, s[76:79], s31 offen lds
v_mfma_f32_16x16x32_bf16 a[68:71], v[160:163], v[92:95], a[68:71]
v_accvgpr_read_b32 v252, a156
v_accvgpr_read_b32 v253, a157
v_mfma_f32_16x16x32_bf16 a[72:75], v[164:167], v[36:39], a[72:75]
ds_read_b64_tr_b16 v[184:185], v218 offset:28672
v_accvgpr_read_b32 v254, a158
v_mfma_f32_16x16x32_bf16 a[76:79], v[164:167], v[92:95], a[76:79]
s_waitcnt lgkmcnt(5)
ds_read_b64_tr_b16 v[186:187], v218 offset:29696
v_accvgpr_read_b32 v255, a159
v_mfma_f32_16x16x32_bf16 a[80:83], v[168:171], v[36:39], a[80:83]
ds_read_b64_tr_b16 v[188:189], v219 offset:28672
ds_read_b64_tr_b16 v[190:191], v219 offset:29696
buffer_load_dwordx4 v197, s[76:79], s31 offen offset:1024 lds
v_mfma_f32_16x16x32_bf16 a[84:87], v[168:171], v[92:95], a[84:87]
v_cvt_pk_bf16_f32 v248, v248, v249
v_cvt_pk_bf16_f32 v249, v250, v251
v_mfma_f32_16x16x32_bf16 a[88:91], v[172:175], v[36:39], a[88:91]
buffer_load_dwordx4 v198, s[76:79], s31 offen offset:2048 lds
v_mfma_f32_16x16x32_bf16 a[92:95], v[172:175], v[92:95], a[92:95]
s_waitcnt lgkmcnt(4)
v_cvt_pk_bf16_f32 v250, v252, v253
v_cvt_pk_bf16_f32 v251, v254, v255
v_mfma_f32_16x16x32_bf16 a[96:99], v[176:179], v[36:39], a[96:99]
ds_read_b64_tr_b16 v[128:129], v220 offset:0
ds_read_b64_tr_b16 v[130:131], v220 offset:1024
ds_read_b64_tr_b16 v[132:133], v221 offset:0
ds_read_b64_tr_b16 v[134:135], v221 offset:1024
v_mfma_f32_16x16x32_bf16 a[100:103], v[176:179], v[92:95], a[100:103]
buffer_load_dwordx4 v199, s[76:79], s31 offen offset:3072 lds
s_add_u32 s27, s27, 32768
s_cmp_eq_u32 s27, 163840
s_cselect_b32 s27, 0, s27
buffer_store_dwordx4 v[248:251], v1, s[84:87], s91 offen offset:3072 sc1
s_add_u32 s91, s91, s89
v_mfma_f32_16x16x32_bf16 a[104:107], v[180:183], v[36:39], a[104:107]
ds_read_b64_tr_b16 v[136:137], v222 offset:0
v_add_u32 v216, s28, v208
v_mfma_f32_16x16x32_bf16 a[108:111], v[180:183], v[92:95], a[108:111]
s_waitcnt vmcnt(28) lgkmcnt(5)
ds_read_b64_tr_b16 v[138:139], v222 offset:1024
v_add_u32 v217, s28, v209
v_mfma_f32_16x16x32_bf16 a[112:115], v[184:187], v[36:39], a[112:115]
s_barrier
ds_read_b64_tr_b16 v[140:141], v223 offset:0
ds_read_b64_tr_b16 v[142:143], v223 offset:1024
v_mfma_f32_16x16x32_bf16 a[116:119], v[184:187], v[92:95], a[116:119]
ds_read_b64_tr_b16 v[144:145], v220 offset:4096
v_add_u32 v218, s28, v210
v_mfma_f32_16x16x32_bf16 a[120:123], v[188:191], v[36:39], a[120:123]
v_add_u32 v219, s28, v211
s_add_u32 s28, s28, 32768
s_cmp_eq_u32 s28, 163840
s_cselect_b32 s28, 0, s28
v_mfma_f32_16x16x32_bf16 a[124:127], v[188:191], v[92:95], a[124:127]
ds_read_b64_tr_b16 v[146:147], v220 offset:5120
ds_read_b64_tr_b16 v[148:149], v221 offset:4096
ds_read_b64_tr_b16 v[150:151], v221 offset:5120
s_waitcnt lgkmcnt(8)
v_mfma_f32_16x16x32_bf16 a[0:3], v[128:131], v[40:43], a[0:3]
ds_read_b64_tr_b16 v[152:153], v222 offset:4096
v_mfma_f32_16x16x32_bf16 a[4:7], v[128:131], v[96:99], a[4:7]
ds_read_b64_tr_b16 v[154:155], v222 offset:5120
v_mfma_f32_16x16x32_bf16 a[8:11], v[132:135], v[40:43], a[8:11]
ds_read_b64_tr_b16 v[156:157], v223 offset:4096
v_accvgpr_read_b32 v224, a160
v_mfma_f32_16x16x32_bf16 a[12:15], v[132:135], v[96:99], a[12:15]
s_waitcnt lgkmcnt(7)
ds_read_b64_tr_b16 v[158:159], v223 offset:5120
v_accvgpr_read_b32 v225, a161
v_mfma_f32_16x16x32_bf16 a[16:19], v[136:139], v[40:43], a[16:19]
ds_read_b64_tr_b16 v[160:161], v220 offset:8192
v_accvgpr_read_b32 v226, a162
v_mfma_f32_16x16x32_bf16 a[20:23], v[136:139], v[96:99], a[20:23]
ds_read_b64_tr_b16 v[162:163], v220 offset:9216
v_accvgpr_read_b32 v227, a163
v_mfma_f32_16x16x32_bf16 a[24:27], v[140:143], v[40:43], a[24:27]
ds_read_b64_tr_b16 v[164:165], v221 offset:8192
v_accvgpr_read_b32 v228, a164
v_mfma_f32_16x16x32_bf16 a[28:31], v[140:143], v[96:99], a[28:31]
s_waitcnt lgkmcnt(7)
ds_read_b64_tr_b16 v[166:167], v221 offset:9216
v_accvgpr_read_b32 v229, a165
v_mfma_f32_16x16x32_bf16 a[32:35], v[144:147], v[40:43], a[32:35]
ds_read_b64_tr_b16 v[168:169], v222 offset:8192
v_accvgpr_read_b32 v230, a166
v_mfma_f32_16x16x32_bf16 a[36:39], v[144:147], v[96:99], a[36:39]
ds_read_b64_tr_b16 v[170:171], v222 offset:9216
v_accvgpr_read_b32 v231, a167
v_mfma_f32_16x16x32_bf16 a[40:43], v[148:151], v[40:43], a[40:43]
ds_read_b64_tr_b16 v[172:173], v223 offset:8192
v_cvt_pk_bf16_f32 v224, v224, v225
v_mfma_f32_16x16x32_bf16 a[44:47], v[148:151], v[96:99], a[44:47]
s_waitcnt lgkmcnt(7)
v_cvt_pk_bf16_f32 v225, v226, v227
v_cvt_pk_bf16_f32 v226, v228, v229
v_mfma_f32_16x16x32_bf16 a[48:51], v[152:155], v[40:43], a[48:51]
ds_read_b64_tr_b16 v[174:175], v223 offset:9216
v_cvt_pk_bf16_f32 v227, v230, v231
v_mfma_f32_16x16x32_bf16 a[52:55], v[152:155], v[96:99], a[52:55]
buffer_store_dwordx4 v[224:227], v1, s[84:87], s91 offen offset:0 sc1
v_mfma_f32_16x16x32_bf16 a[56:59], v[156:159], v[40:43], a[56:59]
v_accvgpr_read_b32 v232, a168
v_accvgpr_read_b32 v233, a169
v_mfma_f32_16x16x32_bf16 a[60:63], v[156:159], v[96:99], a[60:63]
s_waitcnt lgkmcnt(4)
v_accvgpr_read_b32 v234, a170
v_accvgpr_read_b32 v235, a171
v_mfma_f32_16x16x32_bf16 a[64:67], v[160:163], v[40:43], a[64:67]
ds_read_b64_tr_b16 v[176:177], v220 offset:12288
ds_read_b64_tr_b16 v[178:179], v220 offset:13312
ds_read_b64_tr_b16 v[180:181], v221 offset:12288
ds_read_b64_tr_b16 v[182:183], v221 offset:13312
v_mfma_f32_16x16x32_bf16 a[68:71], v[160:163], v[96:99], a[68:71]
v_accvgpr_read_b32 v236, a172
v_accvgpr_read_b32 v237, a173
v_mfma_f32_16x16x32_bf16 a[72:75], v[164:167], v[40:43], a[72:75]
v_accvgpr_read_b32 v238, a174
v_accvgpr_read_b32 v239, a175
v_mfma_f32_16x16x32_bf16 a[76:79], v[164:167], v[96:99], a[76:79]
s_waitcnt lgkmcnt(4)
ds_read_b64_tr_b16 v[184:185], v222 offset:12288
v_cvt_pk_bf16_f32 v232, v232, v233
v_mfma_f32_16x16x32_bf16 a[80:83], v[168:171], v[40:43], a[80:83]
ds_read_b64_tr_b16 v[186:187], v222 offset:13312
ds_read_b64_tr_b16 v[188:189], v223 offset:12288
ds_read_b64_tr_b16 v[190:191], v223 offset:13312
v_cvt_pk_bf16_f32 v233, v234, v235
v_mfma_f32_16x16x32_bf16 a[84:87], v[168:171], v[96:99], a[84:87]
v_cvt_pk_bf16_f32 v234, v236, v237
v_cvt_pk_bf16_f32 v235, v238, v239
v_mfma_f32_16x16x32_bf16 a[88:91], v[172:175], v[40:43], a[88:91]
buffer_store_dwordx4 v[232:235], v1, s[84:87], s91 offen offset:1024 sc1
v_mfma_f32_16x16x32_bf16 a[92:95], v[172:175], v[96:99], a[92:95]
s_waitcnt lgkmcnt(4)
v_accvgpr_read_b32 v240, a176
v_accvgpr_read_b32 v241, a177
v_mfma_f32_16x16x32_bf16 a[96:99], v[176:179], v[40:43], a[96:99]
ds_read_b64_tr_b16 v[128:129], v220 offset:16384
ds_read_b64_tr_b16 v[130:131], v220 offset:17408
ds_read_b64_tr_b16 v[132:133], v221 offset:16384
ds_read_b64_tr_b16 v[134:135], v221 offset:17408
v_accvgpr_read_b32 v242, a178
v_mfma_f32_16x16x32_bf16 a[100:103], v[176:179], v[96:99], a[100:103]
v_accvgpr_read_b32 v243, a179
v_accvgpr_read_b32 v244, a180
v_mfma_f32_16x16x32_bf16 a[104:107], v[180:183], v[40:43], a[104:107]
v_accvgpr_read_b32 v245, a181
v_accvgpr_read_b32 v246, a182
v_mfma_f32_16x16x32_bf16 a[108:111], v[180:183], v[96:99], a[108:111]
s_waitcnt lgkmcnt(4)
ds_read_b64_tr_b16 v[136:137], v222 offset:16384
v_accvgpr_read_b32 v247, a183
v_mfma_f32_16x16x32_bf16 a[112:115], v[184:187], v[40:43], a[112:115]
ds_read_b64_tr_b16 v[138:139], v222 offset:17408
ds_read_b64_tr_b16 v[140:141], v223 offset:16384
ds_read_b64_tr_b16 v[142:143], v223 offset:17408
v_cvt_pk_bf16_f32 v240, v240, v241
v_mfma_f32_16x16x32_bf16 a[116:119], v[184:187], v[96:99], a[116:119]
v_cvt_pk_bf16_f32 v241, v242, v243
v_cvt_pk_bf16_f32 v242, v244, v245
v_mfma_f32_16x16x32_bf16 a[120:123], v[188:191], v[40:43], a[120:123]
v_cvt_pk_bf16_f32 v243, v246, v247
v_mfma_f32_16x16x32_bf16 a[124:127], v[188:191], v[96:99], a[124:127]
s_waitcnt lgkmcnt(4)
buffer_store_dwordx4 v[240:243], v1, s[84:87], s91 offen offset:2048 sc1
v_mfma_f32_16x16x32_bf16 a[0:3], v[128:131], v[44:47], a[0:3]
ds_read_b64_tr_b16 v[144:145], v220 offset:20480
ds_read_b64_tr_b16 v[146:147], v220 offset:21504
ds_read_b64_tr_b16 v[148:149], v221 offset:20480
ds_read_b64_tr_b16 v[150:151], v221 offset:21504
v_accvgpr_read_b32 v248, a184
v_mfma_f32_16x16x32_bf16 a[4:7], v[128:131], v[100:103], a[4:7]
v_accvgpr_read_b32 v249, a185
v_accvgpr_read_b32 v250, a186
v_mfma_f32_16x16x32_bf16 a[8:11], v[132:135], v[44:47], a[8:11]
v_accvgpr_read_b32 v251, a187
v_accvgpr_read_b32 v252, a188
v_mfma_f32_16x16x32_bf16 a[12:15], v[132:135], v[100:103], a[12:15]
s_waitcnt lgkmcnt(4)
v_accvgpr_read_b32 v253, a189
v_accvgpr_read_b32 v254, a190
v_mfma_f32_16x16x32_bf16 a[16:19], v[136:139], v[44:47], a[16:19]
ds_read_b64_tr_b16 v[152:153], v222 offset:20480
ds_read_b64_tr_b16 v[154:155], v222 offset:21504
ds_read_b64_tr_b16 v[156:157], v223 offset:20480
ds_read_b64_tr_b16 v[158:159], v223 offset:21504
v_mfma_f32_16x16x32_bf16 a[20:23], v[136:139], v[100:103], a[20:23]
v_accvgpr_read_b32 v255, a191
v_cvt_pk_bf16_f32 v248, v248, v249
v_mfma_f32_16x16x32_bf16 a[24:27], v[140:143], v[44:47], a[24:27]
v_cvt_pk_bf16_f32 v249, v250, v251
v_cvt_pk_bf16_f32 v250, v252, v253
v_mfma_f32_16x16x32_bf16 a[28:31], v[140:143], v[100:103], a[28:31]
s_waitcnt lgkmcnt(4)
v_cvt_pk_bf16_f32 v251, v254, v255
v_mfma_f32_16x16x32_bf16 a[32:35], v[144:147], v[44:47], a[32:35]
ds_read_b64_tr_b16 v[160:161], v220 offset:24576
ds_read_b64_tr_b16 v[162:163], v220 offset:25600
ds_read_b64_tr_b16 v[164:165], v221 offset:24576
ds_read_b64_tr_b16 v[166:167], v221 offset:25600
buffer_store_dwordx4 v[248:251], v1, s[84:87], s91 offen offset:3072 sc1
v_mfma_f32_16x16x32_bf16 a[36:39], v[144:147], v[100:103], a[36:39]
s_add_u32 s91, s91, s90
v_accvgpr_read_b32 v224, a192
v_accvgpr_read_b32 v225, a193
v_mfma_f32_16x16x32_bf16 a[40:43], v[148:151], v[44:47], a[40:43]
ds_read_b64_tr_b16 v[168:169], v222 offset:24576
v_accvgpr_read_b32 v226, a194
v_mfma_f32_16x16x32_bf16 a[44:47], v[148:151], v[100:103], a[44:47]
s_waitcnt lgkmcnt(5)
v_accvgpr_read_b32 v227, a195
v_accvgpr_read_b32 v228, a196
v_mfma_f32_16x16x32_bf16 a[48:51], v[152:155], v[44:47], a[48:51]
ds_read_b64_tr_b16 v[170:171], v222 offset:25600
ds_read_b64_tr_b16 v[172:173], v223 offset:24576
ds_read_b64_tr_b16 v[174:175], v223 offset:25600
v_mfma_f32_16x16x32_bf16 a[52:55], v[152:155], v[100:103], a[52:55]
v_accvgpr_read_b32 v229, a197
v_accvgpr_read_b32 v230, a198
v_mfma_f32_16x16x32_bf16 a[56:59], v[156:159], v[44:47], a[56:59]
v_accvgpr_read_b32 v231, a199
v_cvt_pk_bf16_f32 v224, v224, v225
v_mfma_f32_16x16x32_bf16 a[60:63], v[156:159], v[100:103], a[60:63]
s_waitcnt lgkmcnt(4)
ds_read_b64_tr_b16 v[176:177], v220 offset:28672
v_cvt_pk_bf16_f32 v225, v226, v227
v_mfma_f32_16x16x32_bf16 a[64:67], v[160:163], v[44:47], a[64:67]
ds_read_b64_tr_b16 v[178:179], v220 offset:29696
ds_read_b64_tr_b16 v[180:181], v221 offset:28672
ds_read_b64_tr_b16 v[182:183], v221 offset:29696
v_cvt_pk_bf16_f32 v226, v228, v229
v_mfma_f32_16x16x32_bf16 a[68:71], v[160:163], v[100:103], a[68:71]
v_cvt_pk_bf16_f32 v227, v230, v231
v_mfma_f32_16x16x32_bf16 a[72:75], v[164:167], v[44:47], a[72:75]
buffer_store_dwordx4 v[224:227], v1, s[84:87], s91 offen offset:0 sc1
v_accvgpr_read_b32 v232, a200
v_mfma_f32_16x16x32_bf16 a[76:79], v[164:167], v[100:103], a[76:79]
s_waitcnt lgkmcnt(4)
v_accvgpr_read_b32 v233, a201
v_accvgpr_read_b32 v234, a202
v_mfma_f32_16x16x32_bf16 a[80:83], v[168:171], v[44:47], a[80:83]
ds_read_b64_tr_b16 v[184:185], v222 offset:28672
ds_read_b64_tr_b16 v[186:187], v222 offset:29696
ds_read_b64_tr_b16 v[188:189], v223 offset:28672
ds_read_b64_tr_b16 v[190:191], v223 offset:29696
v_accvgpr_read_b32 v235, a203
v_mfma_f32_16x16x32_bf16 a[84:87], v[168:171], v[100:103], a[84:87]
v_accvgpr_read_b32 v236, a204
v_accvgpr_read_b32 v237, a205
v_mfma_f32_16x16x32_bf16 a[88:91], v[172:175], v[44:47], a[88:91]
v_accvgpr_read_b32 v238, a206
v_accvgpr_read_b32 v239, a207
v_mfma_f32_16x16x32_bf16 a[92:95], v[172:175], v[100:103], a[92:95]
s_waitcnt lgkmcnt(4)
ds_read_b64_tr_b16 v[128:129], v216 offset:0
v_cvt_pk_bf16_f32 v232, v232, v233
v_mfma_f32_16x16x32_bf16 a[96:99], v[176:179], v[44:47], a[96:99]
ds_read_b64_tr_b16 v[130:131], v216 offset:1024
ds_read_b64_tr_b16 v[132:133], v217 offset:0
ds_read_b64_tr_b16 v[134:135], v217 offset:1024
v_cvt_pk_bf16_f32 v233, v234, v235
v_mfma_f32_16x16x32_bf16 a[100:103], v[176:179], v[100:103], a[100:103]
v_cvt_pk_bf16_f32 v234, v236, v237
v_cvt_pk_bf16_f32 v235, v238, v239
buffer_store_dwordx4 v[232:235], v1, s[84:87], s91 offen offset:1024 sc1
v_mfma_f32_16x16x32_bf16 a[104:107], v[180:183], v[44:47], a[104:107]
ds_read_b64_tr_b16 v[136:137], v218 offset:0
v_add_u32 v220, s28, v208
v_mfma_f32_16x16x32_bf16 a[108:111], v[180:183], v[100:103], a[108:111]
s_waitcnt vmcnt(20) lgkmcnt(5)
ds_read_b64_tr_b16 v[138:139], v218 offset:1024
v_add_u32 v221, s28, v209
v_mfma_f32_16x16x32_bf16 a[112:115], v[184:187], v[44:47], a[112:115]
s_barrier
ds_read_b64_tr_b16 v[140:141], v219 offset:0
ds_read_b64_tr_b16 v[142:143], v219 offset:1024
v_mfma_f32_16x16x32_bf16 a[116:119], v[184:187], v[100:103], a[116:119]
ds_read_b64_tr_b16 v[144:145], v216 offset:4096
v_add_u32 v222, s28, v210
v_mfma_f32_16x16x32_bf16 a[120:123], v[188:191], v[44:47], a[120:123]
v_add_u32 v223, s28, v211
s_add_u32 s28, s28, 32768
s_cmp_eq_u32 s28, 163840
s_cselect_b32 s28, 0, s28
v_mfma_f32_16x16x32_bf16 a[124:127], v[188:191], v[100:103], a[124:127]
ds_read_b64_tr_b16 v[146:147], v216 offset:5120
ds_read_b64_tr_b16 v[148:149], v217 offset:4096
ds_read_b64_tr_b16 v[150:151], v217 offset:5120
s_waitcnt lgkmcnt(8)
v_mfma_f32_16x16x32_bf16 a[0:3], v[128:131], v[48:51], a[0:3]
ds_read_b64_tr_b16 v[152:153], v218 offset:4096
v_mfma_f32_16x16x32_bf16 a[4:7], v[128:131], v[104:107], a[4:7]
ds_read_b64_tr_b16 v[154:155], v218 offset:5120
v_mfma_f32_16x16x32_bf16 a[8:11], v[132:135], v[48:51], a[8:11]
ds_read_b64_tr_b16 v[156:157], v219 offset:4096
v_accvgpr_read_b32 v240, a208
v_mfma_f32_16x16x32_bf16 a[12:15], v[132:135], v[104:107], a[12:15]
s_waitcnt lgkmcnt(7)
ds_read_b64_tr_b16 v[158:159], v219 offset:5120
v_accvgpr_read_b32 v241, a209
v_mfma_f32_16x16x32_bf16 a[16:19], v[136:139], v[48:51], a[16:19]
ds_read_b64_tr_b16 v[160:161], v216 offset:8192
v_accvgpr_read_b32 v242, a210
v_mfma_f32_16x16x32_bf16 a[20:23], v[136:139], v[104:107], a[20:23]
ds_read_b64_tr_b16 v[162:163], v216 offset:9216
v_accvgpr_read_b32 v243, a211
v_mfma_f32_16x16x32_bf16 a[24:27], v[140:143], v[48:51], a[24:27]
ds_read_b64_tr_b16 v[164:165], v217 offset:8192
v_accvgpr_read_b32 v244, a212
v_mfma_f32_16x16x32_bf16 a[28:31], v[140:143], v[104:107], a[28:31]
s_waitcnt lgkmcnt(7)
ds_read_b64_tr_b16 v[166:167], v217 offset:9216
v_accvgpr_read_b32 v245, a213
v_mfma_f32_16x16x32_bf16 a[32:35], v[144:147], v[48:51], a[32:35]
ds_read_b64_tr_b16 v[168:169], v218 offset:8192
v_accvgpr_read_b32 v246, a214
v_mfma_f32_16x16x32_bf16 a[36:39], v[144:147], v[104:107], a[36:39]
ds_read_b64_tr_b16 v[170:171], v218 offset:9216
v_accvgpr_read_b32 v247, a215
v_mfma_f32_16x16x32_bf16 a[40:43], v[148:151], v[48:51], a[40:43]
ds_read_b64_tr_b16 v[172:173], v219 offset:8192
v_cvt_pk_bf16_f32 v240, v240, v241
v_mfma_f32_16x16x32_bf16 a[44:47], v[148:151], v[104:107], a[44:47]
s_waitcnt lgkmcnt(7)
v_cvt_pk_bf16_f32 v241, v242, v243
v_cvt_pk_bf16_f32 v242, v244, v245
v_mfma_f32_16x16x32_bf16 a[48:51], v[152:155], v[48:51], a[48:51]
ds_read_b64_tr_b16 v[174:175], v219 offset:9216
v_cvt_pk_bf16_f32 v243, v246, v247
v_mfma_f32_16x16x32_bf16 a[52:55], v[152:155], v[104:107], a[52:55]
buffer_store_dwordx4 v[240:243], v1, s[84:87], s91 offen offset:2048 sc1
v_mfma_f32_16x16x32_bf16 a[56:59], v[156:159], v[48:51], a[56:59]
v_accvgpr_read_b32 v248, a216
v_accvgpr_read_b32 v249, a217
v_mfma_f32_16x16x32_bf16 a[60:63], v[156:159], v[104:107], a[60:63]
s_waitcnt lgkmcnt(4)
v_accvgpr_read_b32 v250, a218
v_accvgpr_read_b32 v251, a219
v_mfma_f32_16x16x32_bf16 a[64:67], v[160:163], v[48:51], a[64:67]
ds_read_b64_tr_b16 v[176:177], v216 offset:12288
ds_read_b64_tr_b16 v[178:179], v216 offset:13312
ds_read_b64_tr_b16 v[180:181], v217 offset:12288
ds_read_b64_tr_b16 v[182:183], v217 offset:13312
v_mfma_f32_16x16x32_bf16 a[68:71], v[160:163], v[104:107], a[68:71]
v_accvgpr_read_b32 v252, a220
v_accvgpr_read_b32 v253, a221
v_mfma_f32_16x16x32_bf16 a[72:75], v[164:167], v[48:51], a[72:75]
v_accvgpr_read_b32 v254, a222
v_accvgpr_read_b32 v255, a223
v_mfma_f32_16x16x32_bf16 a[76:79], v[164:167], v[104:107], a[76:79]
s_waitcnt lgkmcnt(4)
v_cvt_pk_bf16_f32 v248, v248, v249
v_cvt_pk_bf16_f32 v249, v250, v251
v_mfma_f32_16x16x32_bf16 a[80:83], v[168:171], v[48:51], a[80:83]
ds_read_b64_tr_b16 v[184:185], v218 offset:12288
ds_read_b64_tr_b16 v[186:187], v218 offset:13312
ds_read_b64_tr_b16 v[188:189], v219 offset:12288
ds_read_b64_tr_b16 v[190:191], v219 offset:13312
v_mfma_f32_16x16x32_bf16 a[84:87], v[168:171], v[104:107], a[84:87]
v_cvt_pk_bf16_f32 v250, v252, v253
v_cvt_pk_bf16_f32 v251, v254, v255
v_mfma_f32_16x16x32_bf16 a[88:91], v[172:175], v[48:51], a[88:91]
buffer_store_dwordx4 v[248:251], v1, s[84:87], s91 offen offset:3072 sc1
v_mfma_f32_16x16x32_bf16 a[92:95], v[172:175], v[104:107], a[92:95]
s_waitcnt lgkmcnt(4)
s_add_u32 s91, s91, s89
v_accvgpr_read_b32 v224, a224
v_mfma_f32_16x16x32_bf16 a[96:99], v[176:179], v[48:51], a[96:99]
ds_read_b64_tr_b16 v[128:129], v216 offset:16384
ds_read_b64_tr_b16 v[130:131], v216 offset:17408
ds_read_b64_tr_b16 v[132:133], v217 offset:16384
ds_read_b64_tr_b16 v[134:135], v217 offset:17408
v_accvgpr_read_b32 v225, a225
v_mfma_f32_16x16x32_bf16 a[100:103], v[176:179], v[104:107], a[100:103]
v_accvgpr_read_b32 v226, a226
v_accvgpr_read_b32 v227, a227
v_mfma_f32_16x16x32_bf16 a[104:107], v[180:183], v[48:51], a[104:107]
v_accvgpr_read_b32 v228, a228
v_accvgpr_read_b32 v229, a229
v_mfma_f32_16x16x32_bf16 a[108:111], v[180:183], v[104:107], a[108:111]
s_waitcnt lgkmcnt(4)
v_accvgpr_read_b32 v230, a230
v_accvgpr_read_b32 v231, a231
v_mfma_f32_16x16x32_bf16 a[112:115], v[184:187], v[48:51], a[112:115]
ds_read_b64_tr_b16 v[136:137], v218 offset:16384
ds_read_b64_tr_b16 v[138:139], v218 offset:17408
ds_read_b64_tr_b16 v[140:141], v219 offset:16384
ds_read_b64_tr_b16 v[142:143], v219 offset:17408
v_mfma_f32_16x16x32_bf16 a[116:119], v[184:187], v[104:107], a[116:119]
v_cvt_pk_bf16_f32 v224, v224, v225
v_cvt_pk_bf16_f32 v225, v226, v227
v_mfma_f32_16x16x32_bf16 a[120:123], v[188:191], v[48:51], a[120:123]
v_cvt_pk_bf16_f32 v226, v228, v229
v_cvt_pk_bf16_f32 v227, v230, v231
v_mfma_f32_16x16x32_bf16 a[124:127], v[188:191], v[104:107], a[124:127]
s_waitcnt lgkmcnt(4)
ds_read_b64_tr_b16 v[144:145], v216 offset:20480
v_mfma_f32_16x16x32_bf16 a[0:3], v[128:131], v[52:55], a[0:3]
ds_read_b64_tr_b16 v[146:147], v216 offset:21504
ds_read_b64_tr_b16 v[148:149], v217 offset:20480
ds_read_b64_tr_b16 v[150:151], v217 offset:21504
buffer_store_dwordx4 v[224:227], v1, s[84:87], s91 offen offset:0 sc1
v_accvgpr_read_b32 v232, a232
v_mfma_f32_16x16x32_bf16 a[4:7], v[128:131], v[108:111], a[4:7]
v_accvgpr_read_b32 v233, a233
v_accvgpr_read_b32 v234, a234
v_mfma_f32_16x16x32_bf16 a[8:11], v[132:135], v[52:55], a[8:11]
v_accvgpr_read_b32 v235, a235
v_accvgpr_read_b32 v236, a236
v_mfma_f32_16x16x32_bf16 a[12:15], v[132:135], v[108:111], a[12:15]
s_waitcnt lgkmcnt(4)
ds_read_b64_tr_b16 v[152:153], v218 offset:20480
v_accvgpr_read_b32 v237, a237
v_mfma_f32_16x16x32_bf16 a[16:19], v[136:139], v[52:55], a[16:19]
ds_read_b64_tr_b16 v[154:155], v218 offset:21504
ds_read_b64_tr_b16 v[156:157], v219 offset:20480
ds_read_b64_tr_b16 v[158:159], v219 offset:21504
v_accvgpr_read_b32 v238, a238
v_mfma_f32_16x16x32_bf16 a[20:23], v[136:139], v[108:111], a[20:23]
v_accvgpr_read_b32 v239, a239
v_cvt_pk_bf16_f32 v232, v232, v233
v_mfma_f32_16x16x32_bf16 a[24:27], v[140:143], v[52:55], a[24:27]
v_cvt_pk_bf16_f32 v233, v234, v235
v_cvt_pk_bf16_f32 v234, v236, v237
v_mfma_f32_16x16x32_bf16 a[28:31], v[140:143], v[108:111], a[28:31]
s_waitcnt lgkmcnt(4)
ds_read_b64_tr_b16 v[160:161], v216 offset:24576
v_cvt_pk_bf16_f32 v235, v238, v239
v_mfma_f32_16x16x32_bf16 a[32:35], v[144:147], v[52:55], a[32:35]
ds_read_b64_tr_b16 v[162:163], v216 offset:25600
ds_read_b64_tr_b16 v[164:165], v217 offset:24576
ds_read_b64_tr_b16 v[166:167], v217 offset:25600
buffer_store_dwordx4 v[232:235], v1, s[84:87], s91 offen offset:1024 sc1
v_mfma_f32_16x16x32_bf16 a[36:39], v[144:147], v[108:111], a[36:39]
v_accvgpr_read_b32 v240, a240
v_accvgpr_read_b32 v241, a241
v_mfma_f32_16x16x32_bf16 a[40:43], v[148:151], v[52:55], a[40:43]
v_accvgpr_read_b32 v242, a242
v_accvgpr_read_b32 v243, a243
v_mfma_f32_16x16x32_bf16 a[44:47], v[148:151], v[108:111], a[44:47]
s_waitcnt lgkmcnt(4)
ds_read_b64_tr_b16 v[168:169], v218 offset:24576
v_accvgpr_read_b32 v244, a244
v_mfma_f32_16x16x32_bf16 a[48:51], v[152:155], v[52:55], a[48:51]
ds_read_b64_tr_b16 v[170:171], v218 offset:25600
ds_read_b64_tr_b16 v[172:173], v219 offset:24576
ds_read_b64_tr_b16 v[174:175], v219 offset:25600
v_accvgpr_read_b32 v245, a245
v_mfma_f32_16x16x32_bf16 a[52:55], v[152:155], v[108:111], a[52:55]
v_accvgpr_read_b32 v246, a246
v_accvgpr_read_b32 v247, a247
v_mfma_f32_16x16x32_bf16 a[56:59], v[156:159], v[52:55], a[56:59]
v_cvt_pk_bf16_f32 v240, v240, v241
v_cvt_pk_bf16_f32 v241, v242, v243
v_mfma_f32_16x16x32_bf16 a[60:63], v[156:159], v[108:111], a[60:63]
s_waitcnt lgkmcnt(4)
ds_read_b64_tr_b16 v[176:177], v216 offset:28672
v_cvt_pk_bf16_f32 v242, v244, v245
v_mfma_f32_16x16x32_bf16 a[64:67], v[160:163], v[52:55], a[64:67]
ds_read_b64_tr_b16 v[178:179], v216 offset:29696
ds_read_b64_tr_b16 v[180:181], v217 offset:28672
ds_read_b64_tr_b16 v[182:183], v217 offset:29696
v_cvt_pk_bf16_f32 v243, v246, v247
v_mfma_f32_16x16x32_bf16 a[68:71], v[160:163], v[108:111], a[68:71]
buffer_store_dwordx4 v[240:243], v1, s[84:87], s91 offen offset:2048 sc1
v_mfma_f32_16x16x32_bf16 a[72:75], v[164:167], v[52:55], a[72:75]
v_accvgpr_read_b32 v248, a248
v_accvgpr_read_b32 v249, a249
v_mfma_f32_16x16x32_bf16 a[76:79], v[164:167], v[108:111], a[76:79]
s_waitcnt lgkmcnt(4)
v_accvgpr_read_b32 v250, a250
v_accvgpr_read_b32 v251, a251
v_mfma_f32_16x16x32_bf16 a[80:83], v[168:171], v[52:55], a[80:83]
ds_read_b64_tr_b16 v[184:185], v218 offset:28672
ds_read_b64_tr_b16 v[186:187], v218 offset:29696
ds_read_b64_tr_b16 v[188:189], v219 offset:28672
ds_read_b64_tr_b16 v[190:191], v219 offset:29696
v_accvgpr_read_b32 v252, a252
v_mfma_f32_16x16x32_bf16 a[84:87], v[168:171], v[108:111], a[84:87]
v_accvgpr_read_b32 v253, a253
v_accvgpr_read_b32 v254, a254
v_mfma_f32_16x16x32_bf16 a[88:91], v[172:175], v[52:55], a[88:91]
v_accvgpr_read_b32 v255, a255
v_cvt_pk_bf16_f32 v248, v248, v249
v_mfma_f32_16x16x32_bf16 a[92:95], v[172:175], v[108:111], a[92:95]
s_waitcnt lgkmcnt(4)
ds_read_b64_tr_b16 v[128:129], v220 offset:0
v_cvt_pk_bf16_f32 v249, v250, v251
v_mfma_f32_16x16x32_bf16 a[96:99], v[176:179], v[52:55], a[96:99]
ds_read_b64_tr_b16 v[130:131], v220 offset:1024
ds_read_b64_tr_b16 v[132:133], v221 offset:0
ds_read_b64_tr_b16 v[134:135], v221 offset:1024
v_cvt_pk_bf16_f32 v250, v252, v253
v_mfma_f32_16x16x32_bf16 a[100:103], v[176:179], v[108:111], a[100:103]
v_cvt_pk_bf16_f32 v251, v254, v255
v_add_u32 v216, s28, v208
v_mfma_f32_16x16x32_bf16 a[104:107], v[180:183], v[52:55], a[104:107]
buffer_store_dwordx4 v[248:251], v1, s[84:87], s91 offen offset:3072 sc1
s_add_u32 s91, s91, s90
v_mfma_f32_16x16x32_bf16 a[108:111], v[180:183], v[108:111], a[108:111]
s_waitcnt vmcnt(6) lgkmcnt(4)
ds_read_b64_tr_b16 v[136:137], v222 offset:0
v_add_u32 v217, s28, v209
v_mfma_f32_16x16x32_bf16 a[112:115], v[184:187], v[52:55], a[112:115]
s_barrier
ds_read_b64_tr_b16 v[138:139], v222 offset:1024
ds_read_b64_tr_b16 v[140:141], v223 offset:0
ds_read_b64_tr_b16 v[142:143], v223 offset:1024
v_mfma_f32_16x16x32_bf16 a[116:119], v[184:187], v[108:111], a[116:119]
ds_read_b64_tr_b16 v[144:145], v220 offset:4096
v_add_u32 v218, s28, v210
v_mfma_f32_16x16x32_bf16 a[120:123], v[188:191], v[52:55], a[120:123]
v_add_u32 v219, s28, v211
s_add_u32 s28, s28, 32768
s_cmp_eq_u32 s28, 163840
s_cselect_b32 s28, 0, s28
v_mfma_f32_16x16x32_bf16 a[124:127], v[188:191], v[108:111], a[124:127]
ds_read_b64_tr_b16 v[146:147], v220 offset:5120
ds_read_b64_tr_b16 v[148:149], v221 offset:4096
ds_read_b64_tr_b16 v[150:151], v221 offset:5120
s_waitcnt lgkmcnt(8)
v_mfma_f32_16x16x32_bf16 a[0:3], v[128:131], v[56:59], a[0:3]
ds_read_b64_tr_b16 v[152:153], v222 offset:4096
v_mfma_f32_16x16x32_bf16 a[4:7], v[128:131], v[112:115], a[4:7]
ds_read_b64_tr_b16 v[154:155], v222 offset:5120
v_mfma_f32_16x16x32_bf16 a[8:11], v[132:135], v[56:59], a[8:11]
ds_read_b64_tr_b16 v[156:157], v223 offset:4096
v_mfma_f32_16x16x32_bf16 a[12:15], v[132:135], v[112:115], a[12:15]
s_waitcnt lgkmcnt(7)
ds_read_b64_tr_b16 v[158:159], v223 offset:5120
v_mfma_f32_16x16x32_bf16 a[16:19], v[136:139], v[56:59], a[16:19]
ds_read_b64_tr_b16 v[160:161], v220 offset:8192
v_mfma_f32_16x16x32_bf16 a[20:23], v[136:139], v[112:115], a[20:23]
ds_read_b64_tr_b16 v[162:163], v220 offset:9216
v_mfma_f32_16x16x32_bf16 a[24:27], v[140:143], v[56:59], a[24:27]
ds_read_b64_tr_b16 v[164:165], v221 offset:8192
v_mfma_f32_16x16x32_bf16 a[28:31], v[140:143], v[112:115], a[28:31]
s_waitcnt lgkmcnt(7)
ds_read_b64_tr_b16 v[166:167], v221 offset:9216
v_mfma_f32_16x16x32_bf16 a[32:35], v[144:147], v[56:59], a[32:35]
ds_read_b64_tr_b16 v[168:169], v222 offset:8192
v_mfma_f32_16x16x32_bf16 a[36:39], v[144:147], v[112:115], a[36:39]
ds_read_b64_tr_b16 v[170:171], v222 offset:9216
v_mfma_f32_16x16x32_bf16 a[40:43], v[148:151], v[56:59], a[40:43]
ds_read_b64_tr_b16 v[172:173], v223 offset:8192
v_mfma_f32_16x16x32_bf16 a[44:47], v[148:151], v[112:115], a[44:47]
s_waitcnt lgkmcnt(7)
ds_read_b64_tr_b16 v[174:175], v223 offset:9216
v_mfma_f32_16x16x32_bf16 a[48:51], v[152:155], v[56:59], a[48:51]
ds_read_b64_tr_b16 v[176:177], v220 offset:12288
v_mfma_f32_16x16x32_bf16 a[52:55], v[152:155], v[112:115], a[52:55]
ds_read_b64_tr_b16 v[178:179], v220 offset:13312
v_mfma_f32_16x16x32_bf16 a[56:59], v[156:159], v[56:59], a[56:59]
ds_read_b64_tr_b16 v[180:181], v221 offset:12288
v_mfma_f32_16x16x32_bf16 a[60:63], v[156:159], v[112:115], a[60:63]
s_waitcnt lgkmcnt(7)
ds_read_b64_tr_b16 v[182:183], v221 offset:13312
v_mfma_f32_16x16x32_bf16 a[64:67], v[160:163], v[56:59], a[64:67]
ds_read_b64_tr_b16 v[184:185], v222 offset:12288
v_mfma_f32_16x16x32_bf16 a[68:71], v[160:163], v[112:115], a[68:71]
ds_read_b64_tr_b16 v[186:187], v222 offset:13312
v_mfma_f32_16x16x32_bf16 a[72:75], v[164:167], v[56:59], a[72:75]
ds_read_b64_tr_b16 v[188:189], v223 offset:12288
v_mfma_f32_16x16x32_bf16 a[76:79], v[164:167], v[112:115], a[76:79]
s_waitcnt lgkmcnt(7)
ds_read_b64_tr_b16 v[190:191], v223 offset:13312
v_mfma_f32_16x16x32_bf16 a[80:83], v[168:171], v[56:59], a[80:83]
ds_read_b64_tr_b16 v[128:129], v220 offset:16384
v_mfma_f32_16x16x32_bf16 a[84:87], v[168:171], v[112:115], a[84:87]
ds_read_b64_tr_b16 v[130:131], v220 offset:17408
v_mfma_f32_16x16x32_bf16 a[88:91], v[172:175], v[56:59], a[88:91]
ds_read_b64_tr_b16 v[132:133], v221 offset:16384
v_mfma_f32_16x16x32_bf16 a[92:95], v[172:175], v[112:115], a[92:95]
s_waitcnt lgkmcnt(7)
ds_read_b64_tr_b16 v[134:135], v221 offset:17408
v_mfma_f32_16x16x32_bf16 a[96:99], v[176:179], v[56:59], a[96:99]
ds_read_b64_tr_b16 v[136:137], v222 offset:16384
v_mfma_f32_16x16x32_bf16 a[100:103], v[176:179], v[112:115], a[100:103]
ds_read_b64_tr_b16 v[138:139], v222 offset:17408
v_mfma_f32_16x16x32_bf16 a[104:107], v[180:183], v[56:59], a[104:107]
ds_read_b64_tr_b16 v[140:141], v223 offset:16384
v_mfma_f32_16x16x32_bf16 a[108:111], v[180:183], v[112:115], a[108:111]
s_waitcnt lgkmcnt(7)
ds_read_b64_tr_b16 v[142:143], v223 offset:17408
v_mfma_f32_16x16x32_bf16 a[112:115], v[184:187], v[56:59], a[112:115]
ds_read_b64_tr_b16 v[144:145], v220 offset:20480
v_mfma_f32_16x16x32_bf16 a[116:119], v[184:187], v[112:115], a[116:119]
ds_read_b64_tr_b16 v[146:147], v220 offset:21504
v_mfma_f32_16x16x32_bf16 a[120:123], v[188:191], v[56:59], a[120:123]
ds_read_b64_tr_b16 v[148:149], v221 offset:20480
v_mfma_f32_16x16x32_bf16 a[124:127], v[188:191], v[112:115], a[124:127]
s_waitcnt lgkmcnt(7)
ds_read_b64_tr_b16 v[150:151], v221 offset:21504
v_mfma_f32_16x16x32_bf16 a[0:3], v[128:131], v[60:63], a[0:3]
ds_read_b64_tr_b16 v[152:153], v222 offset:20480
v_mfma_f32_16x16x32_bf16 a[4:7], v[128:131], v[116:119], a[4:7]
ds_read_b64_tr_b16 v[154:155], v222 offset:21504
v_mfma_f32_16x16x32_bf16 a[8:11], v[132:135], v[60:63], a[8:11]
ds_read_b64_tr_b16 v[156:157], v223 offset:20480
v_mfma_f32_16x16x32_bf16 a[12:15], v[132:135], v[116:119], a[12:15]
s_waitcnt lgkmcnt(7)
ds_read_b64_tr_b16 v[158:159], v223 offset:21504
v_mfma_f32_16x16x32_bf16 a[16:19], v[136:139], v[60:63], a[16:19]
ds_read_b64_tr_b16 v[160:161], v220 offset:24576
v_mfma_f32_16x16x32_bf16 a[20:23], v[136:139], v[116:119], a[20:23]
ds_read_b64_tr_b16 v[162:163], v220 offset:25600
v_mfma_f32_16x16x32_bf16 a[24:27], v[140:143], v[60:63], a[24:27]
ds_read_b64_tr_b16 v[164:165], v221 offset:24576
v_mfma_f32_16x16x32_bf16 a[28:31], v[140:143], v[116:119], a[28:31]
s_waitcnt lgkmcnt(7)
ds_read_b64_tr_b16 v[166:167], v221 offset:25600
v_mfma_f32_16x16x32_bf16 a[32:35], v[144:147], v[60:63], a[32:35]
ds_read_b64_tr_b16 v[168:169], v222 offset:24576
v_mfma_f32_16x16x32_bf16 a[36:39], v[144:147], v[116:119], a[36:39]
ds_read_b64_tr_b16 v[170:171], v222 offset:25600
v_mfma_f32_16x16x32_bf16 a[40:43], v[148:151], v[60:63], a[40:43]
ds_read_b64_tr_b16 v[172:173], v223 offset:24576
v_mfma_f32_16x16x32_bf16 a[44:47], v[148:151], v[116:119], a[44:47]
s_waitcnt lgkmcnt(7)
ds_read_b64_tr_b16 v[174:175], v223 offset:25600
v_mfma_f32_16x16x32_bf16 a[48:51], v[152:155], v[60:63], a[48:51]
ds_read_b64_tr_b16 v[176:177], v220 offset:28672
v_mfma_f32_16x16x32_bf16 a[52:55], v[152:155], v[116:119], a[52:55]
ds_read_b64_tr_b16 v[178:179], v220 offset:29696
v_mfma_f32_16x16x32_bf16 a[56:59], v[156:159], v[60:63], a[56:59]
ds_read_b64_tr_b16 v[180:181], v221 offset:28672
v_mfma_f32_16x16x32_bf16 a[60:63], v[156:159], v[116:119], a[60:63]
s_waitcnt lgkmcnt(7)
ds_read_b64_tr_b16 v[182:183], v221 offset:29696
v_mfma_f32_16x16x32_bf16 a[64:67], v[160:163], v[60:63], a[64:67]
ds_read_b64_tr_b16 v[184:185], v222 offset:28672
v_mfma_f32_16x16x32_bf16 a[68:71], v[160:163], v[116:119], a[68:71]
ds_read_b64_tr_b16 v[186:187], v222 offset:29696
v_mfma_f32_16x16x32_bf16 a[72:75], v[164:167], v[60:63], a[72:75]
ds_read_b64_tr_b16 v[188:189], v223 offset:28672
v_mfma_f32_16x16x32_bf16 a[76:79], v[164:167], v[116:119], a[76:79]
s_waitcnt lgkmcnt(7)
ds_read_b64_tr_b16 v[190:191], v223 offset:29696
v_mfma_f32_16x16x32_bf16 a[80:83], v[168:171], v[60:63], a[80:83]
ds_read_b64_tr_b16 v[128:129], v216 offset:0
v_mfma_f32_16x16x32_bf16 a[84:87], v[168:171], v[116:119], a[84:87]
ds_read_b64_tr_b16 v[130:131], v216 offset:1024
v_mfma_f32_16x16x32_bf16 a[88:91], v[172:175], v[60:63], a[88:91]
ds_read_b64_tr_b16 v[132:133], v217 offset:0
v_mfma_f32_16x16x32_bf16 a[92:95], v[172:175], v[116:119], a[92:95]
s_waitcnt lgkmcnt(7)
ds_read_b64_tr_b16 v[134:135], v217 offset:1024
v_mfma_f32_16x16x32_bf16 a[96:99], v[176:179], v[60:63], a[96:99]
ds_read_b64_tr_b16 v[136:137], v218 offset:0
v_mfma_f32_16x16x32_bf16 a[100:103], v[176:179], v[116:119], a[100:103]
ds_read_b64_tr_b16 v[138:139], v218 offset:1024
v_mfma_f32_16x16x32_bf16 a[104:107], v[180:183], v[60:63], a[104:107]
ds_read_b64_tr_b16 v[140:141], v219 offset:0
v_mfma_f32_16x16x32_bf16 a[108:111], v[180:183], v[116:119], a[108:111]
s_waitcnt vmcnt(0) lgkmcnt(7)
ds_read_b64_tr_b16 v[142:143], v219 offset:1024
v_mfma_f32_16x16x32_bf16 a[112:115], v[184:187], v[60:63], a[112:115]
s_barrier
ds_read_b64_tr_b16 v[144:145], v216 offset:4096
v_mfma_f32_16x16x32_bf16 a[116:119], v[184:187], v[116:119], a[116:119]
ds_read_b64_tr_b16 v[146:147], v216 offset:5120
v_mfma_f32_16x16x32_bf16 a[120:123], v[188:191], v[60:63], a[120:123]
ds_read_b64_tr_b16 v[148:149], v217 offset:4096
v_mfma_f32_16x16x32_bf16 a[124:127], v[188:191], v[116:119], a[124:127]
ds_read_b64_tr_b16 v[150:151], v217 offset:5120
s_cmp_lg_u32 s20, 0
s_cbranch_scc1 K2_kv_pub
s_add_u32 s40, s21, 48
s_lshl_b32 s40, s40, 7
v_mov_b32 v11, s40
v_mov_b32 v10, 1
v_cmp_eq_u32 vcc, 0, v1
s_and_saveexec_b64 s[40:41], vcc
buffer_atomic_add v10, v11, s[92:95], 0 offen sc1
s_mov_b64 exec, s[40:41]
s_nop 4
K2_kv_pub:
s_waitcnt lgkmcnt(8)
v_mfma_f32_16x16x32_bf16 a[0:3], v[128:131], v[64:67], a[0:3]
ds_read_b64_tr_b16 v[152:153], v218 offset:4096
v_mfma_f32_16x16x32_bf16 a[4:7], v[128:131], v[120:123], a[4:7]
ds_read_b64_tr_b16 v[154:155], v218 offset:5120
v_mfma_f32_16x16x32_bf16 a[8:11], v[132:135], v[64:67], a[8:11]
ds_read_b64_tr_b16 v[156:157], v219 offset:4096
v_mfma_f32_16x16x32_bf16 a[12:15], v[132:135], v[120:123], a[12:15]
s_waitcnt lgkmcnt(7)
ds_read_b64_tr_b16 v[158:159], v219 offset:5120
v_mfma_f32_16x16x32_bf16 a[16:19], v[136:139], v[64:67], a[16:19]
ds_read_b64_tr_b16 v[160:161], v216 offset:8192
v_mfma_f32_16x16x32_bf16 a[20:23], v[136:139], v[120:123], a[20:23]
ds_read_b64_tr_b16 v[162:163], v216 offset:9216
v_mfma_f32_16x16x32_bf16 a[24:27], v[140:143], v[64:67], a[24:27]
ds_read_b64_tr_b16 v[164:165], v217 offset:8192
v_mfma_f32_16x16x32_bf16 a[28:31], v[140:143], v[120:123], a[28:31]
s_waitcnt lgkmcnt(7)
ds_read_b64_tr_b16 v[166:167], v217 offset:9216
v_mfma_f32_16x16x32_bf16 a[32:35], v[144:147], v[64:67], a[32:35]
ds_read_b64_tr_b16 v[168:169], v218 offset:8192
v_mfma_f32_16x16x32_bf16 a[36:39], v[144:147], v[120:123], a[36:39]
ds_read_b64_tr_b16 v[170:171], v218 offset:9216
v_mfma_f32_16x16x32_bf16 a[40:43], v[148:151], v[64:67], a[40:43]
ds_read_b64_tr_b16 v[172:173], v219 offset:8192
v_mfma_f32_16x16x32_bf16 a[44:47], v[148:151], v[120:123], a[44:47]
s_waitcnt lgkmcnt(7)
ds_read_b64_tr_b16 v[174:175], v219 offset:9216
v_mfma_f32_16x16x32_bf16 a[48:51], v[152:155], v[64:67], a[48:51]
ds_read_b64_tr_b16 v[176:177], v216 offset:12288
v_mfma_f32_16x16x32_bf16 a[52:55], v[152:155], v[120:123], a[52:55]
ds_read_b64_tr_b16 v[178:179], v216 offset:13312
v_mfma_f32_16x16x32_bf16 a[56:59], v[156:159], v[64:67], a[56:59]
ds_read_b64_tr_b16 v[180:181], v217 offset:12288
v_mfma_f32_16x16x32_bf16 a[60:63], v[156:159], v[120:123], a[60:63]
s_waitcnt lgkmcnt(7)
ds_read_b64_tr_b16 v[182:183], v217 offset:13312
v_mfma_f32_16x16x32_bf16 a[64:67], v[160:163], v[64:67], a[64:67]
ds_read_b64_tr_b16 v[184:185], v218 offset:12288
v_mfma_f32_16x16x32_bf16 a[68:71], v[160:163], v[120:123], a[68:71]
ds_read_b64_tr_b16 v[186:187], v218 offset:13312
v_mfma_f32_16x16x32_bf16 a[72:75], v[164:167], v[64:67], a[72:75]
ds_read_b64_tr_b16 v[188:189], v219 offset:12288
v_mfma_f32_16x16x32_bf16 a[76:79], v[164:167], v[120:123], a[76:79]
s_waitcnt lgkmcnt(7)
ds_read_b64_tr_b16 v[190:191], v219 offset:13312
v_mfma_f32_16x16x32_bf16 a[80:83], v[168:171], v[64:67], a[80:83]
ds_read_b64_tr_b16 v[128:129], v216 offset:16384
v_mfma_f32_16x16x32_bf16 a[84:87], v[168:171], v[120:123], a[84:87]
ds_read_b64_tr_b16 v[130:131], v216 offset:17408
v_mfma_f32_16x16x32_bf16 a[88:91], v[172:175], v[64:67], a[88:91]
ds_read_b64_tr_b16 v[132:133], v217 offset:16384
v_mfma_f32_16x16x32_bf16 a[92:95], v[172:175], v[120:123], a[92:95]
s_waitcnt lgkmcnt(7)
ds_read_b64_tr_b16 v[134:135], v217 offset:17408
v_mfma_f32_16x16x32_bf16 a[96:99], v[176:179], v[64:67], a[96:99]
ds_read_b64_tr_b16 v[136:137], v218 offset:16384
v_mfma_f32_16x16x32_bf16 a[100:103], v[176:179], v[120:123], a[100:103]
ds_read_b64_tr_b16 v[138:139], v218 offset:17408
v_mfma_f32_16x16x32_bf16 a[104:107], v[180:183], v[64:67], a[104:107]
ds_read_b64_tr_b16 v[140:141], v219 offset:16384
v_mfma_f32_16x16x32_bf16 a[108:111], v[180:183], v[120:123], a[108:111]
s_waitcnt lgkmcnt(7)
ds_read_b64_tr_b16 v[142:143], v219 offset:17408
v_mfma_f32_16x16x32_bf16 a[112:115], v[184:187], v[64:67], a[112:115]
ds_read_b64_tr_b16 v[144:145], v216 offset:20480
v_mfma_f32_16x16x32_bf16 a[116:119], v[184:187], v[120:123], a[116:119]
ds_read_b64_tr_b16 v[146:147], v216 offset:21504
v_mfma_f32_16x16x32_bf16 a[120:123], v[188:191], v[64:67], a[120:123]
ds_read_b64_tr_b16 v[148:149], v217 offset:20480
v_mfma_f32_16x16x32_bf16 a[124:127], v[188:191], v[120:123], a[124:127]
s_waitcnt lgkmcnt(7)
ds_read_b64_tr_b16 v[150:151], v217 offset:21504
v_mfma_f32_16x16x32_bf16 a[0:3], v[128:131], v[68:71], a[0:3]
ds_read_b64_tr_b16 v[152:153], v218 offset:20480
v_mfma_f32_16x16x32_bf16 a[4:7], v[128:131], v[124:127], a[4:7]
ds_read_b64_tr_b16 v[154:155], v218 offset:21504
v_mfma_f32_16x16x32_bf16 a[8:11], v[132:135], v[68:71], a[8:11]
ds_read_b64_tr_b16 v[156:157], v219 offset:20480
v_mfma_f32_16x16x32_bf16 a[12:15], v[132:135], v[124:127], a[12:15]
s_waitcnt lgkmcnt(7)
ds_read_b64_tr_b16 v[158:159], v219 offset:21504
v_mfma_f32_16x16x32_bf16 a[16:19], v[136:139], v[68:71], a[16:19]
ds_read_b64_tr_b16 v[160:161], v216 offset:24576
v_mfma_f32_16x16x32_bf16 a[20:23], v[136:139], v[124:127], a[20:23]
ds_read_b64_tr_b16 v[162:163], v216 offset:25600
v_mfma_f32_16x16x32_bf16 a[24:27], v[140:143], v[68:71], a[24:27]
ds_read_b64_tr_b16 v[164:165], v217 offset:24576
v_mfma_f32_16x16x32_bf16 a[28:31], v[140:143], v[124:127], a[28:31]
s_waitcnt lgkmcnt(7)
ds_read_b64_tr_b16 v[166:167], v217 offset:25600
v_mfma_f32_16x16x32_bf16 a[32:35], v[144:147], v[68:71], a[32:35]
ds_read_b64_tr_b16 v[168:169], v218 offset:24576
v_mfma_f32_16x16x32_bf16 a[36:39], v[144:147], v[124:127], a[36:39]
ds_read_b64_tr_b16 v[170:171], v218 offset:25600
v_mfma_f32_16x16x32_bf16 a[40:43], v[148:151], v[68:71], a[40:43]
ds_read_b64_tr_b16 v[172:173], v219 offset:24576
v_mfma_f32_16x16x32_bf16 a[44:47], v[148:151], v[124:127], a[44:47]
s_waitcnt lgkmcnt(7)
ds_read_b64_tr_b16 v[174:175], v219 offset:25600
v_mfma_f32_16x16x32_bf16 a[48:51], v[152:155], v[68:71], a[48:51]
ds_read_b64_tr_b16 v[176:177], v216 offset:28672
v_mfma_f32_16x16x32_bf16 a[52:55], v[152:155], v[124:127], a[52:55]
ds_read_b64_tr_b16 v[178:179], v216 offset:29696
v_mfma_f32_16x16x32_bf16 a[56:59], v[156:159], v[68:71], a[56:59]
ds_read_b64_tr_b16 v[180:181], v217 offset:28672
v_mfma_f32_16x16x32_bf16 a[60:63], v[156:159], v[124:127], a[60:63]
s_waitcnt lgkmcnt(7)
ds_read_b64_tr_b16 v[182:183], v217 offset:29696
v_mfma_f32_16x16x32_bf16 a[64:67], v[160:163], v[68:71], a[64:67]
ds_read_b64_tr_b16 v[184:185], v218 offset:28672
v_mfma_f32_16x16x32_bf16 a[68:71], v[160:163], v[124:127], a[68:71]
ds_read_b64_tr_b16 v[186:187], v218 offset:29696
v_mfma_f32_16x16x32_bf16 a[72:75], v[164:167], v[68:71], a[72:75]
ds_read_b64_tr_b16 v[188:189], v219 offset:28672
v_mfma_f32_16x16x32_bf16 a[76:79], v[164:167], v[124:127], a[76:79]
s_waitcnt lgkmcnt(7)
ds_read_b64_tr_b16 v[190:191], v219 offset:29696
v_mfma_f32_16x16x32_bf16 a[80:83], v[168:171], v[68:71], a[80:83]
v_mfma_f32_16x16x32_bf16 a[84:87], v[168:171], v[124:127], a[84:87]
v_mfma_f32_16x16x32_bf16 a[88:91], v[172:175], v[68:71], a[88:91]
v_mfma_f32_16x16x32_bf16 a[92:95], v[172:175], v[124:127], a[92:95]
s_waitcnt lgkmcnt(4)
v_mfma_f32_16x16x32_bf16 a[96:99], v[176:179], v[68:71], a[96:99]
v_mfma_f32_16x16x32_bf16 a[100:103], v[176:179], v[124:127], a[100:103]
v_mfma_f32_16x16x32_bf16 a[104:107], v[180:183], v[68:71], a[104:107]
v_mfma_f32_16x16x32_bf16 a[108:111], v[180:183], v[124:127], a[108:111]
s_waitcnt lgkmcnt(0)
v_mfma_f32_16x16x32_bf16 a[112:115], v[184:187], v[68:71], a[112:115]
s_barrier
v_mfma_f32_16x16x32_bf16 a[116:119], v[184:187], v[124:127], a[116:119]
v_mfma_f32_16x16x32_bf16 a[120:123], v[188:191], v[68:71], a[120:123]
v_mfma_f32_16x16x32_bf16 a[124:127], v[188:191], v[124:127], a[124:127]
s_nop 7
v_accvgpr_read_b32 v224, a0
v_accvgpr_read_b32 v225, a1
v_accvgpr_read_b32 v226, a2
v_accvgpr_read_b32 v227, a3
v_accvgpr_read_b32 v228, a8
v_accvgpr_read_b32 v229, a9
v_accvgpr_read_b32 v230, a10
v_accvgpr_read_b32 v231, a11
v_cvt_pk_bf16_f32 v232, v224, v225
v_cvt_pk_bf16_f32 v233, v226, v227
v_cvt_pk_bf16_f32 v234, v228, v229
v_cvt_pk_bf16_f32 v235, v230, v231
v_accvgpr_write_b32 a128, v232
v_accvgpr_write_b32 a129, v233
v_accvgpr_write_b32 a130, v234
v_accvgpr_write_b32 a131, v235
v_accvgpr_read_b32 v236, a4
v_accvgpr_read_b32 v237, a5
v_accvgpr_read_b32 v238, a6
v_accvgpr_read_b32 v239, a7
v_accvgpr_read_b32 v240, a12
v_accvgpr_read_b32 v241, a13
v_accvgpr_read_b32 v242, a14
v_accvgpr_read_b32 v243, a15
v_cvt_pk_bf16_f32 v244, v236, v237
v_cvt_pk_bf16_f32 v245, v238, v239
v_cvt_pk_bf16_f32 v246, v240, v241
v_cvt_pk_bf16_f32 v247, v242, v243
v_accvgpr_write_b32 a160, v244
v_accvgpr_write_b32 a161, v245
v_accvgpr_write_b32 a162, v246
v_accvgpr_write_b32 a163, v247
v_accvgpr_read_b32 v224, a16
v_accvgpr_read_b32 v225, a17
v_accvgpr_read_b32 v226, a18
v_accvgpr_read_b32 v227, a19
v_accvgpr_read_b32 v228, a24
v_accvgpr_read_b32 v229, a25
v_accvgpr_read_b32 v230, a26
v_accvgpr_read_b32 v231, a27
v_cvt_pk_bf16_f32 v232, v224, v225
v_cvt_pk_bf16_f32 v233, v226, v227
v_cvt_pk_bf16_f32 v234, v228, v229
v_cvt_pk_bf16_f32 v235, v230, v231
v_accvgpr_write_b32 a132, v232
v_accvgpr_write_b32 a133, v233
v_accvgpr_write_b32 a134, v234
v_accvgpr_write_b32 a135, v235
v_accvgpr_read_b32 v236, a20
v_accvgpr_read_b32 v237, a21
v_accvgpr_read_b32 v238, a22
v_accvgpr_read_b32 v239, a23
v_accvgpr_read_b32 v240, a28
v_accvgpr_read_b32 v241, a29
v_accvgpr_read_b32 v242, a30
v_accvgpr_read_b32 v243, a31
v_cvt_pk_bf16_f32 v244, v236, v237
v_cvt_pk_bf16_f32 v245, v238, v239
v_cvt_pk_bf16_f32 v246, v240, v241
v_cvt_pk_bf16_f32 v247, v242, v243
v_accvgpr_write_b32 a164, v244
v_accvgpr_write_b32 a165, v245
v_accvgpr_write_b32 a166, v246
v_accvgpr_write_b32 a167, v247
v_accvgpr_read_b32 v224, a32
v_accvgpr_read_b32 v225, a33
v_accvgpr_read_b32 v226, a34
v_accvgpr_read_b32 v227, a35
v_accvgpr_read_b32 v228, a40
v_accvgpr_read_b32 v229, a41
v_accvgpr_read_b32 v230, a42
v_accvgpr_read_b32 v231, a43
v_cvt_pk_bf16_f32 v232, v224, v225
v_cvt_pk_bf16_f32 v233, v226, v227
v_cvt_pk_bf16_f32 v234, v228, v229
v_cvt_pk_bf16_f32 v235, v230, v231
v_accvgpr_write_b32 a136, v232
v_accvgpr_write_b32 a137, v233
v_accvgpr_write_b32 a138, v234
v_accvgpr_write_b32 a139, v235
v_accvgpr_read_b32 v236, a36
v_accvgpr_read_b32 v237, a37
v_accvgpr_read_b32 v238, a38
v_accvgpr_read_b32 v239, a39
v_accvgpr_read_b32 v240, a44
v_accvgpr_read_b32 v241, a45
v_accvgpr_read_b32 v242, a46
v_accvgpr_read_b32 v243, a47
v_cvt_pk_bf16_f32 v244, v236, v237
v_cvt_pk_bf16_f32 v245, v238, v239
v_cvt_pk_bf16_f32 v246, v240, v241
v_cvt_pk_bf16_f32 v247, v242, v243
v_accvgpr_write_b32 a168, v244
v_accvgpr_write_b32 a169, v245
v_accvgpr_write_b32 a170, v246
v_accvgpr_write_b32 a171, v247
v_accvgpr_read_b32 v224, a48
v_accvgpr_read_b32 v225, a49
v_accvgpr_read_b32 v226, a50
v_accvgpr_read_b32 v227, a51
v_accvgpr_read_b32 v228, a56
v_accvgpr_read_b32 v229, a57
v_accvgpr_read_b32 v230, a58
v_accvgpr_read_b32 v231, a59
v_cvt_pk_bf16_f32 v232, v224, v225
v_cvt_pk_bf16_f32 v233, v226, v227
v_cvt_pk_bf16_f32 v234, v228, v229
v_cvt_pk_bf16_f32 v235, v230, v231
v_accvgpr_write_b32 a140, v232
v_accvgpr_write_b32 a141, v233
v_accvgpr_write_b32 a142, v234
v_accvgpr_write_b32 a143, v235
v_accvgpr_read_b32 v236, a52
v_accvgpr_read_b32 v237, a53
v_accvgpr_read_b32 v238, a54
v_accvgpr_read_b32 v239, a55
v_accvgpr_read_b32 v240, a60
v_accvgpr_read_b32 v241, a61
v_accvgpr_read_b32 v242, a62
v_accvgpr_read_b32 v243, a63
v_cvt_pk_bf16_f32 v244, v236, v237
v_cvt_pk_bf16_f32 v245, v238, v239
v_cvt_pk_bf16_f32 v246, v240, v241
v_cvt_pk_bf16_f32 v247, v242, v243
v_accvgpr_write_b32 a172, v244
v_accvgpr_write_b32 a173, v245
v_accvgpr_write_b32 a174, v246
v_accvgpr_write_b32 a175, v247
v_accvgpr_read_b32 v224, a64
v_accvgpr_read_b32 v225, a65
v_accvgpr_read_b32 v226, a66
v_accvgpr_read_b32 v227, a67
v_accvgpr_read_b32 v228, a72
v_accvgpr_read_b32 v229, a73
v_accvgpr_read_b32 v230, a74
v_accvgpr_read_b32 v231, a75
v_cvt_pk_bf16_f32 v232, v224, v225
v_cvt_pk_bf16_f32 v233, v226, v227
v_cvt_pk_bf16_f32 v234, v228, v229
v_cvt_pk_bf16_f32 v235, v230, v231
v_accvgpr_write_b32 a144, v232
v_accvgpr_write_b32 a145, v233
v_accvgpr_write_b32 a146, v234
v_accvgpr_write_b32 a147, v235
v_accvgpr_read_b32 v236, a68
v_accvgpr_read_b32 v237, a69
v_accvgpr_read_b32 v238, a70
v_accvgpr_read_b32 v239, a71
v_accvgpr_read_b32 v240, a76
v_accvgpr_read_b32 v241, a77
v_accvgpr_read_b32 v242, a78
v_accvgpr_read_b32 v243, a79
v_cvt_pk_bf16_f32 v244, v236, v237
v_cvt_pk_bf16_f32 v245, v238, v239
v_cvt_pk_bf16_f32 v246, v240, v241
v_cvt_pk_bf16_f32 v247, v242, v243
v_accvgpr_write_b32 a176, v244
v_accvgpr_write_b32 a177, v245
v_accvgpr_write_b32 a178, v246
v_accvgpr_write_b32 a179, v247
v_accvgpr_read_b32 v224, a80
v_accvgpr_read_b32 v225, a81
v_accvgpr_read_b32 v226, a82
v_accvgpr_read_b32 v227, a83
v_accvgpr_read_b32 v228, a88
v_accvgpr_read_b32 v229, a89
v_accvgpr_read_b32 v230, a90
v_accvgpr_read_b32 v231, a91
v_cvt_pk_bf16_f32 v232, v224, v225
v_cvt_pk_bf16_f32 v233, v226, v227
v_cvt_pk_bf16_f32 v234, v228, v229
v_cvt_pk_bf16_f32 v235, v230, v231
v_accvgpr_write_b32 a148, v232
v_accvgpr_write_b32 a149, v233
v_accvgpr_write_b32 a150, v234
v_accvgpr_write_b32 a151, v235
v_accvgpr_read_b32 v236, a84
v_accvgpr_read_b32 v237, a85
v_accvgpr_read_b32 v238, a86
v_accvgpr_read_b32 v239, a87
v_accvgpr_read_b32 v240, a92
v_accvgpr_read_b32 v241, a93
v_accvgpr_read_b32 v242, a94
v_accvgpr_read_b32 v243, a95
v_cvt_pk_bf16_f32 v244, v236, v237
v_cvt_pk_bf16_f32 v245, v238, v239
v_cvt_pk_bf16_f32 v246, v240, v241
v_cvt_pk_bf16_f32 v247, v242, v243
v_accvgpr_write_b32 a180, v244
v_accvgpr_write_b32 a181, v245
v_accvgpr_write_b32 a182, v246
v_accvgpr_write_b32 a183, v247
v_accvgpr_read_b32 v224, a96
v_accvgpr_read_b32 v225, a97
v_accvgpr_read_b32 v226, a98
v_accvgpr_read_b32 v227, a99
v_accvgpr_read_b32 v228, a104
v_accvgpr_read_b32 v229, a105
v_accvgpr_read_b32 v230, a106
v_accvgpr_read_b32 v231, a107
v_cvt_pk_bf16_f32 v232, v224, v225
v_cvt_pk_bf16_f32 v233, v226, v227
v_cvt_pk_bf16_f32 v234, v228, v229
v_cvt_pk_bf16_f32 v235, v230, v231
v_accvgpr_write_b32 a152, v232
v_accvgpr_write_b32 a153, v233
v_accvgpr_write_b32 a154, v234
v_accvgpr_write_b32 a155, v235
v_accvgpr_read_b32 v236, a100
v_accvgpr_read_b32 v237, a101
v_accvgpr_read_b32 v238, a102
v_accvgpr_read_b32 v239, a103
v_accvgpr_read_b32 v240, a108
v_accvgpr_read_b32 v241, a109
v_accvgpr_read_b32 v242, a110
v_accvgpr_read_b32 v243, a111
v_cvt_pk_bf16_f32 v244, v236, v237
v_cvt_pk_bf16_f32 v245, v238, v239
v_cvt_pk_bf16_f32 v246, v240, v241
v_cvt_pk_bf16_f32 v247, v242, v243
v_accvgpr_write_b32 a184, v244
v_accvgpr_write_b32 a185, v245
v_accvgpr_write_b32 a186, v246
v_accvgpr_write_b32 a187, v247
v_accvgpr_read_b32 v224, a112
v_accvgpr_read_b32 v225, a113
v_accvgpr_read_b32 v226, a114
v_accvgpr_read_b32 v227, a115
v_accvgpr_read_b32 v228, a120
v_accvgpr_read_b32 v229, a121
v_accvgpr_read_b32 v230, a122
v_accvgpr_read_b32 v231, a123
v_cvt_pk_bf16_f32 v232, v224, v225
v_cvt_pk_bf16_f32 v233, v226, v227
v_cvt_pk_bf16_f32 v234, v228, v229
v_cvt_pk_bf16_f32 v235, v230, v231
v_accvgpr_write_b32 a156, v232
v_accvgpr_write_b32 a157, v233
v_accvgpr_write_b32 a158, v234
v_accvgpr_write_b32 a159, v235
v_accvgpr_read_b32 v236, a116
v_accvgpr_read_b32 v237, a117
v_accvgpr_read_b32 v238, a118
v_accvgpr_read_b32 v239, a119
v_accvgpr_read_b32 v240, a124
v_accvgpr_read_b32 v241, a125
v_accvgpr_read_b32 v242, a126
v_accvgpr_read_b32 v243, a127
v_cvt_pk_bf16_f32 v244, v236, v237
v_cvt_pk_bf16_f32 v245, v238, v239
v_cvt_pk_bf16_f32 v246, v240, v241
v_cvt_pk_bf16_f32 v247, v242, v243
v_accvgpr_write_b32 a188, v244
v_accvgpr_write_b32 a189, v245
v_accvgpr_write_b32 a190, v246
v_accvgpr_write_b32 a191, v247
v_mov_b32 v104, 0
v_mov_b32 v105, 0
v_mov_b32 v106, 0
v_mov_b32 v107, 0
v_mov_b32 v108, 0
v_mov_b32 v109, 0
v_mov_b32 v110, 0
v_mov_b32 v111, 0
v_mov_b32 v96, 0
v_mov_b32 v97, 0
v_mov_b32 v98, 0
v_mov_b32 v99, 0
v_mov_b32 v100, 0
v_mov_b32 v101, 0
v_mov_b32 v102, 0
v_mov_b32 v103, 0
s_lshl_b32 s6, s34, 16
s_lshl_b32 s7, s20, 14
s_add_u32 s6, s6, s7
s_add_u32 s6, s6, 117440512
s_add_u32 s84, s50, s6
s_addc_u32 s85, s51, 0
s_mov_b32 s86, 16384
s_mov_b32 s87, 0x20000
s_cmp_lg_u32 s37, 0
s_cbranch_scc1 K2_q_done
v_accvgpr_mov_b32 a192, a128
v_accvgpr_mov_b32 a193, a129
v_accvgpr_mov_b32 a194, a130
v_accvgpr_mov_b32 a195, a131
v_accvgpr_mov_b32 a196, a132
v_accvgpr_mov_b32 a197, a133
v_accvgpr_mov_b32 a198, a134
v_accvgpr_mov_b32 a199, a135
v_accvgpr_mov_b32 a200, a136
v_accvgpr_mov_b32 a201, a137
v_accvgpr_mov_b32 a202, a138
v_accvgpr_mov_b32 a203, a139
v_accvgpr_mov_b32 a204, a140
v_accvgpr_mov_b32 a205, a141
v_accvgpr_mov_b32 a206, a142
v_accvgpr_mov_b32 a207, a143
v_accvgpr_mov_b32 a208, a144
v_accvgpr_mov_b32 a209, a145
v_accvgpr_mov_b32 a210, a146
v_accvgpr_mov_b32 a211, a147
v_accvgpr_mov_b32 a212, a148
v_accvgpr_mov_b32 a213, a149
v_accvgpr_mov_b32 a214, a150
v_accvgpr_mov_b32 a215, a151
v_accvgpr_mov_b32 a216, a152
v_accvgpr_mov_b32 a217, a153
v_accvgpr_mov_b32 a218, a154
v_accvgpr_mov_b32 a219, a155
v_accvgpr_mov_b32 a220, a156
v_accvgpr_mov_b32 a221, a157
v_accvgpr_mov_b32 a222, a158
v_accvgpr_mov_b32 a223, a159
v_accvgpr_mov_b32 a224, a160
v_accvgpr_mov_b32 a225, a161
v_accvgpr_mov_b32 a226, a162
v_accvgpr_mov_b32 a227, a163
v_accvgpr_mov_b32 a228, a164
v_accvgpr_mov_b32 a229, a165
v_accvgpr_mov_b32 a230, a166
v_accvgpr_mov_b32 a231, a167
v_accvgpr_mov_b32 a232, a168
v_accvgpr_mov_b32 a233, a169
v_accvgpr_mov_b32 a234, a170
v_accvgpr_mov_b32 a235, a171
v_accvgpr_mov_b32 a236, a172
v_accvgpr_mov_b32 a237, a173
v_accvgpr_mov_b32 a238, a174
v_accvgpr_mov_b32 a239, a175
v_accvgpr_mov_b32 a240, a176
v_accvgpr_mov_b32 a241, a177
v_accvgpr_mov_b32 a242, a178
v_accvgpr_mov_b32 a243, a179
v_accvgpr_mov_b32 a244, a180
v_accvgpr_mov_b32 a245, a181
v_accvgpr_mov_b32 a246, a182
v_accvgpr_mov_b32 a247, a183
v_accvgpr_mov_b32 a248, a184
v_accvgpr_mov_b32 a249, a185
v_accvgpr_mov_b32 a250, a186
v_accvgpr_mov_b32 a251, a187
v_accvgpr_mov_b32 a252, a188
v_accvgpr_mov_b32 a253, a189
v_accvgpr_mov_b32 a254, a190
v_accvgpr_mov_b32 a255, a191
K2_q_done:
s_add_u32 s40, s21, 48
s_lshl_b32 s40, s40, 7
v_mov_b32 v11, s40
s_add_u32 s40, s40, 2048
v_mov_b32 v13, s40
s_mov_b32 s41, 0
s_cmp_eq_u32 s37, 0
s_cselect_b32 s7, 6, 0
s_cmp_lg_u32 s37, 2
s_cbranch_scc1 K2_kv_noq
buffer_load_dword v10, v11, s[92:95], 0 offen sc1
buffer_load_dword v12, v13, s[92:95], 0 offen sc1
s_mov_b32 s40, 0
buffer_store_dwordx4 a[128:131], v1, s[84:87], s40 offen offset:0 sc1
s_mov_b32 s40, 0
buffer_store_dwordx4 a[132:135], v1, s[84:87], s40 offen offset:1024 sc1
s_mov_b32 s40, 0
buffer_store_dwordx4 a[136:139], v1, s[84:87], s40 offen offset:2048 sc1
s_mov_b32 s40, 0
buffer_store_dwordx4 a[140:143], v1, s[84:87], s40 offen offset:3072 sc1
s_mov_b32 s40, 4096
buffer_store_dwordx4 a[144:147], v1, s[84:87], s40 offen offset:0 sc1
s_mov_b32 s40, 4096
buffer_store_dwordx4 a[148:151], v1, s[84:87], s40 offen offset:1024 sc1
s_mov_b32 s40, 4096
buffer_store_dwordx4 a[152:155], v1, s[84:87], s40 offen offset:2048 sc1
s_mov_b32 s40, 4096
buffer_store_dwordx4 a[156:159], v1, s[84:87], s40 offen offset:3072 sc1
s_mov_b32 s40, 8192
buffer_store_dwordx4 a[160:163], v1, s[84:87], s40 offen offset:0 sc1
s_mov_b32 s40, 8192
buffer_store_dwordx4 a[164:167], v1, s[84:87], s40 offen offset:1024 sc1
s_mov_b32 s40, 8192
buffer_store_dwordx4 a[168:171], v1, s[84:87], s40 offen offset:2048 sc1
s_mov_b32 s40, 8192
buffer_store_dwordx4 a[172:175], v1, s[84:87], s40 offen offset:3072 sc1
s_mov_b32 s40, 12288
buffer_store_dwordx4 a[176:179], v1, s[84:87], s40 offen offset:0 sc1
s_mov_b32 s40, 12288
buffer_store_dwordx4 a[180:183], v1, s[84:87], s40 offen offset:1024 sc1
s_mov_b32 s40, 12288
buffer_store_dwordx4 a[184:187], v1, s[84:87], s40 offen offset:2048 sc1
s_mov_b32 s40, 12288
buffer_store_dwordx4 a[188:191], v1, s[84:87], s40 offen offset:3072 sc1
s_cmp_lg_u32 s20, 0
s_cbranch_scc1 K2_kv_got
s_waitcnt vmcnt(16)
s_branch K2_kv_chk
K2_kv_noq:
s_cmp_lg_u32 s20, 0
s_cbranch_scc1 K2_kv_got
K2_kv_spin:
buffer_load_dword v10, v11, s[92:95], 0 offen sc1
buffer_load_dword v12, v13, s[92:95], 0 offen sc1
s_waitcnt vmcnt(0)
K2_kv_chk:
v_readfirstlane_b32 s6, v10
v_readfirstlane_b32 s3, v12
s_nop 3
s_cmp_ge_u32 s6, 16
s_cselect_b32 s6, 1, 0
s_cmp_ge_u32 s3, s7
s_cselect_b32 s3, 1, 0
s_and_b32 s6, s6, s3
s_cbranch_scc1 K2_kv_got
s_add_u32 s41, s41, 1
s_cmp_lt_u32 s41, 0x40000
s_cbranch_scc0 K2_kv_got
s_sleep 1
s_branch K2_kv_spin
K2_kv_got:
s_barrier
s_cmp_lg_u32 s37, 0
s_cbranch_scc1 K2_q_have
s_mov_b32 s40, 0
buffer_load_dwordx4 a[128:131], v1, s[84:87], s40 offen offset:0 sc1
s_mov_b32 s40, 0
buffer_load_dwordx4 a[132:135], v1, s[84:87], s40 offen offset:1024 sc1
s_mov_b32 s40, 0
buffer_load_dwordx4 a[136:139], v1, s[84:87], s40 offen offset:2048 sc1
s_mov_b32 s40, 0
buffer_load_dwordx4 a[140:143], v1, s[84:87], s40 offen offset:3072 sc1
s_mov_b32 s40, 4096
buffer_load_dwordx4 a[144:147], v1, s[84:87], s40 offen offset:0 sc1
s_mov_b32 s40, 4096
buffer_load_dwordx4 a[148:151], v1, s[84:87], s40 offen offset:1024 sc1
s_mov_b32 s40, 4096
buffer_load_dwordx4 a[152:155], v1, s[84:87], s40 offen offset:2048 sc1
s_mov_b32 s40, 4096
buffer_load_dwordx4 a[156:159], v1, s[84:87], s40 offen offset:3072 sc1
s_mov_b32 s40, 8192
buffer_load_dwordx4 a[160:163], v1, s[84:87], s40 offen offset:0 sc1
s_mov_b32 s40, 8192
buffer_load_dwordx4 a[164:167], v1, s[84:87], s40 offen offset:1024 sc1
s_mov_b32 s40, 8192
buffer_load_dwordx4 a[168:171], v1, s[84:87], s40 offen offset:2048 sc1
s_mov_b32 s40, 8192
buffer_load_dwordx4 a[172:175], v1, s[84:87], s40 offen offset:3072 sc1
s_mov_b32 s40, 12288
buffer_load_dwordx4 a[176:179], v1, s[84:87], s40 offen offset:0 sc1
s_mov_b32 s40, 12288
buffer_load_dwordx4 a[180:183], v1, s[84:87], s40 offen offset:1024 sc1
s_mov_b32 s40, 12288
buffer_load_dwordx4 a[184:187], v1, s[84:87], s40 offen offset:2048 sc1
s_mov_b32 s40, 12288
buffer_load_dwordx4 a[188:191], v1, s[84:87], s40 offen offset:3072 sc1
K2_q_have:
s_add_u32 m0, s29, s27
s_add_u32 s31, s25, 4096
buffer_load_dwordx4 v4, s[8:11], s25 offen lds
buffer_load_dwordx4 v4, s[8:11], s25 offen offset:1024 lds
buffer_load_dwordx4 v4, s[8:11], s25 offen offset:2048 lds
buffer_load_dwordx4 v4, s[8:11], s25 offen offset:3072 lds
s_add_u32 m0, m0, 4096
s_add_u32 s25, s25, 32768
buffer_load_dwordx4 v4, s[8:11], s31 offen lds
buffer_load_dwordx4 v4, s[8:11], s31 offen offset:1024 lds
buffer_load_dwordx4 v4, s[8:11], s31 offen offset:2048 lds
buffer_load_dwordx4 v4, s[8:11], s31 offen offset:3072 lds
s_add_u32 s27, s27, 32768
s_cmp_eq_u32 s27, 163840
s_cselect_b32 s27, 0, s27
s_add_u32 m0, s29, s27
s_add_u32 s31, s25, 4096
buffer_load_dwordx4 v4, s[8:11], s25 offen lds
buffer_load_dwordx4 v4, s[8:11], s25 offen offset:1024 lds
buffer_load_dwordx4 v4, s[8:11], s25 offen offset:2048 lds
buffer_load_dwordx4 v4, s[8:11], s25 offen offset:3072 lds
s_add_u32 m0, m0, 4096
s_add_u32 s25, s25, 32768
buffer_load_dwordx4 v4, s[8:11], s31 offen lds
buffer_load_dwordx4 v4, s[8:11], s31 offen offset:1024 lds
buffer_load_dwordx4 v4, s[8:11], s31 offen offset:2048 lds
buffer_load_dwordx4 v4, s[8:11], s31 offen offset:3072 lds
s_add_u32 s27, s27, 32768
s_cmp_eq_u32 s27, 163840
s_cselect_b32 s27, 0, s27
s_add_u32 m0, s29, s27
s_add_u32 s31, s26, 4096
buffer_load_dwordx4 v4, s[8:11], s26 offen lds
buffer_load_dwordx4 v4, s[8:11], s26 offen offset:1024 lds
buffer_load_dwordx4 v4, s[8:11], s26 offen offset:2048 lds
buffer_load_dwordx4 v4, s[8:11], s26 offen offset:3072 lds
s_add_u32 m0, m0, 4096
s_add_u32 s26, s26, 32768
buffer_load_dwordx4 v4, s[8:11], s31 offen lds
buffer_load_dwordx4 v4, s[8:11], s31 offen offset:1024 lds
buffer_load_dwordx4 v4, s[8:11], s31 offen offset:2048 lds
buffer_load_dwordx4 v4, s[8:11], s31 offen offset:3072 lds
s_add_u32 s27, s27, 32768
s_cmp_eq_u32 s27, 163840
s_cselect_b32 s27, 0, s27
s_add_u32 m0, s29, s27
s_add_u32 s31, s25, 4096
buffer_load_dwordx4 v4, s[8:11], s25 offen lds
buffer_load_dwordx4 v4, s[8:11], s25 offen offset:1024 lds
buffer_load_dwordx4 v4, s[8:11], s25 offen offset:2048 lds
buffer_load_dwordx4 v4, s[8:11], s25 offen offset:3072 lds
s_add_u32 m0, m0, 4096
s_add_u32 s25, s25, 32768
buffer_load_dwordx4 v4, s[8:11], s31 offen lds
buffer_load_dwordx4 v4, s[8:11], s31 offen offset:1024 lds
buffer_load_dwordx4 v4, s[8:11], s31 offen offset:2048 lds
buffer_load_dwordx4 v4, s[8:11], s31 offen offset:3072 lds
s_add_u32 s27, s27, 32768
s_cmp_eq_u32 s27, 163840
s_cselect_b32 s27, 0, s27
s_mov_b32 s28, 65536
v_add_u32 v3, s28, v1
s_add_u32 s28, s28, 32768
s_cmp_eq_u32 s28, 163840
s_cselect_b32 s28, 0, s28
v_add_u32 v2, s28, v1
s_add_u32 s28, s28, 32768
s_cmp_eq_u32 s28, 163840
s_cselect_b32 s28, 0, s28
s_cmp_lg_u32 s37, 2
s_cbranch_scc1 K2_qw
s_waitcnt vmcnt(0)
K2_qw:
s_waitcnt vmcnt(16)
s_barrier
s_cmp_lg_u32 s37, 2
s_cbranch_scc1 K2_qa
s_cmp_lg_u32 s20, 0
s_cbranch_scc1 K2_qa
s_add_u32 s40, s21, 64
s_lshl_b32 s40, s40, 7
v_mov_b32 v11, s40
v_mov_b32 v10, 1
v_cmp_eq_u32 vcc, 0, v1
s_and_saveexec_b64 s[40:41], vcc
buffer_atomic_add v10, v11, s[92:95], 0 offen sc1
s_mov_b64 exec, s[40:41]
s_nop 4
K2_qa:
ds_read_b128 v[128:131], v3 offset:0
ds_read_b128 v[132:135], v3 offset:1024
ds_read_b128 v[136:139], v3 offset:2048
ds_read_b128 v[140:143], v3 offset:3072
ds_read_b128 v[144:147], v3 offset:4096
ds_read_b128 v[148:151], v3 offset:5120
ds_read_b128 v[152:155], v3 offset:6144
ds_read_b128 v[156:159], v3 offset:7168
ds_read_b128 v[160:163], v3 offset:8192
ds_read_b128 v[164:167], v3 offset:9216
ds_read_b128 v[168:171], v3 offset:10240
ds_read_b128 v[172:175], v3 offset:11264
s_branch K2_afterq
K2_B2:
s_mov_b32 s22, s33
s_mov_b32 s23, 0
s_lshl_b32 s24, s33, 1
s_mov_b32 s37, 1
K2_seg:
s_waitcnt vmcnt(0) lgkmcnt(0)
s_barrier
s_mov_b32 s27, 65536
s_lshl_b32 s25, s23, 15
s_add_u32 s26, s25, 16777216
v_accvgpr_mov_b32 a128, a192
v_accvgpr_mov_b32 a129, a193
v_accvgpr_mov_b32 a130, a194
v_accvgpr_mov_b32 a131, a195
v_accvgpr_mov_b32 a132, a196
v_accvgpr_mov_b32 a133, a197
v_accvgpr_mov_b32 a134, a198
v_accvgpr_mov_b32 a135, a199
v_accvgpr_mov_b32 a136, a200
v_accvgpr_mov_b32 a137, a201
v_accvgpr_mov_b32 a138, a202
v_accvgpr_mov_b32 a139, a203
v_accvgpr_mov_b32 a140, a204
v_accvgpr_mov_b32 a141, a205
v_accvgpr_mov_b32 a142, a206
v_accvgpr_mov_b32 a143, a207
v_accvgpr_mov_b32 a144, a208
v_accvgpr_mov_b32 a145, a209
v_accvgpr_mov_b32 a146, a210
v_accvgpr_mov_b32 a147, a211
v_accvgpr_mov_b32 a148, a212
v_accvgpr_mov_b32 a149, a213
v_accvgpr_mov_b32 a150, a214
v_accvgpr_mov_b32 a151, a215
v_accvgpr_mov_b32 a152, a216
v_accvgpr_mov_b32 a153, a217
v_accvgpr_mov_b32 a154, a218
v_accvgpr_mov_b32 a155, a219
v_accvgpr_mov_b32 a156, a220
v_accvgpr_mov_b32 a157, a221
v_accvgpr_mov_b32 a158, a222
v_accvgpr_mov_b32 a159, a223
v_accvgpr_mov_b32 a160, a224
v_accvgpr_mov_b32 a161, a225
v_accvgpr_mov_b32 a162, a226
v_accvgpr_mov_b32 a163, a227
v_accvgpr_mov_b32 a164, a228
v_accvgpr_mov_b32 a165, a229
v_accvgpr_mov_b32 a166, a230
v_accvgpr_mov_b32 a167, a231
v_accvgpr_mov_b32 a168, a232
v_accvgpr_mov_b32 a169, a233
v_accvgpr_mov_b32 a170, a234
v_accvgpr_mov_b32 a171, a235
v_accvgpr_mov_b32 a172, a236
v_accvgpr_mov_b32 a173, a237
v_accvgpr_mov_b32 a174, a238
v_accvgpr_mov_b32 a175, a239
v_accvgpr_mov_b32 a176, a240
v_accvgpr_mov_b32 a177, a241
v_accvgpr_mov_b32 a178, a242
v_accvgpr_mov_b32 a179, a243
v_accvgpr_mov_b32 a180, a244
v_accvgpr_mov_b32 a181, a245
v_accvgpr_mov_b32 a182, a246
v_accvgpr_mov_b32 a183, a247
v_accvgpr_mov_b32 a184, a248
v_accvgpr_mov_b32 a185, a249
v_accvgpr_mov_b32 a186, a250
v_accvgpr_mov_b32 a187, a251
v_accvgpr_mov_b32 a188, a252
v_accvgpr_mov_b32 a189, a253
v_accvgpr_mov_b32 a190, a254
v_accvgpr_mov_b32 a191, a255
v_mov_b32 v104, 0
v_mov_b32 v105, 0
v_mov_b32 v106, 0
v_mov_b32 v107, 0
v_mov_b32 v108, 0
v_mov_b32 v109, 0
v_mov_b32 v110, 0
v_mov_b32 v111, 0
v_mov_b32 v96, 0
v_mov_b32 v97, 0
v_mov_b32 v98, 0
v_mov_b32 v99, 0
v_mov_b32 v100, 0
v_mov_b32 v101, 0
v_mov_b32 v102, 0
v_mov_b32 v103, 0
s_add_u32 m0, s29, s27
s_add_u32 s31, s25, 4096
buffer_load_dwordx4 v4, s[8:11], s25 offen lds
buffer_load_dwordx4 v4, s[8:11], s25 offen offset:1024 lds
buffer_load_dwordx4 v4, s[8:11], s25 offen offset:2048 lds
buffer_load_dwordx4 v4, s[8:11], s25 offen offset:3072 lds
s_add_u32 m0, m0, 4096
s_add_u32 s25, s25, 32768
buffer_load_dwordx4 v4, s[8:11], s31 offen lds
buffer_load_dwordx4 v4, s[8:11], s31 offen offset:1024 lds
buffer_load_dwordx4 v4, s[8:11], s31 offen offset:2048 lds
buffer_load_dwordx4 v4, s[8:11], s31 offen offset:3072 lds
s_add_u32 s27, s27, 32768
s_cmp_eq_u32 s27, 163840
s_cselect_b32 s27, 0, s27
s_add_u32 m0, s29, s27
s_add_u32 s31, s25, 4096
buffer_load_dwordx4 v4, s[8:11], s25 offen lds
buffer_load_dwordx4 v4, s[8:11], s25 offen offset:1024 lds
buffer_load_dwordx4 v4, s[8:11], s25 offen offset:2048 lds
buffer_load_dwordx4 v4, s[8:11], s25 offen offset:3072 lds
s_add_u32 m0, m0, 4096
s_add_u32 s25, s25, 32768
buffer_load_dwordx4 v4, s[8:11], s31 offen lds
buffer_load_dwordx4 v4, s[8:11], s31 offen offset:1024 lds
buffer_load_dwordx4 v4, s[8:11], s31 offen offset:2048 lds
buffer_load_dwordx4 v4, s[8:11], s31 offen offset:3072 lds
s_add_u32 s27, s27, 32768
s_cmp_eq_u32 s27, 163840
s_cselect_b32 s27, 0, s27
s_add_u32 m0, s29, s27
s_add_u32 s31, s26, 4096
buffer_load_dwordx4 v4, s[8:11], s26 offen lds
buffer_load_dwordx4 v4, s[8:11], s26 offen offset:1024 lds
buffer_load_dwordx4 v4, s[8:11], s26 offen offset:2048 lds
buffer_load_dwordx4 v4, s[8:11], s26 offen offset:3072 lds
s_add_u32 m0, m0, 4096
s_add_u32 s26, s26, 32768
buffer_load_dwordx4 v4, s[8:11], s31 offen lds
buffer_load_dwordx4 v4, s[8:11], s31 offen offset:1024 lds
buffer_load_dwordx4 v4, s[8:11], s31 offen offset:2048 lds
buffer_load_dwordx4 v4, s[8:11], s31 offen offset:3072 lds
s_add_u32 s27, s27, 32768
s_cmp_eq_u32 s27, 163840
s_cselect_b32 s27, 0, s27
s_add_u32 m0, s29, s27
s_add_u32 s31, s25, 4096
buffer_load_dwordx4 v4, s[8:11], s25 offen lds
buffer_load_dwordx4 v4, s[8:11], s25 offen offset:1024 lds
buffer_load_dwordx4 v4, s[8:11], s25 offen offset:2048 lds
buffer_load_dwordx4 v4, s[8:11], s25 offen offset:3072 lds
s_add_u32 m0, m0, 4096
s_add_u32 s25, s25, 32768
buffer_load_dwordx4 v4, s[8:11], s31 offen lds
buffer_load_dwordx4 v4, s[8:11], s31 offen offset:1024 lds
buffer_load_dwordx4 v4, s[8:11], s31 offen offset:2048 lds
buffer_load_dwordx4 v4, s[8:11], s31 offen offset:3072 lds
s_add_u32 s27, s27, 32768
s_cmp_eq_u32 s27, 163840
s_cselect_b32 s27, 0, s27
s_mov_b32 s28, 65536
v_add_u32 v3, s28, v1
s_add_u32 s28, s28, 32768
s_cmp_eq_u32 s28, 163840
s_cselect_b32 s28, 0, s28
v_add_u32 v2, s28, v1
s_add_u32 s28, s28, 32768
s_cmp_eq_u32 s28, 163840
s_cselect_b32 s28, 0, s28
s_waitcnt vmcnt(16)
s_barrier
ds_read_b128 v[128:131], v3 offset:0
ds_read_b128 v[132:135], v3 offset:1024
ds_read_b128 v[136:139], v3 offset:2048
ds_read_b128 v[140:143], v3 offset:3072
ds_read_b128 v[144:147], v3 offset:4096
ds_read_b128 v[148:151], v3 offset:5120
ds_read_b128 v[152:155], v3 offset:6144
ds_read_b128 v[156:159], v3 offset:7168
ds_read_b128 v[160:163], v3 offset:8192
ds_read_b128 v[164:167], v3 offset:9216
ds_read_b128 v[168:171], v3 offset:10240
ds_read_b128 v[172:175], v3 offset:11264
K2_afterq:
s_waitcnt lgkmcnt(8)
v_mfma_f32_16x16x32_bf16 v[48:51], v[128:131], a[128:131], 0
s_add_u32 m0, s29, s27
v_accvgpr_write_b32 a0, 0
v_accvgpr_write_b32 a1, 0
v_mfma_f32_16x16x32_bf16 v[52:55], v[128:131], a[160:163], 0
s_add_u32 s31, s26, 4096
buffer_load_dwordx4 v4, s[8:11], s26 offen lds
v_mfma_f32_16x16x32_bf16 v[48:51], v[132:135], a[132:135], v[48:51]
v_accvgpr_write_b32 a2, 0
v_accvgpr_write_b32 a3, 0
v_mfma_f32_16x16x32_bf16 v[52:55], v[132:135], a[164:167], v[52:55]
v_accvgpr_write_b32 a4, 0
v_accvgpr_write_b32 a5, 0
v_mfma_f32_16x16x32_bf16 v[48:51], v[136:139], a[136:139], v[48:51]
v_accvgpr_write_b32 a6, 0
v_accvgpr_write_b32 a7, 0
v_mfma_f32_16x16x32_bf16 v[52:55], v[136:139], a[168:171], v[52:55]
v_accvgpr_write_b32 a8, 0
v_accvgpr_write_b32 a9, 0
v_mfma_f32_16x16x32_bf16 v[48:51], v[140:143], a[140:143], v[48:51]
buffer_load_dwordx4 v4, s[8:11], s26 offen offset:1024 lds
v_mfma_f32_16x16x32_bf16 v[52:55], v[140:143], a[172:175], v[52:55]
s_waitcnt lgkmcnt(4)
v_accvgpr_write_b32 a10, 0
v_accvgpr_write_b32 a11, 0
v_mfma_f32_16x16x32_bf16 v[48:51], v[144:147], a[144:147], v[48:51]
v_accvgpr_write_b32 a12, 0
v_accvgpr_write_b32 a13, 0
v_mfma_f32_16x16x32_bf16 v[52:55], v[144:147], a[176:179], v[52:55]
v_accvgpr_write_b32 a14, 0
v_accvgpr_write_b32 a15, 0
v_mfma_f32_16x16x32_bf16 v[48:51], v[148:151], a[148:151], v[48:51]
v_accvgpr_write_b32 a16, 0
v_accvgpr_write_b32 a17, 0
v_mfma_f32_16x16x32_bf16 v[52:55], v[148:151], a[180:183], v[52:55]
ds_read_b128 v[176:179], v3 offset:12288
v_accvgpr_write_b32 a18, 0
v_mfma_f32_16x16x32_bf16 v[48:51], v[152:155], a[152:155], v[48:51]
v_accvgpr_write_b32 a19, 0
v_accvgpr_write_b32 a20, 0
v_mfma_f32_16x16x32_bf16 v[52:55], v[152:155], a[184:187], v[52:55]
v_accvgpr_write_b32 a21, 0
v_accvgpr_write_b32 a22, 0
v_mfma_f32_16x16x32_bf16 v[48:51], v[156:159], a[156:159], v[48:51]
v_accvgpr_write_b32 a23, 0
v_accvgpr_write_b32 a24, 0
v_mfma_f32_16x16x32_bf16 v[52:55], v[156:159], a[188:191], v[52:55]
s_waitcnt lgkmcnt(1)
v_accvgpr_write_b32 a25, 0
v_accvgpr_write_b32 a26, 0
v_mfma_f32_16x16x32_bf16 v[56:59], v[160:163], a[128:131], 0
ds_read_b128 v[180:183], v3 offset:13312
ds_read_b128 v[184:187], v3 offset:14336
ds_read_b128 v[188:191], v3 offset:15360
v_accvgpr_write_b32 a27, 0
v_mfma_f32_16x16x32_bf16 v[60:63], v[160:163], a[160:163], 0
v_accvgpr_write_b32 a28, 0
v_accvgpr_write_b32 a29, 0
v_mfma_f32_16x16x32_bf16 v[56:59], v[164:167], a[132:135], v[56:59]
v_accvgpr_write_b32 a30, 0
v_accvgpr_write_b32 a31, 0
v_mfma_f32_16x16x32_bf16 v[60:63], v[164:167], a[164:167], v[60:63]
buffer_load_dwordx4 v4, s[8:11], s26 offen offset:2048 lds
v_accvgpr_write_b32 a32, 0
v_accvgpr_write_b32 a33, 0
v_mfma_f32_16x16x32_bf16 v[56:59], v[168:171], a[136:139], v[56:59]
v_accvgpr_write_b32 a34, 0
v_accvgpr_write_b32 a35, 0
v_mfma_f32_16x16x32_bf16 v[60:63], v[168:171], a[168:171], v[60:63]
v_accvgpr_write_b32 a36, 0
v_accvgpr_write_b32 a37, 0
v_mfma_f32_16x16x32_bf16 v[56:59], v[172:175], a[140:143], v[56:59]
v_accvgpr_write_b32 a38, 0
v_accvgpr_write_b32 a39, 0
v_mfma_f32_16x16x32_bf16 v[60:63], v[172:175], a[172:175], v[60:63]
s_waitcnt lgkmcnt(0)
v_accvgpr_write_b32 a40, 0
v_accvgpr_write_b32 a41, 0
v_mfma_f32_16x16x32_bf16 v[56:59], v[176:179], a[144:147], v[56:59]
ds_read_b128 v[128:131], v3 offset:16384
ds_read_b128 v[132:135], v3 offset:17408
ds_read_b128 v[136:139], v3 offset:18432
ds_read_b128 v[140:143], v3 offset:19456
v_accvgpr_write_b32 a42, 0
v_accvgpr_write_b32 a43, 0
v_mfma_f32_16x16x32_bf16 v[60:63], v[176:179], a[176:179], v[60:63]
buffer_load_dwordx4 v4, s[8:11], s26 offen offset:3072 lds
v_accvgpr_write_b32 a44, 0
v_accvgpr_write_b32 a45, 0
v_mfma_f32_16x16x32_bf16 v[56:59], v[180:183], a[148:151], v[56:59]
s_add_u32 m0, m0, 4096
v_accvgpr_write_b32 a46, 0
v_accvgpr_write_b32 a47, 0
v_mfma_f32_16x16x32_bf16 v[60:63], v[180:183], a[180:183], v[60:63]
s_add_u32 s26, s26, 32768
v_accvgpr_write_b32 a48, 0
v_accvgpr_write_b32 a49, 0
v_mfma_f32_16x16x32_bf16 v[56:59], v[184:187], a[152:155], v[56:59]
v_accvgpr_write_b32 a50, 0
v_accvgpr_write_b32 a51, 0
v_mfma_f32_16x16x32_bf16 v[60:63], v[184:187], a[184:187], v[60:63]
v_accvgpr_write_b32 a52, 0
v_accvgpr_write_b32 a53, 0
v_mfma_f32_16x16x32_bf16 v[56:59], v[188:191], a[156:159], v[56:59]
v_accvgpr_write_b32 a54, 0
v_accvgpr_write_b32 a55, 0
v_mfma_f32_16x16x32_bf16 v[60:63], v[188:191], a[188:191], v[60:63]
s_waitcnt lgkmcnt(0)
v_accvgpr_write_b32 a56, 0
v_accvgpr_write_b32 a57, 0
v_mfma_f32_16x16x32_bf16 v[64:67], v[128:131], a[128:131], 0
ds_read_b128 v[144:147], v3 offset:20480
ds_read_b128 v[148:151], v3 offset:21504
ds_read_b128 v[152:155], v3 offset:22528
ds_read_b128 v[156:159], v3 offset:23552
buffer_load_dwordx4 v4, s[8:11], s31 offen lds
v_accvgpr_write_b32 a58, 0
v_accvgpr_write_b32 a59, 0
v_mfma_f32_16x16x32_bf16 v[68:71], v[128:131], a[160:163], 0
v_accvgpr_write_b32 a60, 0
v_accvgpr_write_b32 a61, 0
v_mfma_f32_16x16x32_bf16 v[64:67], v[132:135], a[132:135], v[64:67]
v_accvgpr_write_b32 a62, 0
v_accvgpr_write_b32 a63, 0
v_accvgpr_write_b32 a64, 0
v_mfma_f32_16x16x32_bf16 v[68:71], v[132:135], a[164:167], v[68:71]
v_accvgpr_write_b32 a65, 0
v_accvgpr_write_b32 a66, 0
v_mfma_f32_16x16x32_bf16 v[64:67], v[136:139], a[136:139], v[64:67]
v_accvgpr_write_b32 a67, 0
v_accvgpr_write_b32 a68, 0
v_mfma_f32_16x16x32_bf16 v[68:71], v[136:139], a[168:171], v[68:71]
v_accvgpr_write_b32 a69, 0
v_accvgpr_write_b32 a70, 0
v_mfma_f32_16x16x32_bf16 v[64:67], v[140:143], a[140:143], v[64:67]
v_accvgpr_write_b32 a71, 0
v_accvgpr_write_b32 a72, 0
v_mfma_f32_16x16x32_bf16 v[68:71], v[140:143], a[172:175], v[68:71]
s_waitcnt lgkmcnt(0)
buffer_load_dwordx4 v4, s[8:11], s31 offen offset:1024 lds
v_accvgpr_write_b32 a73, 0
v_accvgpr_write_b32 a74, 0
v_mfma_f32_16x16x32_bf16 v[64:67], v[144:147], a[144:147], v[64:67]
ds_read_b128 v[160:163], v3 offset:24576
ds_read_b128 v[164:167], v3 offset:25600
ds_read_b128 v[168:171], v3 offset:26624
ds_read_b128 v[172:175], v3 offset:27648
v_accvgpr_write_b32 a75, 0
v_accvgpr_write_b32 a76, 0
v_mfma_f32_16x16x32_bf16 v[68:71], v[144:147], a[176:179], v[68:71]
v_accvgpr_write_b32 a77, 0
v_accvgpr_write_b32 a78, 0
v_mfma_f32_16x16x32_bf16 v[64:67], v[148:151], a[148:151], v[64:67]
v_accvgpr_write_b32 a79, 0
v_accvgpr_write_b32 a80, 0
v_mfma_f32_16x16x32_bf16 v[68:71], v[148:151], a[180:183], v[68:71]
v_accvgpr_write_b32 a81, 0
v_accvgpr_write_b32 a82, 0
v_mfma_f32_16x16x32_bf16 v[64:67], v[152:155], a[152:155], v[64:67]
v_accvgpr_write_b32 a83, 0
v_accvgpr_write_b32 a84, 0
v_mfma_f32_16x16x32_bf16 v[68:71], v[152:155], a[184:187], v[68:71]
buffer_load_dwordx4 v4, s[8:11], s31 offen offset:2048 lds
v_accvgpr_write_b32 a85, 0
v_accvgpr_write_b32 a86, 0
v_mfma_f32_16x16x32_bf16 v[64:67], v[156:159], a[156:159], v[64:67]
v_accvgpr_write_b32 a87, 0
v_accvgpr_write_b32 a88, 0
v_mfma_f32_16x16x32_bf16 v[68:71], v[156:159], a[188:191], v[68:71]
s_waitcnt lgkmcnt(0)
v_accvgpr_write_b32 a89, 0
v_accvgpr_write_b32 a90, 0
v_mfma_f32_16x16x32_bf16 v[72:75], v[160:163], a[128:131], 0
ds_read_b128 v[176:179], v3 offset:28672
ds_read_b128 v[180:183], v3 offset:29696
ds_read_b128 v[184:187], v3 offset:30720
ds_read_b128 v[188:191], v3 offset:31744
v_accvgpr_write_b32 a91, 0
v_accvgpr_write_b32 a92, 0
v_mfma_f32_16x16x32_bf16 v[76:79], v[160:163], a[160:163], 0
v_accvgpr_write_b32 a93, 0
v_accvgpr_write_b32 a94, 0
v_mfma_f32_16x16x32_bf16 v[72:75], v[164:167], a[132:135], v[72:75]
v_accvgpr_write_b32 a95, 0
v_accvgpr_write_b32 a96, 0
v_mfma_f32_16x16x32_bf16 v[76:79], v[164:167], a[164:167], v[76:79]
v_accvgpr_write_b32 a97, 0
v_accvgpr_write_b32 a98, 0
v_mfma_f32_16x16x32_bf16 v[72:75], v[168:171], a[136:139], v[72:75]
buffer_load_dwordx4 v4, s[8:11], s31 offen offset:3072 lds
v_accvgpr_write_b32 a99, 0
v_accvgpr_write_b32 a100, 0
v_mfma_f32_16x16x32_bf16 v[76:79], v[168:171], a[168:171], v[76:79]
s_add_u32 s27, s27, 32768
s_cmp_eq_u32 s27, 163840
s_cselect_b32 s27, 0, s27
v_accvgpr_write_b32 a101, 0
v_accvgpr_write_b32 a102, 0
v_mfma_f32_16x16x32_bf16 v[72:75], v[172:175], a[140:143], v[72:75]
v_accvgpr_write_b32 a103, 0
v_accvgpr_write_b32 a104, 0
v_mfma_f32_16x16x32_bf16 v[76:79], v[172:175], a[172:175], v[76:79]
s_waitcnt vmcnt(16) lgkmcnt(0)
v_accvgpr_write_b32 a105, 0
v_accvgpr_write_b32 a106, 0
v_mfma_f32_16x16x32_bf16 v[72:75], v[176:179], a[144:147], v[72:75]
s_barrier
ds_read_b128 v[128:131], v2 offset:0
ds_read_b128 v[132:135], v2 offset:1024
ds_read_b128 v[136:139], v2 offset:2048
ds_read_b128 v[140:143], v2 offset:3072
v_accvgpr_write_b32 a107, 0
v_accvgpr_write_b32 a108, 0
v_mfma_f32_16x16x32_bf16 v[76:79], v[176:179], a[176:179], v[76:79]
v_accvgpr_write_b32 a109, 0
v_accvgpr_write_b32 a110, 0
v_mfma_f32_16x16x32_bf16 v[72:75], v[180:183], a[148:151], v[72:75]
v_add_u32 v3, s28, v1
s_add_u32 s28, s28, 32768
s_cmp_eq_u32 s28, 163840
s_cselect_b32 s28, 0, s28
v_accvgpr_write_b32 a111, 0
v_accvgpr_write_b32 a112, 0
v_mfma_f32_16x16x32_bf16 v[76:79], v[180:183], a[180:183], v[76:79]
v_accvgpr_write_b32 a113, 0
v_accvgpr_write_b32 a114, 0
v_mfma_f32_16x16x32_bf16 v[72:75], v[184:187], a[152:155], v[72:75]
v_accvgpr_write_b32 a115, 0
v_accvgpr_write_b32 a116, 0
v_mfma_f32_16x16x32_bf16 v[76:79], v[184:187], a[184:187], v[76:79]
v_accvgpr_write_b32 a117, 0
v_accvgpr_write_b32 a118, 0
v_mfma_f32_16x16x32_bf16 v[72:75], v[188:191], a[156:159], v[72:75]
v_accvgpr_write_b32 a119, 0
v_accvgpr_write_b32 a120, 0
v_mfma_f32_16x16x32_bf16 v[76:79], v[188:191], a[188:191], v[76:79]
ds_read_b128 v[144:147], v2 offset:4096
ds_read_b128 v[148:151], v2 offset:5120
ds_read_b128 v[152:155], v2 offset:6144
ds_read_b128 v[156:159], v2 offset:7168
ds_read_b128 v[160:163], v2 offset:8192
ds_read_b128 v[164:167], v2 offset:9216
ds_read_b128 v[168:171], v2 offset:10240
ds_read_b128 v[172:175], v2 offset:11264
v_accvgpr_write_b32 a121, 0
v_accvgpr_write_b32 a122, 0
v_accvgpr_write_b32 a123, 0
v_accvgpr_write_b32 a124, 0
v_accvgpr_write_b32 a125, 0
v_accvgpr_write_b32 a126, 0
v_accvgpr_write_b32 a127, 0
s_nop 7
s_cmp_lg_u32 s24, 0
s_cbranch_scc1 K2_pro1_nomask
s_lshl_b32 s30, s20, 5
s_sub_i32 s30, s30, 0
v_sub_u32 v6, s30, v5
v_mov_b32 v7, 0xff800000
v_cmp_le_i32 s[84:85], 0, v6
v_cmp_le_i32 s[86:87], 1, v6
v_cmp_le_i32 s[88:89], 2, v6
v_cmp_le_i32 s[90:91], 3, v6
v_cndmask_b32 v48, v7, v48, s[84:85]
v_cndmask_b32 v49, v7, v49, s[86:87]
v_cndmask_b32 v50, v7, v50, s[88:89]
v_cndmask_b32 v51, v7, v51, s[90:91]
v_cmp_le_i32 s[84:85], -16, v6
v_cmp_le_i32 s[86:87], -15, v6
v_cmp_le_i32 s[88:89], -14, v6
v_cmp_le_i32 s[90:91], -13, v6
v_cndmask_b32 v52, v7, v52, s[84:85]
v_cndmask_b32 v53, v7, v53, s[86:87]
v_cndmask_b32 v54, v7, v54, s[88:89]
v_cndmask_b32 v55, v7, v55, s[90:91]
v_cmp_le_i32 s[84:85], 16, v6
v_cmp_le_i32 s[86:87], 17, v6
v_cmp_le_i32 s[88:89], 18, v6
v_cmp_le_i32 s[90:91], 19, v6
v_cndmask_b32 v56, v7, v56, s[84:85]
v_cndmask_b32 v57, v7, v57, s[86:87]
v_cndmask_b32 v58, v7, v58, s[88:89]
v_cndmask_b32 v59, v7, v59, s[90:91]
v_cmp_le_i32 s[84:85], 0, v6
v_cmp_le_i32 s[86:87], 1, v6
v_cmp_le_i32 s[88:89], 2, v6
v_cmp_le_i32 s[90:91], 3, v6
v_cndmask_b32 v60, v7, v60, s[84:85]
v_cndmask_b32 v61, v7, v61, s[86:87]
v_cndmask_b32 v62, v7, v62, s[88:89]
v_cndmask_b32 v63, v7, v63, s[90:91]
v_cmp_le_i32 s[84:85], 32, v6
v_cmp_le_i32 s[86:87], 33, v6
v_cmp_le_i32 s[88:89], 34, v6
v_cmp_le_i32 s[90:91], 35, v6
v_cndmask_b32 v64, v7, v64, s[84:85]
v_cndmask_b32 v65, v7, v65, s[86:87]
v_cndmask_b32 v66, v7, v66, s[88:89]
v_cndmask_b32 v67, v7, v67, s[90:91]
v_cmp_le_i32 s[84:85], 16, v6
v_cmp_le_i32 s[86:87], 17, v6
v_cmp_le_i32 s[88:89], 18, v6
v_cmp_le_i32 s[90:91], 19, v6
v_cndmask_b32 v68, v7, v68, s[84:85]
v_cndmask_b32 v69, v7, v69, s[86:87]
v_cndmask_b32 v70, v7, v70, s[88:89]
v_cndmask_b32 v71, v7, v71, s[90:91]
v_cmp_le_i32 s[84:85], 48, v6
v_cmp_le_i32 s[86:87], 49, v6
v_cmp_le_i32 s[88:89], 50, v6
v_cmp_le_i32 s[90:91], 51, v6
v_cndmask_b32 v72, v7, v72, s[84:85]
v_cndmask_b32 v73, v7, v73, s[86:87]
v_cndmask_b32 v74, v7, v74, s[88:89]
v_cndmask_b32 v75, v7, v75, s[90:91]
v_cmp_le_i32 s[84:85], 32, v6
v_cmp_le_i32 s[86:87], 33, v6
v_cmp_le_i32 s[88:89], 34, v6
v_cmp_le_i32 s[90:91], 35, v6
v_cndmask_b32 v76, v7, v76, s[84:85]
v_cndmask_b32 v77, v7, v77, s[86:87]
v_cndmask_b32 v78, v7, v78, s[88:89]
v_cndmask_b32 v79, v7, v79, s[90:91]
K2_pro1_nomask:
v_max3_f32 v12, v48, v49, v50
v_max3_f32 v12, v12, v51, v56
v_max3_f32 v12, v12, v57, v58
v_max3_f32 v12, v12, v59, v64
v_max3_f32 v12, v12, v65, v66
v_max3_f32 v12, v12, v67, v72
v_max3_f32 v12, v12, v73, v74
v_max_f32 v12, v12, v75
v_max3_f32 v13, v52, v53, v54
v_max3_f32 v13, v13, v55, v60
v_max3_f32 v13, v13, v61, v62
v_max3_f32 v13, v13, v63, v68
v_max3_f32 v13, v13, v69, v70
v_max3_f32 v13, v13, v71, v76
v_max3_f32 v13, v13, v77, v78
v_max_f32 v13, v13, v79
v_mov_b32 v6, v12
v_mov_b32 v7, v13
s_nop 1
v_permlane16_swap_b32 v12, v6
v_permlane16_swap_b32 v13, v7
s_nop 1
v_max_f32 v12, v12, v6
v_max_f32 v13, v13, v7
v_mov_b32 v6, v12
v_mov_b32 v7, v13
s_nop 1
v_permlane32_swap_b32 v12, v6
v_permlane32_swap_b32 v13, v7
s_nop 1
v_max_f32 v12, v12, v6
v_max_f32 v13, v13, v7
v_sub_f32 v48, v48, v12
v_sub_f32 v49, v49, v12
v_sub_f32 v50, v50, v12
v_sub_f32 v51, v51, v12
v_sub_f32 v56, v56, v12
v_sub_f32 v57, v57, v12
v_sub_f32 v58, v58, v12
v_sub_f32 v59, v59, v12
v_sub_f32 v64, v64, v12
v_sub_f32 v65, v65, v12
v_sub_f32 v66, v66, v12
v_sub_f32 v67, v67, v12
v_sub_f32 v72, v72, v12
v_sub_f32 v73, v73, v12
v_sub_f32 v74, v74, v12
v_sub_f32 v75, v75, v12
v_sub_f32 v96, 0, v12
v_sub_f32 v97, 0, v12
v_sub_f32 v98, 0, v12
v_sub_f32 v99, 0, v12
v_sub_f32 v52, v52, v13
v_sub_f32 v53, v53, v13
v_sub_f32 v54, v54, v13
v_sub_f32 v55, v55, v13
v_sub_f32 v60, v60, v13
v_sub_f32 v61, v61, v13
v_sub_f32 v62, v62, v13
v_sub_f32 v63, v63, v13
v_sub_f32 v68, v68, v13
v_sub_f32 v69, v69, v13
v_sub_f32 v70, v70, v13
v_sub_f32 v71, v71, v13
v_sub_f32 v76, v76, v13
v_sub_f32 v77, v77, v13
v_sub_f32 v78, v78, v13
v_sub_f32 v79, v79, v13
v_sub_f32 v100, 0, v13
v_sub_f32 v101, 0, v13
v_sub_f32 v102, 0, v13
v_sub_f32 v103, 0, v13
s_nop 1
s_mov_b32 s38, 0
s_cmp_eq_u32 s24, 0
s_cbranch_scc1 K2_it1d1
s_lshr_b32 s32, s24, 1
s_branch K2_it1
.p2align 3
K2_it0:
s_waitcnt lgkmcnt(8)
v_mfma_f32_16x16x32_bf16 v[48:51], v[128:131], a[128:131], v[96:99]
s_add_u32 m0, s29, s27
v_exp_f32 v16, v16
v_mfma_f32_16x16x32_bf16 v[52:55], v[128:131], a[160:163], v[100:103]
s_add_u32 s31, s25, 4096
buffer_load_dwordx4 v4, s[8:11], s25 offen lds
v_mfma_f32_16x16x32_bf16 v[48:51], v[132:135], a[132:135], v[48:51]
v_exp_f32 v17, v17
v_mfma_f32_16x16x32_bf16 v[52:55], v[132:135], a[164:167], v[52:55]
v_exp_f32 v18, v18
v_mfma_f32_16x16x32_bf16 v[48:51], v[136:139], a[136:139], v[48:51]
v_exp_f32 v19, v19
v_mfma_f32_16x16x32_bf16 v[52:55], v[136:139], a[168:171], v[52:55]
v_exp_f32 v24, v24
v_mfma_f32_16x16x32_bf16 v[48:51], v[140:143], a[140:143], v[48:51]
buffer_load_dwordx4 v4, s[8:11], s25 offen offset:1024 lds
v_mfma_f32_16x16x32_bf16 v[52:55], v[140:143], a[172:175], v[52:55]
s_waitcnt lgkmcnt(4)
v_exp_f32 v25, v25
v_mfma_f32_16x16x32_bf16 v[48:51], v[144:147], a[144:147], v[48:51]
v_exp_f32 v26, v26
v_mfma_f32_16x16x32_bf16 v[52:55], v[144:147], a[176:179], v[52:55]
ds_read_b128 v[176:179], v2 offset:12288
v_mfma_f32_16x16x32_bf16 v[48:51], v[148:151], a[148:151], v[48:51]
ds_read_b128 v[180:183], v2 offset:13312
v_mfma_f32_16x16x32_bf16 v[52:55], v[148:151], a[180:183], v[52:55]
ds_read_b128 v[184:187], v2 offset:14336
v_mfma_f32_16x16x32_bf16 v[48:51], v[152:155], a[152:155], v[48:51]
ds_read_b128 v[188:191], v2 offset:15360
v_mfma_f32_16x16x32_bf16 v[52:55], v[152:155], a[184:187], v[52:55]
v_exp_f32 v27, v27
v_mfma_f32_16x16x32_bf16 v[48:51], v[156:159], a[156:159], v[48:51]
buffer_load_dwordx4 v4, s[8:11], s25 offen offset:2048 lds
v_mfma_f32_16x16x32_bf16 v[52:55], v[156:159], a[188:191], v[52:55]
s_waitcnt lgkmcnt(4)
v_cvt_pk_bf16_f32 v80, v16, v17
v_cvt_pk_bf16_f32 v81, v18, v19
v_mfma_f32_16x16x32_bf16 v[56:59], v[160:163], a[128:131], v[96:99]
ds_read_b128 v[128:131], v2 offset:16384
v_cvt_pk_bf16_f32 v82, v24, v25
v_mfma_f32_16x16x32_bf16 v[60:63], v[160:163], a[160:163], v[100:103]
ds_read_b128 v[132:135], v2 offset:17408
v_cvt_pk_bf16_f32 v83, v26, v27
v_mfma_f32_16x16x32_bf16 v[56:59], v[164:167], a[132:135], v[56:59]
ds_read_b128 v[136:139], v2 offset:18432
v_mfma_f32_16x16x32_bf16 v[60:63], v[164:167], a[164:167], v[60:63]
ds_read_b128 v[140:143], v2 offset:19456
v_mfma_f32_16x16x32_bf16 v[56:59], v[168:171], a[136:139], v[56:59]
buffer_load_dwordx4 v4, s[8:11], s25 offen offset:3072 lds
v_mfma_f32_16x16x32_bf16 v[60:63], v[168:171], a[168:171], v[60:63]
v_exp_f32 v20, v20
v_mfma_f32_16x16x32_bf16 v[56:59], v[172:175], a[140:143], v[56:59]
v_exp_f32 v21, v21
v_mfma_f32_16x16x32_bf16 v[60:63], v[172:175], a[172:175], v[60:63]
s_waitcnt lgkmcnt(4)
v_exp_f32 v22, v22
v_mfma_f32_16x16x32_bf16 v[56:59], v[176:179], a[144:147], v[56:59]
s_add_u32 m0, m0, 4096
v_exp_f32 v23, v23
v_mfma_f32_16x16x32_bf16 v[60:63], v[176:179], a[176:179], v[60:63]
s_add_u32 s25, s25, 32768
ds_read_b128 v[144:147], v2 offset:20480
v_mfma_f32_16x16x32_bf16 v[56:59], v[180:183], a[148:151], v[56:59]
ds_read_b128 v[148:151], v2 offset:21504
v_mfma_f32_16x16x32_bf16 v[60:63], v[180:183], a[180:183], v[60:63]
ds_read_b128 v[152:155], v2 offset:22528
v_mfma_f32_16x16x32_bf16 v[56:59], v[184:187], a[152:155], v[56:59]
ds_read_b128 v[156:159], v2 offset:23552
v_mfma_f32_16x16x32_bf16 v[60:63], v[184:187], a[184:187], v[60:63]
buffer_load_dwordx4 v4, s[8:11], s31 offen lds
v_mfma_f32_16x16x32_bf16 v[56:59], v[188:191], a[156:159], v[56:59]
v_exp_f32 v28, v28
v_mfma_f32_16x16x32_bf16 v[60:63], v[188:191], a[188:191], v[60:63]
s_waitcnt lgkmcnt(4)
v_exp_f32 v29, v29
v_mfma_f32_16x16x32_bf16 v[64:67], v[128:131], a[128:131], v[96:99]
v_exp_f32 v30, v30
v_mfma_f32_16x16x32_bf16 v[68:71], v[128:131], a[160:163], v[100:103]
v_exp_f32 v31, v31
v_mfma_f32_16x16x32_bf16 v[64:67], v[132:135], a[132:135], v[64:67]
buffer_load_dwordx4 v4, s[8:11], s31 offen offset:1024 lds
v_mfma_f32_16x16x32_bf16 v[68:71], v[132:135], a[164:167], v[68:71]
ds_read_b128 v[160:163], v2 offset:24576
v_cvt_pk_bf16_f32 v84, v20, v21
v_mfma_f32_16x16x32_bf16 v[64:67], v[136:139], a[136:139], v[64:67]
ds_read_b128 v[164:167], v2 offset:25600
v_cvt_pk_bf16_f32 v85, v22, v23
v_mfma_f32_16x16x32_bf16 v[68:71], v[136:139], a[168:171], v[68:71]
ds_read_b128 v[168:171], v2 offset:26624
v_cvt_pk_bf16_f32 v86, v28, v29
v_mfma_f32_16x16x32_bf16 v[64:67], v[140:143], a[140:143], v[64:67]
ds_read_b128 v[172:175], v2 offset:27648
v_cvt_pk_bf16_f32 v87, v30, v31
v_mfma_f32_16x16x32_bf16 v[68:71], v[140:143], a[172:175], v[68:71]
s_waitcnt lgkmcnt(4)
buffer_load_dwordx4 v4, s[8:11], s31 offen offset:2048 lds
v_mfma_f32_16x16x32_bf16 v[64:67], v[144:147], a[144:147], v[64:67]
v_exp_f32 v32, v32
v_mfma_f32_16x16x32_bf16 v[68:71], v[144:147], a[176:179], v[68:71]
ds_read_b128 v[176:179], v2 offset:28672
v_mfma_f32_16x16x32_bf16 v[64:67], v[148:151], a[148:151], v[64:67]
ds_read_b128 v[180:183], v2 offset:29696
v_mfma_f32_16x16x32_bf16 v[68:71], v[148:151], a[180:183], v[68:71]
ds_read_b128 v[184:187], v2 offset:30720
v_mfma_f32_16x16x32_bf16 v[64:67], v[152:155], a[152:155], v[64:67]
ds_read_b128 v[188:191], v2 offset:31744
v_mfma_f32_16x16x32_bf16 v[68:71], v[152:155], a[184:187], v[68:71]
v_exp_f32 v33, v33
v_mfma_f32_16x16x32_bf16 v[64:67], v[156:159], a[156:159], v[64:67]
v_exp_f32 v34, v34
v_mfma_f32_16x16x32_bf16 v[68:71], v[156:159], a[188:191], v[68:71]
s_waitcnt lgkmcnt(4)
buffer_load_dwordx4 v4, s[8:11], s31 offen offset:3072 lds
v_mfma_f32_16x16x32_bf16 v[72:75], v[160:163], a[128:131], v[96:99]
v_exp_f32 v35, v35
v_mfma_f32_16x16x32_bf16 v[76:79], v[160:163], a[160:163], v[100:103]
v_exp_f32 v40, v40
v_mfma_f32_16x16x32_bf16 v[72:75], v[164:167], a[132:135], v[72:75]
s_add_u32 s27, s27, 32768
v_exp_f32 v41, v41
v_mfma_f32_16x16x32_bf16 v[76:79], v[164:167], a[164:167], v[76:79]
s_cmp_eq_u32 s27, 163840
s_cselect_b32 s27, 0, s27
ds_read_b128 v[128:131], v3 offset:0
v_add_u32 v2, s28, v1
v_mfma_f32_16x16x32_bf16 v[72:75], v[168:171], a[136:139], v[72:75]
s_add_u32 s28, s28, 32768
ds_read_b128 v[132:135], v3 offset:1024
s_cmp_eq_u32 s28, 163840
s_cselect_b32 s28, 0, s28
v_mfma_f32_16x16x32_bf16 v[76:79], v[168:171], a[168:171], v[76:79]
ds_read_b128 v[136:139], v3 offset:2048
v_mfma_f32_16x16x32_bf16 v[72:75], v[172:175], a[140:143], v[72:75]
ds_read_b128 v[140:143], v3 offset:3072
v_mfma_f32_16x16x32_bf16 v[76:79], v[172:175], a[172:175], v[76:79]
s_waitcnt vmcnt(16) lgkmcnt(4)
v_exp_f32 v42, v42
v_mfma_f32_16x16x32_bf16 v[72:75], v[176:179], a[144:147], v[72:75]
s_barrier
v_exp_f32 v43, v43
v_mfma_f32_16x16x32_bf16 v[76:79], v[176:179], a[176:179], v[76:79]
ds_read_b128 v[144:147], v3 offset:4096
v_cvt_pk_bf16_f32 v88, v32, v33
v_mfma_f32_16x16x32_bf16 v[72:75], v[180:183], a[148:151], v[72:75]
ds_read_b128 v[148:151], v3 offset:5120
v_cvt_pk_bf16_f32 v89, v34, v35
v_mfma_f32_16x16x32_bf16 v[76:79], v[180:183], a[180:183], v[76:79]
ds_read_b128 v[152:155], v3 offset:6144
v_cvt_pk_bf16_f32 v90, v40, v41
v_mfma_f32_16x16x32_bf16 v[72:75], v[184:187], a[152:155], v[72:75]
ds_read_b128 v[156:159], v3 offset:7168
v_cvt_pk_bf16_f32 v91, v42, v43
v_mfma_f32_16x16x32_bf16 v[76:79], v[184:187], a[184:187], v[76:79]
ds_read_b128 v[160:163], v3 offset:8192
v_mfma_f32_16x16x32_bf16 v[72:75], v[188:191], a[156:159], v[72:75]
ds_read_b128 v[164:167], v3 offset:9216
v_mfma_f32_16x16x32_bf16 v[76:79], v[188:191], a[188:191], v[76:79]
ds_read_b128 v[168:171], v3 offset:10240
ds_read_b128 v[172:175], v3 offset:11264
s_waitcnt lgkmcnt(8)
v_mfma_f32_16x16x32_bf16 a[0:3], v[128:131], v[80:83], a[0:3]
s_add_u32 m0, s29, s27
v_exp_f32 v36, v36
v_mfma_f32_16x16x32_bf16 a[4:7], v[128:131], v[84:87], a[4:7]
s_add_u32 s31, s26, 4096
buffer_load_dwordx4 v4, s[8:11], s26 offen lds
v_mfma_f32_16x16x32_bf16 a[8:11], v[132:135], v[80:83], a[8:11]
v_exp_f32 v37, v37
v_mfma_f32_16x16x32_bf16 a[12:15], v[132:135], v[84:87], a[12:15]
v_exp_f32 v38, v38
v_mfma_f32_16x16x32_bf16 a[16:19], v[136:139], v[80:83], a[16:19]
ds_read_b128 v[176:179], v3 offset:12288
v_mfma_f32_16x16x32_bf16 v[104:107], v[192:195], v[80:83], v[104:107]
v_exp_f32 v39, v39
v_mfma_f32_16x16x32_bf16 a[20:23], v[136:139], v[84:87], a[20:23]
ds_read_b128 v[180:183], v3 offset:13312
v_mfma_f32_16x16x32_bf16 a[24:27], v[140:143], v[80:83], a[24:27]
buffer_load_dwordx4 v4, s[8:11], s26 offen offset:1024 lds
v_mfma_f32_16x16x32_bf16 a[28:31], v[140:143], v[84:87], a[28:31]
s_waitcnt lgkmcnt(6)
v_exp_f32 v44, v44
v_mfma_f32_16x16x32_bf16 a[32:35], v[144:147], v[80:83], a[32:35]
v_exp_f32 v45, v45
v_mfma_f32_16x16x32_bf16 v[108:111], v[192:195], v[84:87], v[108:111]
ds_read_b128 v[184:187], v3 offset:14336
v_mfma_f32_16x16x32_bf16 a[36:39], v[144:147], v[84:87], a[36:39]
ds_read_b128 v[188:191], v3 offset:15360
v_mfma_f32_16x16x32_bf16 a[40:43], v[148:151], v[80:83], a[40:43]
v_exp_f32 v46, v46
v_mfma_f32_16x16x32_bf16 a[44:47], v[148:151], v[84:87], a[44:47]
ds_read_b128 v[128:131], v3 offset:16384
v_mfma_f32_16x16x32_bf16 a[48:51], v[152:155], v[80:83], a[48:51]
buffer_load_dwordx4 v4, s[8:11], s26 offen offset:2048 lds
v_mfma_f32_16x16x32_bf16 a[52:55], v[152:155], v[84:87], a[52:55]
v_exp_f32 v47, v47
v_mfma_f32_16x16x32_bf16 a[56:59], v[156:159], v[80:83], a[56:59]
v_max3_f32 v12, v48, v49, v50
v_max3_f32 v12, v12, v51, v56
v_mfma_f32_16x16x32_bf16 a[60:63], v[156:159], v[84:87], a[60:63]
s_waitcnt lgkmcnt(5)
ds_read_b128 v[132:135], v3 offset:17408
v_cvt_pk_bf16_f32 v92, v36, v37
v_mfma_f32_16x16x32_bf16 a[64:67], v[160:163], v[80:83], a[64:67]
ds_read_b128 v[136:139], v3 offset:18432
v_max3_f32 v12, v12, v57, v58
v_mfma_f32_16x16x32_bf16 a[68:71], v[160:163], v[84:87], a[68:71]
ds_read_b128 v[140:143], v3 offset:19456
v_cvt_pk_bf16_f32 v93, v38, v39
v_mfma_f32_16x16x32_bf16 a[72:75], v[164:167], v[80:83], a[72:75]
v_max3_f32 v12, v12, v59, v64
v_mfma_f32_16x16x32_bf16 a[76:79], v[164:167], v[84:87], a[76:79]
buffer_load_dwordx4 v4, s[8:11], s26 offen offset:3072 lds
v_mfma_f32_16x16x32_bf16 a[80:83], v[168:171], v[80:83], a[80:83]
v_cvt_pk_bf16_f32 v94, v44, v45
v_max3_f32 v12, v12, v65, v66
v_mfma_f32_16x16x32_bf16 a[84:87], v[168:171], v[84:87], a[84:87]
v_cvt_pk_bf16_f32 v95, v46, v47
v_mfma_f32_16x16x32_bf16 a[88:91], v[172:175], v[80:83], a[88:91]
ds_read_b128 v[144:147], v3 offset:20480
v_mfma_f32_16x16x32_bf16 a[92:95], v[172:175], v[84:87], a[92:95]
s_waitcnt lgkmcnt(5)
ds_read_b128 v[148:151], v3 offset:21504
v_max3_f32 v12, v12, v67, v72
v_mfma_f32_16x16x32_bf16 a[96:99], v[176:179], v[80:83], a[96:99]
s_add_u32 m0, m0, 4096
ds_read_b128 v[152:155], v3 offset:22528
s_add_u32 s26, s26, 32768
v_mfma_f32_16x16x32_bf16 a[100:103], v[176:179], v[84:87], a[100:103]
ds_read_b128 v[156:159], v3 offset:23552
v_mfma_f32_16x16x32_bf16 a[104:107], v[180:183], v[80:83], a[104:107]
buffer_load_dwordx4 v4, s[8:11], s31 offen lds
v_mfma_f32_16x16x32_bf16 a[108:111], v[180:183], v[84:87], a[108:111]
v_max3_f32 v12, v12, v73, v74
v_mfma_f32_16x16x32_bf16 a[112:115], v[184:187], v[80:83], a[112:115]
ds_read_b128 v[160:163], v3 offset:24576
v_mfma_f32_16x16x32_bf16 a[116:119], v[184:187], v[84:87], a[116:119]
v_max_f32 v12, v12, v75
v_mfma_f32_16x16x32_bf16 a[120:123], v[188:191], v[80:83], a[120:123]
ds_read_b128 v[164:167], v3 offset:25600
v_mfma_f32_16x16x32_bf16 a[124:127], v[188:191], v[84:87], a[124:127]
s_waitcnt lgkmcnt(6)
ds_read_b128 v[168:171], v3 offset:26624
v_max3_f32 v13, v52, v53, v54
v_mfma_f32_16x16x32_bf16 a[0:3], v[128:131], v[88:91], a[0:3]
ds_read_b128 v[172:175], v3 offset:27648
v_mfma_f32_16x16x32_bf16 a[4:7], v[128:131], v[92:95], a[4:7]
buffer_load_dwordx4 v4, s[8:11], s31 offen offset:1024 lds
v_mfma_f32_16x16x32_bf16 a[8:11], v[132:135], v[88:91], a[8:11]
v_max3_f32 v13, v13, v55, v60
v_mfma_f32_16x16x32_bf16 a[12:15], v[132:135], v[92:95], a[12:15]
ds_read_b128 v[176:179], v3 offset:28672
v_mfma_f32_16x16x32_bf16 a[16:19], v[136:139], v[88:91], a[16:19]
ds_read_b128 v[180:183], v3 offset:29696
v_mfma_f32_16x16x32_bf16 a[20:23], v[136:139], v[92:95], a[20:23]
v_max3_f32 v13, v13, v61, v62
v_mfma_f32_16x16x32_bf16 a[24:27], v[140:143], v[88:91], a[24:27]
ds_read_b128 v[184:187], v3 offset:30720
v_mfma_f32_16x16x32_bf16 a[28:31], v[140:143], v[92:95], a[28:31]
s_waitcnt lgkmcnt(7)
ds_read_b128 v[188:191], v3 offset:31744
v_mfma_f32_16x16x32_bf16 a[32:35], v[144:147], v[88:91], a[32:35]
buffer_load_dwordx4 v4, s[8:11], s31 offen offset:2048 lds
v_mfma_f32_16x16x32_bf16 v[104:107], v[192:195], v[88:91], v[104:107]
v_max3_f32 v13, v13, v63, v68
v_mfma_f32_16x16x32_bf16 a[36:39], v[144:147], v[92:95], a[36:39]
v_max3_f32 v13, v13, v69, v70
v_mfma_f32_16x16x32_bf16 a[40:43], v[148:151], v[88:91], a[40:43]
ds_read_b128 v[128:131], v2 offset:0
v_mfma_f32_16x16x32_bf16 a[44:47], v[148:151], v[92:95], a[44:47]
ds_read_b128 v[132:135], v2 offset:1024
v_mfma_f32_16x16x32_bf16 a[48:51], v[152:155], v[88:91], a[48:51]
v_max3_f32 v13, v13, v71, v76
v_mfma_f32_16x16x32_bf16 v[108:111], v[192:195], v[92:95], v[108:111]
ds_read_b128 v[136:139], v2 offset:2048
v_mfma_f32_16x16x32_bf16 a[52:55], v[152:155], v[92:95], a[52:55]
buffer_load_dwordx4 v4, s[8:11], s31 offen offset:3072 lds
v_mfma_f32_16x16x32_bf16 a[56:59], v[156:159], v[88:91], a[56:59]
ds_read_b128 v[140:143], v2 offset:3072
v_max3_f32 v13, v13, v77, v78
v_mfma_f32_16x16x32_bf16 a[60:63], v[156:159], v[92:95], a[60:63]
s_waitcnt lgkmcnt(8)
ds_read_b128 v[144:147], v2 offset:4096
v_mfma_f32_16x16x32_bf16 a[64:67], v[160:163], v[88:91], a[64:67]
ds_read_b128 v[148:151], v2 offset:5120
v_mfma_f32_16x16x32_bf16 a[68:71], v[160:163], v[92:95], a[68:71]
v_max_f32 v13, v13, v79
v_add_u32 v3, s28, v1
v_mfma_f32_16x16x32_bf16 a[72:75], v[164:167], v[88:91], a[72:75]
s_add_u32 s27, s27, 32768
ds_read_b128 v[152:155], v2 offset:6144
s_cmp_eq_u32 s27, 163840
s_cselect_b32 s27, 0, s27
v_mfma_f32_16x16x32_bf16 a[76:79], v[164:167], v[92:95], a[76:79]
s_add_u32 s28, s28, 32768
ds_read_b128 v[156:159], v2 offset:7168
v_max_f32 v8, v12, v13
v_mfma_f32_16x16x32_bf16 a[80:83], v[168:171], v[88:91], a[80:83]
s_cmp_eq_u32 s28, 163840
s_cselect_b32 s28, 0, s28
ds_read_b128 v[160:163], v2 offset:8192
v_mfma_f32_16x16x32_bf16 a[84:87], v[168:171], v[92:95], a[84:87]
ds_read_b128 v[164:167], v2 offset:9216
v_mfma_f32_16x16x32_bf16 a[88:91], v[172:175], v[88:91], a[88:91]
s_nop 0
v_mfma_f32_16x16x32_bf16 a[92:95], v[172:175], v[92:95], a[92:95]
s_waitcnt vmcnt(16) lgkmcnt(10)
ds_read_b128 v[168:171], v2 offset:10240
v_mfma_f32_16x16x32_bf16 a[96:99], v[176:179], v[88:91], a[96:99]
s_barrier
v_mfma_f32_16x16x32_bf16 a[100:103], v[176:179], v[92:95], a[100:103]
ds_read_b128 v[172:175], v2 offset:11264
v_cmp_lt_f32 vcc, s36, v8
v_mfma_f32_16x16x32_bf16 a[104:107], v[180:183], v[88:91], a[104:107]
v_mfma_f32_16x16x32_bf16 a[108:111], v[180:183], v[92:95], a[108:111]
v_mfma_f32_16x16x32_bf16 a[112:115], v[184:187], v[88:91], a[112:115]
v_mfma_f32_16x16x32_bf16 a[116:119], v[184:187], v[92:95], a[116:119]
v_mfma_f32_16x16x32_bf16 a[120:123], v[188:191], v[88:91], a[120:123]
v_mfma_f32_16x16x32_bf16 a[124:127], v[188:191], v[92:95], a[124:127]
s_cbranch_vccz K2_r0
s_call_b64 s[96:97], K2_slow1
K2_r0:
K2_it1:
s_waitcnt lgkmcnt(8)
v_mfma_f32_16x16x32_bf16 v[16:19], v[128:131], a[128:131], v[96:99]
s_add_u32 m0, s29, s27
v_exp_f32 v48, v48
v_mfma_f32_16x16x32_bf16 v[20:23], v[128:131], a[160:163], v[100:103]
s_add_u32 s31, s25, 4096
buffer_load_dwordx4 v4, s[8:11], s25 offen lds
v_mfma_f32_16x16x32_bf16 v[16:19], v[132:135], a[132:135], v[16:19]
v_exp_f32 v49, v49
v_mfma_f32_16x16x32_bf16 v[20:23], v[132:135], a[164:167], v[20:23]
v_exp_f32 v50, v50
v_mfma_f32_16x16x32_bf16 v[16:19], v[136:139], a[136:139], v[16:19]
v_exp_f32 v51, v51
v_mfma_f32_16x16x32_bf16 v[20:23], v[136:139], a[168:171], v[20:23]
v_exp_f32 v56, v56
v_mfma_f32_16x16x32_bf16 v[16:19], v[140:143], a[140:143], v[16:19]
buffer_load_dwordx4 v4, s[8:11], s25 offen offset:1024 lds
v_mfma_f32_16x16x32_bf16 v[20:23], v[140:143], a[172:175], v[20:23]
s_waitcnt lgkmcnt(4)
v_exp_f32 v57, v57
v_mfma_f32_16x16x32_bf16 v[16:19], v[144:147], a[144:147], v[16:19]
v_exp_f32 v58, v58
v_mfma_f32_16x16x32_bf16 v[20:23], v[144:147], a[176:179], v[20:23]
ds_read_b128 v[176:179], v2 offset:12288
v_mfma_f32_16x16x32_bf16 v[16:19], v[148:151], a[148:151], v[16:19]
ds_read_b128 v[180:183], v2 offset:13312
v_mfma_f32_16x16x32_bf16 v[20:23], v[148:151], a[180:183], v[20:23]
ds_read_b128 v[184:187], v2 offset:14336
v_mfma_f32_16x16x32_bf16 v[16:19], v[152:155], a[152:155], v[16:19]
ds_read_b128 v[188:191], v2 offset:15360
v_mfma_f32_16x16x32_bf16 v[20:23], v[152:155], a[184:187], v[20:23]
v_exp_f32 v59, v59
v_mfma_f32_16x16x32_bf16 v[16:19], v[156:159], a[156:159], v[16:19]
buffer_load_dwordx4 v4, s[8:11], s25 offen offset:2048 lds
v_mfma_f32_16x16x32_bf16 v[20:23], v[156:159], a[188:191], v[20:23]
s_waitcnt lgkmcnt(4)
v_cvt_pk_bf16_f32 v80, v48, v49
v_cvt_pk_bf16_f32 v81, v50, v51
v_mfma_f32_16x16x32_bf16 v[24:27], v[160:163], a[128:131], v[96:99]
ds_read_b128 v[128:131], v2 offset:16384
v_cvt_pk_bf16_f32 v82, v56, v57
v_mfma_f32_16x16x32_bf16 v[28:31], v[160:163], a[160:163], v[100:103]
ds_read_b128 v[132:135], v2 offset:17408
v_cvt_pk_bf16_f32 v83, v58, v59
v_mfma_f32_16x16x32_bf16 v[24:27], v[164:167], a[132:135], v[24:27]
ds_read_b128 v[136:139], v2 offset:18432
v_mfma_f32_16x16x32_bf16 v[28:31], v[164:167], a[164:167], v[28:31]
ds_read_b128 v[140:143], v2 offset:19456
v_mfma_f32_16x16x32_bf16 v[24:27], v[168:171], a[136:139], v[24:27]
buffer_load_dwordx4 v4, s[8:11], s25 offen offset:3072 lds
v_mfma_f32_16x16x32_bf16 v[28:31], v[168:171], a[168:171], v[28:31]
v_exp_f32 v52, v52
v_mfma_f32_16x16x32_bf16 v[24:27], v[172:175], a[140:143], v[24:27]
v_exp_f32 v53, v53
v_mfma_f32_16x16x32_bf16 v[28:31], v[172:175], a[172:175], v[28:31]
s_waitcnt lgkmcnt(4)
v_exp_f32 v54, v54
v_mfma_f32_16x16x32_bf16 v[24:27], v[176:179], a[144:147], v[24:27]
s_add_u32 m0, m0, 4096
v_exp_f32 v55, v55
v_mfma_f32_16x16x32_bf16 v[28:31], v[176:179], a[176:179], v[28:31]
s_add_u32 s25, s25, 32768
ds_read_b128 v[144:147], v2 offset:20480
v_mfma_f32_16x16x32_bf16 v[24:27], v[180:183], a[148:151], v[24:27]
ds_read_b128 v[148:151], v2 offset:21504
v_mfma_f32_16x16x32_bf16 v[28:31], v[180:183], a[180:183], v[28:31]
ds_read_b128 v[152:155], v2 offset:22528
v_mfma_f32_16x16x32_bf16 v[24:27], v[184:187], a[152:155], v[24:27]
ds_read_b128 v[156:159], v2 offset:23552
v_mfma_f32_16x16x32_bf16 v[28:31], v[184:187], a[184:187], v[28:31]
buffer_load_dwordx4 v4, s[8:11], s31 offen lds
v_mfma_f32_16x16x32_bf16 v[24:27], v[188:191], a[156:159], v[24:27]
v_exp_f32 v60, v60
v_mfma_f32_16x16x32_bf16 v[28:31], v[188:191], a[188:191], v[28:31]
s_waitcnt lgkmcnt(4)
v_exp_f32 v61, v61
v_mfma_f32_16x16x32_bf16 v[32:35], v[128:131], a[128:131], v[96:99]
v_exp_f32 v62, v62
v_mfma_f32_16x16x32_bf16 v[36:39], v[128:131], a[160:163], v[100:103]
v_exp_f32 v63, v63
v_mfma_f32_16x16x32_bf16 v[32:35], v[132:135], a[132:135], v[32:35]
buffer_load_dwordx4 v4, s[8:11], s31 offen offset:1024 lds
v_mfma_f32_16x16x32_bf16 v[36:39], v[132:135], a[164:167], v[36:39]
ds_read_b128 v[160:163], v2 offset:24576
v_cvt_pk_bf16_f32 v84, v52, v53
v_mfma_f32_16x16x32_bf16 v[32:35], v[136:139], a[136:139], v[32:35]
ds_read_b128 v[164:167], v2 offset:25600
v_cvt_pk_bf16_f32 v85, v54, v55
v_mfma_f32_16x16x32_bf16 v[36:39], v[136:139], a[168:171], v[36:39]
ds_read_b128 v[168:171], v2 offset:26624
v_cvt_pk_bf16_f32 v86, v60, v61
v_mfma_f32_16x16x32_bf16 v[32:35], v[140:143], a[140:143], v[32:35]
ds_read_b128 v[172:175], v2 offset:27648
v_cvt_pk_bf16_f32 v87, v62, v63
v_mfma_f32_16x16x32_bf16 v[36:39], v[140:143], a[172:175], v[36:39]
s_waitcnt lgkmcnt(4)
buffer_load_dwordx4 v4, s[8:11], s31 offen offset:2048 lds
v_mfma_f32_16x16x32_bf16 v[32:35], v[144:147], a[144:147], v[32:35]
v_exp_f32 v64, v64
v_mfma_f32_16x16x32_bf16 v[36:39], v[144:147], a[176:179], v[36:39]
ds_read_b128 v[176:179], v2 offset:28672
v_mfma_f32_16x16x32_bf16 v[32:35], v[148:151], a[148:151], v[32:35]
ds_read_b128 v[180:183], v2 offset:29696
v_mfma_f32_16x16x32_bf16 v[36:39], v[148:151], a[180:183], v[36:39]
ds_read_b128 v[184:187], v2 offset:30720
v_mfma_f32_16x16x32_bf16 v[32:35], v[152:155], a[152:155], v[32:35]
ds_read_b128 v[188:191], v2 offset:31744
v_mfma_f32_16x16x32_bf16 v[36:39], v[152:155], a[184:187], v[36:39]
v_exp_f32 v65, v65
v_mfma_f32_16x16x32_bf16 v[32:35], v[156:159], a[156:159], v[32:35]
v_exp_f32 v66, v66
v_mfma_f32_16x16x32_bf16 v[36:39], v[156:159], a[188:191], v[36:39]
s_waitcnt lgkmcnt(4)
buffer_load_dwordx4 v4, s[8:11], s31 offen offset:3072 lds
v_mfma_f32_16x16x32_bf16 v[40:43], v[160:163], a[128:131], v[96:99]
v_exp_f32 v67, v67
v_mfma_f32_16x16x32_bf16 v[44:47], v[160:163], a[160:163], v[100:103]
v_exp_f32 v72, v72
v_mfma_f32_16x16x32_bf16 v[40:43], v[164:167], a[132:135], v[40:43]
s_add_u32 s27, s27, 32768
v_exp_f32 v73, v73
v_mfma_f32_16x16x32_bf16 v[44:47], v[164:167], a[164:167], v[44:47]
s_cmp_eq_u32 s27, 163840
s_cselect_b32 s27, 0, s27
ds_read_b128 v[128:131], v3 offset:0
v_add_u32 v2, s28, v1
v_mfma_f32_16x16x32_bf16 v[40:43], v[168:171], a[136:139], v[40:43]
s_add_u32 s28, s28, 32768
ds_read_b128 v[132:135], v3 offset:1024
s_cmp_eq_u32 s28, 163840
s_cselect_b32 s28, 0, s28
v_mfma_f32_16x16x32_bf16 v[44:47], v[168:171], a[168:171], v[44:47]
ds_read_b128 v[136:139], v3 offset:2048
v_mfma_f32_16x16x32_bf16 v[40:43], v[172:175], a[140:143], v[40:43]
ds_read_b128 v[140:143], v3 offset:3072
v_mfma_f32_16x16x32_bf16 v[44:47], v[172:175], a[172:175], v[44:47]
s_waitcnt vmcnt(16) lgkmcnt(4)
v_exp_f32 v74, v74
v_mfma_f32_16x16x32_bf16 v[40:43], v[176:179], a[144:147], v[40:43]
s_barrier
v_exp_f32 v75, v75
v_mfma_f32_16x16x32_bf16 v[44:47], v[176:179], a[176:179], v[44:47]
ds_read_b128 v[144:147], v3 offset:4096
v_cvt_pk_bf16_f32 v88, v64, v65
v_mfma_f32_16x16x32_bf16 v[40:43], v[180:183], a[148:151], v[40:43]
ds_read_b128 v[148:151], v3 offset:5120
v_cvt_pk_bf16_f32 v89, v66, v67
v_mfma_f32_16x16x32_bf16 v[44:47], v[180:183], a[180:183], v[44:47]
ds_read_b128 v[152:155], v3 offset:6144
v_cvt_pk_bf16_f32 v90, v72, v73
v_mfma_f32_16x16x32_bf16 v[40:43], v[184:187], a[152:155], v[40:43]
ds_read_b128 v[156:159], v3 offset:7168
v_cvt_pk_bf16_f32 v91, v74, v75
v_mfma_f32_16x16x32_bf16 v[44:47], v[184:187], a[184:187], v[44:47]
ds_read_b128 v[160:163], v3 offset:8192
v_mfma_f32_16x16x32_bf16 v[40:43], v[188:191], a[156:159], v[40:43]
ds_read_b128 v[164:167], v3 offset:9216
v_mfma_f32_16x16x32_bf16 v[44:47], v[188:191], a[188:191], v[44:47]
ds_read_b128 v[168:171], v3 offset:10240
ds_read_b128 v[172:175], v3 offset:11264
s_waitcnt lgkmcnt(8)
v_mfma_f32_16x16x32_bf16 a[0:3], v[128:131], v[80:83], a[0:3]
s_add_u32 m0, s29, s27
v_exp_f32 v68, v68
v_mfma_f32_16x16x32_bf16 a[4:7], v[128:131], v[84:87], a[4:7]
s_add_u32 s31, s26, 4096
buffer_load_dwordx4 v4, s[8:11], s26 offen lds
v_mfma_f32_16x16x32_bf16 a[8:11], v[132:135], v[80:83], a[8:11]
v_exp_f32 v69, v69
v_mfma_f32_16x16x32_bf16 a[12:15], v[132:135], v[84:87], a[12:15]
v_exp_f32 v70, v70
v_mfma_f32_16x16x32_bf16 a[16:19], v[136:139], v[80:83], a[16:19]
ds_read_b128 v[176:179], v3 offset:12288
v_mfma_f32_16x16x32_bf16 v[104:107], v[192:195], v[80:83], v[104:107]
v_exp_f32 v71, v71
v_mfma_f32_16x16x32_bf16 a[20:23], v[136:139], v[84:87], a[20:23]
ds_read_b128 v[180:183], v3 offset:13312
v_mfma_f32_16x16x32_bf16 a[24:27], v[140:143], v[80:83], a[24:27]
buffer_load_dwordx4 v4, s[8:11], s26 offen offset:1024 lds
v_mfma_f32_16x16x32_bf16 a[28:31], v[140:143], v[84:87], a[28:31]
s_waitcnt lgkmcnt(6)
v_exp_f32 v76, v76
v_mfma_f32_16x16x32_bf16 a[32:35], v[144:147], v[80:83], a[32:35]
v_exp_f32 v77, v77
v_mfma_f32_16x16x32_bf16 v[108:111], v[192:195], v[84:87], v[108:111]
ds_read_b128 v[184:187], v3 offset:14336
v_mfma_f32_16x16x32_bf16 a[36:39], v[144:147], v[84:87], a[36:39]
ds_read_b128 v[188:191], v3 offset:15360
v_mfma_f32_16x16x32_bf16 a[40:43], v[148:151], v[80:83], a[40:43]
v_exp_f32 v78, v78
v_mfma_f32_16x16x32_bf16 a[44:47], v[148:151], v[84:87], a[44:47]
ds_read_b128 v[128:131], v3 offset:16384
v_mfma_f32_16x16x32_bf16 a[48:51], v[152:155], v[80:83], a[48:51]
buffer_load_dwordx4 v4, s[8:11], s26 offen offset:2048 lds
v_mfma_f32_16x16x32_bf16 a[52:55], v[152:155], v[84:87], a[52:55]
v_exp_f32 v79, v79
v_mfma_f32_16x16x32_bf16 a[56:59], v[156:159], v[80:83], a[56:59]
v_max3_f32 v12, v16, v17, v18
v_max3_f32 v12, v12, v19, v24
v_mfma_f32_16x16x32_bf16 a[60:63], v[156:159], v[84:87], a[60:63]
s_waitcnt lgkmcnt(5)
ds_read_b128 v[132:135], v3 offset:17408
v_cvt_pk_bf16_f32 v92, v68, v69
v_mfma_f32_16x16x32_bf16 a[64:67], v[160:163], v[80:83], a[64:67]
ds_read_b128 v[136:139], v3 offset:18432
v_max3_f32 v12, v12, v25, v26
v_mfma_f32_16x16x32_bf16 a[68:71], v[160:163], v[84:87], a[68:71]
ds_read_b128 v[140:143], v3 offset:19456
v_cvt_pk_bf16_f32 v93, v70, v71
v_mfma_f32_16x16x32_bf16 a[72:75], v[164:167], v[80:83], a[72:75]
v_max3_f32 v12, v12, v27, v32
v_mfma_f32_16x16x32_bf16 a[76:79], v[164:167], v[84:87], a[76:79]
buffer_load_dwordx4 v4, s[8:11], s26 offen offset:3072 lds
v_mfma_f32_16x16x32_bf16 a[80:83], v[168:171], v[80:83], a[80:83]
v_cvt_pk_bf16_f32 v94, v76, v77
v_max3_f32 v12, v12, v33, v34
v_mfma_f32_16x16x32_bf16 a[84:87], v[168:171], v[84:87], a[84:87]
v_cvt_pk_bf16_f32 v95, v78, v79
v_mfma_f32_16x16x32_bf16 a[88:91], v[172:175], v[80:83], a[88:91]
ds_read_b128 v[144:147], v3 offset:20480
v_mfma_f32_16x16x32_bf16 a[92:95], v[172:175], v[84:87], a[92:95]
s_waitcnt lgkmcnt(5)
ds_read_b128 v[148:151], v3 offset:21504
v_max3_f32 v12, v12, v35, v40
v_mfma_f32_16x16x32_bf16 a[96:99], v[176:179], v[80:83], a[96:99]
s_add_u32 m0, m0, 4096
ds_read_b128 v[152:155], v3 offset:22528
s_add_u32 s26, s26, 32768
v_mfma_f32_16x16x32_bf16 a[100:103], v[176:179], v[84:87], a[100:103]
ds_read_b128 v[156:159], v3 offset:23552
v_mfma_f32_16x16x32_bf16 a[104:107], v[180:183], v[80:83], a[104:107]
buffer_load_dwordx4 v4, s[8:11], s31 offen lds
v_mfma_f32_16x16x32_bf16 a[108:111], v[180:183], v[84:87], a[108:111]
v_max3_f32 v12, v12, v41, v42
v_mfma_f32_16x16x32_bf16 a[112:115], v[184:187], v[80:83], a[112:115]
ds_read_b128 v[160:163], v3 offset:24576
v_mfma_f32_16x16x32_bf16 a[116:119], v[184:187], v[84:87], a[116:119]
v_max_f32 v12, v12, v43
v_mfma_f32_16x16x32_bf16 a[120:123], v[188:191], v[80:83], a[120:123]
ds_read_b128 v[164:167], v3 offset:25600
v_mfma_f32_16x16x32_bf16 a[124:127], v[188:191], v[84:87], a[124:127]
s_waitcnt lgkmcnt(6)
ds_read_b128 v[168:171], v3 offset:26624
v_max3_f32 v13, v20, v21, v22
v_mfma_f32_16x16x32_bf16 a[0:3], v[128:131], v[88:91], a[0:3]
ds_read_b128 v[172:175], v3 offset:27648
v_mfma_f32_16x16x32_bf16 a[4:7], v[128:131], v[92:95], a[4:7]
buffer_load_dwordx4 v4, s[8:11], s31 offen offset:1024 lds
v_mfma_f32_16x16x32_bf16 a[8:11], v[132:135], v[88:91], a[8:11]
v_max3_f32 v13, v13, v23, v28
v_mfma_f32_16x16x32_bf16 a[12:15], v[132:135], v[92:95], a[12:15]
ds_read_b128 v[176:179], v3 offset:28672
v_mfma_f32_16x16x32_bf16 a[16:19], v[136:139], v[88:91], a[16:19]
ds_read_b128 v[180:183], v3 offset:29696
v_mfma_f32_16x16x32_bf16 a[20:23], v[136:139], v[92:95], a[20:23]
v_max3_f32 v13, v13, v29, v30
v_mfma_f32_16x16x32_bf16 a[24:27], v[140:143], v[88:91], a[24:27]
ds_read_b128 v[184:187], v3 offset:30720
v_mfma_f32_16x16x32_bf16 a[28:31], v[140:143], v[92:95], a[28:31]
s_waitcnt lgkmcnt(7)
ds_read_b128 v[188:191], v3 offset:31744
v_mfma_f32_16x16x32_bf16 a[32:35], v[144:147], v[88:91], a[32:35]
buffer_load_dwordx4 v4, s[8:11], s31 offen offset:2048 lds
v_mfma_f32_16x16x32_bf16 v[104:107], v[192:195], v[88:91], v[104:107]
v_max3_f32 v13, v13, v31, v36
v_mfma_f32_16x16x32_bf16 a[36:39], v[144:147], v[92:95], a[36:39]
v_max3_f32 v13, v13, v37, v38
v_mfma_f32_16x16x32_bf16 a[40:43], v[148:151], v[88:91], a[40:43]
ds_read_b128 v[128:131], v2 offset:0
v_mfma_f32_16x16x32_bf16 a[44:47], v[148:151], v[92:95], a[44:47]
ds_read_b128 v[132:135], v2 offset:1024
v_mfma_f32_16x16x32_bf16 a[48:51], v[152:155], v[88:91], a[48:51]
v_max3_f32 v13, v13, v39, v44
v_mfma_f32_16x16x32_bf16 v[108:111], v[192:195], v[92:95], v[108:111]
ds_read_b128 v[136:139], v2 offset:2048
v_mfma_f32_16x16x32_bf16 a[52:55], v[152:155], v[92:95], a[52:55]
buffer_load_dwordx4 v4, s[8:11], s31 offen offset:3072 lds
v_mfma_f32_16x16x32_bf16 a[56:59], v[156:159], v[88:91], a[56:59]
ds_read_b128 v[140:143], v2 offset:3072
v_max3_f32 v13, v13, v45, v46
v_mfma_f32_16x16x32_bf16 a[60:63], v[156:159], v[92:95], a[60:63]
s_waitcnt lgkmcnt(8)
ds_read_b128 v[144:147], v2 offset:4096
v_mfma_f32_16x16x32_bf16 a[64:67], v[160:163], v[88:91], a[64:67]
ds_read_b128 v[148:151], v2 offset:5120
v_mfma_f32_16x16x32_bf16 a[68:71], v[160:163], v[92:95], a[68:71]
v_max_f32 v13, v13, v47
v_add_u32 v3, s28, v1
v_mfma_f32_16x16x32_bf16 a[72:75], v[164:167], v[88:91], a[72:75]
s_add_u32 s27, s27, 32768
ds_read_b128 v[152:155], v2 offset:6144
s_cmp_eq_u32 s27, 163840
s_cselect_b32 s27, 0, s27
v_mfma_f32_16x16x32_bf16 a[76:79], v[164:167], v[92:95], a[76:79]
s_add_u32 s28, s28, 32768
ds_read_b128 v[156:159], v2 offset:7168
v_max_f32 v8, v12, v13
v_mfma_f32_16x16x32_bf16 a[80:83], v[168:171], v[88:91], a[80:83]
s_cmp_eq_u32 s28, 163840
s_cselect_b32 s28, 0, s28
ds_read_b128 v[160:163], v2 offset:8192
v_mfma_f32_16x16x32_bf16 a[84:87], v[168:171], v[92:95], a[84:87]
ds_read_b128 v[164:167], v2 offset:9216
v_mfma_f32_16x16x32_bf16 a[88:91], v[172:175], v[88:91], a[88:91]
s_nop 0
v_mfma_f32_16x16x32_bf16 a[92:95], v[172:175], v[92:95], a[92:95]
s_waitcnt vmcnt(16) lgkmcnt(10)
ds_read_b128 v[168:171], v2 offset:10240
v_mfma_f32_16x16x32_bf16 a[96:99], v[176:179], v[88:91], a[96:99]
s_barrier
v_mfma_f32_16x16x32_bf16 a[100:103], v[176:179], v[92:95], a[100:103]
ds_read_b128 v[172:175], v2 offset:11264
v_cmp_lt_f32 vcc, s36, v8
v_mfma_f32_16x16x32_bf16 a[104:107], v[180:183], v[88:91], a[104:107]
v_mfma_f32_16x16x32_bf16 a[108:111], v[180:183], v[92:95], a[108:111]
v_mfma_f32_16x16x32_bf16 a[112:115], v[184:187], v[88:91], a[112:115]
v_mfma_f32_16x16x32_bf16 a[116:119], v[184:187], v[92:95], a[116:119]
v_mfma_f32_16x16x32_bf16 a[120:123], v[188:191], v[88:91], a[120:123]
v_mfma_f32_16x16x32_bf16 a[124:127], v[188:191], v[92:95], a[124:127]
s_cbranch_vccz K2_r1
s_call_b64 s[96:97], K2_slow0
K2_r1:
s_sub_u32 s32, s32, 1
s_cmp_lg_u32 s32, 0
s_cbranch_scc1 K2_it0
K2_loopdone:
s_cmp_eq_u32 s37, 0
s_cbranch_scc1 K2_fin
s_lshl_b32 s40, s34, 2
s_add_u32 s40, s40, s20
s_lshr_b32 s41, s40, 5
s_lshl_b32 s41, s41, 2
s_and_b32 s40, s40, 31
s_lshl_b32 s43, 1, s40
v_mov_b32 v11, s41
buffer_load_dword v10, v11, s[56:59], 0 offen sc1
s_waitcnt lgkmcnt(8)
v_mfma_f32_16x16x32_bf16 v[48:51], v[128:131], a[128:131], v[96:99]
s_add_u32 m0, s29, s27
v_exp_f32 v16, v16
v_mfma_f32_16x16x32_bf16 v[52:55], v[128:131], a[160:163], v[100:103]
s_add_u32 s31, s25, 4096
buffer_load_dwordx4 v4, s[8:11], s25 offen lds
v_mfma_f32_16x16x32_bf16 v[48:51], v[132:135], a[132:135], v[48:51]
v_exp_f32 v17, v17
v_mfma_f32_16x16x32_bf16 v[52:55], v[132:135], a[164:167], v[52:55]
v_exp_f32 v18, v18
v_mfma_f32_16x16x32_bf16 v[48:51], v[136:139], a[136:139], v[48:51]
v_exp_f32 v19, v19
v_mfma_f32_16x16x32_bf16 v[52:55], v[136:139], a[168:171], v[52:55]
v_exp_f32 v24, v24
v_mfma_f32_16x16x32_bf16 v[48:51], v[140:143], a[140:143], v[48:51]
buffer_load_dwordx4 v4, s[8:11], s25 offen offset:1024 lds
v_mfma_f32_16x16x32_bf16 v[52:55], v[140:143], a[172:175], v[52:55]
s_waitcnt lgkmcnt(4)
v_exp_f32 v25, v25
v_mfma_f32_16x16x32_bf16 v[48:51], v[144:147], a[144:147], v[48:51]
v_exp_f32 v26, v26
v_mfma_f32_16x16x32_bf16 v[52:55], v[144:147], a[176:179], v[52:55]
ds_read_b128 v[176:179], v2 offset:12288
v_mfma_f32_16x16x32_bf16 v[48:51], v[148:151], a[148:151], v[48:51]
ds_read_b128 v[180:183], v2 offset:13312
v_mfma_f32_16x16x32_bf16 v[52:55], v[148:151], a[180:183], v[52:55]
ds_read_b128 v[184:187], v2 offset:14336
v_mfma_f32_16x16x32_bf16 v[48:51], v[152:155], a[152:155], v[48:51]
ds_read_b128 v[188:191], v2 offset:15360
v_mfma_f32_16x16x32_bf16 v[52:55], v[152:155], a[184:187], v[52:55]
v_exp_f32 v27, v27
v_mfma_f32_16x16x32_bf16 v[48:51], v[156:159], a[156:159], v[48:51]
buffer_load_dwordx4 v4, s[8:11], s25 offen offset:2048 lds
v_mfma_f32_16x16x32_bf16 v[52:55], v[156:159], a[188:191], v[52:55]
s_waitcnt lgkmcnt(4)
v_cvt_pk_bf16_f32 v80, v16, v17
v_cvt_pk_bf16_f32 v81, v18, v19
v_mfma_f32_16x16x32_bf16 v[56:59], v[160:163], a[128:131], v[96:99]
ds_read_b128 v[128:131], v2 offset:16384
v_cvt_pk_bf16_f32 v82, v24, v25
v_mfma_f32_16x16x32_bf16 v[60:63], v[160:163], a[160:163], v[100:103]
ds_read_b128 v[132:135], v2 offset:17408
v_cvt_pk_bf16_f32 v83, v26, v27
v_mfma_f32_16x16x32_bf16 v[56:59], v[164:167], a[132:135], v[56:59]
ds_read_b128 v[136:139], v2 offset:18432
v_mfma_f32_16x16x32_bf16 v[60:63], v[164:167], a[164:167], v[60:63]
ds_read_b128 v[140:143], v2 offset:19456
v_mfma_f32_16x16x32_bf16 v[56:59], v[168:171], a[136:139], v[56:59]
buffer_load_dwordx4 v4, s[8:11], s25 offen offset:3072 lds
v_mfma_f32_16x16x32_bf16 v[60:63], v[168:171], a[168:171], v[60:63]
v_exp_f32 v20, v20
v_mfma_f32_16x16x32_bf16 v[56:59], v[172:175], a[140:143], v[56:59]
v_exp_f32 v21, v21
v_mfma_f32_16x16x32_bf16 v[60:63], v[172:175], a[172:175], v[60:63]
s_waitcnt lgkmcnt(4)
v_exp_f32 v22, v22
v_mfma_f32_16x16x32_bf16 v[56:59], v[176:179], a[144:147], v[56:59]
s_add_u32 m0, m0, 4096
v_exp_f32 v23, v23
v_mfma_f32_16x16x32_bf16 v[60:63], v[176:179], a[176:179], v[60:63]
s_add_u32 s25, s25, 32768
ds_read_b128 v[144:147], v2 offset:20480
v_mfma_f32_16x16x32_bf16 v[56:59], v[180:183], a[148:151], v[56:59]
ds_read_b128 v[148:151], v2 offset:21504
v_mfma_f32_16x16x32_bf16 v[60:63], v[180:183], a[180:183], v[60:63]
ds_read_b128 v[152:155], v2 offset:22528
v_mfma_f32_16x16x32_bf16 v[56:59], v[184:187], a[152:155], v[56:59]
ds_read_b128 v[156:159], v2 offset:23552
v_mfma_f32_16x16x32_bf16 v[60:63], v[184:187], a[184:187], v[60:63]
buffer_load_dwordx4 v4, s[8:11], s31 offen lds
v_mfma_f32_16x16x32_bf16 v[56:59], v[188:191], a[156:159], v[56:59]
v_exp_f32 v28, v28
v_mfma_f32_16x16x32_bf16 v[60:63], v[188:191], a[188:191], v[60:63]
s_waitcnt lgkmcnt(4)
v_exp_f32 v29, v29
v_mfma_f32_16x16x32_bf16 v[64:67], v[128:131], a[128:131], v[96:99]
v_exp_f32 v30, v30
v_mfma_f32_16x16x32_bf16 v[68:71], v[128:131], a[160:163], v[100:103]
v_exp_f32 v31, v31
v_mfma_f32_16x16x32_bf16 v[64:67], v[132:135], a[132:135], v[64:67]
buffer_load_dwordx4 v4, s[8:11], s31 offen offset:1024 lds
v_mfma_f32_16x16x32_bf16 v[68:71], v[132:135], a[164:167], v[68:71]
ds_read_b128 v[160:163], v2 offset:24576
v_cvt_pk_bf16_f32 v84, v20, v21
v_mfma_f32_16x16x32_bf16 v[64:67], v[136:139], a[136:139], v[64:67]
ds_read_b128 v[164:167], v2 offset:25600
v_cvt_pk_bf16_f32 v85, v22, v23
v_mfma_f32_16x16x32_bf16 v[68:71], v[136:139], a[168:171], v[68:71]
ds_read_b128 v[168:171], v2 offset:26624
v_cvt_pk_bf16_f32 v86, v28, v29
v_mfma_f32_16x16x32_bf16 v[64:67], v[140:143], a[140:143], v[64:67]
ds_read_b128 v[172:175], v2 offset:27648
v_cvt_pk_bf16_f32 v87, v30, v31
v_mfma_f32_16x16x32_bf16 v[68:71], v[140:143], a[172:175], v[68:71]
s_waitcnt lgkmcnt(4)
buffer_load_dwordx4 v4, s[8:11], s31 offen offset:2048 lds
v_mfma_f32_16x16x32_bf16 v[64:67], v[144:147], a[144:147], v[64:67]
v_exp_f32 v32, v32
v_mfma_f32_16x16x32_bf16 v[68:71], v[144:147], a[176:179], v[68:71]
ds_read_b128 v[176:179], v2 offset:28672
v_mfma_f32_16x16x32_bf16 v[64:67], v[148:151], a[148:151], v[64:67]
ds_read_b128 v[180:183], v2 offset:29696
v_mfma_f32_16x16x32_bf16 v[68:71], v[148:151], a[180:183], v[68:71]
ds_read_b128 v[184:187], v2 offset:30720
v_mfma_f32_16x16x32_bf16 v[64:67], v[152:155], a[152:155], v[64:67]
ds_read_b128 v[188:191], v2 offset:31744
v_mfma_f32_16x16x32_bf16 v[68:71], v[152:155], a[184:187], v[68:71]
v_exp_f32 v33, v33
v_mfma_f32_16x16x32_bf16 v[64:67], v[156:159], a[156:159], v[64:67]
v_exp_f32 v34, v34
v_mfma_f32_16x16x32_bf16 v[68:71], v[156:159], a[188:191], v[68:71]
s_waitcnt lgkmcnt(4)
buffer_load_dwordx4 v4, s[8:11], s31 offen offset:3072 lds
v_mfma_f32_16x16x32_bf16 v[72:75], v[160:163], a[128:131], v[96:99]
v_exp_f32 v35, v35
v_mfma_f32_16x16x32_bf16 v[76:79], v[160:163], a[160:163], v[100:103]
v_exp_f32 v40, v40
v_mfma_f32_16x16x32_bf16 v[72:75], v[164:167], a[132:135], v[72:75]
s_add_u32 s27, s27, 32768
v_exp_f32 v41, v41
v_mfma_f32_16x16x32_bf16 v[76:79], v[164:167], a[164:167], v[76:79]
s_cmp_eq_u32 s27, 163840
s_cselect_b32 s27, 0, s27
ds_read_b128 v[128:131], v3 offset:0
v_add_u32 v2, s28, v1
v_mfma_f32_16x16x32_bf16 v[72:75], v[168:171], a[136:139], v[72:75]
s_add_u32 s28, s28, 32768
ds_read_b128 v[132:135], v3 offset:1024
s_cmp_eq_u32 s28, 163840
s_cselect_b32 s28, 0, s28
v_mfma_f32_16x16x32_bf16 v[76:79], v[168:171], a[168:171], v[76:79]
ds_read_b128 v[136:139], v3 offset:2048
v_mfma_f32_16x16x32_bf16 v[72:75], v[172:175], a[140:143], v[72:75]
ds_read_b128 v[140:143], v3 offset:3072
v_mfma_f32_16x16x32_bf16 v[76:79], v[172:175], a[172:175], v[76:79]
s_waitcnt vmcnt(17) lgkmcnt(4)
v_exp_f32 v42, v42
v_mfma_f32_16x16x32_bf16 v[72:75], v[176:179], a[144:147], v[72:75]
s_barrier
v_exp_f32 v43, v43
v_mfma_f32_16x16x32_bf16 v[76:79], v[176:179], a[176:179], v[76:79]
ds_read_b128 v[144:147], v3 offset:4096
v_cvt_pk_bf16_f32 v88, v32, v33
v_mfma_f32_16x16x32_bf16 v[72:75], v[180:183], a[148:151], v[72:75]
ds_read_b128 v[148:151], v3 offset:5120
v_cvt_pk_bf16_f32 v89, v34, v35
v_mfma_f32_16x16x32_bf16 v[76:79], v[180:183], a[180:183], v[76:79]
ds_read_b128 v[152:155], v3 offset:6144
v_cvt_pk_bf16_f32 v90, v40, v41
v_mfma_f32_16x16x32_bf16 v[72:75], v[184:187], a[152:155], v[72:75]
ds_read_b128 v[156:159], v3 offset:7168
v_cvt_pk_bf16_f32 v91, v42, v43
v_mfma_f32_16x16x32_bf16 v[76:79], v[184:187], a[184:187], v[76:79]
ds_read_b128 v[160:163], v3 offset:8192
v_mfma_f32_16x16x32_bf16 v[72:75], v[188:191], a[156:159], v[72:75]
ds_read_b128 v[164:167], v3 offset:9216
v_mfma_f32_16x16x32_bf16 v[76:79], v[188:191], a[188:191], v[76:79]
ds_read_b128 v[168:171], v3 offset:10240
ds_read_b128 v[172:175], v3 offset:11264
s_waitcnt lgkmcnt(8)
v_mfma_f32_16x16x32_bf16 a[0:3], v[128:131], v[80:83], a[0:3]
s_add_u32 m0, s29, s27
v_exp_f32 v36, v36
v_mfma_f32_16x16x32_bf16 a[4:7], v[128:131], v[84:87], a[4:7]
s_add_u32 s31, s26, 4096
buffer_load_dwordx4 v4, s[8:11], s26 offen lds
v_mfma_f32_16x16x32_bf16 a[8:11], v[132:135], v[80:83], a[8:11]
v_exp_f32 v37, v37
v_mfma_f32_16x16x32_bf16 a[12:15], v[132:135], v[84:87], a[12:15]
v_exp_f32 v38, v38
v_mfma_f32_16x16x32_bf16 a[16:19], v[136:139], v[80:83], a[16:19]
ds_read_b128 v[176:179], v3 offset:12288
v_mfma_f32_16x16x32_bf16 v[104:107], v[192:195], v[80:83], v[104:107]
v_exp_f32 v39, v39
v_mfma_f32_16x16x32_bf16 a[20:23], v[136:139], v[84:87], a[20:23]
ds_read_b128 v[180:183], v3 offset:13312
v_mfma_f32_16x16x32_bf16 a[24:27], v[140:143], v[80:83], a[24:27]
buffer_load_dwordx4 v4, s[8:11], s26 offen offset:1024 lds
v_mfma_f32_16x16x32_bf16 a[28:31], v[140:143], v[84:87], a[28:31]
s_waitcnt lgkmcnt(6)
v_exp_f32 v44, v44
v_mfma_f32_16x16x32_bf16 a[32:35], v[144:147], v[80:83], a[32:35]
v_exp_f32 v45, v45
v_mfma_f32_16x16x32_bf16 v[108:111], v[192:195], v[84:87], v[108:111]
ds_read_b128 v[184:187], v3 offset:14336
v_mfma_f32_16x16x32_bf16 a[36:39], v[144:147], v[84:87], a[36:39]
ds_read_b128 v[188:191], v3 offset:15360
v_mfma_f32_16x16x32_bf16 a[40:43], v[148:151], v[80:83], a[40:43]
v_exp_f32 v46, v46
v_mfma_f32_16x16x32_bf16 a[44:47], v[148:151], v[84:87], a[44:47]
ds_read_b128 v[128:131], v3 offset:16384
v_mfma_f32_16x16x32_bf16 a[48:51], v[152:155], v[80:83], a[48:51]
s_lshl_b32 s30, s20, 5
buffer_load_dwordx4 v4, s[8:11], s26 offen offset:2048 lds
v_mfma_f32_16x16x32_bf16 a[52:55], v[152:155], v[84:87], a[52:55]
s_sub_i32 s30, s30, 0
v_exp_f32 v47, v47
v_mfma_f32_16x16x32_bf16 a[56:59], v[156:159], v[80:83], a[56:59]
v_sub_u32 v6, s30, v5
v_mov_b32 v7, 0xff800000
v_mfma_f32_16x16x32_bf16 a[60:63], v[156:159], v[84:87], a[60:63]
s_waitcnt lgkmcnt(5)
v_cmp_le_i32 s[84:85], 0, v6
v_cmp_le_i32 s[86:87], 1, v6
v_mfma_f32_16x16x32_bf16 a[64:67], v[160:163], v[80:83], a[64:67]
v_cmp_le_i32 s[88:89], 2, v6
v_cmp_le_i32 s[90:91], 3, v6
v_mfma_f32_16x16x32_bf16 a[68:71], v[160:163], v[84:87], a[68:71]
ds_read_b128 v[132:135], v3 offset:17408
v_cndmask_b32 v48, v7, v48, s[84:85]
v_mfma_f32_16x16x32_bf16 a[72:75], v[164:167], v[80:83], a[72:75]
ds_read_b128 v[136:139], v3 offset:18432
v_cndmask_b32 v49, v7, v49, s[86:87]
v_mfma_f32_16x16x32_bf16 a[76:79], v[164:167], v[84:87], a[76:79]
ds_read_b128 v[140:143], v3 offset:19456
v_cndmask_b32 v50, v7, v50, s[88:89]
v_mfma_f32_16x16x32_bf16 a[80:83], v[168:171], v[80:83], a[80:83]
buffer_load_dwordx4 v4, s[8:11], s26 offen offset:3072 lds
v_mfma_f32_16x16x32_bf16 a[84:87], v[168:171], v[84:87], a[84:87]
v_cvt_pk_bf16_f32 v92, v36, v37
v_cndmask_b32 v51, v7, v51, s[90:91]
v_mfma_f32_16x16x32_bf16 a[88:91], v[172:175], v[80:83], a[88:91]
v_cmp_le_i32 s[84:85], -16, v6
v_cmp_le_i32 s[86:87], -15, v6
v_mfma_f32_16x16x32_bf16 a[92:95], v[172:175], v[84:87], a[92:95]
s_waitcnt lgkmcnt(4)
v_cmp_le_i32 s[88:89], -14, v6
v_cvt_pk_bf16_f32 v93, v38, v39
v_mfma_f32_16x16x32_bf16 a[96:99], v[176:179], v[80:83], a[96:99]
s_add_u32 m0, m0, 4096
v_cmp_le_i32 s[90:91], -13, v6
v_cndmask_b32 v52, v7, v52, s[84:85]
v_mfma_f32_16x16x32_bf16 a[100:103], v[176:179], v[84:87], a[100:103]
s_add_u32 s26, s26, 32768
v_cndmask_b32 v53, v7, v53, s[86:87]
v_cvt_pk_bf16_f32 v94, v44, v45
v_mfma_f32_16x16x32_bf16 a[104:107], v[180:183], v[80:83], a[104:107]
v_cvt_pk_bf16_f32 v95, v46, v47
v_cndmask_b32 v54, v7, v54, s[88:89]
v_cndmask_b32 v55, v7, v55, s[90:91]
v_mfma_f32_16x16x32_bf16 a[108:111], v[180:183], v[84:87], a[108:111]
v_cmp_le_i32 s[84:85], 16, v6
v_cmp_le_i32 s[86:87], 17, v6
v_mfma_f32_16x16x32_bf16 a[112:115], v[184:187], v[80:83], a[112:115]
v_cmp_le_i32 s[88:89], 18, v6
v_cmp_le_i32 s[90:91], 19, v6
v_mfma_f32_16x16x32_bf16 a[116:119], v[184:187], v[84:87], a[116:119]
v_cndmask_b32 v56, v7, v56, s[84:85]
v_cndmask_b32 v57, v7, v57, s[86:87]
v_mfma_f32_16x16x32_bf16 a[120:123], v[188:191], v[80:83], a[120:123]
ds_read_b128 v[144:147], v3 offset:20480
v_cndmask_b32 v58, v7, v58, s[88:89]
v_mfma_f32_16x16x32_bf16 a[124:127], v[188:191], v[84:87], a[124:127]
s_waitcnt lgkmcnt(1)
v_cndmask_b32 v59, v7, v59, s[90:91]
v_cmp_le_i32 s[84:85], 0, v6
v_mfma_f32_16x16x32_bf16 a[0:3], v[128:131], v[88:91], a[0:3]
ds_read_b128 v[148:151], v3 offset:21504
ds_read_b128 v[152:155], v3 offset:22528
ds_read_b128 v[156:159], v3 offset:23552
buffer_load_dwordx4 v4, s[8:11], s31 offen lds
v_cmp_le_i32 s[86:87], 1, v6
v_mfma_f32_16x16x32_bf16 a[4:7], v[128:131], v[92:95], a[4:7]
v_cmp_le_i32 s[88:89], 2, v6
v_cmp_le_i32 s[90:91], 3, v6
v_mfma_f32_16x16x32_bf16 a[8:11], v[132:135], v[88:91], a[8:11]
v_cndmask_b32 v60, v7, v60, s[84:85]
v_cndmask_b32 v61, v7, v61, s[86:87]
v_mfma_f32_16x16x32_bf16 a[12:15], v[132:135], v[92:95], a[12:15]
v_cndmask_b32 v62, v7, v62, s[88:89]
v_cndmask_b32 v63, v7, v63, s[90:91]
v_mfma_f32_16x16x32_bf16 a[16:19], v[136:139], v[88:91], a[16:19]
buffer_load_dwordx4 v4, s[8:11], s31 offen offset:1024 lds
v_mfma_f32_16x16x32_bf16 a[20:23], v[136:139], v[92:95], a[20:23]
v_cmp_le_i32 s[84:85], 32, v6
v_cmp_le_i32 s[86:87], 33, v6
v_mfma_f32_16x16x32_bf16 a[24:27], v[140:143], v[88:91], a[24:27]
v_cmp_le_i32 s[88:89], 34, v6
v_cmp_le_i32 s[90:91], 35, v6
v_mfma_f32_16x16x32_bf16 a[28:31], v[140:143], v[92:95], a[28:31]
s_waitcnt lgkmcnt(0)
v_cndmask_b32 v64, v7, v64, s[84:85]
v_cndmask_b32 v65, v7, v65, s[86:87]
v_mfma_f32_16x16x32_bf16 a[32:35], v[144:147], v[88:91], a[32:35]
v_cndmask_b32 v66, v7, v66, s[88:89]
v_cndmask_b32 v67, v7, v67, s[90:91]
v_mfma_f32_16x16x32_bf16 v[104:107], v[192:195], v[88:91], v[104:107]
v_cmp_le_i32 s[84:85], 16, v6
v_cmp_le_i32 s[86:87], 17, v6
v_mfma_f32_16x16x32_bf16 a[36:39], v[144:147], v[92:95], a[36:39]
ds_read_b128 v[160:163], v3 offset:24576
ds_read_b128 v[164:167], v3 offset:25600
ds_read_b128 v[168:171], v3 offset:26624
ds_read_b128 v[172:175], v3 offset:27648
v_mfma_f32_16x16x32_bf16 a[40:43], v[148:151], v[88:91], a[40:43]
v_cmp_le_i32 s[88:89], 18, v6
v_cmp_le_i32 s[90:91], 19, v6
v_mfma_f32_16x16x32_bf16 a[44:47], v[148:151], v[92:95], a[44:47]
v_cndmask_b32 v68, v7, v68, s[84:85]
v_cndmask_b32 v69, v7, v69, s[86:87]
v_mfma_f32_16x16x32_bf16 a[48:51], v[152:155], v[88:91], a[48:51]
v_cndmask_b32 v70, v7, v70, s[88:89]
v_cndmask_b32 v71, v7, v71, s[90:91]
v_mfma_f32_16x16x32_bf16 v[108:111], v[192:195], v[92:95], v[108:111]
buffer_load_dwordx4 v4, s[8:11], s31 offen offset:2048 lds
v_cmp_le_i32 s[84:85], 48, v6
v_mfma_f32_16x16x32_bf16 a[52:55], v[152:155], v[92:95], a[52:55]
v_cmp_le_i32 s[86:87], 49, v6
v_cmp_le_i32 s[88:89], 50, v6
v_mfma_f32_16x16x32_bf16 a[56:59], v[156:159], v[88:91], a[56:59]
v_cmp_le_i32 s[90:91], 51, v6
v_cndmask_b32 v72, v7, v72, s[84:85]
v_mfma_f32_16x16x32_bf16 a[60:63], v[156:159], v[92:95], a[60:63]
s_waitcnt lgkmcnt(0)
v_cndmask_b32 v73, v7, v73, s[86:87]
v_cndmask_b32 v74, v7, v74, s[88:89]
v_mfma_f32_16x16x32_bf16 a[64:67], v[160:163], v[88:91], a[64:67]
ds_read_b128 v[176:179], v3 offset:28672
ds_read_b128 v[180:183], v3 offset:29696
ds_read_b128 v[184:187], v3 offset:30720
ds_read_b128 v[188:191], v3 offset:31744
v_cndmask_b32 v75, v7, v75, s[90:91]
v_mfma_f32_16x16x32_bf16 a[68:71], v[160:163], v[92:95], a[68:71]
v_cmp_le_i32 s[84:85], 32, v6
v_cmp_le_i32 s[86:87], 33, v6
v_mfma_f32_16x16x32_bf16 a[72:75], v[164:167], v[88:91], a[72:75]
v_cmp_le_i32 s[88:89], 34, v6
v_cmp_le_i32 s[90:91], 35, v6
v_mfma_f32_16x16x32_bf16 a[76:79], v[164:167], v[92:95], a[76:79]
buffer_load_dwordx4 v4, s[8:11], s31 offen offset:3072 lds
v_cndmask_b32 v76, v7, v76, s[84:85]
v_mfma_f32_16x16x32_bf16 a[80:83], v[168:171], v[88:91], a[80:83]
s_add_u32 s27, s27, 32768
v_cndmask_b32 v77, v7, v77, s[86:87]
v_cndmask_b32 v78, v7, v78, s[88:89]
v_mfma_f32_16x16x32_bf16 a[84:87], v[168:171], v[92:95], a[84:87]
s_cmp_eq_u32 s27, 163840
s_cselect_b32 s27, 0, s27
v_cndmask_b32 v79, v7, v79, s[90:91]
v_max3_f32 v12, v48, v49, v50
v_mfma_f32_16x16x32_bf16 a[88:91], v[172:175], v[88:91], a[88:91]
v_max3_f32 v12, v12, v51, v56
v_max3_f32 v12, v12, v57, v58
v_mfma_f32_16x16x32_bf16 a[92:95], v[172:175], v[92:95], a[92:95]
s_waitcnt vmcnt(16) lgkmcnt(0)
ds_read_b128 v[128:131], v2 offset:0
v_max3_f32 v12, v12, v59, v64
v_mfma_f32_16x16x32_bf16 a[96:99], v[176:179], v[88:91], a[96:99]
s_barrier
ds_read_b128 v[132:135], v2 offset:1024
ds_read_b128 v[136:139], v2 offset:2048
ds_read_b128 v[140:143], v2 offset:3072
v_max3_f32 v12, v12, v65, v66
v_mfma_f32_16x16x32_bf16 a[100:103], v[176:179], v[92:95], a[100:103]
v_max3_f32 v12, v12, v67, v72
v_max3_f32 v12, v12, v73, v74
v_mfma_f32_16x16x32_bf16 a[104:107], v[180:183], v[88:91], a[104:107]
v_add_u32 v3, s28, v1
s_add_u32 s28, s28, 32768
s_cmp_eq_u32 s28, 163840
s_cselect_b32 s28, 0, s28
v_max_f32 v12, v12, v75
v_mfma_f32_16x16x32_bf16 a[108:111], v[180:183], v[92:95], a[108:111]
v_max3_f32 v13, v52, v53, v54
v_max3_f32 v13, v13, v55, v60
v_mfma_f32_16x16x32_bf16 a[112:115], v[184:187], v[88:91], a[112:115]
v_max3_f32 v13, v13, v61, v62
v_max3_f32 v13, v13, v63, v68
v_mfma_f32_16x16x32_bf16 a[116:119], v[184:187], v[92:95], a[116:119]
v_max3_f32 v13, v13, v69, v70
v_max3_f32 v13, v13, v71, v76
v_mfma_f32_16x16x32_bf16 a[120:123], v[188:191], v[88:91], a[120:123]
v_max3_f32 v13, v13, v77, v78
v_max_f32 v13, v13, v79
v_mfma_f32_16x16x32_bf16 a[124:127], v[188:191], v[92:95], a[124:127]
ds_read_b128 v[144:147], v2 offset:4096
ds_read_b128 v[148:151], v2 offset:5120
ds_read_b128 v[152:155], v2 offset:6144
ds_read_b128 v[156:159], v2 offset:7168
ds_read_b128 v[160:163], v2 offset:8192
ds_read_b128 v[164:167], v2 offset:9216
ds_read_b128 v[168:171], v2 offset:10240
ds_read_b128 v[172:175], v2 offset:11264
v_max_f32 v8, v12, v13
s_nop 0
v_cmp_lt_f32 vcc, s36, v8
s_cbranch_vccz K2_r2
s_call_b64 s[96:97], K2_slow1
K2_r2:
K2_it1d1:
s_waitcnt lgkmcnt(8)
v_mfma_f32_16x16x32_bf16 v[16:19], v[128:131], a[128:131], v[96:99]
s_add_u32 m0, s29, s27
v_exp_f32 v48, v48
v_mfma_f32_16x16x32_bf16 v[20:23], v[128:131], a[160:163], v[100:103]
s_add_u32 s31, s38, 28672
buffer_load_dwordx4 v200, s[80:83], s38 offen lds
v_mfma_f32_16x16x32_bf16 v[16:19], v[132:135], a[132:135], v[16:19]
v_exp_f32 v49, v49
v_mfma_f32_16x16x32_bf16 v[20:23], v[132:135], a[164:167], v[20:23]
v_exp_f32 v50, v50
v_mfma_f32_16x16x32_bf16 v[16:19], v[136:139], a[136:139], v[16:19]
v_exp_f32 v51, v51
v_mfma_f32_16x16x32_bf16 v[20:23], v[136:139], a[168:171], v[20:23]
v_exp_f32 v56, v56
v_mfma_f32_16x16x32_bf16 v[16:19], v[140:143], a[140:143], v[16:19]
buffer_load_dwordx4 v201, s[80:83], s38 offen offset:1024 lds
v_mfma_f32_16x16x32_bf16 v[20:23], v[140:143], a[172:175], v[20:23]
s_waitcnt lgkmcnt(4)
v_exp_f32 v57, v57
v_mfma_f32_16x16x32_bf16 v[16:19], v[144:147], a[144:147], v[16:19]
v_exp_f32 v58, v58
v_mfma_f32_16x16x32_bf16 v[20:23], v[144:147], a[176:179], v[20:23]
ds_read_b128 v[176:179], v2 offset:12288
v_mfma_f32_16x16x32_bf16 v[16:19], v[148:151], a[148:151], v[16:19]
ds_read_b128 v[180:183], v2 offset:13312
v_mfma_f32_16x16x32_bf16 v[20:23], v[148:151], a[180:183], v[20:23]
ds_read_b128 v[184:187], v2 offset:14336
v_mfma_f32_16x16x32_bf16 v[16:19], v[152:155], a[152:155], v[16:19]
ds_read_b128 v[188:191], v2 offset:15360
v_mfma_f32_16x16x32_bf16 v[20:23], v[152:155], a[184:187], v[20:23]
v_exp_f32 v59, v59
v_mfma_f32_16x16x32_bf16 v[16:19], v[156:159], a[156:159], v[16:19]
buffer_load_dwordx4 v202, s[80:83], s38 offen offset:2048 lds
v_mfma_f32_16x16x32_bf16 v[20:23], v[156:159], a[188:191], v[20:23]
s_waitcnt lgkmcnt(4)
v_cvt_pk_bf16_f32 v80, v48, v49
v_cvt_pk_bf16_f32 v81, v50, v51
v_mfma_f32_16x16x32_bf16 v[24:27], v[160:163], a[128:131], v[96:99]
ds_read_b128 v[128:131], v2 offset:16384
v_cvt_pk_bf16_f32 v82, v56, v57
v_mfma_f32_16x16x32_bf16 v[28:31], v[160:163], a[160:163], v[100:103]
ds_read_b128 v[132:135], v2 offset:17408
v_cvt_pk_bf16_f32 v83, v58, v59
v_mfma_f32_16x16x32_bf16 v[24:27], v[164:167], a[132:135], v[24:27]
ds_read_b128 v[136:139], v2 offset:18432
v_mfma_f32_16x16x32_bf16 v[28:31], v[164:167], a[164:167], v[28:31]
ds_read_b128 v[140:143], v2 offset:19456
v_mfma_f32_16x16x32_bf16 v[24:27], v[168:171], a[136:139], v[24:27]
buffer_load_dwordx4 v203, s[80:83], s38 offen offset:3072 lds
v_mfma_f32_16x16x32_bf16 v[28:31], v[168:171], a[168:171], v[28:31]
v_exp_f32 v52, v52
v_mfma_f32_16x16x32_bf16 v[24:27], v[172:175], a[140:143], v[24:27]
v_exp_f32 v53, v53
v_mfma_f32_16x16x32_bf16 v[28:31], v[172:175], a[172:175], v[28:31]
s_waitcnt lgkmcnt(4)
v_exp_f32 v54, v54
v_mfma_f32_16x16x32_bf16 v[24:27], v[176:179], a[144:147], v[24:27]
s_add_u32 m0, m0, 4096
v_exp_f32 v55, v55
v_mfma_f32_16x16x32_bf16 v[28:31], v[176:179], a[176:179], v[28:31]
s_add_u32 s38, s38, 128
ds_read_b128 v[144:147], v2 offset:20480
v_mfma_f32_16x16x32_bf16 v[24:27], v[180:183], a[148:151], v[24:27]
ds_read_b128 v[148:151], v2 offset:21504
v_mfma_f32_16x16x32_bf16 v[28:31], v[180:183], a[180:183], v[28:31]
ds_read_b128 v[152:155], v2 offset:22528
v_mfma_f32_16x16x32_bf16 v[24:27], v[184:187], a[152:155], v[24:27]
ds_read_b128 v[156:159], v2 offset:23552
v_mfma_f32_16x16x32_bf16 v[28:31], v[184:187], a[184:187], v[28:31]
buffer_load_dwordx4 v200, s[80:83], s31 offen lds
v_mfma_f32_16x16x32_bf16 v[24:27], v[188:191], a[156:159], v[24:27]
v_exp_f32 v60, v60
v_mfma_f32_16x16x32_bf16 v[28:31], v[188:191], a[188:191], v[28:31]
s_waitcnt lgkmcnt(4)
v_exp_f32 v61, v61
v_mfma_f32_16x16x32_bf16 v[32:35], v[128:131], a[128:131], v[96:99]
v_exp_f32 v62, v62
v_mfma_f32_16x16x32_bf16 v[36:39], v[128:131], a[160:163], v[100:103]
v_exp_f32 v63, v63
v_mfma_f32_16x16x32_bf16 v[32:35], v[132:135], a[132:135], v[32:35]
buffer_load_dwordx4 v201, s[80:83], s31 offen offset:1024 lds
v_mfma_f32_16x16x32_bf16 v[36:39], v[132:135], a[164:167], v[36:39]
ds_read_b128 v[160:163], v2 offset:24576
v_cvt_pk_bf16_f32 v84, v52, v53
v_mfma_f32_16x16x32_bf16 v[32:35], v[136:139], a[136:139], v[32:35]
ds_read_b128 v[164:167], v2 offset:25600
v_cvt_pk_bf16_f32 v85, v54, v55
v_mfma_f32_16x16x32_bf16 v[36:39], v[136:139], a[168:171], v[36:39]
ds_read_b128 v[168:171], v2 offset:26624
v_cvt_pk_bf16_f32 v86, v60, v61
v_mfma_f32_16x16x32_bf16 v[32:35], v[140:143], a[140:143], v[32:35]
ds_read_b128 v[172:175], v2 offset:27648
v_cvt_pk_bf16_f32 v87, v62, v63
v_mfma_f32_16x16x32_bf16 v[36:39], v[140:143], a[172:175], v[36:39]
s_waitcnt lgkmcnt(4)
buffer_load_dwordx4 v202, s[80:83], s31 offen offset:2048 lds
v_mfma_f32_16x16x32_bf16 v[32:35], v[144:147], a[144:147], v[32:35]
v_exp_f32 v64, v64
v_mfma_f32_16x16x32_bf16 v[36:39], v[144:147], a[176:179], v[36:39]
ds_read_b128 v[176:179], v2 offset:28672
v_mfma_f32_16x16x32_bf16 v[32:35], v[148:151], a[148:151], v[32:35]
ds_read_b128 v[180:183], v2 offset:29696
v_mfma_f32_16x16x32_bf16 v[36:39], v[148:151], a[180:183], v[36:39]
ds_read_b128 v[184:187], v2 offset:30720
v_mfma_f32_16x16x32_bf16 v[32:35], v[152:155], a[152:155], v[32:35]
ds_read_b128 v[188:191], v2 offset:31744
v_mfma_f32_16x16x32_bf16 v[36:39], v[152:155], a[184:187], v[36:39]
v_exp_f32 v65, v65
v_mfma_f32_16x16x32_bf16 v[32:35], v[156:159], a[156:159], v[32:35]
v_exp_f32 v66, v66
v_mfma_f32_16x16x32_bf16 v[36:39], v[156:159], a[188:191], v[36:39]
s_waitcnt lgkmcnt(4)
buffer_load_dwordx4 v203, s[80:83], s31 offen offset:3072 lds
v_mfma_f32_16x16x32_bf16 v[40:43], v[160:163], a[128:131], v[96:99]
v_exp_f32 v67, v67
v_mfma_f32_16x16x32_bf16 v[44:47], v[160:163], a[160:163], v[100:103]
v_exp_f32 v72, v72
v_mfma_f32_16x16x32_bf16 v[40:43], v[164:167], a[132:135], v[40:43]
s_add_u32 s27, s27, 32768
v_exp_f32 v73, v73
v_mfma_f32_16x16x32_bf16 v[44:47], v[164:167], a[164:167], v[44:47]
s_cmp_eq_u32 s27, 163840
s_cselect_b32 s27, 0, s27
ds_read_b128 v[128:131], v3 offset:0
v_add_u32 v2, s28, v1
v_mfma_f32_16x16x32_bf16 v[40:43], v[168:171], a[136:139], v[40:43]
s_add_u32 s28, s28, 32768
ds_read_b128 v[132:135], v3 offset:1024
s_cmp_eq_u32 s28, 163840
s_cselect_b32 s28, 0, s28
v_mfma_f32_16x16x32_bf16 v[44:47], v[168:171], a[168:171], v[44:47]
ds_read_b128 v[136:139], v3 offset:2048
v_mfma_f32_16x16x32_bf16 v[40:43], v[172:175], a[140:143], v[40:43]
ds_read_b128 v[140:143], v3 offset:3072
v_mfma_f32_16x16x32_bf16 v[44:47], v[172:175], a[172:175], v[44:47]
s_waitcnt vmcnt(16) lgkmcnt(4)
v_exp_f32 v74, v74
v_mfma_f32_16x16x32_bf16 v[40:43], v[176:179], a[144:147], v[40:43]
s_barrier
v_exp_f32 v75, v75
v_mfma_f32_16x16x32_bf16 v[44:47], v[176:179], a[176:179], v[44:47]
ds_read_b128 v[144:147], v3 offset:4096
v_cvt_pk_bf16_f32 v88, v64, v65
v_mfma_f32_16x16x32_bf16 v[40:43], v[180:183], a[148:151], v[40:43]
ds_read_b128 v[148:151], v3 offset:5120
v_cvt_pk_bf16_f32 v89, v66, v67
v_mfma_f32_16x16x32_bf16 v[44:47], v[180:183], a[180:183], v[44:47]
ds_read_b128 v[152:155], v3 offset:6144
v_cvt_pk_bf16_f32 v90, v72, v73
v_mfma_f32_16x16x32_bf16 v[40:43], v[184:187], a[152:155], v[40:43]
ds_read_b128 v[156:159], v3 offset:7168
v_cvt_pk_bf16_f32 v91, v74, v75
v_mfma_f32_16x16x32_bf16 v[44:47], v[184:187], a[184:187], v[44:47]
ds_read_b128 v[160:163], v3 offset:8192
v_mfma_f32_16x16x32_bf16 v[40:43], v[188:191], a[156:159], v[40:43]
ds_read_b128 v[164:167], v3 offset:9216
v_mfma_f32_16x16x32_bf16 v[44:47], v[188:191], a[188:191], v[44:47]
ds_read_b128 v[168:171], v3 offset:10240
ds_read_b128 v[172:175], v3 offset:11264
s_waitcnt lgkmcnt(8)
v_mfma_f32_16x16x32_bf16 a[0:3], v[128:131], v[80:83], a[0:3]
s_add_u32 m0, s29, s27
v_exp_f32 v68, v68
v_mfma_f32_16x16x32_bf16 a[4:7], v[128:131], v[84:87], a[4:7]
s_add_u32 s31, s38, 28672
buffer_load_dwordx4 v200, s[80:83], s38 offen lds
v_mfma_f32_16x16x32_bf16 a[8:11], v[132:135], v[80:83], a[8:11]
v_exp_f32 v69, v69
v_mfma_f32_16x16x32_bf16 a[12:15], v[132:135], v[84:87], a[12:15]
v_exp_f32 v70, v70
v_mfma_f32_16x16x32_bf16 a[16:19], v[136:139], v[80:83], a[16:19]
ds_read_b128 v[176:179], v3 offset:12288
v_mfma_f32_16x16x32_bf16 v[104:107], v[192:195], v[80:83], v[104:107]
v_exp_f32 v71, v71
v_mfma_f32_16x16x32_bf16 a[20:23], v[136:139], v[84:87], a[20:23]
ds_read_b128 v[180:183], v3 offset:13312
v_mfma_f32_16x16x32_bf16 a[24:27], v[140:143], v[80:83], a[24:27]
buffer_load_dwordx4 v201, s[80:83], s38 offen offset:1024 lds
v_mfma_f32_16x16x32_bf16 a[28:31], v[140:143], v[84:87], a[28:31]
s_waitcnt lgkmcnt(6)
v_exp_f32 v76, v76
v_mfma_f32_16x16x32_bf16 a[32:35], v[144:147], v[80:83], a[32:35]
v_exp_f32 v77, v77
v_mfma_f32_16x16x32_bf16 v[108:111], v[192:195], v[84:87], v[108:111]
ds_read_b128 v[184:187], v3 offset:14336
v_mfma_f32_16x16x32_bf16 a[36:39], v[144:147], v[84:87], a[36:39]
ds_read_b128 v[188:191], v3 offset:15360
v_mfma_f32_16x16x32_bf16 a[40:43], v[148:151], v[80:83], a[40:43]
v_exp_f32 v78, v78
v_mfma_f32_16x16x32_bf16 a[44:47], v[148:151], v[84:87], a[44:47]
ds_read_b128 v[128:131], v3 offset:16384
v_mfma_f32_16x16x32_bf16 a[48:51], v[152:155], v[80:83], a[48:51]
s_lshl_b32 s30, s20, 5
buffer_load_dwordx4 v202, s[80:83], s38 offen offset:2048 lds
v_mfma_f32_16x16x32_bf16 a[52:55], v[152:155], v[84:87], a[52:55]
s_sub_i32 s30, s30, 64
v_exp_f32 v79, v79
v_mfma_f32_16x16x32_bf16 a[56:59], v[156:159], v[80:83], a[56:59]
v_sub_u32 v6, s30, v5
v_mov_b32 v7, 0xff800000
v_mfma_f32_16x16x32_bf16 a[60:63], v[156:159], v[84:87], a[60:63]
s_waitcnt lgkmcnt(5)
v_cmp_le_i32 s[84:85], 0, v6
v_cmp_le_i32 s[86:87], 1, v6
v_mfma_f32_16x16x32_bf16 a[64:67], v[160:163], v[80:83], a[64:67]
v_cmp_le_i32 s[88:89], 2, v6
v_cmp_le_i32 s[90:91], 3, v6
v_mfma_f32_16x16x32_bf16 a[68:71], v[160:163], v[84:87], a[68:71]
ds_read_b128 v[132:135], v3 offset:17408
v_cndmask_b32 v16, v7, v16, s[84:85]
v_mfma_f32_16x16x32_bf16 a[72:75], v[164:167], v[80:83], a[72:75]
ds_read_b128 v[136:139], v3 offset:18432
v_cndmask_b32 v17, v7, v17, s[86:87]
v_mfma_f32_16x16x32_bf16 a[76:79], v[164:167], v[84:87], a[76:79]
ds_read_b128 v[140:143], v3 offset:19456
v_cndmask_b32 v18, v7, v18, s[88:89]
v_mfma_f32_16x16x32_bf16 a[80:83], v[168:171], v[80:83], a[80:83]
buffer_load_dwordx4 v203, s[80:83], s38 offen offset:3072 lds
v_mfma_f32_16x16x32_bf16 a[84:87], v[168:171], v[84:87], a[84:87]
v_cvt_pk_bf16_f32 v92, v68, v69
v_cndmask_b32 v19, v7, v19, s[90:91]
v_mfma_f32_16x16x32_bf16 a[88:91], v[172:175], v[80:83], a[88:91]
v_cmp_le_i32 s[84:85], -16, v6
v_cmp_le_i32 s[86:87], -15, v6
v_mfma_f32_16x16x32_bf16 a[92:95], v[172:175], v[84:87], a[92:95]
s_waitcnt lgkmcnt(4)
v_cmp_le_i32 s[88:89], -14, v6
v_cvt_pk_bf16_f32 v93, v70, v71
v_mfma_f32_16x16x32_bf16 a[96:99], v[176:179], v[80:83], a[96:99]
s_add_u32 m0, m0, 4096
v_cmp_le_i32 s[90:91], -13, v6
v_cndmask_b32 v20, v7, v20, s[84:85]
v_mfma_f32_16x16x32_bf16 a[100:103], v[176:179], v[84:87], a[100:103]
s_add_u32 s38, s38, 128
v_cndmask_b32 v21, v7, v21, s[86:87]
v_cvt_pk_bf16_f32 v94, v76, v77
v_mfma_f32_16x16x32_bf16 a[104:107], v[180:183], v[80:83], a[104:107]
v_cvt_pk_bf16_f32 v95, v78, v79
v_cndmask_b32 v22, v7, v22, s[88:89]
v_cndmask_b32 v23, v7, v23, s[90:91]
v_mfma_f32_16x16x32_bf16 a[108:111], v[180:183], v[84:87], a[108:111]
v_cmp_le_i32 s[84:85], 16, v6
v_cmp_le_i32 s[86:87], 17, v6
v_mfma_f32_16x16x32_bf16 a[112:115], v[184:187], v[80:83], a[112:115]
v_cmp_le_i32 s[88:89], 18, v6
v_cmp_le_i32 s[90:91], 19, v6
v_mfma_f32_16x16x32_bf16 a[116:119], v[184:187], v[84:87], a[116:119]
v_cndmask_b32 v24, v7, v24, s[84:85]
v_cndmask_b32 v25, v7, v25, s[86:87]
v_mfma_f32_16x16x32_bf16 a[120:123], v[188:191], v[80:83], a[120:123]
ds_read_b128 v[144:147], v3 offset:20480
v_cndmask_b32 v26, v7, v26, s[88:89]
v_mfma_f32_16x16x32_bf16 a[124:127], v[188:191], v[84:87], a[124:127]
s_waitcnt lgkmcnt(1)
v_cndmask_b32 v27, v7, v27, s[90:91]
v_cmp_le_i32 s[84:85], 0, v6
v_mfma_f32_16x16x32_bf16 a[0:3], v[128:131], v[88:91], a[0:3]
ds_read_b128 v[148:151], v3 offset:21504
ds_read_b128 v[152:155], v3 offset:22528
ds_read_b128 v[156:159], v3 offset:23552
buffer_load_dwordx4 v200, s[80:83], s31 offen lds
v_cmp_le_i32 s[86:87], 1, v6
v_mfma_f32_16x16x32_bf16 a[4:7], v[128:131], v[92:95], a[4:7]
v_cmp_le_i32 s[88:89], 2, v6
v_cmp_le_i32 s[90:91], 3, v6
v_mfma_f32_16x16x32_bf16 a[8:11], v[132:135], v[88:91], a[8:11]
v_cndmask_b32 v28, v7, v28, s[84:85]
v_cndmask_b32 v29, v7, v29, s[86:87]
v_mfma_f32_16x16x32_bf16 a[12:15], v[132:135], v[92:95], a[12:15]
v_cndmask_b32 v30, v7, v30, s[88:89]
v_cndmask_b32 v31, v7, v31, s[90:91]
v_mfma_f32_16x16x32_bf16 a[16:19], v[136:139], v[88:91], a[16:19]
buffer_load_dwordx4 v201, s[80:83], s31 offen offset:1024 lds
v_mfma_f32_16x16x32_bf16 a[20:23], v[136:139], v[92:95], a[20:23]
v_cmp_le_i32 s[84:85], 32, v6
v_cmp_le_i32 s[86:87], 33, v6
v_mfma_f32_16x16x32_bf16 a[24:27], v[140:143], v[88:91], a[24:27]
v_cmp_le_i32 s[88:89], 34, v6
v_cmp_le_i32 s[90:91], 35, v6
v_mfma_f32_16x16x32_bf16 a[28:31], v[140:143], v[92:95], a[28:31]
s_waitcnt lgkmcnt(0)
v_cndmask_b32 v32, v7, v32, s[84:85]
v_cndmask_b32 v33, v7, v33, s[86:87]
v_mfma_f32_16x16x32_bf16 a[32:35], v[144:147], v[88:91], a[32:35]
v_cndmask_b32 v34, v7, v34, s[88:89]
v_cndmask_b32 v35, v7, v35, s[90:91]
v_mfma_f32_16x16x32_bf16 v[104:107], v[192:195], v[88:91], v[104:107]
v_cmp_le_i32 s[84:85], 16, v6
v_cmp_le_i32 s[86:87], 17, v6
v_mfma_f32_16x16x32_bf16 a[36:39], v[144:147], v[92:95], a[36:39]
ds_read_b128 v[160:163], v3 offset:24576
ds_read_b128 v[164:167], v3 offset:25600
ds_read_b128 v[168:171], v3 offset:26624
ds_read_b128 v[172:175], v3 offset:27648
v_mfma_f32_16x16x32_bf16 a[40:43], v[148:151], v[88:91], a[40:43]
v_cmp_le_i32 s[88:89], 18, v6
v_cmp_le_i32 s[90:91], 19, v6
v_mfma_f32_16x16x32_bf16 a[44:47], v[148:151], v[92:95], a[44:47]
v_cndmask_b32 v36, v7, v36, s[84:85]
v_cndmask_b32 v37, v7, v37, s[86:87]
v_mfma_f32_16x16x32_bf16 a[48:51], v[152:155], v[88:91], a[48:51]
v_cndmask_b32 v38, v7, v38, s[88:89]
v_cndmask_b32 v39, v7, v39, s[90:91]
v_mfma_f32_16x16x32_bf16 v[108:111], v[192:195], v[92:95], v[108:111]
buffer_load_dwordx4 v202, s[80:83], s31 offen offset:2048 lds
v_cmp_le_i32 s[84:85], 48, v6
v_mfma_f32_16x16x32_bf16 a[52:55], v[152:155], v[92:95], a[52:55]
v_cmp_le_i32 s[86:87], 49, v6
v_cmp_le_i32 s[88:89], 50, v6
v_mfma_f32_16x16x32_bf16 a[56:59], v[156:159], v[88:91], a[56:59]
v_cmp_le_i32 s[90:91], 51, v6
v_cndmask_b32 v40, v7, v40, s[84:85]
v_mfma_f32_16x16x32_bf16 a[60:63], v[156:159], v[92:95], a[60:63]
s_waitcnt lgkmcnt(0)
v_cndmask_b32 v41, v7, v41, s[86:87]
v_cndmask_b32 v42, v7, v42, s[88:89]
v_mfma_f32_16x16x32_bf16 a[64:67], v[160:163], v[88:91], a[64:67]
ds_read_b128 v[176:179], v3 offset:28672
ds_read_b128 v[180:183], v3 offset:29696
ds_read_b128 v[184:187], v3 offset:30720
ds_read_b128 v[188:191], v3 offset:31744
v_cndmask_b32 v43, v7, v43, s[90:91]
v_mfma_f32_16x16x32_bf16 a[68:71], v[160:163], v[92:95], a[68:71]
v_cmp_le_i32 s[84:85], 32, v6
v_cmp_le_i32 s[86:87], 33, v6
v_mfma_f32_16x16x32_bf16 a[72:75], v[164:167], v[88:91], a[72:75]
v_cmp_le_i32 s[88:89], 34, v6
v_cmp_le_i32 s[90:91], 35, v6
v_mfma_f32_16x16x32_bf16 a[76:79], v[164:167], v[92:95], a[76:79]
buffer_load_dwordx4 v203, s[80:83], s31 offen offset:3072 lds
v_cndmask_b32 v44, v7, v44, s[84:85]
v_mfma_f32_16x16x32_bf16 a[80:83], v[168:171], v[88:91], a[80:83]
s_add_u32 s27, s27, 32768
v_cndmask_b32 v45, v7, v45, s[86:87]
v_cndmask_b32 v46, v7, v46, s[88:89]
v_mfma_f32_16x16x32_bf16 a[84:87], v[168:171], v[92:95], a[84:87]
s_cmp_eq_u32 s27, 163840
s_cselect_b32 s27, 0, s27
v_cndmask_b32 v47, v7, v47, s[90:91]
v_max3_f32 v12, v16, v17, v18
v_mfma_f32_16x16x32_bf16 a[88:91], v[172:175], v[88:91], a[88:91]
v_max3_f32 v12, v12, v19, v24
v_max3_f32 v12, v12, v25, v26
v_mfma_f32_16x16x32_bf16 a[92:95], v[172:175], v[92:95], a[92:95]
s_waitcnt vmcnt(16) lgkmcnt(0)
ds_read_b128 v[128:131], v2 offset:0
v_max3_f32 v12, v12, v27, v32
v_mfma_f32_16x16x32_bf16 a[96:99], v[176:179], v[88:91], a[96:99]
s_barrier
ds_read_b128 v[132:135], v2 offset:1024
ds_read_b128 v[136:139], v2 offset:2048
ds_read_b128 v[140:143], v2 offset:3072
v_max3_f32 v12, v12, v33, v34
v_mfma_f32_16x16x32_bf16 a[100:103], v[176:179], v[92:95], a[100:103]
v_max3_f32 v12, v12, v35, v40
v_max3_f32 v12, v12, v41, v42
v_mfma_f32_16x16x32_bf16 a[104:107], v[180:183], v[88:91], a[104:107]
v_add_u32 v3, s28, v1
s_add_u32 s28, s28, 32768
s_cmp_eq_u32 s28, 163840
s_cselect_b32 s28, 0, s28
v_max_f32 v12, v12, v43
v_mfma_f32_16x16x32_bf16 a[108:111], v[180:183], v[92:95], a[108:111]
v_max3_f32 v13, v20, v21, v22
v_max3_f32 v13, v13, v23, v28
v_mfma_f32_16x16x32_bf16 a[112:115], v[184:187], v[88:91], a[112:115]
v_max3_f32 v13, v13, v29, v30
v_max3_f32 v13, v13, v31, v36
v_mfma_f32_16x16x32_bf16 a[116:119], v[184:187], v[92:95], a[116:119]
v_max3_f32 v13, v13, v37, v38
v_max3_f32 v13, v13, v39, v44
v_mfma_f32_16x16x32_bf16 a[120:123], v[188:191], v[88:91], a[120:123]
v_max3_f32 v13, v13, v45, v46
v_max_f32 v13, v13, v47
v_mfma_f32_16x16x32_bf16 a[124:127], v[188:191], v[92:95], a[124:127]
ds_read_b128 v[144:147], v2 offset:4096
ds_read_b128 v[148:151], v2 offset:5120
ds_read_b128 v[152:155], v2 offset:6144
ds_read_b128 v[156:159], v2 offset:7168
ds_read_b128 v[160:163], v2 offset:8192
ds_read_b128 v[164:167], v2 offset:9216
ds_read_b128 v[168:171], v2 offset:10240
ds_read_b128 v[172:175], v2 offset:11264
v_max_f32 v8, v12, v13
s_nop 0
v_cmp_lt_f32 vcc, s36, v8
s_cbranch_vccz K2_r3
s_call_b64 s[96:97], K2_slow0
K2_r3:
K2_fin:
s_waitcnt lgkmcnt(0)
ds_read_b128 v[128:131], v3 offset:0
ds_read_b128 v[132:135], v3 offset:1024
ds_read_b128 v[136:139], v3 offset:2048
ds_read_b128 v[140:143], v3 offset:3072
ds_read_b128 v[144:147], v3 offset:4096
ds_read_b128 v[148:151], v3 offset:5120
ds_read_b128 v[152:155], v3 offset:6144
ds_read_b128 v[156:159], v3 offset:7168
ds_read_b128 v[160:163], v3 offset:8192
ds_read_b128 v[164:167], v3 offset:9216
ds_read_b128 v[168:171], v3 offset:10240
ds_read_b128 v[172:175], v3 offset:11264
v_exp_f32 v16, v16
v_exp_f32 v17, v17
v_exp_f32 v18, v18
v_exp_f32 v19, v19
v_exp_f32 v24, v24
v_exp_f32 v25, v25
v_exp_f32 v26, v26
v_exp_f32 v27, v27
v_cvt_pk_bf16_f32 v80, v16, v17
v_cvt_pk_bf16_f32 v81, v18, v19
v_cvt_pk_bf16_f32 v82, v24, v25
v_cvt_pk_bf16_f32 v83, v26, v27
v_exp_f32 v20, v20
v_exp_f32 v21, v21
v_exp_f32 v22, v22
v_exp_f32 v23, v23
v_exp_f32 v28, v28
v_exp_f32 v29, v29
v_exp_f32 v30, v30
v_exp_f32 v31, v31
v_cvt_pk_bf16_f32 v84, v20, v21
v_cvt_pk_bf16_f32 v85, v22, v23
v_cvt_pk_bf16_f32 v86, v28, v29
v_cvt_pk_bf16_f32 v87, v30, v31
s_cmp_lg_u32 s37, 2
s_cbranch_scc1 K2_nocomb
v_readfirstlane_b32 s5, v10
s_nop 3
s_and_b32 s5, s5, s43
s_cbranch_scc1 K2_got
s_mov_b32 s4, 0
K2_spin:
buffer_load_dword v10, v11, s[56:59], 0 offen sc1
s_waitcnt vmcnt(0)
v_readfirstlane_b32 s5, v10
s_nop 3
s_and_b32 s5, s5, s43
s_cbranch_scc1 K2_got
s_add_u32 s4, s4, 1
s_cmp_lt_u32 s4, 0x100000
s_cbranch_scc0 K2_got
s_sleep 2
s_branch K2_spin
K2_got:
buffer_load_dwordx4 v[224:227], v1, s[52:55], 0 offen sc1
s_mov_b32 s40, 8192
buffer_load_dwordx4 v[48:51], v1, s[44:47], s40 offen offset:0 sc1
s_mov_b32 s40, 8192
buffer_load_dwordx4 v[52:55], v1, s[44:47], s40 offen offset:1024 sc1
s_mov_b32 s40, 8192
buffer_load_dwordx4 v[56:59], v1, s[44:47], s40 offen offset:2048 sc1
s_mov_b32 s40, 8192
buffer_load_dwordx4 v[60:63], v1, s[44:47], s40 offen offset:3072 sc1
s_mov_b32 s40, 12288
buffer_load_dwordx4 v[64:67], v1, s[44:47], s40 offen offset:0 sc1
s_mov_b32 s40, 12288
buffer_load_dwordx4 v[68:71], v1, s[44:47], s40 offen offset:1024 sc1
s_mov_b32 s40, 12288
buffer_load_dwordx4 v[72:75], v1, s[44:47], s40 offen offset:2048 sc1
s_mov_b32 s40, 12288
buffer_load_dwordx4 v[76:79], v1, s[44:47], s40 offen offset:3072 sc1
s_mov_b32 s40, 0
buffer_load_dwordx4 v[16:19], v1, s[44:47], s40 offen offset:0 sc1
s_mov_b32 s40, 0
buffer_load_dwordx4 v[20:23], v1, s[44:47], s40 offen offset:1024 sc1
s_mov_b32 s40, 0
buffer_load_dwordx4 v[24:27], v1, s[44:47], s40 offen offset:2048 sc1
s_mov_b32 s40, 0
buffer_load_dwordx4 v[28:31], v1, s[44:47], s40 offen offset:3072 sc1
s_mov_b32 s40, 4096
buffer_load_dwordx4 v[112:115], v1, s[44:47], s40 offen offset:0 sc1
s_mov_b32 s40, 4096
buffer_load_dwordx4 v[116:119], v1, s[44:47], s40 offen offset:1024 sc1
s_mov_b32 s40, 4096
buffer_load_dwordx4 v[120:123], v1, s[44:47], s40 offen offset:2048 sc1
s_mov_b32 s40, 4096
buffer_load_dwordx4 v[124:127], v1, s[44:47], s40 offen offset:3072 sc1
K2_nocomb:
s_waitcnt lgkmcnt(8)
v_mfma_f32_16x16x32_bf16 a[0:3], v[128:131], v[80:83], a[0:3]
s_add_u32 m0, s29, s27
v_exp_f32 v32, v32
v_mfma_f32_16x16x32_bf16 a[4:7], v[128:131], v[84:87], a[4:7]
s_add_u32 s31, s38, 28672
v_exp_f32 v33, v33
v_mfma_f32_16x16x32_bf16 a[8:11], v[132:135], v[80:83], a[8:11]
buffer_load_dwordx4 v200, s[80:83], s38 offen lds
v_mfma_f32_16x16x32_bf16 a[12:15], v[132:135], v[84:87], a[12:15]
v_exp_f32 v34, v34
v_mfma_f32_16x16x32_bf16 a[16:19], v[136:139], v[80:83], a[16:19]
v_exp_f32 v35, v35
v_mfma_f32_16x16x32_bf16 v[104:107], v[192:195], v[80:83], v[104:107]
v_exp_f32 v40, v40
v_mfma_f32_16x16x32_bf16 a[20:23], v[136:139], v[84:87], a[20:23]
buffer_load_dwordx4 v201, s[80:83], s38 offen offset:1024 lds
v_mfma_f32_16x16x32_bf16 a[24:27], v[140:143], v[80:83], a[24:27]
v_exp_f32 v41, v41
v_mfma_f32_16x16x32_bf16 a[28:31], v[140:143], v[84:87], a[28:31]
s_waitcnt lgkmcnt(4)
v_exp_f32 v42, v42
v_mfma_f32_16x16x32_bf16 a[32:35], v[144:147], v[80:83], a[32:35]
v_exp_f32 v43, v43
v_mfma_f32_16x16x32_bf16 v[108:111], v[192:195], v[84:87], v[108:111]
buffer_load_dwordx4 v202, s[80:83], s38 offen offset:2048 lds
v_mfma_f32_16x16x32_bf16 a[36:39], v[144:147], v[84:87], a[36:39]
ds_read_b128 v[176:179], v3 offset:12288
v_cvt_pk_bf16_f32 v88, v32, v33
v_mfma_f32_16x16x32_bf16 a[40:43], v[148:151], v[80:83], a[40:43]
ds_read_b128 v[180:183], v3 offset:13312
v_cvt_pk_bf16_f32 v89, v34, v35
v_mfma_f32_16x16x32_bf16 a[44:47], v[148:151], v[84:87], a[44:47]
ds_read_b128 v[184:187], v3 offset:14336
v_cvt_pk_bf16_f32 v90, v40, v41
v_mfma_f32_16x16x32_bf16 a[48:51], v[152:155], v[80:83], a[48:51]
ds_read_b128 v[188:191], v3 offset:15360
v_cvt_pk_bf16_f32 v91, v42, v43
v_mfma_f32_16x16x32_bf16 a[52:55], v[152:155], v[84:87], a[52:55]
buffer_load_dwordx4 v203, s[80:83], s38 offen offset:3072 lds
v_mfma_f32_16x16x32_bf16 a[56:59], v[156:159], v[80:83], a[56:59]
s_add_u32 m0, m0, 4096
v_exp_f32 v36, v36
v_mfma_f32_16x16x32_bf16 a[60:63], v[156:159], v[84:87], a[60:63]
s_waitcnt lgkmcnt(4)
v_exp_f32 v37, v37
v_mfma_f32_16x16x32_bf16 a[64:67], v[160:163], v[80:83], a[64:67]
s_add_u32 s38, s38, 128
v_exp_f32 v38, v38
v_mfma_f32_16x16x32_bf16 a[68:71], v[160:163], v[84:87], a[68:71]
buffer_load_dwordx4 v200, s[80:83], s31 offen lds
v_mfma_f32_16x16x32_bf16 a[72:75], v[164:167], v[80:83], a[72:75]
v_exp_f32 v39, v39
v_mfma_f32_16x16x32_bf16 a[76:79], v[164:167], v[84:87], a[76:79]
v_exp_f32 v44, v44
v_mfma_f32_16x16x32_bf16 a[80:83], v[168:171], v[80:83], a[80:83]
v_exp_f32 v45, v45
v_mfma_f32_16x16x32_bf16 a[84:87], v[168:171], v[84:87], a[84:87]
ds_read_b128 v[128:131], v3 offset:16384
v_mfma_f32_16x16x32_bf16 a[88:91], v[172:175], v[80:83], a[88:91]
ds_read_b128 v[132:135], v3 offset:17408
v_mfma_f32_16x16x32_bf16 a[92:95], v[172:175], v[84:87], a[92:95]
s_waitcnt lgkmcnt(2)
ds_read_b128 v[136:139], v3 offset:18432
v_mfma_f32_16x16x32_bf16 a[96:99], v[176:179], v[80:83], a[96:99]
ds_read_b128 v[140:143], v3 offset:19456
buffer_load_dwordx4 v201, s[80:83], s31 offen offset:1024 lds
v_exp_f32 v46, v46
v_mfma_f32_16x16x32_bf16 a[100:103], v[176:179], v[84:87], a[100:103]
v_exp_f32 v47, v47
v_mfma_f32_16x16x32_bf16 a[104:107], v[180:183], v[80:83], a[104:107]
buffer_load_dwordx4 v202, s[80:83], s31 offen offset:2048 lds
v_mfma_f32_16x16x32_bf16 a[108:111], v[180:183], v[84:87], a[108:111]
v_cvt_pk_bf16_f32 v92, v36, v37
v_cvt_pk_bf16_f32 v93, v38, v39
v_mfma_f32_16x16x32_bf16 a[112:115], v[184:187], v[80:83], a[112:115]
ds_read_b128 v[144:147], v3 offset:20480
v_cvt_pk_bf16_f32 v94, v44, v45
v_cvt_pk_bf16_f32 v95, v46, v47
v_mfma_f32_16x16x32_bf16 a[116:119], v[184:187], v[84:87], a[116:119]
ds_read_b128 v[148:151], v3 offset:21504
v_mfma_f32_16x16x32_bf16 a[120:123], v[188:191], v[80:83], a[120:123]
ds_read_b128 v[152:155], v3 offset:22528
v_mfma_f32_16x16x32_bf16 a[124:127], v[188:191], v[84:87], a[124:127]
s_waitcnt lgkmcnt(3)
ds_read_b128 v[156:159], v3 offset:23552
v_mfma_f32_16x16x32_bf16 a[0:3], v[128:131], v[88:91], a[0:3]
buffer_load_dwordx4 v203, s[80:83], s31 offen offset:3072 lds
v_mfma_f32_16x16x32_bf16 a[4:7], v[128:131], v[92:95], a[4:7]
s_add_u32 s27, s27, 32768
ds_read_b128 v[160:163], v3 offset:24576
s_cmp_eq_u32 s27, 163840
s_cselect_b32 s27, 0, s27
v_mfma_f32_16x16x32_bf16 a[8:11], v[132:135], v[88:91], a[8:11]
s_add_u32 m0, s29, s27
ds_read_b128 v[164:167], v3 offset:25600
s_add_u32 s31, s38, 28672
v_mfma_f32_16x16x32_bf16 a[12:15], v[132:135], v[92:95], a[12:15]
buffer_load_dwordx4 v200, s[80:83], s38 offen lds
v_mfma_f32_16x16x32_bf16 a[16:19], v[136:139], v[88:91], a[16:19]
buffer_load_dwordx4 v201, s[80:83], s38 offen offset:1024 lds
v_mfma_f32_16x16x32_bf16 a[20:23], v[136:139], v[92:95], a[20:23]
ds_read_b128 v[168:171], v3 offset:26624
v_mfma_f32_16x16x32_bf16 a[24:27], v[140:143], v[88:91], a[24:27]
ds_read_b128 v[172:175], v3 offset:27648
v_mfma_f32_16x16x32_bf16 a[28:31], v[140:143], v[92:95], a[28:31]
s_waitcnt lgkmcnt(4)
buffer_load_dwordx4 v202, s[80:83], s38 offen offset:2048 lds
v_mfma_f32_16x16x32_bf16 a[32:35], v[144:147], v[88:91], a[32:35]
ds_read_b128 v[176:179], v3 offset:28672
v_mfma_f32_16x16x32_bf16 v[104:107], v[192:195], v[88:91], v[104:107]
ds_read_b128 v[180:183], v3 offset:29696
v_mfma_f32_16x16x32_bf16 a[36:39], v[144:147], v[92:95], a[36:39]
buffer_load_dwordx4 v203, s[80:83], s38 offen offset:3072 lds
v_mfma_f32_16x16x32_bf16 a[40:43], v[148:151], v[88:91], a[40:43]
s_add_u32 m0, m0, 4096
ds_read_b128 v[184:187], v3 offset:30720
s_add_u32 s38, s38, 128
v_mfma_f32_16x16x32_bf16 a[44:47], v[148:151], v[92:95], a[44:47]
ds_read_b128 v[188:191], v3 offset:31744
v_mfma_f32_16x16x32_bf16 a[48:51], v[152:155], v[88:91], a[48:51]
v_mfma_f32_16x16x32_bf16 v[108:111], v[192:195], v[92:95], v[108:111]
buffer_load_dwordx4 v200, s[80:83], s31 offen lds
v_mfma_f32_16x16x32_bf16 a[52:55], v[152:155], v[92:95], a[52:55]
v_mfma_f32_16x16x32_bf16 a[56:59], v[156:159], v[88:91], a[56:59]
v_mfma_f32_16x16x32_bf16 a[60:63], v[156:159], v[92:95], a[60:63]
s_waitcnt lgkmcnt(4)
v_mfma_f32_16x16x32_bf16 a[64:67], v[160:163], v[88:91], a[64:67]
buffer_load_dwordx4 v201, s[80:83], s31 offen offset:1024 lds
v_mfma_f32_16x16x32_bf16 a[68:71], v[160:163], v[92:95], a[68:71]
v_mfma_f32_16x16x32_bf16 a[72:75], v[164:167], v[88:91], a[72:75]
v_mfma_f32_16x16x32_bf16 a[76:79], v[164:167], v[92:95], a[76:79]
v_mfma_f32_16x16x32_bf16 a[80:83], v[168:171], v[88:91], a[80:83]
buffer_load_dwordx4 v202, s[80:83], s31 offen offset:2048 lds
v_mfma_f32_16x16x32_bf16 a[84:87], v[168:171], v[92:95], a[84:87]
v_mfma_f32_16x16x32_bf16 a[88:91], v[172:175], v[88:91], a[88:91]
v_mfma_f32_16x16x32_bf16 a[92:95], v[172:175], v[92:95], a[92:95]
s_waitcnt lgkmcnt(0)
v_mfma_f32_16x16x32_bf16 a[96:99], v[176:179], v[88:91], a[96:99]
buffer_load_dwordx4 v203, s[80:83], s31 offen offset:3072 lds
v_mfma_f32_16x16x32_bf16 a[100:103], v[176:179], v[92:95], a[100:103]
s_add_u32 s27, s27, 32768
v_mfma_f32_16x16x32_bf16 a[104:107], v[180:183], v[88:91], a[104:107]
s_cmp_eq_u32 s27, 163840
s_cselect_b32 s27, 0, s27
v_mfma_f32_16x16x32_bf16 a[108:111], v[180:183], v[92:95], a[108:111]
v_mfma_f32_16x16x32_bf16 a[112:115], v[184:187], v[88:91], a[112:115]
v_mfma_f32_16x16x32_bf16 a[116:119], v[184:187], v[92:95], a[116:119]
v_mfma_f32_16x16x32_bf16 a[120:123], v[188:191], v[88:91], a[120:123]
v_mfma_f32_16x16x32_bf16 a[124:127], v[188:191], v[92:95], a[124:127]
s_cmp_eq_u32 s37, 0
s_cbranch_scc0 K2_final
s_nop 15
v_accvgpr_read_b32 v224, a0
v_accvgpr_read_b32 v225, a1
v_accvgpr_read_b32 v226, a2
v_accvgpr_read_b32 v227, a3
v_accvgpr_read_b32 v228, a8
v_accvgpr_read_b32 v229, a9
v_accvgpr_read_b32 v230, a10
v_accvgpr_read_b32 v231, a11
v_cvt_pk_bf16_f32 v224, v224, v225
v_cvt_pk_bf16_f32 v225, v226, v227
v_cvt_pk_bf16_f32 v226, v228, v229
v_cvt_pk_bf16_f32 v227, v230, v231
s_mov_b32 s40, 0
buffer_store_dwordx4 v[224:227], v1, s[44:47], s40 offen offset:0 sc1
v_accvgpr_read_b32 v232, a16
v_accvgpr_read_b32 v233, a17
v_accvgpr_read_b32 v234, a18
v_accvgpr_read_b32 v235, a19
v_accvgpr_read_b32 v236, a24
v_accvgpr_read_b32 v237, a25
v_accvgpr_read_b32 v238, a26
v_accvgpr_read_b32 v239, a27
v_cvt_pk_bf16_f32 v232, v232, v233
v_cvt_pk_bf16_f32 v233, v234, v235
v_cvt_pk_bf16_f32 v234, v236, v237
v_cvt_pk_bf16_f32 v235, v238, v239
s_mov_b32 s40, 0
buffer_store_dwordx4 v[232:235], v1, s[44:47], s40 offen offset:1024 sc1
v_accvgpr_read_b32 v240, a32
v_accvgpr_read_b32 v241, a33
v_accvgpr_read_b32 v242, a34
v_accvgpr_read_b32 v243, a35
v_accvgpr_read_b32 v244, a40
v_accvgpr_read_b32 v245, a41
v_accvgpr_read_b32 v246, a42
v_accvgpr_read_b32 v247, a43
v_cvt_pk_bf16_f32 v240, v240, v241
v_cvt_pk_bf16_f32 v241, v242, v243
v_cvt_pk_bf16_f32 v242, v244, v245
v_cvt_pk_bf16_f32 v243, v246, v247
s_mov_b32 s40, 0
buffer_store_dwordx4 v[240:243], v1, s[44:47], s40 offen offset:2048 sc1
v_accvgpr_read_b32 v248, a48
v_accvgpr_read_b32 v249, a49
v_accvgpr_read_b32 v250, a50
v_accvgpr_read_b32 v251, a51
v_accvgpr_read_b32 v252, a56
v_accvgpr_read_b32 v253, a57
v_accvgpr_read_b32 v254, a58
v_accvgpr_read_b32 v255, a59
v_cvt_pk_bf16_f32 v248, v248, v249
v_cvt_pk_bf16_f32 v249, v250, v251
v_cvt_pk_bf16_f32 v250, v252, v253
v_cvt_pk_bf16_f32 v251, v254, v255
s_mov_b32 s40, 0
buffer_store_dwordx4 v[248:251], v1, s[44:47], s40 offen offset:3072 sc1
v_accvgpr_read_b32 v224, a64
v_accvgpr_read_b32 v225, a65
v_accvgpr_read_b32 v226, a66
v_accvgpr_read_b32 v227, a67
v_accvgpr_read_b32 v228, a72
v_accvgpr_read_b32 v229, a73
v_accvgpr_read_b32 v230, a74
v_accvgpr_read_b32 v231, a75
v_cvt_pk_bf16_f32 v224, v224, v225
v_cvt_pk_bf16_f32 v225, v226, v227
v_cvt_pk_bf16_f32 v226, v228, v229
v_cvt_pk_bf16_f32 v227, v230, v231
s_mov_b32 s40, 4096
buffer_store_dwordx4 v[224:227], v1, s[44:47], s40 offen offset:0 sc1
v_accvgpr_read_b32 v232, a80
v_accvgpr_read_b32 v233, a81
v_accvgpr_read_b32 v234, a82
v_accvgpr_read_b32 v235, a83
v_accvgpr_read_b32 v236, a88
v_accvgpr_read_b32 v237, a89
v_accvgpr_read_b32 v238, a90
v_accvgpr_read_b32 v239, a91
v_cvt_pk_bf16_f32 v232, v232, v233
v_cvt_pk_bf16_f32 v233, v234, v235
v_cvt_pk_bf16_f32 v234, v236, v237
v_cvt_pk_bf16_f32 v235, v238, v239
s_mov_b32 s40, 4096
buffer_store_dwordx4 v[232:235], v1, s[44:47], s40 offen offset:1024 sc1
v_accvgpr_read_b32 v240, a96
v_accvgpr_read_b32 v241, a97
v_accvgpr_read_b32 v242, a98
v_accvgpr_read_b32 v243, a99
v_accvgpr_read_b32 v244, a104
v_accvgpr_read_b32 v245, a105
v_accvgpr_read_b32 v246, a106
v_accvgpr_read_b32 v247, a107
v_cvt_pk_bf16_f32 v240, v240, v241
v_cvt_pk_bf16_f32 v241, v242, v243
v_cvt_pk_bf16_f32 v242, v244, v245
v_cvt_pk_bf16_f32 v243, v246, v247
s_mov_b32 s40, 4096
buffer_store_dwordx4 v[240:243], v1, s[44:47], s40 offen offset:2048 sc1
v_accvgpr_read_b32 v248, a112
v_accvgpr_read_b32 v249, a113
v_accvgpr_read_b32 v250, a114
v_accvgpr_read_b32 v251, a115
v_accvgpr_read_b32 v252, a120
v_accvgpr_read_b32 v253, a121
v_accvgpr_read_b32 v254, a122
v_accvgpr_read_b32 v255, a123
v_cvt_pk_bf16_f32 v248, v248, v249
v_cvt_pk_bf16_f32 v249, v250, v251
v_cvt_pk_bf16_f32 v250, v252, v253
v_cvt_pk_bf16_f32 v251, v254, v255
s_mov_b32 s40, 4096
buffer_store_dwordx4 v[248:251], v1, s[44:47], s40 offen offset:3072 sc1
v_accvgpr_read_b32 v224, a4
v_accvgpr_read_b32 v225, a5
v_accvgpr_read_b32 v226, a6
v_accvgpr_read_b32 v227, a7
v_accvgpr_read_b32 v228, a12
v_accvgpr_read_b32 v229, a13
v_accvgpr_read_b32 v230, a14
v_accvgpr_read_b32 v231, a15
v_cvt_pk_bf16_f32 v224, v224, v225
v_cvt_pk_bf16_f32 v225, v226, v227
v_cvt_pk_bf16_f32 v226, v228, v229
v_cvt_pk_bf16_f32 v227, v230, v231
s_mov_b32 s40, 8192
buffer_store_dwordx4 v[224:227], v1, s[44:47], s40 offen offset:0 sc1
v_accvgpr_read_b32 v232, a20
v_accvgpr_read_b32 v233, a21
v_accvgpr_read_b32 v234, a22
v_accvgpr_read_b32 v235, a23
v_accvgpr_read_b32 v236, a28
v_accvgpr_read_b32 v237, a29
v_accvgpr_read_b32 v238, a30
v_accvgpr_read_b32 v239, a31
v_cvt_pk_bf16_f32 v232, v232, v233
v_cvt_pk_bf16_f32 v233, v234, v235
v_cvt_pk_bf16_f32 v234, v236, v237
v_cvt_pk_bf16_f32 v235, v238, v239
s_mov_b32 s40, 8192
buffer_store_dwordx4 v[232:235], v1, s[44:47], s40 offen offset:1024 sc1
v_accvgpr_read_b32 v240, a36
v_accvgpr_read_b32 v241, a37
v_accvgpr_read_b32 v242, a38
v_accvgpr_read_b32 v243, a39
v_accvgpr_read_b32 v244, a44
v_accvgpr_read_b32 v245, a45
v_accvgpr_read_b32 v246, a46
v_accvgpr_read_b32 v247, a47
v_cvt_pk_bf16_f32 v240, v240, v241
v_cvt_pk_bf16_f32 v241, v242, v243
v_cvt_pk_bf16_f32 v242, v244, v245
v_cvt_pk_bf16_f32 v243, v246, v247
s_mov_b32 s40, 8192
buffer_store_dwordx4 v[240:243], v1, s[44:47], s40 offen offset:2048 sc1
v_accvgpr_read_b32 v248, a52
v_accvgpr_read_b32 v249, a53
v_accvgpr_read_b32 v250, a54
v_accvgpr_read_b32 v251, a55
v_accvgpr_read_b32 v252, a60
v_accvgpr_read_b32 v253, a61
v_accvgpr_read_b32 v254, a62
v_accvgpr_read_b32 v255, a63
v_cvt_pk_bf16_f32 v248, v248, v249
v_cvt_pk_bf16_f32 v249, v250, v251
v_cvt_pk_bf16_f32 v250, v252, v253
v_cvt_pk_bf16_f32 v251, v254, v255
s_mov_b32 s40, 8192
buffer_store_dwordx4 v[248:251], v1, s[44:47], s40 offen offset:3072 sc1
v_accvgpr_read_b32 v224, a68
v_accvgpr_read_b32 v225, a69
v_accvgpr_read_b32 v226, a70
v_accvgpr_read_b32 v227, a71
v_accvgpr_read_b32 v228, a76
v_accvgpr_read_b32 v229, a77
v_accvgpr_read_b32 v230, a78
v_accvgpr_read_b32 v231, a79
v_cvt_pk_bf16_f32 v224, v224, v225
v_cvt_pk_bf16_f32 v225, v226, v227
v_cvt_pk_bf16_f32 v226, v228, v229
v_cvt_pk_bf16_f32 v227, v230, v231
s_mov_b32 s40, 12288
buffer_store_dwordx4 v[224:227], v1, s[44:47], s40 offen offset:0 sc1
v_accvgpr_read_b32 v232, a84
v_accvgpr_read_b32 v233, a85
v_accvgpr_read_b32 v234, a86
v_accvgpr_read_b32 v235, a87
v_accvgpr_read_b32 v236, a92
v_accvgpr_read_b32 v237, a93
v_accvgpr_read_b32 v238, a94
v_accvgpr_read_b32 v239, a95
v_cvt_pk_bf16_f32 v232, v232, v233
v_cvt_pk_bf16_f32 v233, v234, v235
v_cvt_pk_bf16_f32 v234, v236, v237
v_cvt_pk_bf16_f32 v235, v238, v239
s_mov_b32 s40, 12288
buffer_store_dwordx4 v[232:235], v1, s[44:47], s40 offen offset:1024 sc1
v_accvgpr_read_b32 v240, a100
v_accvgpr_read_b32 v241, a101
v_accvgpr_read_b32 v242, a102
v_accvgpr_read_b32 v243, a103
v_accvgpr_read_b32 v244, a108
v_accvgpr_read_b32 v245, a109
v_accvgpr_read_b32 v246, a110
v_accvgpr_read_b32 v247, a111
v_cvt_pk_bf16_f32 v240, v240, v241
v_cvt_pk_bf16_f32 v241, v242, v243
v_cvt_pk_bf16_f32 v242, v244, v245
v_cvt_pk_bf16_f32 v243, v246, v247
s_mov_b32 s40, 12288
buffer_store_dwordx4 v[240:243], v1, s[44:47], s40 offen offset:2048 sc1
v_accvgpr_read_b32 v248, a116
v_accvgpr_read_b32 v249, a117
v_accvgpr_read_b32 v250, a118
v_accvgpr_read_b32 v251, a119
v_accvgpr_read_b32 v252, a124
v_accvgpr_read_b32 v253, a125
v_accvgpr_read_b32 v254, a126
v_accvgpr_read_b32 v255, a127
v_cvt_pk_bf16_f32 v248, v248, v249
v_cvt_pk_bf16_f32 v249, v250, v251
v_cvt_pk_bf16_f32 v250, v252, v253
v_cvt_pk_bf16_f32 v251, v254, v255
s_mov_b32 s40, 12288
buffer_store_dwordx4 v[248:251], v1, s[44:47], s40 offen offset:3072 sc1
v_mov_b32 v16, v96
v_mov_b32 v17, v100
v_mov_b32 v18, v104
v_mov_b32 v19, v108
buffer_store_dwordx4 v[16:19], v1, s[52:55], 0 offen sc1
s_load_dwordx4 s[84:87], s[0:1], 56
s_load_dwordx2 s[88:89], s[0:1], 72
s_lshl_b32 s40, s33, 4
s_add_u32 s40, s40, s21
s_lshl_b32 s40, s40, 2
s_add_u32 s40, s40, s20
s_mul_i32 s40, s40, 33
v_lshrrev_b32 v7, 4, v1
v_add_u32 v6, s40, v7
v_lshlrev_b32 v6, 7, v6
v_cmp_gt_u32 vcc, 33, v7
v_mov_b32 v9, 0x80000000
s_nop 0
v_cndmask_b32 v6, v9, v6, vcc
s_waitcnt lgkmcnt(0)
s_mov_b32 s4, s84
s_mov_b32 s5, s85
s_mov_b32 s6, 1605632
s_mov_b32 s7, 0x20000
buffer_load_dword v20, v6, s[4:7], 0 offen
s_mov_b32 s4, s86
s_mov_b32 s5, s87
s_mov_b32 s6, 1605632
s_mov_b32 s7, 0x20000
buffer_load_dword v21, v6, s[4:7], 0 offen
s_mov_b32 s4, s88
s_mov_b32 s5, s89
s_mov_b32 s6, 1605632
s_mov_b32 s7, 0x20000
buffer_load_dword v22, v6, s[4:7], 0 offen
s_waitcnt vmcnt(0)
s_lshl_b32 s40, s34, 2
s_add_u32 s40, s40, s20
s_lshr_b32 s41, s40, 5
s_lshl_b32 s41, s41, 2
s_and_b32 s40, s40, 31
s_lshl_b32 s40, 1, s40
v_mov_b32 v6, s40
v_mov_b32 v7, s41
v_cmp_eq_u32 vcc, 0, v1
s_and_saveexec_b64 s[40:41], vcc
buffer_atomic_or v6, v7, s[56:59], 0 offen sc1
s_mov_b64 exec, s[40:41]
s_branch K2_B2
K2_final:
s_cmp_eq_u32 s37, 2
s_cbranch_scc1 K2_comb
s_nop 15
v_rcp_f32 v104, v104
v_rcp_f32 v108, v108
s_nop 0
v_mov_b32 v6, v104
v_mov_b32 v7, v108
v_accvgpr_read_b32 v228, a0
v_accvgpr_read_b32 v229, a1
v_accvgpr_read_b32 v230, a2
v_accvgpr_read_b32 v231, a3
v_accvgpr_read_b32 v232, a8
v_accvgpr_read_b32 v233, a9
v_accvgpr_read_b32 v234, a10
v_accvgpr_read_b32 v235, a11
v_mul_f32 v228, v228, v6
v_mul_f32 v229, v229, v6
v_mul_f32 v230, v230, v6
v_mul_f32 v231, v231, v6
v_mul_f32 v232, v232, v6
v_mul_f32 v233, v233, v6
v_mul_f32 v234, v234, v6
v_mul_f32 v235, v235, v6
v_cvt_pk_bf16_f32 v16, v228, v229
v_cvt_pk_bf16_f32 v17, v230, v231
v_cvt_pk_bf16_f32 v18, v232, v233
v_cvt_pk_bf16_f32 v19, v234, v235
v_accvgpr_read_b32 v240, a16
v_accvgpr_read_b32 v241, a17
v_accvgpr_read_b32 v242, a18
v_accvgpr_read_b32 v243, a19
v_accvgpr_read_b32 v244, a24
v_accvgpr_read_b32 v245, a25
v_accvgpr_read_b32 v246, a26
v_accvgpr_read_b32 v247, a27
v_mul_f32 v240, v240, v6
v_mul_f32 v241, v241, v6
v_mul_f32 v242, v242, v6
v_mul_f32 v243, v243, v6
v_mul_f32 v244, v244, v6
v_mul_f32 v245, v245, v6
v_mul_f32 v246, v246, v6
v_mul_f32 v247, v247, v6
v_cvt_pk_bf16_f32 v20, v240, v241
v_cvt_pk_bf16_f32 v21, v242, v243
v_cvt_pk_bf16_f32 v22, v244, v245
v_cvt_pk_bf16_f32 v23, v246, v247
v_accvgpr_read_b32 v228, a32
v_accvgpr_read_b32 v229, a33
v_accvgpr_read_b32 v230, a34
v_accvgpr_read_b32 v231, a35
v_accvgpr_read_b32 v232, a40
v_accvgpr_read_b32 v233, a41
v_accvgpr_read_b32 v234, a42
v_accvgpr_read_b32 v235, a43
v_mul_f32 v228, v228, v6
v_mul_f32 v229, v229, v6
v_mul_f32 v230, v230, v6
v_mul_f32 v231, v231, v6
v_mul_f32 v232, v232, v6
v_mul_f32 v233, v233, v6
v_mul_f32 v234, v234, v6
v_mul_f32 v235, v235, v6
v_cvt_pk_bf16_f32 v24, v228, v229
v_cvt_pk_bf16_f32 v25, v230, v231
v_cvt_pk_bf16_f32 v26, v232, v233
v_cvt_pk_bf16_f32 v27, v234, v235
v_accvgpr_read_b32 v240, a48
v_accvgpr_read_b32 v241, a49
v_accvgpr_read_b32 v242, a50
v_accvgpr_read_b32 v243, a51
v_accvgpr_read_b32 v244, a56
v_accvgpr_read_b32 v245, a57
v_accvgpr_read_b32 v246, a58
v_accvgpr_read_b32 v247, a59
v_mul_f32 v240, v240, v6
v_mul_f32 v241, v241, v6
v_mul_f32 v242, v242, v6
v_mul_f32 v243, v243, v6
v_mul_f32 v244, v244, v6
v_mul_f32 v245, v245, v6
v_mul_f32 v246, v246, v6
v_mul_f32 v247, v247, v6
v_cvt_pk_bf16_f32 v28, v240, v241
v_cvt_pk_bf16_f32 v29, v242, v243
v_cvt_pk_bf16_f32 v30, v244, v245
v_cvt_pk_bf16_f32 v31, v246, v247
v_accvgpr_read_b32 v228, a64
v_accvgpr_read_b32 v229, a65
v_accvgpr_read_b32 v230, a66
v_accvgpr_read_b32 v231, a67
v_accvgpr_read_b32 v232, a72
v_accvgpr_read_b32 v233, a73
v_accvgpr_read_b32 v234, a74
v_accvgpr_read_b32 v235, a75
v_mul_f32 v228, v228, v6
v_mul_f32 v229, v229, v6
v_mul_f32 v230, v230, v6
v_mul_f32 v231, v231, v6
v_mul_f32 v232, v232, v6
v_mul_f32 v233, v233, v6
v_mul_f32 v234, v234, v6
v_mul_f32 v235, v235, v6
v_cvt_pk_bf16_f32 v32, v228, v229
v_cvt_pk_bf16_f32 v33, v230, v231
v_cvt_pk_bf16_f32 v34, v232, v233
v_cvt_pk_bf16_f32 v35, v234, v235
v_accvgpr_read_b32 v240, a80
v_accvgpr_read_b32 v241, a81
v_accvgpr_read_b32 v242, a82
v_accvgpr_read_b32 v243, a83
v_accvgpr_read_b32 v244, a88
v_accvgpr_read_b32 v245, a89
v_accvgpr_read_b32 v246, a90
v_accvgpr_read_b32 v247, a91
v_mul_f32 v240, v240, v6
v_mul_f32 v241, v241, v6
v_mul_f32 v242, v242, v6
v_mul_f32 v243, v243, v6
v_mul_f32 v244, v244, v6
v_mul_f32 v245, v245, v6
v_mul_f32 v246, v246, v6
v_mul_f32 v247, v247, v6
v_cvt_pk_bf16_f32 v36, v240, v241
v_cvt_pk_bf16_f32 v37, v242, v243
v_cvt_pk_bf16_f32 v38, v244, v245
v_cvt_pk_bf16_f32 v39, v246, v247
v_accvgpr_read_b32 v228, a96
v_accvgpr_read_b32 v229, a97
v_accvgpr_read_b32 v230, a98
v_accvgpr_read_b32 v231, a99
v_accvgpr_read_b32 v232, a104
v_accvgpr_read_b32 v233, a105
v_accvgpr_read_b32 v234, a106
v_accvgpr_read_b32 v235, a107
v_mul_f32 v228, v228, v6
v_mul_f32 v229, v229, v6
v_mul_f32 v230, v230, v6
v_mul_f32 v231, v231, v6
v_mul_f32 v232, v232, v6
v_mul_f32 v233, v233, v6
v_mul_f32 v234, v234, v6
v_mul_f32 v235, v235, v6
v_cvt_pk_bf16_f32 v40, v228, v229
v_cvt_pk_bf16_f32 v41, v230, v231
v_cvt_pk_bf16_f32 v42, v232, v233
v_cvt_pk_bf16_f32 v43, v234, v235
v_accvgpr_read_b32 v240, a112
v_accvgpr_read_b32 v241, a113
v_accvgpr_read_b32 v242, a114
v_accvgpr_read_b32 v243, a115
v_accvgpr_read_b32 v244, a120
v_accvgpr_read_b32 v245, a121
v_accvgpr_read_b32 v246, a122
v_accvgpr_read_b32 v247, a123
v_mul_f32 v240, v240, v6
v_mul_f32 v241, v241, v6
v_mul_f32 v242, v242, v6
v_mul_f32 v243, v243, v6
v_mul_f32 v244, v244, v6
v_mul_f32 v245, v245, v6
v_mul_f32 v246, v246, v6
v_mul_f32 v247, v247, v6
v_cvt_pk_bf16_f32 v44, v240, v241
v_cvt_pk_bf16_f32 v45, v242, v243
v_cvt_pk_bf16_f32 v46, v244, v245
v_cvt_pk_bf16_f32 v47, v246, v247
v_accvgpr_read_b32 v228, a4
v_accvgpr_read_b32 v229, a5
v_accvgpr_read_b32 v230, a6
v_accvgpr_read_b32 v231, a7
v_accvgpr_read_b32 v232, a12
v_accvgpr_read_b32 v233, a13
v_accvgpr_read_b32 v234, a14
v_accvgpr_read_b32 v235, a15
v_mul_f32 v228, v228, v7
v_mul_f32 v229, v229, v7
v_mul_f32 v230, v230, v7
v_mul_f32 v231, v231, v7
v_mul_f32 v232, v232, v7
v_mul_f32 v233, v233, v7
v_mul_f32 v234, v234, v7
v_mul_f32 v235, v235, v7
v_cvt_pk_bf16_f32 v48, v228, v229
v_cvt_pk_bf16_f32 v49, v230, v231
v_cvt_pk_bf16_f32 v50, v232, v233
v_cvt_pk_bf16_f32 v51, v234, v235
v_accvgpr_read_b32 v240, a20
v_accvgpr_read_b32 v241, a21
v_accvgpr_read_b32 v242, a22
v_accvgpr_read_b32 v243, a23
v_accvgpr_read_b32 v244, a28
v_accvgpr_read_b32 v245, a29
v_accvgpr_read_b32 v246, a30
v_accvgpr_read_b32 v247, a31
v_mul_f32 v240, v240, v7
v_mul_f32 v241, v241, v7
v_mul_f32 v242, v242, v7
v_mul_f32 v243, v243, v7
v_mul_f32 v244, v244, v7
v_mul_f32 v245, v245, v7
v_mul_f32 v246, v246, v7
v_mul_f32 v247, v247, v7
v_cvt_pk_bf16_f32 v52, v240, v241
v_cvt_pk_bf16_f32 v53, v242, v243
v_cvt_pk_bf16_f32 v54, v244, v245
v_cvt_pk_bf16_f32 v55, v246, v247
v_accvgpr_read_b32 v228, a36
v_accvgpr_read_b32 v229, a37
v_accvgpr_read_b32 v230, a38
v_accvgpr_read_b32 v231, a39
v_accvgpr_read_b32 v232, a44
v_accvgpr_read_b32 v233, a45
v_accvgpr_read_b32 v234, a46
v_accvgpr_read_b32 v235, a47
v_mul_f32 v228, v228, v7
v_mul_f32 v229, v229, v7
v_mul_f32 v230, v230, v7
v_mul_f32 v231, v231, v7
v_mul_f32 v232, v232, v7
v_mul_f32 v233, v233, v7
v_mul_f32 v234, v234, v7
v_mul_f32 v235, v235, v7
v_cvt_pk_bf16_f32 v56, v228, v229
v_cvt_pk_bf16_f32 v57, v230, v231
v_cvt_pk_bf16_f32 v58, v232, v233
v_cvt_pk_bf16_f32 v59, v234, v235
v_accvgpr_read_b32 v240, a52
v_accvgpr_read_b32 v241, a53
v_accvgpr_read_b32 v242, a54
v_accvgpr_read_b32 v243, a55
v_accvgpr_read_b32 v244, a60
v_accvgpr_read_b32 v245, a61
v_accvgpr_read_b32 v246, a62
v_accvgpr_read_b32 v247, a63
v_mul_f32 v240, v240, v7
v_mul_f32 v241, v241, v7
v_mul_f32 v242, v242, v7
v_mul_f32 v243, v243, v7
v_mul_f32 v244, v244, v7
v_mul_f32 v245, v245, v7
v_mul_f32 v246, v246, v7
v_mul_f32 v247, v247, v7
v_cvt_pk_bf16_f32 v60, v240, v241
v_cvt_pk_bf16_f32 v61, v242, v243
v_cvt_pk_bf16_f32 v62, v244, v245
v_cvt_pk_bf16_f32 v63, v246, v247
v_accvgpr_read_b32 v228, a68
v_accvgpr_read_b32 v229, a69
v_accvgpr_read_b32 v230, a70
v_accvgpr_read_b32 v231, a71
v_accvgpr_read_b32 v232, a76
v_accvgpr_read_b32 v233, a77
v_accvgpr_read_b32 v234, a78
v_accvgpr_read_b32 v235, a79
v_mul_f32 v228, v228, v7
v_mul_f32 v229, v229, v7
v_mul_f32 v230, v230, v7
v_mul_f32 v231, v231, v7
v_mul_f32 v232, v232, v7
v_mul_f32 v233, v233, v7
v_mul_f32 v234, v234, v7
v_mul_f32 v235, v235, v7
v_cvt_pk_bf16_f32 v64, v228, v229
v_cvt_pk_bf16_f32 v65, v230, v231
v_cvt_pk_bf16_f32 v66, v232, v233
v_cvt_pk_bf16_f32 v67, v234, v235
v_accvgpr_read_b32 v240, a84
v_accvgpr_read_b32 v241, a85
v_accvgpr_read_b32 v242, a86
v_accvgpr_read_b32 v243, a87
v_accvgpr_read_b32 v244, a92
v_accvgpr_read_b32 v245, a93
v_accvgpr_read_b32 v246, a94
v_accvgpr_read_b32 v247, a95
v_mul_f32 v240, v240, v7
v_mul_f32 v241, v241, v7
v_mul_f32 v242, v242, v7
v_mul_f32 v243, v243, v7
v_mul_f32 v244, v244, v7
v_mul_f32 v245, v245, v7
v_mul_f32 v246, v246, v7
v_mul_f32 v247, v247, v7
v_cvt_pk_bf16_f32 v68, v240, v241
v_cvt_pk_bf16_f32 v69, v242, v243
v_cvt_pk_bf16_f32 v70, v244, v245
v_cvt_pk_bf16_f32 v71, v246, v247
v_accvgpr_read_b32 v228, a100
v_accvgpr_read_b32 v229, a101
v_accvgpr_read_b32 v230, a102
v_accvgpr_read_b32 v231, a103
v_accvgpr_read_b32 v232, a108
v_accvgpr_read_b32 v233, a109
v_accvgpr_read_b32 v234, a110
v_accvgpr_read_b32 v235, a111
v_mul_f32 v228, v228, v7
v_mul_f32 v229, v229, v7
v_mul_f32 v230, v230, v7
v_mul_f32 v231, v231, v7
v_mul_f32 v232, v232, v7
v_mul_f32 v233, v233, v7
v_mul_f32 v234, v234, v7
v_mul_f32 v235, v235, v7
v_cvt_pk_bf16_f32 v72, v228, v229
v_cvt_pk_bf16_f32 v73, v230, v231
v_cvt_pk_bf16_f32 v74, v232, v233
v_cvt_pk_bf16_f32 v75, v234, v235
v_accvgpr_read_b32 v240, a116
v_accvgpr_read_b32 v241, a117
v_accvgpr_read_b32 v242, a118
v_accvgpr_read_b32 v243, a119
v_accvgpr_read_b32 v244, a124
v_accvgpr_read_b32 v245, a125
v_accvgpr_read_b32 v246, a126
v_accvgpr_read_b32 v247, a127
v_mul_f32 v240, v240, v7
v_mul_f32 v241, v241, v7
v_mul_f32 v242, v242, v7
v_mul_f32 v243, v243, v7
v_mul_f32 v244, v244, v7
v_mul_f32 v245, v245, v7
v_mul_f32 v246, v246, v7
v_mul_f32 v247, v247, v7
v_cvt_pk_bf16_f32 v76, v240, v241
v_cvt_pk_bf16_f32 v77, v242, v243
v_cvt_pk_bf16_f32 v78, v244, v245
v_cvt_pk_bf16_f32 v79, v246, v247
s_branch K2_op
K2_comb:
s_waitcnt vmcnt(0)
s_nop 15
v_min_f32 v10, v96, v224
v_min_f32 v11, v100, v225
v_sub_f32 v6, v10, v96
v_sub_f32 v8, v10, v224
v_sub_f32 v7, v11, v100
v_sub_f32 v9, v11, v225
v_exp_f32 v6, v6
v_exp_f32 v8, v8
v_exp_f32 v7, v7
v_exp_f32 v9, v9
s_nop 0
v_mul_f32 v104, v104, v6
v_fmac_f32 v104, v226, v8
v_mul_f32 v108, v108, v7
v_fmac_f32 v108, v227, v9
v_rcp_f32 v104, v104
v_rcp_f32 v108, v108
s_nop 0
v_mul_f32 v6, v6, v104
v_mul_f32 v8, v8, v104
v_mul_f32 v7, v7, v108
v_mul_f32 v9, v9, v108
v_accvgpr_read_b32 v228, a0
v_accvgpr_read_b32 v229, a1
v_accvgpr_read_b32 v230, a2
v_accvgpr_read_b32 v231, a3
v_accvgpr_read_b32 v232, a8
v_accvgpr_read_b32 v233, a9
v_accvgpr_read_b32 v234, a10
v_accvgpr_read_b32 v235, a11
v_mul_f32 v228, v228, v6
v_mul_f32 v229, v229, v6
v_mul_f32 v230, v230, v6
v_mul_f32 v231, v231, v6
v_mul_f32 v232, v232, v6
v_mul_f32 v233, v233, v6
v_mul_f32 v234, v234, v6
v_mul_f32 v235, v235, v6
v_lshlrev_b32 v236, 16, v16
v_and_b32 v237, 0xffff0000, v16
v_fmac_f32 v228, v236, v8
v_fmac_f32 v229, v237, v8
v_lshlrev_b32 v236, 16, v17
v_and_b32 v237, 0xffff0000, v17
v_fmac_f32 v230, v236, v8
v_fmac_f32 v231, v237, v8
v_lshlrev_b32 v236, 16, v18
v_and_b32 v237, 0xffff0000, v18
v_fmac_f32 v232, v236, v8
v_fmac_f32 v233, v237, v8
v_lshlrev_b32 v236, 16, v19
v_and_b32 v237, 0xffff0000, v19
v_fmac_f32 v234, v236, v8
v_fmac_f32 v235, v237, v8
v_cvt_pk_bf16_f32 v16, v228, v229
v_cvt_pk_bf16_f32 v17, v230, v231
v_cvt_pk_bf16_f32 v18, v232, v233
v_cvt_pk_bf16_f32 v19, v234, v235
v_accvgpr_read_b32 v240, a16
v_accvgpr_read_b32 v241, a17
v_accvgpr_read_b32 v242, a18
v_accvgpr_read_b32 v243, a19
v_accvgpr_read_b32 v244, a24
v_accvgpr_read_b32 v245, a25
v_accvgpr_read_b32 v246, a26
v_accvgpr_read_b32 v247, a27
v_mul_f32 v240, v240, v6
v_mul_f32 v241, v241, v6
v_mul_f32 v242, v242, v6
v_mul_f32 v243, v243, v6
v_mul_f32 v244, v244, v6
v_mul_f32 v245, v245, v6
v_mul_f32 v246, v246, v6
v_mul_f32 v247, v247, v6
v_lshlrev_b32 v248, 16, v20
v_and_b32 v249, 0xffff0000, v20
v_fmac_f32 v240, v248, v8
v_fmac_f32 v241, v249, v8
v_lshlrev_b32 v248, 16, v21
v_and_b32 v249, 0xffff0000, v21
v_fmac_f32 v242, v248, v8
v_fmac_f32 v243, v249, v8
v_lshlrev_b32 v248, 16, v22
v_and_b32 v249, 0xffff0000, v22
v_fmac_f32 v244, v248, v8
v_fmac_f32 v245, v249, v8
v_lshlrev_b32 v248, 16, v23
v_and_b32 v249, 0xffff0000, v23
v_fmac_f32 v246, v248, v8
v_fmac_f32 v247, v249, v8
v_cvt_pk_bf16_f32 v20, v240, v241
v_cvt_pk_bf16_f32 v21, v242, v243
v_cvt_pk_bf16_f32 v22, v244, v245
v_cvt_pk_bf16_f32 v23, v246, v247
v_accvgpr_read_b32 v228, a32
v_accvgpr_read_b32 v229, a33
v_accvgpr_read_b32 v230, a34
v_accvgpr_read_b32 v231, a35
v_accvgpr_read_b32 v232, a40
v_accvgpr_read_b32 v233, a41
v_accvgpr_read_b32 v234, a42
v_accvgpr_read_b32 v235, a43
v_mul_f32 v228, v228, v6
v_mul_f32 v229, v229, v6
v_mul_f32 v230, v230, v6
v_mul_f32 v231, v231, v6
v_mul_f32 v232, v232, v6
v_mul_f32 v233, v233, v6
v_mul_f32 v234, v234, v6
v_mul_f32 v235, v235, v6
v_lshlrev_b32 v236, 16, v24
v_and_b32 v237, 0xffff0000, v24
v_fmac_f32 v228, v236, v8
v_fmac_f32 v229, v237, v8
v_lshlrev_b32 v236, 16, v25
v_and_b32 v237, 0xffff0000, v25
v_fmac_f32 v230, v236, v8
v_fmac_f32 v231, v237, v8
v_lshlrev_b32 v236, 16, v26
v_and_b32 v237, 0xffff0000, v26
v_fmac_f32 v232, v236, v8
v_fmac_f32 v233, v237, v8
v_lshlrev_b32 v236, 16, v27
v_and_b32 v237, 0xffff0000, v27
v_fmac_f32 v234, v236, v8
v_fmac_f32 v235, v237, v8
v_cvt_pk_bf16_f32 v24, v228, v229
v_cvt_pk_bf16_f32 v25, v230, v231
v_cvt_pk_bf16_f32 v26, v232, v233
v_cvt_pk_bf16_f32 v27, v234, v235
v_accvgpr_read_b32 v240, a48
v_accvgpr_read_b32 v241, a49
v_accvgpr_read_b32 v242, a50
v_accvgpr_read_b32 v243, a51
v_accvgpr_read_b32 v244, a56
v_accvgpr_read_b32 v245, a57
v_accvgpr_read_b32 v246, a58
v_accvgpr_read_b32 v247, a59
v_mul_f32 v240, v240, v6
v_mul_f32 v241, v241, v6
v_mul_f32 v242, v242, v6
v_mul_f32 v243, v243, v6
v_mul_f32 v244, v244, v6
v_mul_f32 v245, v245, v6
v_mul_f32 v246, v246, v6
v_mul_f32 v247, v247, v6
v_lshlrev_b32 v248, 16, v28
v_and_b32 v249, 0xffff0000, v28
v_fmac_f32 v240, v248, v8
v_fmac_f32 v241, v249, v8
v_lshlrev_b32 v248, 16, v29
v_and_b32 v249, 0xffff0000, v29
v_fmac_f32 v242, v248, v8
v_fmac_f32 v243, v249, v8
v_lshlrev_b32 v248, 16, v30
v_and_b32 v249, 0xffff0000, v30
v_fmac_f32 v244, v248, v8
v_fmac_f32 v245, v249, v8
v_lshlrev_b32 v248, 16, v31
v_and_b32 v249, 0xffff0000, v31
v_fmac_f32 v246, v248, v8
v_fmac_f32 v247, v249, v8
v_cvt_pk_bf16_f32 v28, v240, v241
v_cvt_pk_bf16_f32 v29, v242, v243
v_cvt_pk_bf16_f32 v30, v244, v245
v_cvt_pk_bf16_f32 v31, v246, v247
v_accvgpr_read_b32 v228, a64
v_accvgpr_read_b32 v229, a65
v_accvgpr_read_b32 v230, a66
v_accvgpr_read_b32 v231, a67
v_accvgpr_read_b32 v232, a72
v_accvgpr_read_b32 v233, a73
v_accvgpr_read_b32 v234, a74
v_accvgpr_read_b32 v235, a75
v_mul_f32 v228, v228, v6
v_mul_f32 v229, v229, v6
v_mul_f32 v230, v230, v6
v_mul_f32 v231, v231, v6
v_mul_f32 v232, v232, v6
v_mul_f32 v233, v233, v6
v_mul_f32 v234, v234, v6
v_mul_f32 v235, v235, v6
v_lshlrev_b32 v236, 16, v112
v_and_b32 v237, 0xffff0000, v112
v_fmac_f32 v228, v236, v8
v_fmac_f32 v229, v237, v8
v_lshlrev_b32 v236, 16, v113
v_and_b32 v237, 0xffff0000, v113
v_fmac_f32 v230, v236, v8
v_fmac_f32 v231, v237, v8
v_lshlrev_b32 v236, 16, v114
v_and_b32 v237, 0xffff0000, v114
v_fmac_f32 v232, v236, v8
v_fmac_f32 v233, v237, v8
v_lshlrev_b32 v236, 16, v115
v_and_b32 v237, 0xffff0000, v115
v_fmac_f32 v234, v236, v8
v_fmac_f32 v235, v237, v8
v_cvt_pk_bf16_f32 v32, v228, v229
v_cvt_pk_bf16_f32 v33, v230, v231
v_cvt_pk_bf16_f32 v34, v232, v233
v_cvt_pk_bf16_f32 v35, v234, v235
v_accvgpr_read_b32 v240, a80
v_accvgpr_read_b32 v241, a81
v_accvgpr_read_b32 v242, a82
v_accvgpr_read_b32 v243, a83
v_accvgpr_read_b32 v244, a88
v_accvgpr_read_b32 v245, a89
v_accvgpr_read_b32 v246, a90
v_accvgpr_read_b32 v247, a91
v_mul_f32 v240, v240, v6
v_mul_f32 v241, v241, v6
v_mul_f32 v242, v242, v6
v_mul_f32 v243, v243, v6
v_mul_f32 v244, v244, v6
v_mul_f32 v245, v245, v6
v_mul_f32 v246, v246, v6
v_mul_f32 v247, v247, v6
v_lshlrev_b32 v248, 16, v116
v_and_b32 v249, 0xffff0000, v116
v_fmac_f32 v240, v248, v8
v_fmac_f32 v241, v249, v8
v_lshlrev_b32 v248, 16, v117
v_and_b32 v249, 0xffff0000, v117
v_fmac_f32 v242, v248, v8
v_fmac_f32 v243, v249, v8
v_lshlrev_b32 v248, 16, v118
v_and_b32 v249, 0xffff0000, v118
v_fmac_f32 v244, v248, v8
v_fmac_f32 v245, v249, v8
v_lshlrev_b32 v248, 16, v119
v_and_b32 v249, 0xffff0000, v119
v_fmac_f32 v246, v248, v8
v_fmac_f32 v247, v249, v8
v_cvt_pk_bf16_f32 v36, v240, v241
v_cvt_pk_bf16_f32 v37, v242, v243
v_cvt_pk_bf16_f32 v38, v244, v245
v_cvt_pk_bf16_f32 v39, v246, v247
v_accvgpr_read_b32 v228, a96
v_accvgpr_read_b32 v229, a97
v_accvgpr_read_b32 v230, a98
v_accvgpr_read_b32 v231, a99
v_accvgpr_read_b32 v232, a104
v_accvgpr_read_b32 v233, a105
v_accvgpr_read_b32 v234, a106
v_accvgpr_read_b32 v235, a107
v_mul_f32 v228, v228, v6
v_mul_f32 v229, v229, v6
v_mul_f32 v230, v230, v6
v_mul_f32 v231, v231, v6
v_mul_f32 v232, v232, v6
v_mul_f32 v233, v233, v6
v_mul_f32 v234, v234, v6
v_mul_f32 v235, v235, v6
v_lshlrev_b32 v236, 16, v120
v_and_b32 v237, 0xffff0000, v120
v_fmac_f32 v228, v236, v8
v_fmac_f32 v229, v237, v8
v_lshlrev_b32 v236, 16, v121
v_and_b32 v237, 0xffff0000, v121
v_fmac_f32 v230, v236, v8
v_fmac_f32 v231, v237, v8
v_lshlrev_b32 v236, 16, v122
v_and_b32 v237, 0xffff0000, v122
v_fmac_f32 v232, v236, v8
v_fmac_f32 v233, v237, v8
v_lshlrev_b32 v236, 16, v123
v_and_b32 v237, 0xffff0000, v123
v_fmac_f32 v234, v236, v8
v_fmac_f32 v235, v237, v8
v_cvt_pk_bf16_f32 v40, v228, v229
v_cvt_pk_bf16_f32 v41, v230, v231
v_cvt_pk_bf16_f32 v42, v232, v233
v_cvt_pk_bf16_f32 v43, v234, v235
v_accvgpr_read_b32 v240, a112
v_accvgpr_read_b32 v241, a113
v_accvgpr_read_b32 v242, a114
v_accvgpr_read_b32 v243, a115
v_accvgpr_read_b32 v244, a120
v_accvgpr_read_b32 v245, a121
v_accvgpr_read_b32 v246, a122
v_accvgpr_read_b32 v247, a123
v_mul_f32 v240, v240, v6
v_mul_f32 v241, v241, v6
v_mul_f32 v242, v242, v6
v_mul_f32 v243, v243, v6
v_mul_f32 v244, v244, v6
v_mul_f32 v245, v245, v6
v_mul_f32 v246, v246, v6
v_mul_f32 v247, v247, v6
v_lshlrev_b32 v248, 16, v124
v_and_b32 v249, 0xffff0000, v124
v_fmac_f32 v240, v248, v8
v_fmac_f32 v241, v249, v8
v_lshlrev_b32 v248, 16, v125
v_and_b32 v249, 0xffff0000, v125
v_fmac_f32 v242, v248, v8
v_fmac_f32 v243, v249, v8
v_lshlrev_b32 v248, 16, v126
v_and_b32 v249, 0xffff0000, v126
v_fmac_f32 v244, v248, v8
v_fmac_f32 v245, v249, v8
v_lshlrev_b32 v248, 16, v127
v_and_b32 v249, 0xffff0000, v127
v_fmac_f32 v246, v248, v8
v_fmac_f32 v247, v249, v8
v_cvt_pk_bf16_f32 v44, v240, v241
v_cvt_pk_bf16_f32 v45, v242, v243
v_cvt_pk_bf16_f32 v46, v244, v245
v_cvt_pk_bf16_f32 v47, v246, v247
v_accvgpr_read_b32 v228, a4
v_accvgpr_read_b32 v229, a5
v_accvgpr_read_b32 v230, a6
v_accvgpr_read_b32 v231, a7
v_accvgpr_read_b32 v232, a12
v_accvgpr_read_b32 v233, a13
v_accvgpr_read_b32 v234, a14
v_accvgpr_read_b32 v235, a15
v_mul_f32 v228, v228, v7
v_mul_f32 v229, v229, v7
v_mul_f32 v230, v230, v7
v_mul_f32 v231, v231, v7
v_mul_f32 v232, v232, v7
v_mul_f32 v233, v233, v7
v_mul_f32 v234, v234, v7
v_mul_f32 v235, v235, v7
v_lshlrev_b32 v236, 16, v48
v_and_b32 v237, 0xffff0000, v48
v_fmac_f32 v228, v236, v9
v_fmac_f32 v229, v237, v9
v_lshlrev_b32 v236, 16, v49
v_and_b32 v237, 0xffff0000, v49
v_fmac_f32 v230, v236, v9
v_fmac_f32 v231, v237, v9
v_lshlrev_b32 v236, 16, v50
v_and_b32 v237, 0xffff0000, v50
v_fmac_f32 v232, v236, v9
v_fmac_f32 v233, v237, v9
v_lshlrev_b32 v236, 16, v51
v_and_b32 v237, 0xffff0000, v51
v_fmac_f32 v234, v236, v9
v_fmac_f32 v235, v237, v9
v_cvt_pk_bf16_f32 v48, v228, v229
v_cvt_pk_bf16_f32 v49, v230, v231
v_cvt_pk_bf16_f32 v50, v232, v233
v_cvt_pk_bf16_f32 v51, v234, v235
v_accvgpr_read_b32 v240, a20
v_accvgpr_read_b32 v241, a21
v_accvgpr_read_b32 v242, a22
v_accvgpr_read_b32 v243, a23
v_accvgpr_read_b32 v244, a28
v_accvgpr_read_b32 v245, a29
v_accvgpr_read_b32 v246, a30
v_accvgpr_read_b32 v247, a31
v_mul_f32 v240, v240, v7
v_mul_f32 v241, v241, v7
v_mul_f32 v242, v242, v7
v_mul_f32 v243, v243, v7
v_mul_f32 v244, v244, v7
v_mul_f32 v245, v245, v7
v_mul_f32 v246, v246, v7
v_mul_f32 v247, v247, v7
v_lshlrev_b32 v248, 16, v52
v_and_b32 v249, 0xffff0000, v52
v_fmac_f32 v240, v248, v9
v_fmac_f32 v241, v249, v9
v_lshlrev_b32 v248, 16, v53
v_and_b32 v249, 0xffff0000, v53
v_fmac_f32 v242, v248, v9
v_fmac_f32 v243, v249, v9
v_lshlrev_b32 v248, 16, v54
v_and_b32 v249, 0xffff0000, v54
v_fmac_f32 v244, v248, v9
v_fmac_f32 v245, v249, v9
v_lshlrev_b32 v248, 16, v55
v_and_b32 v249, 0xffff0000, v55
v_fmac_f32 v246, v248, v9
v_fmac_f32 v247, v249, v9
v_cvt_pk_bf16_f32 v52, v240, v241
v_cvt_pk_bf16_f32 v53, v242, v243
v_cvt_pk_bf16_f32 v54, v244, v245
v_cvt_pk_bf16_f32 v55, v246, v247
v_accvgpr_read_b32 v228, a36
v_accvgpr_read_b32 v229, a37
v_accvgpr_read_b32 v230, a38
v_accvgpr_read_b32 v231, a39
v_accvgpr_read_b32 v232, a44
v_accvgpr_read_b32 v233, a45
v_accvgpr_read_b32 v234, a46
v_accvgpr_read_b32 v235, a47
v_mul_f32 v228, v228, v7
v_mul_f32 v229, v229, v7
v_mul_f32 v230, v230, v7
v_mul_f32 v231, v231, v7
v_mul_f32 v232, v232, v7
v_mul_f32 v233, v233, v7
v_mul_f32 v234, v234, v7
v_mul_f32 v235, v235, v7
v_lshlrev_b32 v236, 16, v56
v_and_b32 v237, 0xffff0000, v56
v_fmac_f32 v228, v236, v9
v_fmac_f32 v229, v237, v9
v_lshlrev_b32 v236, 16, v57
v_and_b32 v237, 0xffff0000, v57
v_fmac_f32 v230, v236, v9
v_fmac_f32 v231, v237, v9
v_lshlrev_b32 v236, 16, v58
v_and_b32 v237, 0xffff0000, v58
v_fmac_f32 v232, v236, v9
v_fmac_f32 v233, v237, v9
v_lshlrev_b32 v236, 16, v59
v_and_b32 v237, 0xffff0000, v59
v_fmac_f32 v234, v236, v9
v_fmac_f32 v235, v237, v9
v_cvt_pk_bf16_f32 v56, v228, v229
v_cvt_pk_bf16_f32 v57, v230, v231
v_cvt_pk_bf16_f32 v58, v232, v233
v_cvt_pk_bf16_f32 v59, v234, v235
v_accvgpr_read_b32 v240, a52
v_accvgpr_read_b32 v241, a53
v_accvgpr_read_b32 v242, a54
v_accvgpr_read_b32 v243, a55
v_accvgpr_read_b32 v244, a60
v_accvgpr_read_b32 v245, a61
v_accvgpr_read_b32 v246, a62
v_accvgpr_read_b32 v247, a63
v_mul_f32 v240, v240, v7
v_mul_f32 v241, v241, v7
v_mul_f32 v242, v242, v7
v_mul_f32 v243, v243, v7
v_mul_f32 v244, v244, v7
v_mul_f32 v245, v245, v7
v_mul_f32 v246, v246, v7
v_mul_f32 v247, v247, v7
v_lshlrev_b32 v248, 16, v60
v_and_b32 v249, 0xffff0000, v60
v_fmac_f32 v240, v248, v9
v_fmac_f32 v241, v249, v9
v_lshlrev_b32 v248, 16, v61
v_and_b32 v249, 0xffff0000, v61
v_fmac_f32 v242, v248, v9
v_fmac_f32 v243, v249, v9
v_lshlrev_b32 v248, 16, v62
v_and_b32 v249, 0xffff0000, v62
v_fmac_f32 v244, v248, v9
v_fmac_f32 v245, v249, v9
v_lshlrev_b32 v248, 16, v63
v_and_b32 v249, 0xffff0000, v63
v_fmac_f32 v246, v248, v9
v_fmac_f32 v247, v249, v9
v_cvt_pk_bf16_f32 v60, v240, v241
v_cvt_pk_bf16_f32 v61, v242, v243
v_cvt_pk_bf16_f32 v62, v244, v245
v_cvt_pk_bf16_f32 v63, v246, v247
v_accvgpr_read_b32 v228, a68
v_accvgpr_read_b32 v229, a69
v_accvgpr_read_b32 v230, a70
v_accvgpr_read_b32 v231, a71
v_accvgpr_read_b32 v232, a76
v_accvgpr_read_b32 v233, a77
v_accvgpr_read_b32 v234, a78
v_accvgpr_read_b32 v235, a79
v_mul_f32 v228, v228, v7
v_mul_f32 v229, v229, v7
v_mul_f32 v230, v230, v7
v_mul_f32 v231, v231, v7
v_mul_f32 v232, v232, v7
v_mul_f32 v233, v233, v7
v_mul_f32 v234, v234, v7
v_mul_f32 v235, v235, v7
v_lshlrev_b32 v236, 16, v64
v_and_b32 v237, 0xffff0000, v64
v_fmac_f32 v228, v236, v9
v_fmac_f32 v229, v237, v9
v_lshlrev_b32 v236, 16, v65
v_and_b32 v237, 0xffff0000, v65
v_fmac_f32 v230, v236, v9
v_fmac_f32 v231, v237, v9
v_lshlrev_b32 v236, 16, v66
v_and_b32 v237, 0xffff0000, v66
v_fmac_f32 v232, v236, v9
v_fmac_f32 v233, v237, v9
v_lshlrev_b32 v236, 16, v67
v_and_b32 v237, 0xffff0000, v67
v_fmac_f32 v234, v236, v9
v_fmac_f32 v235, v237, v9
v_cvt_pk_bf16_f32 v64, v228, v229
v_cvt_pk_bf16_f32 v65, v230, v231
v_cvt_pk_bf16_f32 v66, v232, v233
v_cvt_pk_bf16_f32 v67, v234, v235
v_accvgpr_read_b32 v240, a84
v_accvgpr_read_b32 v241, a85
v_accvgpr_read_b32 v242, a86
v_accvgpr_read_b32 v243, a87
v_accvgpr_read_b32 v244, a92
v_accvgpr_read_b32 v245, a93
v_accvgpr_read_b32 v246, a94
v_accvgpr_read_b32 v247, a95
v_mul_f32 v240, v240, v7
v_mul_f32 v241, v241, v7
v_mul_f32 v242, v242, v7
v_mul_f32 v243, v243, v7
v_mul_f32 v244, v244, v7
v_mul_f32 v245, v245, v7
v_mul_f32 v246, v246, v7
v_mul_f32 v247, v247, v7
v_lshlrev_b32 v248, 16, v68
v_and_b32 v249, 0xffff0000, v68
v_fmac_f32 v240, v248, v9
v_fmac_f32 v241, v249, v9
v_lshlrev_b32 v248, 16, v69
v_and_b32 v249, 0xffff0000, v69
v_fmac_f32 v242, v248, v9
v_fmac_f32 v243, v249, v9
v_lshlrev_b32 v248, 16, v70
v_and_b32 v249, 0xffff0000, v70
v_fmac_f32 v244, v248, v9
v_fmac_f32 v245, v249, v9
v_lshlrev_b32 v248, 16, v71
v_and_b32 v249, 0xffff0000, v71
v_fmac_f32 v246, v248, v9
v_fmac_f32 v247, v249, v9
v_cvt_pk_bf16_f32 v68, v240, v241
v_cvt_pk_bf16_f32 v69, v242, v243
v_cvt_pk_bf16_f32 v70, v244, v245
v_cvt_pk_bf16_f32 v71, v246, v247
v_accvgpr_read_b32 v228, a100
v_accvgpr_read_b32 v229, a101
v_accvgpr_read_b32 v230, a102
v_accvgpr_read_b32 v231, a103
v_accvgpr_read_b32 v232, a108
v_accvgpr_read_b32 v233, a109
v_accvgpr_read_b32 v234, a110
v_accvgpr_read_b32 v235, a111
v_mul_f32 v228, v228, v7
v_mul_f32 v229, v229, v7
v_mul_f32 v230, v230, v7
v_mul_f32 v231, v231, v7
v_mul_f32 v232, v232, v7
v_mul_f32 v233, v233, v7
v_mul_f32 v234, v234, v7
v_mul_f32 v235, v235, v7
v_lshlrev_b32 v236, 16, v72
v_and_b32 v237, 0xffff0000, v72
v_fmac_f32 v228, v236, v9
v_fmac_f32 v229, v237, v9
v_lshlrev_b32 v236, 16, v73
v_and_b32 v237, 0xffff0000, v73
v_fmac_f32 v230, v236, v9
v_fmac_f32 v231, v237, v9
v_lshlrev_b32 v236, 16, v74
v_and_b32 v237, 0xffff0000, v74
v_fmac_f32 v232, v236, v9
v_fmac_f32 v233, v237, v9
v_lshlrev_b32 v236, 16, v75
v_and_b32 v237, 0xffff0000, v75
v_fmac_f32 v234, v236, v9
v_fmac_f32 v235, v237, v9
v_cvt_pk_bf16_f32 v72, v228, v229
v_cvt_pk_bf16_f32 v73, v230, v231
v_cvt_pk_bf16_f32 v74, v232, v233
v_cvt_pk_bf16_f32 v75, v234, v235
v_accvgpr_read_b32 v240, a116
v_accvgpr_read_b32 v241, a117
v_accvgpr_read_b32 v242, a118
v_accvgpr_read_b32 v243, a119
v_accvgpr_read_b32 v244, a124
v_accvgpr_read_b32 v245, a125
v_accvgpr_read_b32 v246, a126
v_accvgpr_read_b32 v247, a127
v_mul_f32 v240, v240, v7
v_mul_f32 v241, v241, v7
v_mul_f32 v242, v242, v7
v_mul_f32 v243, v243, v7
v_mul_f32 v244, v244, v7
v_mul_f32 v245, v245, v7
v_mul_f32 v246, v246, v7
v_mul_f32 v247, v247, v7
v_lshlrev_b32 v248, 16, v76
v_and_b32 v249, 0xffff0000, v76
v_fmac_f32 v240, v248, v9
v_fmac_f32 v241, v249, v9
v_lshlrev_b32 v248, 16, v77
v_and_b32 v249, 0xffff0000, v77
v_fmac_f32 v242, v248, v9
v_fmac_f32 v243, v249, v9
v_lshlrev_b32 v248, 16, v78
v_and_b32 v249, 0xffff0000, v78
v_fmac_f32 v244, v248, v9
v_fmac_f32 v245, v249, v9
v_lshlrev_b32 v248, 16, v79
v_and_b32 v249, 0xffff0000, v79
v_fmac_f32 v246, v248, v9
v_fmac_f32 v247, v249, v9
v_cvt_pk_bf16_f32 v76, v240, v241
v_cvt_pk_bf16_f32 v77, v242, v243
v_cvt_pk_bf16_f32 v78, v244, v245
v_cvt_pk_bf16_f32 v79, v246, v247
K2_op:
s_waitcnt vmcnt(0)
s_barrier
v_add_u32 v216, s28, v212
v_add_u32 v217, s28, v213
v_add_u32 v218, s28, v214
v_add_u32 v219, s28, v215
s_add_u32 s28, s28, 32768
s_cmp_eq_u32 s28, 163840
s_cselect_b32 s28, 0, s28
v_add_u32 v220, s28, v212
v_add_u32 v221, s28, v213
v_add_u32 v222, s28, v214
v_add_u32 v223, s28, v215
s_add_u32 s28, s28, 32768
s_cmp_eq_u32 s28, 163840
s_cselect_b32 s28, 0, s28
s_lshl_b32 s30, s21, 8
s_lshl_b32 s40, s22, 4
s_add_u32 s30, s30, s40
s_lshl_b32 s40, s20, 2
s_add_u32 s30, s30, s40
s_mul_i32 s40, s30, 7168
s_add_u32 s41, s40, 14336
s_add_u32 s44, s50, 125829120
s_addc_u32 s45, s51, 0
s_mov_b32 s46, 12288
s_mov_b32 s47, 0x20000
ds_read_b64_tr_b16 v[128:129], v216 offset:0
ds_read_b64_tr_b16 v[130:131], v216 offset:2048
ds_read_b64_tr_b16 v[132:133], v217 offset:0
ds_read_b64_tr_b16 v[134:135], v217 offset:2048
ds_read_b64_tr_b16 v[136:137], v218 offset:0
ds_read_b64_tr_b16 v[138:139], v218 offset:2048
ds_read_b64_tr_b16 v[140:141], v219 offset:0
ds_read_b64_tr_b16 v[142:143], v219 offset:2048
ds_read_b64_tr_b16 v[144:145], v216 offset:4096
ds_read_b64_tr_b16 v[146:147], v216 offset:6144
ds_read_b64_tr_b16 v[148:149], v217 offset:4096
ds_read_b64_tr_b16 v[150:151], v217 offset:6144
s_waitcnt lgkmcnt(8)
v_mfma_f32_16x16x32_bf16 a[0:3], v[128:131], v[16:19], 0
s_add_u32 m0, s29, s27
ds_read_b64_tr_b16 v[152:153], v218 offset:4096
s_add_u32 s31, s38, 28672
v_mfma_f32_16x16x32_bf16 a[4:7], v[128:131], v[48:51], 0
ds_read_b64_tr_b16 v[154:155], v218 offset:6144
v_mfma_f32_16x16x32_bf16 a[8:11], v[132:135], v[16:19], 0
ds_read_b64_tr_b16 v[156:157], v219 offset:4096
v_mfma_f32_16x16x32_bf16 a[12:15], v[132:135], v[48:51], 0
s_waitcnt lgkmcnt(7)
ds_read_b64_tr_b16 v[158:159], v219 offset:6144
v_mfma_f32_16x16x32_bf16 a[16:19], v[136:139], v[16:19], 0
buffer_load_dwordx4 v200, s[80:83], s38 offen lds
v_mfma_f32_16x16x32_bf16 a[20:23], v[136:139], v[48:51], 0
ds_read_b64_tr_b16 v[160:161], v216 offset:8192
v_mfma_f32_16x16x32_bf16 a[24:27], v[140:143], v[16:19], 0
ds_read_b64_tr_b16 v[162:163], v216 offset:10240
v_mfma_f32_16x16x32_bf16 a[28:31], v[140:143], v[48:51], 0
s_waitcnt lgkmcnt(6)
ds_read_b64_tr_b16 v[164:165], v217 offset:8192
v_mfma_f32_16x16x32_bf16 a[0:3], v[144:147], v[20:23], a[0:3]
ds_read_b64_tr_b16 v[166:167], v217 offset:10240
v_mfma_f32_16x16x32_bf16 a[4:7], v[144:147], v[52:55], a[4:7]
ds_read_b64_tr_b16 v[168:169], v218 offset:8192
v_mfma_f32_16x16x32_bf16 a[8:11], v[148:151], v[20:23], a[8:11]
ds_read_b64_tr_b16 v[170:171], v218 offset:10240
v_mfma_f32_16x16x32_bf16 a[12:15], v[148:151], v[52:55], a[12:15]
s_waitcnt lgkmcnt(6)
ds_read_b64_tr_b16 v[172:173], v219 offset:8192
v_mfma_f32_16x16x32_bf16 a[16:19], v[152:155], v[20:23], a[16:19]
ds_read_b64_tr_b16 v[174:175], v219 offset:10240
v_mfma_f32_16x16x32_bf16 a[20:23], v[152:155], v[52:55], a[20:23]
buffer_load_dwordx4 v201, s[80:83], s38 offen offset:1024 lds
v_mfma_f32_16x16x32_bf16 a[24:27], v[156:159], v[20:23], a[24:27]
ds_read_b64_tr_b16 v[176:177], v216 offset:12288
v_mfma_f32_16x16x32_bf16 a[28:31], v[156:159], v[52:55], a[28:31]
s_waitcnt lgkmcnt(5)
ds_read_b64_tr_b16 v[178:179], v216 offset:14336
v_mfma_f32_16x16x32_bf16 a[0:3], v[160:163], v[24:27], a[0:3]
ds_read_b64_tr_b16 v[180:181], v217 offset:12288
ds_read_b64_tr_b16 v[182:183], v217 offset:14336
v_mfma_f32_16x16x32_bf16 a[4:7], v[160:163], v[56:59], a[4:7]
ds_read_b64_tr_b16 v[184:185], v218 offset:12288
v_mfma_f32_16x16x32_bf16 a[8:11], v[164:167], v[24:27], a[8:11]
ds_read_b64_tr_b16 v[186:187], v218 offset:14336
v_mfma_f32_16x16x32_bf16 a[12:15], v[164:167], v[56:59], a[12:15]
s_waitcnt lgkmcnt(6)
ds_read_b64_tr_b16 v[188:189], v219 offset:12288
v_mfma_f32_16x16x32_bf16 a[16:19], v[168:171], v[24:27], a[16:19]
ds_read_b64_tr_b16 v[190:191], v219 offset:14336
buffer_load_dwordx4 v202, s[80:83], s38 offen offset:2048 lds
v_mfma_f32_16x16x32_bf16 a[20:23], v[168:171], v[56:59], a[20:23]
ds_read_b64_tr_b16 v[128:129], v216 offset:16384
v_mfma_f32_16x16x32_bf16 a[24:27], v[172:175], v[24:27], a[24:27]
ds_read_b64_tr_b16 v[130:131], v216 offset:18432
v_mfma_f32_16x16x32_bf16 a[28:31], v[172:175], v[56:59], a[28:31]
s_waitcnt lgkmcnt(6)
ds_read_b64_tr_b16 v[132:133], v217 offset:16384
v_mfma_f32_16x16x32_bf16 a[0:3], v[176:179], v[28:31], a[0:3]
ds_read_b64_tr_b16 v[134:135], v217 offset:18432
v_mfma_f32_16x16x32_bf16 a[4:7], v[176:179], v[60:63], a[4:7]
buffer_load_dwordx4 v203, s[80:83], s38 offen offset:3072 lds
v_mfma_f32_16x16x32_bf16 a[8:11], v[180:183], v[28:31], a[8:11]
s_add_u32 m0, m0, 4096
ds_read_b64_tr_b16 v[136:137], v218 offset:16384
s_add_u32 s38, s38, 128
v_mfma_f32_16x16x32_bf16 a[12:15], v[180:183], v[60:63], a[12:15]
s_waitcnt lgkmcnt(5)
ds_read_b64_tr_b16 v[138:139], v218 offset:18432
v_mfma_f32_16x16x32_bf16 a[16:19], v[184:187], v[28:31], a[16:19]
ds_read_b64_tr_b16 v[140:141], v219 offset:16384
ds_read_b64_tr_b16 v[142:143], v219 offset:18432
v_mfma_f32_16x16x32_bf16 a[20:23], v[184:187], v[60:63], a[20:23]
ds_read_b64_tr_b16 v[144:145], v216 offset:20480
v_mfma_f32_16x16x32_bf16 a[24:27], v[188:191], v[28:31], a[24:27]
ds_read_b64_tr_b16 v[146:147], v216 offset:22528
v_mfma_f32_16x16x32_bf16 a[28:31], v[188:191], v[60:63], a[28:31]
s_waitcnt lgkmcnt(6)
ds_read_b64_tr_b16 v[148:149], v217 offset:20480
v_mfma_f32_16x16x32_bf16 a[0:3], v[128:131], v[32:35], a[0:3]
ds_read_b64_tr_b16 v[150:151], v217 offset:22528
v_mfma_f32_16x16x32_bf16 a[4:7], v[128:131], v[64:67], a[4:7]
buffer_load_dwordx4 v200, s[80:83], s31 offen lds
v_mfma_f32_16x16x32_bf16 a[8:11], v[132:135], v[32:35], a[8:11]
ds_read_b64_tr_b16 v[152:153], v218 offset:20480
v_mfma_f32_16x16x32_bf16 a[12:15], v[132:135], v[64:67], a[12:15]
s_waitcnt lgkmcnt(5)
ds_read_b64_tr_b16 v[154:155], v218 offset:22528
v_mfma_f32_16x16x32_bf16 a[16:19], v[136:139], v[32:35], a[16:19]
ds_read_b64_tr_b16 v[156:157], v219 offset:20480
ds_read_b64_tr_b16 v[158:159], v219 offset:22528
v_mfma_f32_16x16x32_bf16 a[20:23], v[136:139], v[64:67], a[20:23]
ds_read_b64_tr_b16 v[160:161], v216 offset:24576
v_mfma_f32_16x16x32_bf16 a[24:27], v[140:143], v[32:35], a[24:27]
ds_read_b64_tr_b16 v[162:163], v216 offset:26624
v_mfma_f32_16x16x32_bf16 a[28:31], v[140:143], v[64:67], a[28:31]
s_waitcnt lgkmcnt(6)
ds_read_b64_tr_b16 v[164:165], v217 offset:24576
v_mfma_f32_16x16x32_bf16 a[0:3], v[144:147], v[36:39], a[0:3]
ds_read_b64_tr_b16 v[166:167], v217 offset:26624
v_mfma_f32_16x16x32_bf16 a[4:7], v[144:147], v[68:71], a[4:7]
buffer_load_dwordx4 v201, s[80:83], s31 offen offset:1024 lds
v_mfma_f32_16x16x32_bf16 a[8:11], v[148:151], v[36:39], a[8:11]
ds_read_b64_tr_b16 v[168:169], v218 offset:24576
v_mfma_f32_16x16x32_bf16 a[12:15], v[148:151], v[68:71], a[12:15]
s_waitcnt lgkmcnt(5)
ds_read_b64_tr_b16 v[170:171], v218 offset:26624
v_mfma_f32_16x16x32_bf16 a[16:19], v[152:155], v[36:39], a[16:19]
ds_read_b64_tr_b16 v[172:173], v219 offset:24576
ds_read_b64_tr_b16 v[174:175], v219 offset:26624
v_mfma_f32_16x16x32_bf16 a[20:23], v[152:155], v[68:71], a[20:23]
ds_read_b64_tr_b16 v[176:177], v216 offset:28672
v_mfma_f32_16x16x32_bf16 a[24:27], v[156:159], v[36:39], a[24:27]
ds_read_b64_tr_b16 v[178:179], v216 offset:30720
v_mfma_f32_16x16x32_bf16 a[28:31], v[156:159], v[68:71], a[28:31]
s_waitcnt lgkmcnt(6)
ds_read_b64_tr_b16 v[180:181], v217 offset:28672
v_mfma_f32_16x16x32_bf16 a[0:3], v[160:163], v[40:43], a[0:3]
ds_read_b64_tr_b16 v[182:183], v217 offset:30720
buffer_load_dwordx4 v202, s[80:83], s31 offen offset:2048 lds
v_mfma_f32_16x16x32_bf16 a[4:7], v[160:163], v[72:75], a[4:7]
ds_read_b64_tr_b16 v[184:185], v218 offset:28672
v_mfma_f32_16x16x32_bf16 a[8:11], v[164:167], v[40:43], a[8:11]
ds_read_b64_tr_b16 v[186:187], v218 offset:30720
v_mfma_f32_16x16x32_bf16 a[12:15], v[164:167], v[72:75], a[12:15]
s_waitcnt lgkmcnt(6)
ds_read_b64_tr_b16 v[188:189], v219 offset:28672
v_mfma_f32_16x16x32_bf16 a[16:19], v[168:171], v[40:43], a[16:19]
ds_read_b64_tr_b16 v[190:191], v219 offset:30720
v_mfma_f32_16x16x32_bf16 a[20:23], v[168:171], v[72:75], a[20:23]
buffer_load_dwordx4 v203, s[80:83], s31 offen offset:3072 lds
v_mfma_f32_16x16x32_bf16 a[24:27], v[172:175], v[40:43], a[24:27]
s_add_u32 s27, s27, 32768
ds_read_b64_tr_b16 v[128:129], v220 offset:0
v_add_u32 v216, s28, v212
v_mfma_f32_16x16x32_bf16 a[28:31], v[172:175], v[72:75], a[28:31]
s_waitcnt lgkmcnt(5)
ds_read_b64_tr_b16 v[130:131], v220 offset:2048
v_add_u32 v217, s28, v213
v_mfma_f32_16x16x32_bf16 a[0:3], v[176:179], v[44:47], a[0:3]
s_cmp_eq_u32 s27, 163840
s_cselect_b32 s27, 0, s27
ds_read_b64_tr_b16 v[132:133], v221 offset:0
ds_read_b64_tr_b16 v[134:135], v221 offset:2048
v_mfma_f32_16x16x32_bf16 a[4:7], v[176:179], v[76:79], a[4:7]
ds_read_b64_tr_b16 v[136:137], v222 offset:0
v_add_u32 v218, s28, v214
v_mfma_f32_16x16x32_bf16 a[8:11], v[180:183], v[44:47], a[8:11]
ds_read_b64_tr_b16 v[138:139], v222 offset:2048
v_add_u32 v219, s28, v215
v_mfma_f32_16x16x32_bf16 a[12:15], v[180:183], v[76:79], a[12:15]
s_waitcnt lgkmcnt(6)
ds_read_b64_tr_b16 v[140:141], v223 offset:0
s_add_u32 s28, s28, 32768
v_mfma_f32_16x16x32_bf16 a[16:19], v[184:187], v[44:47], a[16:19]
s_barrier
ds_read_b64_tr_b16 v[142:143], v223 offset:2048
s_cmp_eq_u32 s28, 163840
s_cselect_b32 s28, 0, s28
v_mfma_f32_16x16x32_bf16 a[20:23], v[184:187], v[76:79], a[20:23]
ds_read_b64_tr_b16 v[144:145], v220 offset:4096
v_mfma_f32_16x16x32_bf16 a[24:27], v[188:191], v[44:47], a[24:27]
ds_read_b64_tr_b16 v[146:147], v220 offset:6144
v_mfma_f32_16x16x32_bf16 a[28:31], v[188:191], v[76:79], a[28:31]
ds_read_b64_tr_b16 v[148:149], v221 offset:4096
ds_read_b64_tr_b16 v[150:151], v221 offset:6144
s_waitcnt lgkmcnt(8)
v_mfma_f32_16x16x32_bf16 a[32:35], v[128:131], v[16:19], 0
s_add_u32 m0, s29, s27
ds_read_b64_tr_b16 v[152:153], v222 offset:4096
s_add_u32 s31, s38, 28672
v_mfma_f32_16x16x32_bf16 a[36:39], v[128:131], v[48:51], 0
ds_read_b64_tr_b16 v[154:155], v222 offset:6144
v_mfma_f32_16x16x32_bf16 a[40:43], v[132:135], v[16:19], 0
ds_read_b64_tr_b16 v[156:157], v223 offset:4096
v_mfma_f32_16x16x32_bf16 a[44:47], v[132:135], v[48:51], 0
s_waitcnt lgkmcnt(7)
ds_read_b64_tr_b16 v[158:159], v223 offset:6144
v_mfma_f32_16x16x32_bf16 a[48:51], v[136:139], v[16:19], 0
buffer_load_dwordx4 v200, s[80:83], s38 offen lds
v_mfma_f32_16x16x32_bf16 a[52:55], v[136:139], v[48:51], 0
ds_read_b64_tr_b16 v[160:161], v220 offset:8192
v_mfma_f32_16x16x32_bf16 a[56:59], v[140:143], v[16:19], 0
ds_read_b64_tr_b16 v[162:163], v220 offset:10240
v_mfma_f32_16x16x32_bf16 a[60:63], v[140:143], v[48:51], 0
s_waitcnt lgkmcnt(6)
ds_read_b64_tr_b16 v[164:165], v221 offset:8192
v_mfma_f32_16x16x32_bf16 a[32:35], v[144:147], v[20:23], a[32:35]
ds_read_b64_tr_b16 v[166:167], v221 offset:10240
v_mfma_f32_16x16x32_bf16 a[36:39], v[144:147], v[52:55], a[36:39]
ds_read_b64_tr_b16 v[168:169], v222 offset:8192
v_mfma_f32_16x16x32_bf16 a[40:43], v[148:151], v[20:23], a[40:43]
ds_read_b64_tr_b16 v[170:171], v222 offset:10240
v_accvgpr_read_b32 v224, a0
v_mfma_f32_16x16x32_bf16 a[44:47], v[148:151], v[52:55], a[44:47]
s_waitcnt lgkmcnt(6)
ds_read_b64_tr_b16 v[172:173], v223 offset:8192
v_accvgpr_read_b32 v225, a1
v_mfma_f32_16x16x32_bf16 a[48:51], v[152:155], v[20:23], a[48:51]
ds_read_b64_tr_b16 v[174:175], v223 offset:10240
v_accvgpr_read_b32 v226, a2
v_mfma_f32_16x16x32_bf16 a[52:55], v[152:155], v[52:55], a[52:55]
buffer_load_dwordx4 v201, s[80:83], s38 offen offset:1024 lds
v_mfma_f32_16x16x32_bf16 a[56:59], v[156:159], v[20:23], a[56:59]
ds_read_b64_tr_b16 v[176:177], v220 offset:12288
v_accvgpr_read_b32 v227, a3
v_mfma_f32_16x16x32_bf16 a[60:63], v[156:159], v[52:55], a[60:63]
s_waitcnt lgkmcnt(5)
ds_read_b64_tr_b16 v[178:179], v220 offset:14336
v_accvgpr_read_b32 v228, a8
v_mfma_f32_16x16x32_bf16 a[32:35], v[160:163], v[24:27], a[32:35]
ds_read_b64_tr_b16 v[180:181], v221 offset:12288
ds_read_b64_tr_b16 v[182:183], v221 offset:14336
v_mfma_f32_16x16x32_bf16 a[36:39], v[160:163], v[56:59], a[36:39]
v_accvgpr_read_b32 v229, a9
v_accvgpr_read_b32 v230, a10
v_mfma_f32_16x16x32_bf16 a[40:43], v[164:167], v[24:27], a[40:43]
ds_read_b64_tr_b16 v[184:185], v222 offset:12288
v_accvgpr_read_b32 v231, a11
v_mfma_f32_16x16x32_bf16 a[44:47], v[164:167], v[56:59], a[44:47]
s_waitcnt lgkmcnt(5)
ds_read_b64_tr_b16 v[186:187], v222 offset:14336
v_cvt_pk_bf16_f32 v224, v224, v225
v_mfma_f32_16x16x32_bf16 a[48:51], v[168:171], v[24:27], a[48:51]
ds_read_b64_tr_b16 v[188:189], v223 offset:12288
ds_read_b64_tr_b16 v[190:191], v223 offset:14336
buffer_load_dwordx4 v202, s[80:83], s38 offen offset:2048 lds
v_cvt_pk_bf16_f32 v225, v226, v227
v_mfma_f32_16x16x32_bf16 a[52:55], v[168:171], v[56:59], a[52:55]
v_cvt_pk_bf16_f32 v226, v228, v229
v_cvt_pk_bf16_f32 v227, v230, v231
v_mfma_f32_16x16x32_bf16 a[56:59], v[172:175], v[24:27], a[56:59]
buffer_store_dwordx4 v[224:227], v14, s[16:19], s40 offen offset:0 sc1
v_mfma_f32_16x16x32_bf16 a[60:63], v[172:175], v[56:59], a[60:63]
s_waitcnt lgkmcnt(4)
v_accvgpr_read_b32 v232, a16
v_accvgpr_read_b32 v233, a17
v_mfma_f32_16x16x32_bf16 a[32:35], v[176:179], v[28:31], a[32:35]
ds_read_b64_tr_b16 v[128:129], v220 offset:16384
ds_read_b64_tr_b16 v[130:131], v220 offset:18432
ds_read_b64_tr_b16 v[132:133], v221 offset:16384
ds_read_b64_tr_b16 v[134:135], v221 offset:18432
v_mfma_f32_16x16x32_bf16 a[36:39], v[176:179], v[60:63], a[36:39]
v_accvgpr_read_b32 v234, a18
v_accvgpr_read_b32 v235, a19
v_mfma_f32_16x16x32_bf16 a[40:43], v[180:183], v[28:31], a[40:43]
buffer_load_dwordx4 v203, s[80:83], s38 offen offset:3072 lds
v_mfma_f32_16x16x32_bf16 a[44:47], v[180:183], v[60:63], a[44:47]
s_waitcnt lgkmcnt(4)
v_accvgpr_read_b32 v236, a24
v_accvgpr_read_b32 v237, a25
v_mfma_f32_16x16x32_bf16 a[48:51], v[184:187], v[28:31], a[48:51]
s_add_u32 m0, m0, 4096
ds_read_b64_tr_b16 v[136:137], v222 offset:16384
ds_read_b64_tr_b16 v[138:139], v222 offset:18432
ds_read_b64_tr_b16 v[140:141], v223 offset:16384
ds_read_b64_tr_b16 v[142:143], v223 offset:18432
v_accvgpr_read_b32 v238, a26
v_mfma_f32_16x16x32_bf16 a[52:55], v[184:187], v[60:63], a[52:55]
s_add_u32 s38, s38, 128
v_accvgpr_read_b32 v239, a27
v_cvt_pk_bf16_f32 v232, v232, v233
v_mfma_f32_16x16x32_bf16 a[56:59], v[188:191], v[28:31], a[56:59]
v_cvt_pk_bf16_f32 v233, v234, v235
v_cvt_pk_bf16_f32 v234, v236, v237
v_mfma_f32_16x16x32_bf16 a[60:63], v[188:191], v[60:63], a[60:63]
s_waitcnt lgkmcnt(4)
ds_read_b64_tr_b16 v[144:145], v220 offset:20480
v_cvt_pk_bf16_f32 v235, v238, v239
v_mfma_f32_16x16x32_bf16 a[32:35], v[128:131], v[32:35], a[32:35]
ds_read_b64_tr_b16 v[146:147], v220 offset:22528
ds_read_b64_tr_b16 v[148:149], v221 offset:20480
ds_read_b64_tr_b16 v[150:151], v221 offset:22528
v_mfma_f32_16x16x32_bf16 a[36:39], v[128:131], v[64:67], a[36:39]
buffer_store_dwordx4 v[232:235], v14, s[16:19], s40 offen offset:512 sc1
v_mfma_f32_16x16x32_bf16 a[40:43], v[132:135], v[32:35], a[40:43]
buffer_load_dwordx4 v200, s[80:83], s31 offen lds
v_accvgpr_read_b32 v224, a4
v_accvgpr_read_b32 v225, a5
v_mfma_f32_16x16x32_bf16 a[44:47], v[132:135], v[64:67], a[44:47]
s_waitcnt lgkmcnt(4)
v_accvgpr_read_b32 v226, a6
v_accvgpr_read_b32 v227, a7
v_mfma_f32_16x16x32_bf16 a[48:51], v[136:139], v[32:35], a[48:51]
ds_read_b64_tr_b16 v[152:153], v222 offset:20480
ds_read_b64_tr_b16 v[154:155], v222 offset:22528
ds_read_b64_tr_b16 v[156:157], v223 offset:20480
ds_read_b64_tr_b16 v[158:159], v223 offset:22528
v_mfma_f32_16x16x32_bf16 a[52:55], v[136:139], v[64:67], a[52:55]
v_accvgpr_read_b32 v228, a12
v_accvgpr_read_b32 v229, a13
v_mfma_f32_16x16x32_bf16 a[56:59], v[140:143], v[32:35], a[56:59]
v_accvgpr_read_b32 v230, a14
v_accvgpr_read_b32 v231, a15
v_mfma_f32_16x16x32_bf16 a[60:63], v[140:143], v[64:67], a[60:63]
s_waitcnt lgkmcnt(4)
ds_read_b64_tr_b16 v[160:161], v220 offset:24576
v_cvt_pk_bf16_f32 v224, v224, v225
v_mfma_f32_16x16x32_bf16 a[32:35], v[144:147], v[36:39], a[32:35]
ds_read_b64_tr_b16 v[162:163], v220 offset:26624
ds_read_b64_tr_b16 v[164:165], v221 offset:24576
ds_read_b64_tr_b16 v[166:167], v221 offset:26624
v_mfma_f32_16x16x32_bf16 a[36:39], v[144:147], v[68:71], a[36:39]
buffer_load_dwordx4 v201, s[80:83], s31 offen offset:1024 lds
v_cvt_pk_bf16_f32 v225, v226, v227
v_cvt_pk_bf16_f32 v226, v228, v229
v_mfma_f32_16x16x32_bf16 a[40:43], v[148:151], v[36:39], a[40:43]
v_cvt_pk_bf16_f32 v227, v230, v231
v_mfma_f32_16x16x32_bf16 a[44:47], v[148:151], v[68:71], a[44:47]
s_waitcnt lgkmcnt(4)
buffer_store_dwordx4 v[224:227], v14, s[16:19], s41 offen offset:0 sc1
v_mfma_f32_16x16x32_bf16 a[48:51], v[152:155], v[36:39], a[48:51]
ds_read_b64_tr_b16 v[168:169], v222 offset:24576
ds_read_b64_tr_b16 v[170:171], v222 offset:26624
ds_read_b64_tr_b16 v[172:173], v223 offset:24576
ds_read_b64_tr_b16 v[174:175], v223 offset:26624
v_accvgpr_read_b32 v232, a20
v_accvgpr_read_b32 v233, a21
v_mfma_f32_16x16x32_bf16 a[52:55], v[152:155], v[68:71], a[52:55]
v_accvgpr_read_b32 v234, a22
v_accvgpr_read_b32 v235, a23
v_mfma_f32_16x16x32_bf16 a[56:59], v[156:159], v[36:39], a[56:59]
ds_read_b64_tr_b16 v[176:177], v220 offset:28672
v_accvgpr_read_b32 v236, a28
v_mfma_f32_16x16x32_bf16 a[60:63], v[156:159], v[68:71], a[60:63]
s_waitcnt lgkmcnt(5)
ds_read_b64_tr_b16 v[178:179], v220 offset:30720
v_accvgpr_read_b32 v237, a29
v_mfma_f32_16x16x32_bf16 a[32:35], v[160:163], v[40:43], a[32:35]
ds_read_b64_tr_b16 v[180:181], v221 offset:28672
ds_read_b64_tr_b16 v[182:183], v221 offset:30720
buffer_load_dwordx4 v202, s[80:83], s31 offen offset:2048 lds
v_accvgpr_read_b32 v238, a30
v_mfma_f32_16x16x32_bf16 a[36:39], v[160:163], v[72:75], a[36:39]
v_accvgpr_read_b32 v239, a31
v_cvt_pk_bf16_f32 v232, v232, v233
v_mfma_f32_16x16x32_bf16 a[40:43], v[164:167], v[40:43], a[40:43]
ds_read_b64_tr_b16 v[184:185], v222 offset:28672
v_cvt_pk_bf16_f32 v233, v234, v235
v_mfma_f32_16x16x32_bf16 a[44:47], v[164:167], v[72:75], a[44:47]
s_waitcnt lgkmcnt(5)
v_cvt_pk_bf16_f32 v234, v236, v237
v_cvt_pk_bf16_f32 v235, v238, v239
v_mfma_f32_16x16x32_bf16 a[48:51], v[168:171], v[40:43], a[48:51]
ds_read_b64_tr_b16 v[186:187], v222 offset:30720
ds_read_b64_tr_b16 v[188:189], v223 offset:28672
ds_read_b64_tr_b16 v[190:191], v223 offset:30720
v_mfma_f32_16x16x32_bf16 a[52:55], v[168:171], v[72:75], a[52:55]
buffer_store_dwordx4 v[232:235], v14, s[16:19], s41 offen offset:512 sc1
v_mfma_f32_16x16x32_bf16 a[56:59], v[172:175], v[40:43], a[56:59]
s_add_u32 s40, s40, 1024
s_add_u32 s41, s41, 1024
ds_read_b64_tr_b16 v[128:129], v216 offset:0
v_mfma_f32_16x16x32_bf16 a[60:63], v[172:175], v[72:75], a[60:63]
s_waitcnt lgkmcnt(5)
buffer_load_dwordx4 v203, s[80:83], s31 offen offset:3072 lds
v_mfma_f32_16x16x32_bf16 a[32:35], v[176:179], v[44:47], a[32:35]
s_add_u32 s27, s27, 32768
ds_read_b64_tr_b16 v[130:131], v216 offset:2048
ds_read_b64_tr_b16 v[132:133], v217 offset:0
ds_read_b64_tr_b16 v[134:135], v217 offset:2048
v_mfma_f32_16x16x32_bf16 a[36:39], v[176:179], v[76:79], a[36:39]
s_cmp_eq_u32 s27, 163840
s_cselect_b32 s27, 0, s27
ds_read_b64_tr_b16 v[136:137], v218 offset:0
v_add_u32 v220, s28, v212
v_mfma_f32_16x16x32_bf16 a[40:43], v[180:183], v[44:47], a[40:43]
ds_read_b64_tr_b16 v[138:139], v218 offset:2048
v_add_u32 v221, s28, v213
v_mfma_f32_16x16x32_bf16 a[44:47], v[180:183], v[76:79], a[44:47]
s_waitcnt lgkmcnt(6)
ds_read_b64_tr_b16 v[140:141], v219 offset:0
v_add_u32 v222, s28, v214
v_mfma_f32_16x16x32_bf16 a[48:51], v[184:187], v[44:47], a[48:51]
s_barrier
ds_read_b64_tr_b16 v[142:143], v219 offset:2048
v_add_u32 v223, s28, v215
v_mfma_f32_16x16x32_bf16 a[52:55], v[184:187], v[76:79], a[52:55]
s_add_u32 s28, s28, 32768
ds_read_b64_tr_b16 v[144:145], v216 offset:4096
s_cmp_eq_u32 s28, 163840
s_cselect_b32 s28, 0, s28
v_mfma_f32_16x16x32_bf16 a[56:59], v[188:191], v[44:47], a[56:59]
ds_read_b64_tr_b16 v[146:147], v216 offset:6144
v_mfma_f32_16x16x32_bf16 a[60:63], v[188:191], v[76:79], a[60:63]
ds_read_b64_tr_b16 v[148:149], v217 offset:4096
ds_read_b64_tr_b16 v[150:151], v217 offset:6144
s_waitcnt lgkmcnt(8)
v_mfma_f32_16x16x32_bf16 a[0:3], v[128:131], v[16:19], 0
s_add_u32 m0, s29, s27
ds_read_b64_tr_b16 v[152:153], v218 offset:4096
s_add_u32 s31, s38, 28672
v_mfma_f32_16x16x32_bf16 a[4:7], v[128:131], v[48:51], 0
ds_read_b64_tr_b16 v[154:155], v218 offset:6144
v_mfma_f32_16x16x32_bf16 a[8:11], v[132:135], v[16:19], 0
ds_read_b64_tr_b16 v[156:157], v219 offset:4096
v_mfma_f32_16x16x32_bf16 a[12:15], v[132:135], v[48:51], 0
s_waitcnt lgkmcnt(7)
ds_read_b64_tr_b16 v[158:159], v219 offset:6144
v_mfma_f32_16x16x32_bf16 a[16:19], v[136:139], v[16:19], 0
buffer_load_dwordx4 v200, s[80:83], s38 offen lds
v_mfma_f32_16x16x32_bf16 a[20:23], v[136:139], v[48:51], 0
ds_read_b64_tr_b16 v[160:161], v216 offset:8192
v_mfma_f32_16x16x32_bf16 a[24:27], v[140:143], v[16:19], 0
ds_read_b64_tr_b16 v[162:163], v216 offset:10240
v_mfma_f32_16x16x32_bf16 a[28:31], v[140:143], v[48:51], 0
s_waitcnt lgkmcnt(6)
ds_read_b64_tr_b16 v[164:165], v217 offset:8192
v_mfma_f32_16x16x32_bf16 a[0:3], v[144:147], v[20:23], a[0:3]
ds_read_b64_tr_b16 v[166:167], v217 offset:10240
v_mfma_f32_16x16x32_bf16 a[4:7], v[144:147], v[52:55], a[4:7]
ds_read_b64_tr_b16 v[168:169], v218 offset:8192
v_mfma_f32_16x16x32_bf16 a[8:11], v[148:151], v[20:23], a[8:11]
ds_read_b64_tr_b16 v[170:171], v218 offset:10240
v_accvgpr_read_b32 v224, a32
v_mfma_f32_16x16x32_bf16 a[12:15], v[148:151], v[52:55], a[12:15]
s_waitcnt lgkmcnt(6)
ds_read_b64_tr_b16 v[172:173], v219 offset:8192
v_accvgpr_read_b32 v225, a33
v_mfma_f32_16x16x32_bf16 a[16:19], v[152:155], v[20:23], a[16:19]
ds_read_b64_tr_b16 v[174:175], v219 offset:10240
v_accvgpr_read_b32 v226, a34
v_mfma_f32_16x16x32_bf16 a[20:23], v[152:155], v[52:55], a[20:23]
buffer_load_dwordx4 v201, s[80:83], s38 offen offset:1024 lds
v_mfma_f32_16x16x32_bf16 a[24:27], v[156:159], v[20:23], a[24:27]
ds_read_b64_tr_b16 v[176:177], v216 offset:12288
v_accvgpr_read_b32 v227, a35
v_mfma_f32_16x16x32_bf16 a[28:31], v[156:159], v[52:55], a[28:31]
s_waitcnt lgkmcnt(5)
ds_read_b64_tr_b16 v[178:179], v216 offset:14336
v_accvgpr_read_b32 v228, a40
v_mfma_f32_16x16x32_bf16 a[0:3], v[160:163], v[24:27], a[0:3]
ds_read_b64_tr_b16 v[180:181], v217 offset:12288
ds_read_b64_tr_b16 v[182:183], v217 offset:14336
v_mfma_f32_16x16x32_bf16 a[4:7], v[160:163], v[56:59], a[4:7]
v_accvgpr_read_b32 v229, a41
v_accvgpr_read_b32 v230, a42
v_mfma_f32_16x16x32_bf16 a[8:11], v[164:167], v[24:27], a[8:11]
ds_read_b64_tr_b16 v[184:185], v218 offset:12288
v_accvgpr_read_b32 v231, a43
v_mfma_f32_16x16x32_bf16 a[12:15], v[164:167], v[56:59], a[12:15]
s_waitcnt lgkmcnt(5)
ds_read_b64_tr_b16 v[186:187], v218 offset:14336
v_cvt_pk_bf16_f32 v224, v224, v225
v_mfma_f32_16x16x32_bf16 a[16:19], v[168:171], v[24:27], a[16:19]
ds_read_b64_tr_b16 v[188:189], v219 offset:12288
ds_read_b64_tr_b16 v[190:191], v219 offset:14336
buffer_load_dwordx4 v202, s[80:83], s38 offen offset:2048 lds
v_cvt_pk_bf16_f32 v225, v226, v227
v_mfma_f32_16x16x32_bf16 a[20:23], v[168:171], v[56:59], a[20:23]
v_cvt_pk_bf16_f32 v226, v228, v229
v_cvt_pk_bf16_f32 v227, v230, v231
v_mfma_f32_16x16x32_bf16 a[24:27], v[172:175], v[24:27], a[24:27]
buffer_store_dwordx4 v[224:227], v14, s[16:19], s40 offen offset:0 sc1
v_mfma_f32_16x16x32_bf16 a[28:31], v[172:175], v[56:59], a[28:31]
s_waitcnt lgkmcnt(4)
v_accvgpr_read_b32 v232, a48
v_accvgpr_read_b32 v233, a49
v_mfma_f32_16x16x32_bf16 a[0:3], v[176:179], v[28:31], a[0:3]
ds_read_b64_tr_b16 v[128:129], v216 offset:16384
ds_read_b64_tr_b16 v[130:131], v216 offset:18432
ds_read_b64_tr_b16 v[132:133], v217 offset:16384
ds_read_b64_tr_b16 v[134:135], v217 offset:18432
v_mfma_f32_16x16x32_bf16 a[4:7], v[176:179], v[60:63], a[4:7]
v_accvgpr_read_b32 v234, a50
v_accvgpr_read_b32 v235, a51
v_mfma_f32_16x16x32_bf16 a[8:11], v[180:183], v[28:31], a[8:11]
buffer_load_dwordx4 v203, s[80:83], s38 offen offset:3072 lds
v_mfma_f32_16x16x32_bf16 a[12:15], v[180:183], v[60:63], a[12:15]
s_waitcnt lgkmcnt(4)
v_accvgpr_read_b32 v236, a56
v_accvgpr_read_b32 v237, a57
v_mfma_f32_16x16x32_bf16 a[16:19], v[184:187], v[28:31], a[16:19]
s_add_u32 m0, m0, 4096
ds_read_b64_tr_b16 v[136:137], v218 offset:16384
ds_read_b64_tr_b16 v[138:139], v218 offset:18432
ds_read_b64_tr_b16 v[140:141], v219 offset:16384
ds_read_b64_tr_b16 v[142:143], v219 offset:18432
v_accvgpr_read_b32 v238, a58
v_mfma_f32_16x16x32_bf16 a[20:23], v[184:187], v[60:63], a[20:23]
s_add_u32 s38, s38, 128
v_accvgpr_read_b32 v239, a59
v_cvt_pk_bf16_f32 v232, v232, v233
v_mfma_f32_16x16x32_bf16 a[24:27], v[188:191], v[28:31], a[24:27]
v_cvt_pk_bf16_f32 v233, v234, v235
v_cvt_pk_bf16_f32 v234, v236, v237
v_mfma_f32_16x16x32_bf16 a[28:31], v[188:191], v[60:63], a[28:31]
s_waitcnt lgkmcnt(4)
ds_read_b64_tr_b16 v[144:145], v216 offset:20480
v_cvt_pk_bf16_f32 v235, v238, v239
v_mfma_f32_16x16x32_bf16 a[0:3], v[128:131], v[32:35], a[0:3]
ds_read_b64_tr_b16 v[146:147], v216 offset:22528
ds_read_b64_tr_b16 v[148:149], v217 offset:20480
ds_read_b64_tr_b16 v[150:151], v217 offset:22528
v_mfma_f32_16x16x32_bf16 a[4:7], v[128:131], v[64:67], a[4:7]
buffer_store_dwordx4 v[232:235], v14, s[16:19], s40 offen offset:512 sc1
v_mfma_f32_16x16x32_bf16 a[8:11], v[132:135], v[32:35], a[8:11]
buffer_load_dwordx4 v200, s[80:83], s31 offen lds
v_accvgpr_read_b32 v224, a36
v_accvgpr_read_b32 v225, a37
v_mfma_f32_16x16x32_bf16 a[12:15], v[132:135], v[64:67], a[12:15]
s_waitcnt lgkmcnt(4)
v_accvgpr_read_b32 v226, a38
v_accvgpr_read_b32 v227, a39
v_mfma_f32_16x16x32_bf16 a[16:19], v[136:139], v[32:35], a[16:19]
ds_read_b64_tr_b16 v[152:153], v218 offset:20480
ds_read_b64_tr_b16 v[154:155], v218 offset:22528
ds_read_b64_tr_b16 v[156:157], v219 offset:20480
ds_read_b64_tr_b16 v[158:159], v219 offset:22528
v_mfma_f32_16x16x32_bf16 a[20:23], v[136:139], v[64:67], a[20:23]
v_accvgpr_read_b32 v228, a44
v_accvgpr_read_b32 v229, a45
v_mfma_f32_16x16x32_bf16 a[24:27], v[140:143], v[32:35], a[24:27]
v_accvgpr_read_b32 v230, a46
v_accvgpr_read_b32 v231, a47
v_mfma_f32_16x16x32_bf16 a[28:31], v[140:143], v[64:67], a[28:31]
s_waitcnt lgkmcnt(4)
ds_read_b64_tr_b16 v[160:161], v216 offset:24576
v_cvt_pk_bf16_f32 v224, v224, v225
v_mfma_f32_16x16x32_bf16 a[0:3], v[144:147], v[36:39], a[0:3]
ds_read_b64_tr_b16 v[162:163], v216 offset:26624
ds_read_b64_tr_b16 v[164:165], v217 offset:24576
ds_read_b64_tr_b16 v[166:167], v217 offset:26624
v_mfma_f32_16x16x32_bf16 a[4:7], v[144:147], v[68:71], a[4:7]
buffer_load_dwordx4 v201, s[80:83], s31 offen offset:1024 lds
v_cvt_pk_bf16_f32 v225, v226, v227
v_cvt_pk_bf16_f32 v226, v228, v229
v_mfma_f32_16x16x32_bf16 a[8:11], v[148:151], v[36:39], a[8:11]
v_cvt_pk_bf16_f32 v227, v230, v231
v_mfma_f32_16x16x32_bf16 a[12:15], v[148:151], v[68:71], a[12:15]
s_waitcnt lgkmcnt(4)
buffer_store_dwordx4 v[224:227], v14, s[16:19], s41 offen offset:0 sc1
v_mfma_f32_16x16x32_bf16 a[16:19], v[152:155], v[36:39], a[16:19]
ds_read_b64_tr_b16 v[168:169], v218 offset:24576
ds_read_b64_tr_b16 v[170:171], v218 offset:26624
ds_read_b64_tr_b16 v[172:173], v219 offset:24576
ds_read_b64_tr_b16 v[174:175], v219 offset:26624
v_accvgpr_read_b32 v232, a52
v_accvgpr_read_b32 v233, a53
v_mfma_f32_16x16x32_bf16 a[20:23], v[152:155], v[68:71], a[20:23]
v_accvgpr_read_b32 v234, a54
v_accvgpr_read_b32 v235, a55
v_mfma_f32_16x16x32_bf16 a[24:27], v[156:159], v[36:39], a[24:27]
ds_read_b64_tr_b16 v[176:177], v216 offset:28672
v_accvgpr_read_b32 v236, a60
v_mfma_f32_16x16x32_bf16 a[28:31], v[156:159], v[68:71], a[28:31]
s_waitcnt lgkmcnt(5)
ds_read_b64_tr_b16 v[178:179], v216 offset:30720
v_accvgpr_read_b32 v237, a61
v_mfma_f32_16x16x32_bf16 a[0:3], v[160:163], v[40:43], a[0:3]
ds_read_b64_tr_b16 v[180:181], v217 offset:28672
ds_read_b64_tr_b16 v[182:183], v217 offset:30720
buffer_load_dwordx4 v202, s[80:83], s31 offen offset:2048 lds
v_accvgpr_read_b32 v238, a62
v_mfma_f32_16x16x32_bf16 a[4:7], v[160:163], v[72:75], a[4:7]
v_accvgpr_read_b32 v239, a63
v_cvt_pk_bf16_f32 v232, v232, v233
v_mfma_f32_16x16x32_bf16 a[8:11], v[164:167], v[40:43], a[8:11]
ds_read_b64_tr_b16 v[184:185], v218 offset:28672
v_cvt_pk_bf16_f32 v233, v234, v235
v_mfma_f32_16x16x32_bf16 a[12:15], v[164:167], v[72:75], a[12:15]
s_waitcnt lgkmcnt(5)
v_cvt_pk_bf16_f32 v234, v236, v237
v_cvt_pk_bf16_f32 v235, v238, v239
v_mfma_f32_16x16x32_bf16 a[16:19], v[168:171], v[40:43], a[16:19]
ds_read_b64_tr_b16 v[186:187], v218 offset:30720
ds_read_b64_tr_b16 v[188:189], v219 offset:28672
ds_read_b64_tr_b16 v[190:191], v219 offset:30720
v_mfma_f32_16x16x32_bf16 a[20:23], v[168:171], v[72:75], a[20:23]
buffer_store_dwordx4 v[232:235], v14, s[16:19], s41 offen offset:512 sc1
v_mfma_f32_16x16x32_bf16 a[24:27], v[172:175], v[40:43], a[24:27]
s_add_u32 s40, s40, 1024
s_add_u32 s41, s41, 1024
ds_read_b64_tr_b16 v[128:129], v220 offset:0
v_mfma_f32_16x16x32_bf16 a[28:31], v[172:175], v[72:75], a[28:31]
s_waitcnt lgkmcnt(5)
buffer_load_dwordx4 v203, s[80:83], s31 offen offset:3072 lds
v_mfma_f32_16x16x32_bf16 a[0:3], v[176:179], v[44:47], a[0:3]
s_add_u32 s27, s27, 32768
ds_read_b64_tr_b16 v[130:131], v220 offset:2048
ds_read_b64_tr_b16 v[132:133], v221 offset:0
ds_read_b64_tr_b16 v[134:135], v221 offset:2048
v_mfma_f32_16x16x32_bf16 a[4:7], v[176:179], v[76:79], a[4:7]
s_cmp_eq_u32 s27, 163840
s_cselect_b32 s27, 0, s27
ds_read_b64_tr_b16 v[136:137], v222 offset:0
v_add_u32 v216, s28, v212
v_mfma_f32_16x16x32_bf16 a[8:11], v[180:183], v[44:47], a[8:11]
ds_read_b64_tr_b16 v[138:139], v222 offset:2048
v_add_u32 v217, s28, v213
v_mfma_f32_16x16x32_bf16 a[12:15], v[180:183], v[76:79], a[12:15]
s_waitcnt vmcnt(24) lgkmcnt(6)
ds_read_b64_tr_b16 v[140:141], v223 offset:0
v_add_u32 v218, s28, v214
v_mfma_f32_16x16x32_bf16 a[16:19], v[184:187], v[44:47], a[16:19]
s_barrier
ds_read_b64_tr_b16 v[142:143], v223 offset:2048
v_add_u32 v219, s28, v215
v_mfma_f32_16x16x32_bf16 a[20:23], v[184:187], v[76:79], a[20:23]
s_add_u32 s28, s28, 32768
ds_read_b64_tr_b16 v[144:145], v220 offset:4096
s_cmp_eq_u32 s28, 163840
s_cselect_b32 s28, 0, s28
v_mfma_f32_16x16x32_bf16 a[24:27], v[188:191], v[44:47], a[24:27]
ds_read_b64_tr_b16 v[146:147], v220 offset:6144
v_mfma_f32_16x16x32_bf16 a[28:31], v[188:191], v[76:79], a[28:31]
ds_read_b64_tr_b16 v[148:149], v221 offset:4096
ds_read_b64_tr_b16 v[150:151], v221 offset:6144
s_waitcnt lgkmcnt(8)
v_mfma_f32_16x16x32_bf16 a[32:35], v[128:131], v[16:19], 0
ds_read_b64_tr_b16 v[152:153], v222 offset:4096
v_mfma_f32_16x16x32_bf16 a[36:39], v[128:131], v[48:51], 0
ds_read_b64_tr_b16 v[154:155], v222 offset:6144
v_mfma_f32_16x16x32_bf16 a[40:43], v[132:135], v[16:19], 0
ds_read_b64_tr_b16 v[156:157], v223 offset:4096
v_mfma_f32_16x16x32_bf16 a[44:47], v[132:135], v[48:51], 0
s_waitcnt lgkmcnt(7)
ds_read_b64_tr_b16 v[158:159], v223 offset:6144
v_mfma_f32_16x16x32_bf16 a[48:51], v[136:139], v[16:19], 0
ds_read_b64_tr_b16 v[160:161], v220 offset:8192
v_mfma_f32_16x16x32_bf16 a[52:55], v[136:139], v[48:51], 0
ds_read_b64_tr_b16 v[162:163], v220 offset:10240
v_mfma_f32_16x16x32_bf16 a[56:59], v[140:143], v[16:19], 0
ds_read_b64_tr_b16 v[164:165], v221 offset:8192
v_mfma_f32_16x16x32_bf16 a[60:63], v[140:143], v[48:51], 0
s_waitcnt lgkmcnt(7)
ds_read_b64_tr_b16 v[166:167], v221 offset:10240
v_mfma_f32_16x16x32_bf16 a[32:35], v[144:147], v[20:23], a[32:35]
ds_read_b64_tr_b16 v[168:169], v222 offset:8192
v_mfma_f32_16x16x32_bf16 a[36:39], v[144:147], v[52:55], a[36:39]
ds_read_b64_tr_b16 v[170:171], v222 offset:10240
v_mfma_f32_16x16x32_bf16 a[40:43], v[148:151], v[20:23], a[40:43]
ds_read_b64_tr_b16 v[172:173], v223 offset:8192
v_accvgpr_read_b32 v224, a0
v_mfma_f32_16x16x32_bf16 a[44:47], v[148:151], v[52:55], a[44:47]
s_waitcnt lgkmcnt(7)
ds_read_b64_tr_b16 v[174:175], v223 offset:10240
v_accvgpr_read_b32 v225, a1
v_mfma_f32_16x16x32_bf16 a[48:51], v[152:155], v[20:23], a[48:51]
ds_read_b64_tr_b16 v[176:177], v220 offset:12288
v_accvgpr_read_b32 v226, a2
v_mfma_f32_16x16x32_bf16 a[52:55], v[152:155], v[52:55], a[52:55]
ds_read_b64_tr_b16 v[178:179], v220 offset:14336
v_accvgpr_read_b32 v227, a3
v_mfma_f32_16x16x32_bf16 a[56:59], v[156:159], v[20:23], a[56:59]
ds_read_b64_tr_b16 v[180:181], v221 offset:12288
v_accvgpr_read_b32 v228, a8
v_mfma_f32_16x16x32_bf16 a[60:63], v[156:159], v[52:55], a[60:63]
s_waitcnt lgkmcnt(7)
ds_read_b64_tr_b16 v[182:183], v221 offset:14336
v_accvgpr_read_b32 v229, a9
v_mfma_f32_16x16x32_bf16 a[32:35], v[160:163], v[24:27], a[32:35]
ds_read_b64_tr_b16 v[184:185], v222 offset:12288
v_accvgpr_read_b32 v230, a10
v_mfma_f32_16x16x32_bf16 a[36:39], v[160:163], v[56:59], a[36:39]
ds_read_b64_tr_b16 v[186:187], v222 offset:14336
v_accvgpr_read_b32 v231, a11
v_mfma_f32_16x16x32_bf16 a[40:43], v[164:167], v[24:27], a[40:43]
ds_read_b64_tr_b16 v[188:189], v223 offset:12288
v_cvt_pk_bf16_f32 v224, v224, v225
v_mfma_f32_16x16x32_bf16 a[44:47], v[164:167], v[56:59], a[44:47]
s_waitcnt lgkmcnt(7)
ds_read_b64_tr_b16 v[190:191], v223 offset:14336
v_cvt_pk_bf16_f32 v225, v226, v227
v_mfma_f32_16x16x32_bf16 a[48:51], v[168:171], v[24:27], a[48:51]
ds_read_b64_tr_b16 v[128:129], v220 offset:16384
v_cvt_pk_bf16_f32 v226, v228, v229
v_mfma_f32_16x16x32_bf16 a[52:55], v[168:171], v[56:59], a[52:55]
ds_read_b64_tr_b16 v[130:131], v220 offset:18432
v_cvt_pk_bf16_f32 v227, v230, v231
v_mfma_f32_16x16x32_bf16 a[56:59], v[172:175], v[24:27], a[56:59]
buffer_store_dwordx4 v[224:227], v14, s[16:19], s40 offen offset:0 sc1
v_mfma_f32_16x16x32_bf16 a[60:63], v[172:175], v[56:59], a[60:63]
s_waitcnt lgkmcnt(6)
v_accvgpr_read_b32 v232, a16
v_accvgpr_read_b32 v233, a17
v_mfma_f32_16x16x32_bf16 a[32:35], v[176:179], v[28:31], a[32:35]
ds_read_b64_tr_b16 v[132:133], v221 offset:16384
ds_read_b64_tr_b16 v[134:135], v221 offset:18432
v_mfma_f32_16x16x32_bf16 a[36:39], v[176:179], v[60:63], a[36:39]
v_accvgpr_read_b32 v234, a18
v_accvgpr_read_b32 v235, a19
v_mfma_f32_16x16x32_bf16 a[40:43], v[180:183], v[28:31], a[40:43]
ds_read_b64_tr_b16 v[136:137], v222 offset:16384
v_accvgpr_read_b32 v236, a24
v_mfma_f32_16x16x32_bf16 a[44:47], v[180:183], v[60:63], a[44:47]
s_waitcnt lgkmcnt(5)
v_accvgpr_read_b32 v237, a25
v_accvgpr_read_b32 v238, a26
v_mfma_f32_16x16x32_bf16 a[48:51], v[184:187], v[28:31], a[48:51]
ds_read_b64_tr_b16 v[138:139], v222 offset:18432
ds_read_b64_tr_b16 v[140:141], v223 offset:16384
ds_read_b64_tr_b16 v[142:143], v223 offset:18432
v_mfma_f32_16x16x32_bf16 a[52:55], v[184:187], v[60:63], a[52:55]
v_accvgpr_read_b32 v239, a27
v_cvt_pk_bf16_f32 v232, v232, v233
v_mfma_f32_16x16x32_bf16 a[56:59], v[188:191], v[28:31], a[56:59]
v_cvt_pk_bf16_f32 v233, v234, v235
v_cvt_pk_bf16_f32 v234, v236, v237
v_mfma_f32_16x16x32_bf16 a[60:63], v[188:191], v[60:63], a[60:63]
s_waitcnt lgkmcnt(4)
ds_read_b64_tr_b16 v[144:145], v220 offset:20480
v_cvt_pk_bf16_f32 v235, v238, v239
v_mfma_f32_16x16x32_bf16 a[32:35], v[128:131], v[32:35], a[32:35]
ds_read_b64_tr_b16 v[146:147], v220 offset:22528
ds_read_b64_tr_b16 v[148:149], v221 offset:20480
ds_read_b64_tr_b16 v[150:151], v221 offset:22528
v_mfma_f32_16x16x32_bf16 a[36:39], v[128:131], v[64:67], a[36:39]
buffer_store_dwordx4 v[232:235], v14, s[16:19], s40 offen offset:512 sc1
v_mfma_f32_16x16x32_bf16 a[40:43], v[132:135], v[32:35], a[40:43]
v_accvgpr_read_b32 v224, a4
v_accvgpr_read_b32 v225, a5
v_mfma_f32_16x16x32_bf16 a[44:47], v[132:135], v[64:67], a[44:47]
s_waitcnt lgkmcnt(4)
v_accvgpr_read_b32 v226, a6
v_accvgpr_read_b32 v227, a7
v_mfma_f32_16x16x32_bf16 a[48:51], v[136:139], v[32:35], a[48:51]
ds_read_b64_tr_b16 v[152:153], v222 offset:20480
ds_read_b64_tr_b16 v[154:155], v222 offset:22528
ds_read_b64_tr_b16 v[156:157], v223 offset:20480
ds_read_b64_tr_b16 v[158:159], v223 offset:22528
v_mfma_f32_16x16x32_bf16 a[52:55], v[136:139], v[64:67], a[52:55]
v_accvgpr_read_b32 v228, a12
v_accvgpr_read_b32 v229, a13
v_mfma_f32_16x16x32_bf16 a[56:59], v[140:143], v[32:35], a[56:59]
v_accvgpr_read_b32 v230, a14
v_accvgpr_read_b32 v231, a15
v_mfma_f32_16x16x32_bf16 a[60:63], v[140:143], v[64:67], a[60:63]
s_waitcnt lgkmcnt(4)
ds_read_b64_tr_b16 v[160:161], v220 offset:24576
v_cvt_pk_bf16_f32 v224, v224, v225
v_mfma_f32_16x16x32_bf16 a[32:35], v[144:147], v[36:39], a[32:35]
ds_read_b64_tr_b16 v[162:163], v220 offset:26624
ds_read_b64_tr_b16 v[164:165], v221 offset:24576
ds_read_b64_tr_b16 v[166:167], v221 offset:26624
v_mfma_f32_16x16x32_bf16 a[36:39], v[144:147], v[68:71], a[36:39]
v_cvt_pk_bf16_f32 v225, v226, v227
v_cvt_pk_bf16_f32 v226, v228, v229
v_mfma_f32_16x16x32_bf16 a[40:43], v[148:151], v[36:39], a[40:43]
v_cvt_pk_bf16_f32 v227, v230, v231
v_mfma_f32_16x16x32_bf16 a[44:47], v[148:151], v[68:71], a[44:47]
s_waitcnt lgkmcnt(4)
buffer_store_dwordx4 v[224:227], v14, s[16:19], s41 offen offset:0 sc1
v_mfma_f32_16x16x32_bf16 a[48:51], v[152:155], v[36:39], a[48:51]
ds_read_b64_tr_b16 v[168:169], v222 offset:24576
ds_read_b64_tr_b16 v[170:171], v222 offset:26624
ds_read_b64_tr_b16 v[172:173], v223 offset:24576
ds_read_b64_tr_b16 v[174:175], v223 offset:26624
v_accvgpr_read_b32 v232, a20
v_accvgpr_read_b32 v233, a21
v_mfma_f32_16x16x32_bf16 a[52:55], v[152:155], v[68:71], a[52:55]
v_accvgpr_read_b32 v234, a22
v_accvgpr_read_b32 v235, a23
v_mfma_f32_16x16x32_bf16 a[56:59], v[156:159], v[36:39], a[56:59]
ds_read_b64_tr_b16 v[176:177], v220 offset:28672
v_accvgpr_read_b32 v236, a28
v_mfma_f32_16x16x32_bf16 a[60:63], v[156:159], v[68:71], a[60:63]
s_waitcnt lgkmcnt(5)
ds_read_b64_tr_b16 v[178:179], v220 offset:30720
v_accvgpr_read_b32 v237, a29
v_mfma_f32_16x16x32_bf16 a[32:35], v[160:163], v[40:43], a[32:35]
ds_read_b64_tr_b16 v[180:181], v221 offset:28672
ds_read_b64_tr_b16 v[182:183], v221 offset:30720
v_accvgpr_read_b32 v238, a30
v_mfma_f32_16x16x32_bf16 a[36:39], v[160:163], v[72:75], a[36:39]
v_accvgpr_read_b32 v239, a31
v_cvt_pk_bf16_f32 v232, v232, v233
v_mfma_f32_16x16x32_bf16 a[40:43], v[164:167], v[40:43], a[40:43]
ds_read_b64_tr_b16 v[184:185], v222 offset:28672
v_cvt_pk_bf16_f32 v233, v234, v235
v_mfma_f32_16x16x32_bf16 a[44:47], v[164:167], v[72:75], a[44:47]
s_waitcnt lgkmcnt(5)
v_cvt_pk_bf16_f32 v234, v236, v237
v_cvt_pk_bf16_f32 v235, v238, v239
v_mfma_f32_16x16x32_bf16 a[48:51], v[168:171], v[40:43], a[48:51]
ds_read_b64_tr_b16 v[186:187], v222 offset:30720
ds_read_b64_tr_b16 v[188:189], v223 offset:28672
ds_read_b64_tr_b16 v[190:191], v223 offset:30720
v_mfma_f32_16x16x32_bf16 a[52:55], v[168:171], v[72:75], a[52:55]
buffer_store_dwordx4 v[232:235], v14, s[16:19], s41 offen offset:512 sc1
v_mfma_f32_16x16x32_bf16 a[56:59], v[172:175], v[40:43], a[56:59]
s_add_u32 s40, s40, 1024
s_add_u32 s41, s41, 1024
ds_read_b64_tr_b16 v[128:129], v216 offset:0
v_mfma_f32_16x16x32_bf16 a[60:63], v[172:175], v[72:75], a[60:63]
s_waitcnt lgkmcnt(5)
ds_read_b64_tr_b16 v[130:131], v216 offset:2048
v_add_u32 v220, s28, v212
v_mfma_f32_16x16x32_bf16 a[32:35], v[176:179], v[44:47], a[32:35]
ds_read_b64_tr_b16 v[132:133], v217 offset:0
ds_read_b64_tr_b16 v[134:135], v217 offset:2048
v_mfma_f32_16x16x32_bf16 a[36:39], v[176:179], v[76:79], a[36:39]
ds_read_b64_tr_b16 v[136:137], v218 offset:0
v_add_u32 v221, s28, v213
v_mfma_f32_16x16x32_bf16 a[40:43], v[180:183], v[44:47], a[40:43]
ds_read_b64_tr_b16 v[138:139], v218 offset:2048
v_add_u32 v222, s28, v214
v_mfma_f32_16x16x32_bf16 a[44:47], v[180:183], v[76:79], a[44:47]
s_waitcnt vmcnt(16) lgkmcnt(6)
ds_read_b64_tr_b16 v[140:141], v219 offset:0
v_add_u32 v223, s28, v215
v_mfma_f32_16x16x32_bf16 a[48:51], v[184:187], v[44:47], a[48:51]
s_barrier
ds_read_b64_tr_b16 v[142:143], v219 offset:2048
s_add_u32 s28, s28, 32768
v_mfma_f32_16x16x32_bf16 a[52:55], v[184:187], v[76:79], a[52:55]
s_cmp_eq_u32 s28, 163840
s_cselect_b32 s28, 0, s28
ds_read_b64_tr_b16 v[144:145], v216 offset:4096
v_mfma_f32_16x16x32_bf16 a[56:59], v[188:191], v[44:47], a[56:59]
ds_read_b64_tr_b16 v[146:147], v216 offset:6144
v_mfma_f32_16x16x32_bf16 a[60:63], v[188:191], v[76:79], a[60:63]
ds_read_b64_tr_b16 v[148:149], v217 offset:4096
ds_read_b64_tr_b16 v[150:151], v217 offset:6144
s_waitcnt lgkmcnt(8)
v_mfma_f32_16x16x32_bf16 a[0:3], v[128:131], v[16:19], 0
ds_read_b64_tr_b16 v[152:153], v218 offset:4096
v_mfma_f32_16x16x32_bf16 a[4:7], v[128:131], v[48:51], 0
ds_read_b64_tr_b16 v[154:155], v218 offset:6144
v_mfma_f32_16x16x32_bf16 a[8:11], v[132:135], v[16:19], 0
ds_read_b64_tr_b16 v[156:157], v219 offset:4096
v_mfma_f32_16x16x32_bf16 a[12:15], v[132:135], v[48:51], 0
s_waitcnt lgkmcnt(7)
ds_read_b64_tr_b16 v[158:159], v219 offset:6144
v_mfma_f32_16x16x32_bf16 a[16:19], v[136:139], v[16:19], 0
ds_read_b64_tr_b16 v[160:161], v216 offset:8192
v_mfma_f32_16x16x32_bf16 a[20:23], v[136:139], v[48:51], 0
ds_read_b64_tr_b16 v[162:163], v216 offset:10240
v_mfma_f32_16x16x32_bf16 a[24:27], v[140:143], v[16:19], 0
ds_read_b64_tr_b16 v[164:165], v217 offset:8192
v_mfma_f32_16x16x32_bf16 a[28:31], v[140:143], v[48:51], 0
s_waitcnt lgkmcnt(7)
ds_read_b64_tr_b16 v[166:167], v217 offset:10240
v_mfma_f32_16x16x32_bf16 a[0:3], v[144:147], v[20:23], a[0:3]
ds_read_b64_tr_b16 v[168:169], v218 offset:8192
v_mfma_f32_16x16x32_bf16 a[4:7], v[144:147], v[52:55], a[4:7]
ds_read_b64_tr_b16 v[170:171], v218 offset:10240
v_mfma_f32_16x16x32_bf16 a[8:11], v[148:151], v[20:23], a[8:11]
ds_read_b64_tr_b16 v[172:173], v219 offset:8192
v_accvgpr_read_b32 v224, a32
v_mfma_f32_16x16x32_bf16 a[12:15], v[148:151], v[52:55], a[12:15]
s_waitcnt lgkmcnt(7)
ds_read_b64_tr_b16 v[174:175], v219 offset:10240
v_accvgpr_read_b32 v225, a33
v_mfma_f32_16x16x32_bf16 a[16:19], v[152:155], v[20:23], a[16:19]
ds_read_b64_tr_b16 v[176:177], v216 offset:12288
v_accvgpr_read_b32 v226, a34
v_mfma_f32_16x16x32_bf16 a[20:23], v[152:155], v[52:55], a[20:23]
ds_read_b64_tr_b16 v[178:179], v216 offset:14336
v_accvgpr_read_b32 v227, a35
v_mfma_f32_16x16x32_bf16 a[24:27], v[156:159], v[20:23], a[24:27]
ds_read_b64_tr_b16 v[180:181], v217 offset:12288
v_accvgpr_read_b32 v228, a40
v_mfma_f32_16x16x32_bf16 a[28:31], v[156:159], v[52:55], a[28:31]
s_waitcnt lgkmcnt(7)
ds_read_b64_tr_b16 v[182:183], v217 offset:14336
v_accvgpr_read_b32 v229, a41
v_mfma_f32_16x16x32_bf16 a[0:3], v[160:163], v[24:27], a[0:3]
ds_read_b64_tr_b16 v[184:185], v218 offset:12288
v_accvgpr_read_b32 v230, a42
v_mfma_f32_16x16x32_bf16 a[4:7], v[160:163], v[56:59], a[4:7]
ds_read_b64_tr_b16 v[186:187], v218 offset:14336
v_accvgpr_read_b32 v231, a43
v_mfma_f32_16x16x32_bf16 a[8:11], v[164:167], v[24:27], a[8:11]
ds_read_b64_tr_b16 v[188:189], v219 offset:12288
v_cvt_pk_bf16_f32 v224, v224, v225
v_mfma_f32_16x16x32_bf16 a[12:15], v[164:167], v[56:59], a[12:15]
s_waitcnt lgkmcnt(7)
ds_read_b64_tr_b16 v[190:191], v219 offset:14336
v_cvt_pk_bf16_f32 v225, v226, v227
v_mfma_f32_16x16x32_bf16 a[16:19], v[168:171], v[24:27], a[16:19]
ds_read_b64_tr_b16 v[128:129], v216 offset:16384
v_cvt_pk_bf16_f32 v226, v228, v229
v_mfma_f32_16x16x32_bf16 a[20:23], v[168:171], v[56:59], a[20:23]
ds_read_b64_tr_b16 v[130:131], v216 offset:18432
v_cvt_pk_bf16_f32 v227, v230, v231
v_mfma_f32_16x16x32_bf16 a[24:27], v[172:175], v[24:27], a[24:27]
buffer_store_dwordx4 v[224:227], v14, s[16:19], s40 offen offset:0 sc1
v_mfma_f32_16x16x32_bf16 a[28:31], v[172:175], v[56:59], a[28:31]
s_waitcnt lgkmcnt(6)
v_accvgpr_read_b32 v232, a48
v_accvgpr_read_b32 v233, a49
v_mfma_f32_16x16x32_bf16 a[0:3], v[176:179], v[28:31], a[0:3]
ds_read_b64_tr_b16 v[132:133], v217 offset:16384
ds_read_b64_tr_b16 v[134:135], v217 offset:18432
v_mfma_f32_16x16x32_bf16 a[4:7], v[176:179], v[60:63], a[4:7]
v_accvgpr_read_b32 v234, a50
v_accvgpr_read_b32 v235, a51
v_mfma_f32_16x16x32_bf16 a[8:11], v[180:183], v[28:31], a[8:11]
ds_read_b64_tr_b16 v[136:137], v218 offset:16384
v_accvgpr_read_b32 v236, a56
v_mfma_f32_16x16x32_bf16 a[12:15], v[180:183], v[60:63], a[12:15]
s_waitcnt lgkmcnt(5)
v_accvgpr_read_b32 v237, a57
v_accvgpr_read_b32 v238, a58
v_mfma_f32_16x16x32_bf16 a[16:19], v[184:187], v[28:31], a[16:19]
ds_read_b64_tr_b16 v[138:139], v218 offset:18432
ds_read_b64_tr_b16 v[140:141], v219 offset:16384
ds_read_b64_tr_b16 v[142:143], v219 offset:18432
v_mfma_f32_16x16x32_bf16 a[20:23], v[184:187], v[60:63], a[20:23]
v_accvgpr_read_b32 v239, a59
v_cvt_pk_bf16_f32 v232, v232, v233
v_mfma_f32_16x16x32_bf16 a[24:27], v[188:191], v[28:31], a[24:27]
v_cvt_pk_bf16_f32 v233, v234, v235
v_cvt_pk_bf16_f32 v234, v236, v237
v_mfma_f32_16x16x32_bf16 a[28:31], v[188:191], v[60:63], a[28:31]
s_waitcnt lgkmcnt(4)
ds_read_b64_tr_b16 v[144:145], v216 offset:20480
v_cvt_pk_bf16_f32 v235, v238, v239
v_mfma_f32_16x16x32_bf16 a[0:3], v[128:131], v[32:35], a[0:3]
ds_read_b64_tr_b16 v[146:147], v216 offset:22528
ds_read_b64_tr_b16 v[148:149], v217 offset:20480
ds_read_b64_tr_b16 v[150:151], v217 offset:22528
v_mfma_f32_16x16x32_bf16 a[4:7], v[128:131], v[64:67], a[4:7]
buffer_store_dwordx4 v[232:235], v14, s[16:19], s40 offen offset:512 sc1
v_mfma_f32_16x16x32_bf16 a[8:11], v[132:135], v[32:35], a[8:11]
v_accvgpr_read_b32 v224, a36
v_accvgpr_read_b32 v225, a37
v_mfma_f32_16x16x32_bf16 a[12:15], v[132:135], v[64:67], a[12:15]
s_waitcnt lgkmcnt(4)
v_accvgpr_read_b32 v226, a38
v_accvgpr_read_b32 v227, a39
v_mfma_f32_16x16x32_bf16 a[16:19], v[136:139], v[32:35], a[16:19]
ds_read_b64_tr_b16 v[152:153], v218 offset:20480
ds_read_b64_tr_b16 v[154:155], v218 offset:22528
ds_read_b64_tr_b16 v[156:157], v219 offset:20480
ds_read_b64_tr_b16 v[158:159], v219 offset:22528
v_mfma_f32_16x16x32_bf16 a[20:23], v[136:139], v[64:67], a[20:23]
v_accvgpr_read_b32 v228, a44
v_accvgpr_read_b32 v229, a45
v_mfma_f32_16x16x32_bf16 a[24:27], v[140:143], v[32:35], a[24:27]
v_accvgpr_read_b32 v230, a46
v_accvgpr_read_b32 v231, a47
v_mfma_f32_16x16x32_bf16 a[28:31], v[140:143], v[64:67], a[28:31]
s_waitcnt lgkmcnt(4)
ds_read_b64_tr_b16 v[160:161], v216 offset:24576
v_cvt_pk_bf16_f32 v224, v224, v225
v_mfma_f32_16x16x32_bf16 a[0:3], v[144:147], v[36:39], a[0:3]
ds_read_b64_tr_b16 v[162:163], v216 offset:26624
ds_read_b64_tr_b16 v[164:165], v217 offset:24576
ds_read_b64_tr_b16 v[166:167], v217 offset:26624
v_mfma_f32_16x16x32_bf16 a[4:7], v[144:147], v[68:71], a[4:7]
v_cvt_pk_bf16_f32 v225, v226, v227
v_cvt_pk_bf16_f32 v226, v228, v229
v_mfma_f32_16x16x32_bf16 a[8:11], v[148:151], v[36:39], a[8:11]
v_cvt_pk_bf16_f32 v227, v230, v231
v_mfma_f32_16x16x32_bf16 a[12:15], v[148:151], v[68:71], a[12:15]
s_waitcnt lgkmcnt(4)
buffer_store_dwordx4 v[224:227], v14, s[16:19], s41 offen offset:0 sc1
v_mfma_f32_16x16x32_bf16 a[16:19], v[152:155], v[36:39], a[16:19]
ds_read_b64_tr_b16 v[168:169], v218 offset:24576
ds_read_b64_tr_b16 v[170:171], v218 offset:26624
ds_read_b64_tr_b16 v[172:173], v219 offset:24576
ds_read_b64_tr_b16 v[174:175], v219 offset:26624
v_accvgpr_read_b32 v232, a52
v_accvgpr_read_b32 v233, a53
v_mfma_f32_16x16x32_bf16 a[20:23], v[152:155], v[68:71], a[20:23]
v_accvgpr_read_b32 v234, a54
v_accvgpr_read_b32 v235, a55
v_mfma_f32_16x16x32_bf16 a[24:27], v[156:159], v[36:39], a[24:27]
ds_read_b64_tr_b16 v[176:177], v216 offset:28672
v_accvgpr_read_b32 v236, a60
v_mfma_f32_16x16x32_bf16 a[28:31], v[156:159], v[68:71], a[28:31]
s_waitcnt lgkmcnt(5)
ds_read_b64_tr_b16 v[178:179], v216 offset:30720
v_accvgpr_read_b32 v237, a61
v_mfma_f32_16x16x32_bf16 a[0:3], v[160:163], v[40:43], a[0:3]
ds_read_b64_tr_b16 v[180:181], v217 offset:28672
ds_read_b64_tr_b16 v[182:183], v217 offset:30720
v_accvgpr_read_b32 v238, a62
v_mfma_f32_16x16x32_bf16 a[4:7], v[160:163], v[72:75], a[4:7]
v_accvgpr_read_b32 v239, a63
v_cvt_pk_bf16_f32 v232, v232, v233
v_mfma_f32_16x16x32_bf16 a[8:11], v[164:167], v[40:43], a[8:11]
ds_read_b64_tr_b16 v[184:185], v218 offset:28672
v_cvt_pk_bf16_f32 v233, v234, v235
v_mfma_f32_16x16x32_bf16 a[12:15], v[164:167], v[72:75], a[12:15]
s_waitcnt lgkmcnt(5)
v_cvt_pk_bf16_f32 v234, v236, v237
v_cvt_pk_bf16_f32 v235, v238, v239
v_mfma_f32_16x16x32_bf16 a[16:19], v[168:171], v[40:43], a[16:19]
ds_read_b64_tr_b16 v[186:187], v218 offset:30720
ds_read_b64_tr_b16 v[188:189], v219 offset:28672
ds_read_b64_tr_b16 v[190:191], v219 offset:30720
v_mfma_f32_16x16x32_bf16 a[20:23], v[168:171], v[72:75], a[20:23]
buffer_store_dwordx4 v[232:235], v14, s[16:19], s41 offen offset:512 sc1
v_mfma_f32_16x16x32_bf16 a[24:27], v[172:175], v[40:43], a[24:27]
s_add_u32 s40, s40, 1024
s_add_u32 s41, s41, 1024
ds_read_b64_tr_b16 v[128:129], v220 offset:0
v_mfma_f32_16x16x32_bf16 a[28:31], v[172:175], v[72:75], a[28:31]
s_waitcnt lgkmcnt(5)
ds_read_b64_tr_b16 v[130:131], v220 offset:2048
v_add_u32 v216, s28, v212
v_mfma_f32_16x16x32_bf16 a[0:3], v[176:179], v[44:47], a[0:3]
ds_read_b64_tr_b16 v[132:133], v221 offset:0
ds_read_b64_tr_b16 v[134:135], v221 offset:2048
v_mfma_f32_16x16x32_bf16 a[4:7], v[176:179], v[76:79], a[4:7]
ds_read_b64_tr_b16 v[136:137], v222 offset:0
v_add_u32 v217, s28, v213
v_mfma_f32_16x16x32_bf16 a[8:11], v[180:183], v[44:47], a[8:11]
ds_read_b64_tr_b16 v[138:139], v222 offset:2048
v_add_u32 v218, s28, v214
v_mfma_f32_16x16x32_bf16 a[12:15], v[180:183], v[76:79], a[12:15]
s_waitcnt vmcnt(8) lgkmcnt(6)
ds_read_b64_tr_b16 v[140:141], v223 offset:0
v_add_u32 v219, s28, v215
v_mfma_f32_16x16x32_bf16 a[16:19], v[184:187], v[44:47], a[16:19]
s_barrier
ds_read_b64_tr_b16 v[142:143], v223 offset:2048
s_add_u32 s28, s28, 32768
v_mfma_f32_16x16x32_bf16 a[20:23], v[184:187], v[76:79], a[20:23]
s_cmp_eq_u32 s28, 163840
s_cselect_b32 s28, 0, s28
ds_read_b64_tr_b16 v[144:145], v220 offset:4096
v_mfma_f32_16x16x32_bf16 a[24:27], v[188:191], v[44:47], a[24:27]
ds_read_b64_tr_b16 v[146:147], v220 offset:6144
v_mfma_f32_16x16x32_bf16 a[28:31], v[188:191], v[76:79], a[28:31]
ds_read_b64_tr_b16 v[148:149], v221 offset:4096
ds_read_b64_tr_b16 v[150:151], v221 offset:6144
s_waitcnt lgkmcnt(8)
v_mfma_f32_16x16x32_bf16 a[32:35], v[128:131], v[16:19], 0
ds_read_b64_tr_b16 v[152:153], v222 offset:4096
v_mfma_f32_16x16x32_bf16 a[36:39], v[128:131], v[48:51], 0
ds_read_b64_tr_b16 v[154:155], v222 offset:6144
v_mfma_f32_16x16x32_bf16 a[40:43], v[132:135], v[16:19], 0
ds_read_b64_tr_b16 v[156:157], v223 offset:4096
v_mfma_f32_16x16x32_bf16 a[44:47], v[132:135], v[48:51], 0
s_waitcnt lgkmcnt(7)
ds_read_b64_tr_b16 v[158:159], v223 offset:6144
v_mfma_f32_16x16x32_bf16 a[48:51], v[136:139], v[16:19], 0
ds_read_b64_tr_b16 v[160:161], v220 offset:8192
v_mfma_f32_16x16x32_bf16 a[52:55], v[136:139], v[48:51], 0
ds_read_b64_tr_b16 v[162:163], v220 offset:10240
v_mfma_f32_16x16x32_bf16 a[56:59], v[140:143], v[16:19], 0
ds_read_b64_tr_b16 v[164:165], v221 offset:8192
v_mfma_f32_16x16x32_bf16 a[60:63], v[140:143], v[48:51], 0
s_waitcnt lgkmcnt(7)
ds_read_b64_tr_b16 v[166:167], v221 offset:10240
v_mfma_f32_16x16x32_bf16 a[32:35], v[144:147], v[20:23], a[32:35]
ds_read_b64_tr_b16 v[168:169], v222 offset:8192
v_mfma_f32_16x16x32_bf16 a[36:39], v[144:147], v[52:55], a[36:39]
ds_read_b64_tr_b16 v[170:171], v222 offset:10240
v_mfma_f32_16x16x32_bf16 a[40:43], v[148:151], v[20:23], a[40:43]
ds_read_b64_tr_b16 v[172:173], v223 offset:8192
v_accvgpr_read_b32 v224, a0
v_mfma_f32_16x16x32_bf16 a[44:47], v[148:151], v[52:55], a[44:47]
s_waitcnt lgkmcnt(7)
ds_read_b64_tr_b16 v[174:175], v223 offset:10240
v_accvgpr_read_b32 v225, a1
v_mfma_f32_16x16x32_bf16 a[48:51], v[152:155], v[20:23], a[48:51]
ds_read_b64_tr_b16 v[176:177], v220 offset:12288
v_accvgpr_read_b32 v226, a2
v_mfma_f32_16x16x32_bf16 a[52:55], v[152:155], v[52:55], a[52:55]
ds_read_b64_tr_b16 v[178:179], v220 offset:14336
v_accvgpr_read_b32 v227, a3
v_mfma_f32_16x16x32_bf16 a[56:59], v[156:159], v[20:23], a[56:59]
ds_read_b64_tr_b16 v[180:181], v221 offset:12288
v_accvgpr_read_b32 v228, a8
v_mfma_f32_16x16x32_bf16 a[60:63], v[156:159], v[52:55], a[60:63]
s_waitcnt lgkmcnt(7)
ds_read_b64_tr_b16 v[182:183], v221 offset:14336
v_accvgpr_read_b32 v229, a9
v_mfma_f32_16x16x32_bf16 a[32:35], v[160:163], v[24:27], a[32:35]
ds_read_b64_tr_b16 v[184:185], v222 offset:12288
v_accvgpr_read_b32 v230, a10
v_mfma_f32_16x16x32_bf16 a[36:39], v[160:163], v[56:59], a[36:39]
ds_read_b64_tr_b16 v[186:187], v222 offset:14336
v_accvgpr_read_b32 v231, a11
v_mfma_f32_16x16x32_bf16 a[40:43], v[164:167], v[24:27], a[40:43]
ds_read_b64_tr_b16 v[188:189], v223 offset:12288
v_cvt_pk_bf16_f32 v224, v224, v225
v_mfma_f32_16x16x32_bf16 a[44:47], v[164:167], v[56:59], a[44:47]
s_waitcnt lgkmcnt(7)
ds_read_b64_tr_b16 v[190:191], v223 offset:14336
v_cvt_pk_bf16_f32 v225, v226, v227
v_mfma_f32_16x16x32_bf16 a[48:51], v[168:171], v[24:27], a[48:51]
ds_read_b64_tr_b16 v[128:129], v220 offset:16384
v_cvt_pk_bf16_f32 v226, v228, v229
v_mfma_f32_16x16x32_bf16 a[52:55], v[168:171], v[56:59], a[52:55]
ds_read_b64_tr_b16 v[130:131], v220 offset:18432
v_cvt_pk_bf16_f32 v227, v230, v231
v_mfma_f32_16x16x32_bf16 a[56:59], v[172:175], v[24:27], a[56:59]
buffer_store_dwordx4 v[224:227], v14, s[16:19], s40 offen offset:0 sc1
v_mfma_f32_16x16x32_bf16 a[60:63], v[172:175], v[56:59], a[60:63]
s_waitcnt lgkmcnt(6)
v_accvgpr_read_b32 v232, a16
v_accvgpr_read_b32 v233, a17
v_mfma_f32_16x16x32_bf16 a[32:35], v[176:179], v[28:31], a[32:35]
ds_read_b64_tr_b16 v[132:133], v221 offset:16384
ds_read_b64_tr_b16 v[134:135], v221 offset:18432
v_mfma_f32_16x16x32_bf16 a[36:39], v[176:179], v[60:63], a[36:39]
v_accvgpr_read_b32 v234, a18
v_accvgpr_read_b32 v235, a19
v_mfma_f32_16x16x32_bf16 a[40:43], v[180:183], v[28:31], a[40:43]
ds_read_b64_tr_b16 v[136:137], v222 offset:16384
v_accvgpr_read_b32 v236, a24
v_mfma_f32_16x16x32_bf16 a[44:47], v[180:183], v[60:63], a[44:47]
s_waitcnt lgkmcnt(5)
v_accvgpr_read_b32 v237, a25
v_accvgpr_read_b32 v238, a26
v_mfma_f32_16x16x32_bf16 a[48:51], v[184:187], v[28:31], a[48:51]
ds_read_b64_tr_b16 v[138:139], v222 offset:18432
ds_read_b64_tr_b16 v[140:141], v223 offset:16384
ds_read_b64_tr_b16 v[142:143], v223 offset:18432
v_mfma_f32_16x16x32_bf16 a[52:55], v[184:187], v[60:63], a[52:55]
v_accvgpr_read_b32 v239, a27
v_cvt_pk_bf16_f32 v232, v232, v233
v_mfma_f32_16x16x32_bf16 a[56:59], v[188:191], v[28:31], a[56:59]
v_cvt_pk_bf16_f32 v233, v234, v235
v_cvt_pk_bf16_f32 v234, v236, v237
v_mfma_f32_16x16x32_bf16 a[60:63], v[188:191], v[60:63], a[60:63]
s_waitcnt lgkmcnt(4)
ds_read_b64_tr_b16 v[144:145], v220 offset:20480
v_cvt_pk_bf16_f32 v235, v238, v239
v_mfma_f32_16x16x32_bf16 a[32:35], v[128:131], v[32:35], a[32:35]
ds_read_b64_tr_b16 v[146:147], v220 offset:22528
ds_read_b64_tr_b16 v[148:149], v221 offset:20480
ds_read_b64_tr_b16 v[150:151], v221 offset:22528
v_mfma_f32_16x16x32_bf16 a[36:39], v[128:131], v[64:67], a[36:39]
buffer_store_dwordx4 v[232:235], v14, s[16:19], s40 offen offset:512 sc1
v_mfma_f32_16x16x32_bf16 a[40:43], v[132:135], v[32:35], a[40:43]
v_accvgpr_read_b32 v224, a4
v_accvgpr_read_b32 v225, a5
v_mfma_f32_16x16x32_bf16 a[44:47], v[132:135], v[64:67], a[44:47]
s_waitcnt lgkmcnt(4)
v_accvgpr_read_b32 v226, a6
v_accvgpr_read_b32 v227, a7
v_mfma_f32_16x16x32_bf16 a[48:51], v[136:139], v[32:35], a[48:51]
ds_read_b64_tr_b16 v[152:153], v222 offset:20480
ds_read_b64_tr_b16 v[154:155], v222 offset:22528
ds_read_b64_tr_b16 v[156:157], v223 offset:20480
ds_read_b64_tr_b16 v[158:159], v223 offset:22528
v_mfma_f32_16x16x32_bf16 a[52:55], v[136:139], v[64:67], a[52:55]
v_accvgpr_read_b32 v228, a12
v_accvgpr_read_b32 v229, a13
v_mfma_f32_16x16x32_bf16 a[56:59], v[140:143], v[32:35], a[56:59]
v_accvgpr_read_b32 v230, a14
v_accvgpr_read_b32 v231, a15
v_mfma_f32_16x16x32_bf16 a[60:63], v[140:143], v[64:67], a[60:63]
s_waitcnt lgkmcnt(4)
ds_read_b64_tr_b16 v[160:161], v220 offset:24576
v_cvt_pk_bf16_f32 v224, v224, v225
v_mfma_f32_16x16x32_bf16 a[32:35], v[144:147], v[36:39], a[32:35]
ds_read_b64_tr_b16 v[162:163], v220 offset:26624
ds_read_b64_tr_b16 v[164:165], v221 offset:24576
ds_read_b64_tr_b16 v[166:167], v221 offset:26624
v_mfma_f32_16x16x32_bf16 a[36:39], v[144:147], v[68:71], a[36:39]
v_cvt_pk_bf16_f32 v225, v226, v227
v_cvt_pk_bf16_f32 v226, v228, v229
v_mfma_f32_16x16x32_bf16 a[40:43], v[148:151], v[36:39], a[40:43]
v_cvt_pk_bf16_f32 v227, v230, v231
v_mfma_f32_16x16x32_bf16 a[44:47], v[148:151], v[68:71], a[44:47]
s_waitcnt lgkmcnt(4)
buffer_store_dwordx4 v[224:227], v14, s[16:19], s41 offen offset:0 sc1
v_mfma_f32_16x16x32_bf16 a[48:51], v[152:155], v[36:39], a[48:51]
ds_read_b64_tr_b16 v[168:169], v222 offset:24576
ds_read_b64_tr_b16 v[170:171], v222 offset:26624
ds_read_b64_tr_b16 v[172:173], v223 offset:24576
ds_read_b64_tr_b16 v[174:175], v223 offset:26624
v_accvgpr_read_b32 v232, a20
v_accvgpr_read_b32 v233, a21
v_mfma_f32_16x16x32_bf16 a[52:55], v[152:155], v[68:71], a[52:55]
v_accvgpr_read_b32 v234, a22
v_accvgpr_read_b32 v235, a23
v_mfma_f32_16x16x32_bf16 a[56:59], v[156:159], v[36:39], a[56:59]
ds_read_b64_tr_b16 v[176:177], v220 offset:28672
v_accvgpr_read_b32 v236, a28
v_mfma_f32_16x16x32_bf16 a[60:63], v[156:159], v[68:71], a[60:63]
s_waitcnt lgkmcnt(5)
ds_read_b64_tr_b16 v[178:179], v220 offset:30720
v_accvgpr_read_b32 v237, a29
v_mfma_f32_16x16x32_bf16 a[32:35], v[160:163], v[40:43], a[32:35]
ds_read_b64_tr_b16 v[180:181], v221 offset:28672
ds_read_b64_tr_b16 v[182:183], v221 offset:30720
v_accvgpr_read_b32 v238, a30
v_mfma_f32_16x16x32_bf16 a[36:39], v[160:163], v[72:75], a[36:39]
v_accvgpr_read_b32 v239, a31
v_cvt_pk_bf16_f32 v232, v232, v233
v_mfma_f32_16x16x32_bf16 a[40:43], v[164:167], v[40:43], a[40:43]
ds_read_b64_tr_b16 v[184:185], v222 offset:28672
v_cvt_pk_bf16_f32 v233, v234, v235
v_mfma_f32_16x16x32_bf16 a[44:47], v[164:167], v[72:75], a[44:47]
s_waitcnt lgkmcnt(5)
v_cvt_pk_bf16_f32 v234, v236, v237
v_cvt_pk_bf16_f32 v235, v238, v239
v_mfma_f32_16x16x32_bf16 a[48:51], v[168:171], v[40:43], a[48:51]
ds_read_b64_tr_b16 v[186:187], v222 offset:30720
ds_read_b64_tr_b16 v[188:189], v223 offset:28672
ds_read_b64_tr_b16 v[190:191], v223 offset:30720
v_mfma_f32_16x16x32_bf16 a[52:55], v[168:171], v[72:75], a[52:55]
buffer_store_dwordx4 v[232:235], v14, s[16:19], s41 offen offset:512 sc1
v_mfma_f32_16x16x32_bf16 a[56:59], v[172:175], v[40:43], a[56:59]
s_add_u32 s40, s40, 1024
s_add_u32 s41, s41, 1024
ds_read_b64_tr_b16 v[128:129], v216 offset:0
v_mfma_f32_16x16x32_bf16 a[60:63], v[172:175], v[72:75], a[60:63]
s_waitcnt lgkmcnt(5)
ds_read_b64_tr_b16 v[130:131], v216 offset:2048
v_mfma_f32_16x16x32_bf16 a[32:35], v[176:179], v[44:47], a[32:35]
ds_read_b64_tr_b16 v[132:133], v217 offset:0
ds_read_b64_tr_b16 v[134:135], v217 offset:2048
v_mfma_f32_16x16x32_bf16 a[36:39], v[176:179], v[76:79], a[36:39]
ds_read_b64_tr_b16 v[136:137], v218 offset:0
v_mfma_f32_16x16x32_bf16 a[40:43], v[180:183], v[44:47], a[40:43]
ds_read_b64_tr_b16 v[138:139], v218 offset:2048
v_mfma_f32_16x16x32_bf16 a[44:47], v[180:183], v[76:79], a[44:47]
s_waitcnt lgkmcnt(6)
ds_read_b64_tr_b16 v[140:141], v219 offset:0
v_mfma_f32_16x16x32_bf16 a[48:51], v[184:187], v[44:47], a[48:51]
s_barrier
ds_read_b64_tr_b16 v[142:143], v219 offset:2048
v_mfma_f32_16x16x32_bf16 a[52:55], v[184:187], v[76:79], a[52:55]
ds_read_b64_tr_b16 v[144:145], v216 offset:4096
v_mfma_f32_16x16x32_bf16 a[56:59], v[188:191], v[44:47], a[56:59]
ds_read_b64_tr_b16 v[146:147], v216 offset:6144
v_mfma_f32_16x16x32_bf16 a[60:63], v[188:191], v[76:79], a[60:63]
ds_read_b64_tr_b16 v[148:149], v217 offset:4096
ds_read_b64_tr_b16 v[150:151], v217 offset:6144
s_waitcnt lgkmcnt(8)
v_mfma_f32_16x16x32_bf16 a[0:3], v[128:131], v[16:19], 0
ds_read_b64_tr_b16 v[152:153], v218 offset:4096
v_mfma_f32_16x16x32_bf16 a[4:7], v[128:131], v[48:51], 0
ds_read_b64_tr_b16 v[154:155], v218 offset:6144
v_mfma_f32_16x16x32_bf16 a[8:11], v[132:135], v[16:19], 0
ds_read_b64_tr_b16 v[156:157], v219 offset:4096
v_mfma_f32_16x16x32_bf16 a[12:15], v[132:135], v[48:51], 0
s_waitcnt lgkmcnt(7)
ds_read_b64_tr_b16 v[158:159], v219 offset:6144
v_mfma_f32_16x16x32_bf16 a[16:19], v[136:139], v[16:19], 0
ds_read_b64_tr_b16 v[160:161], v216 offset:8192
v_mfma_f32_16x16x32_bf16 a[20:23], v[136:139], v[48:51], 0
ds_read_b64_tr_b16 v[162:163], v216 offset:10240
v_mfma_f32_16x16x32_bf16 a[24:27], v[140:143], v[16:19], 0
ds_read_b64_tr_b16 v[164:165], v217 offset:8192
v_mfma_f32_16x16x32_bf16 a[28:31], v[140:143], v[48:51], 0
s_waitcnt lgkmcnt(7)
ds_read_b64_tr_b16 v[166:167], v217 offset:10240
v_mfma_f32_16x16x32_bf16 a[0:3], v[144:147], v[20:23], a[0:3]
ds_read_b64_tr_b16 v[168:169], v218 offset:8192
v_mfma_f32_16x16x32_bf16 a[4:7], v[144:147], v[52:55], a[4:7]
ds_read_b64_tr_b16 v[170:171], v218 offset:10240
v_mfma_f32_16x16x32_bf16 a[8:11], v[148:151], v[20:23], a[8:11]
ds_read_b64_tr_b16 v[172:173], v219 offset:8192
v_accvgpr_read_b32 v224, a32
v_mfma_f32_16x16x32_bf16 a[12:15], v[148:151], v[52:55], a[12:15]
s_waitcnt lgkmcnt(7)
ds_read_b64_tr_b16 v[174:175], v219 offset:10240
v_accvgpr_read_b32 v225, a33
v_mfma_f32_16x16x32_bf16 a[16:19], v[152:155], v[20:23], a[16:19]
ds_read_b64_tr_b16 v[176:177], v216 offset:12288
v_accvgpr_read_b32 v226, a34
v_mfma_f32_16x16x32_bf16 a[20:23], v[152:155], v[52:55], a[20:23]
ds_read_b64_tr_b16 v[178:179], v216 offset:14336
v_accvgpr_read_b32 v227, a35
v_mfma_f32_16x16x32_bf16 a[24:27], v[156:159], v[20:23], a[24:27]
ds_read_b64_tr_b16 v[180:181], v217 offset:12288
v_accvgpr_read_b32 v228, a40
v_mfma_f32_16x16x32_bf16 a[28:31], v[156:159], v[52:55], a[28:31]
s_waitcnt lgkmcnt(7)
ds_read_b64_tr_b16 v[182:183], v217 offset:14336
v_accvgpr_read_b32 v229, a41
v_mfma_f32_16x16x32_bf16 a[0:3], v[160:163], v[24:27], a[0:3]
ds_read_b64_tr_b16 v[184:185], v218 offset:12288
v_accvgpr_read_b32 v230, a42
v_mfma_f32_16x16x32_bf16 a[4:7], v[160:163], v[56:59], a[4:7]
ds_read_b64_tr_b16 v[186:187], v218 offset:14336
v_accvgpr_read_b32 v231, a43
v_mfma_f32_16x16x32_bf16 a[8:11], v[164:167], v[24:27], a[8:11]
ds_read_b64_tr_b16 v[188:189], v219 offset:12288
v_cvt_pk_bf16_f32 v224, v224, v225
v_mfma_f32_16x16x32_bf16 a[12:15], v[164:167], v[56:59], a[12:15]
s_waitcnt lgkmcnt(7)
ds_read_b64_tr_b16 v[190:191], v219 offset:14336
v_cvt_pk_bf16_f32 v225, v226, v227
v_mfma_f32_16x16x32_bf16 a[16:19], v[168:171], v[24:27], a[16:19]
ds_read_b64_tr_b16 v[128:129], v216 offset:16384
v_cvt_pk_bf16_f32 v226, v228, v229
v_mfma_f32_16x16x32_bf16 a[20:23], v[168:171], v[56:59], a[20:23]
ds_read_b64_tr_b16 v[130:131], v216 offset:18432
v_cvt_pk_bf16_f32 v227, v230, v231
v_mfma_f32_16x16x32_bf16 a[24:27], v[172:175], v[24:27], a[24:27]
buffer_store_dwordx4 v[224:227], v14, s[16:19], s40 offen offset:0 sc1
v_mfma_f32_16x16x32_bf16 a[28:31], v[172:175], v[56:59], a[28:31]
s_waitcnt lgkmcnt(6)
v_accvgpr_read_b32 v232, a48
v_accvgpr_read_b32 v233, a49
v_mfma_f32_16x16x32_bf16 a[0:3], v[176:179], v[28:31], a[0:3]
ds_read_b64_tr_b16 v[132:133], v217 offset:16384
ds_read_b64_tr_b16 v[134:135], v217 offset:18432
v_mfma_f32_16x16x32_bf16 a[4:7], v[176:179], v[60:63], a[4:7]
v_accvgpr_read_b32 v234, a50
v_accvgpr_read_b32 v235, a51
v_mfma_f32_16x16x32_bf16 a[8:11], v[180:183], v[28:31], a[8:11]
ds_read_b64_tr_b16 v[136:137], v218 offset:16384
v_accvgpr_read_b32 v236, a56
v_mfma_f32_16x16x32_bf16 a[12:15], v[180:183], v[60:63], a[12:15]
s_waitcnt lgkmcnt(5)
v_accvgpr_read_b32 v237, a57
v_accvgpr_read_b32 v238, a58
v_mfma_f32_16x16x32_bf16 a[16:19], v[184:187], v[28:31], a[16:19]
ds_read_b64_tr_b16 v[138:139], v218 offset:18432
ds_read_b64_tr_b16 v[140:141], v219 offset:16384
ds_read_b64_tr_b16 v[142:143], v219 offset:18432
v_mfma_f32_16x16x32_bf16 a[20:23], v[184:187], v[60:63], a[20:23]
v_accvgpr_read_b32 v239, a59
v_cvt_pk_bf16_f32 v232, v232, v233
v_mfma_f32_16x16x32_bf16 a[24:27], v[188:191], v[28:31], a[24:27]
v_cvt_pk_bf16_f32 v233, v234, v235
v_cvt_pk_bf16_f32 v234, v236, v237
v_mfma_f32_16x16x32_bf16 a[28:31], v[188:191], v[60:63], a[28:31]
s_waitcnt lgkmcnt(4)
ds_read_b64_tr_b16 v[144:145], v216 offset:20480
v_cvt_pk_bf16_f32 v235, v238, v239
v_mfma_f32_16x16x32_bf16 a[0:3], v[128:131], v[32:35], a[0:3]
ds_read_b64_tr_b16 v[146:147], v216 offset:22528
ds_read_b64_tr_b16 v[148:149], v217 offset:20480
ds_read_b64_tr_b16 v[150:151], v217 offset:22528
v_mfma_f32_16x16x32_bf16 a[4:7], v[128:131], v[64:67], a[4:7]
buffer_store_dwordx4 v[232:235], v14, s[16:19], s40 offen offset:512 sc1
v_mfma_f32_16x16x32_bf16 a[8:11], v[132:135], v[32:35], a[8:11]
v_accvgpr_read_b32 v224, a36
v_accvgpr_read_b32 v225, a37
v_mfma_f32_16x16x32_bf16 a[12:15], v[132:135], v[64:67], a[12:15]
s_waitcnt lgkmcnt(4)
v_accvgpr_read_b32 v226, a38
v_accvgpr_read_b32 v227, a39
v_mfma_f32_16x16x32_bf16 a[16:19], v[136:139], v[32:35], a[16:19]
ds_read_b64_tr_b16 v[152:153], v218 offset:20480
ds_read_b64_tr_b16 v[154:155], v218 offset:22528
ds_read_b64_tr_b16 v[156:157], v219 offset:20480
ds_read_b64_tr_b16 v[158:159], v219 offset:22528
v_mfma_f32_16x16x32_bf16 a[20:23], v[136:139], v[64:67], a[20:23]
v_accvgpr_read_b32 v228, a44
v_accvgpr_read_b32 v229, a45
v_mfma_f32_16x16x32_bf16 a[24:27], v[140:143], v[32:35], a[24:27]
v_accvgpr_read_b32 v230, a46
v_accvgpr_read_b32 v231, a47
v_mfma_f32_16x16x32_bf16 a[28:31], v[140:143], v[64:67], a[28:31]
s_waitcnt lgkmcnt(4)
ds_read_b64_tr_b16 v[160:161], v216 offset:24576
v_cvt_pk_bf16_f32 v224, v224, v225
v_mfma_f32_16x16x32_bf16 a[0:3], v[144:147], v[36:39], a[0:3]
ds_read_b64_tr_b16 v[162:163], v216 offset:26624
ds_read_b64_tr_b16 v[164:165], v217 offset:24576
ds_read_b64_tr_b16 v[166:167], v217 offset:26624
v_mfma_f32_16x16x32_bf16 a[4:7], v[144:147], v[68:71], a[4:7]
v_cvt_pk_bf16_f32 v225, v226, v227
v_cvt_pk_bf16_f32 v226, v228, v229
v_mfma_f32_16x16x32_bf16 a[8:11], v[148:151], v[36:39], a[8:11]
v_cvt_pk_bf16_f32 v227, v230, v231
v_mfma_f32_16x16x32_bf16 a[12:15], v[148:151], v[68:71], a[12:15]
s_waitcnt lgkmcnt(4)
buffer_store_dwordx4 v[224:227], v14, s[16:19], s41 offen offset:0 sc1
v_mfma_f32_16x16x32_bf16 a[16:19], v[152:155], v[36:39], a[16:19]
ds_read_b64_tr_b16 v[168:169], v218 offset:24576
ds_read_b64_tr_b16 v[170:171], v218 offset:26624
ds_read_b64_tr_b16 v[172:173], v219 offset:24576
ds_read_b64_tr_b16 v[174:175], v219 offset:26624
v_accvgpr_read_b32 v232, a52
v_accvgpr_read_b32 v233, a53
v_mfma_f32_16x16x32_bf16 a[20:23], v[152:155], v[68:71], a[20:23]
v_accvgpr_read_b32 v234, a54
v_accvgpr_read_b32 v235, a55
v_mfma_f32_16x16x32_bf16 a[24:27], v[156:159], v[36:39], a[24:27]
ds_read_b64_tr_b16 v[176:177], v216 offset:28672
v_accvgpr_read_b32 v236, a60
v_mfma_f32_16x16x32_bf16 a[28:31], v[156:159], v[68:71], a[28:31]
s_waitcnt lgkmcnt(5)
ds_read_b64_tr_b16 v[178:179], v216 offset:30720
v_accvgpr_read_b32 v237, a61
v_mfma_f32_16x16x32_bf16 a[0:3], v[160:163], v[40:43], a[0:3]
ds_read_b64_tr_b16 v[180:181], v217 offset:28672
ds_read_b64_tr_b16 v[182:183], v217 offset:30720
v_accvgpr_read_b32 v238, a62
v_mfma_f32_16x16x32_bf16 a[4:7], v[160:163], v[72:75], a[4:7]
v_accvgpr_read_b32 v239, a63
v_cvt_pk_bf16_f32 v232, v232, v233
v_mfma_f32_16x16x32_bf16 a[8:11], v[164:167], v[40:43], a[8:11]
ds_read_b64_tr_b16 v[184:185], v218 offset:28672
v_cvt_pk_bf16_f32 v233, v234, v235
v_mfma_f32_16x16x32_bf16 a[12:15], v[164:167], v[72:75], a[12:15]
s_waitcnt lgkmcnt(5)
v_cvt_pk_bf16_f32 v234, v236, v237
v_cvt_pk_bf16_f32 v235, v238, v239
v_mfma_f32_16x16x32_bf16 a[16:19], v[168:171], v[40:43], a[16:19]
ds_read_b64_tr_b16 v[186:187], v218 offset:30720
ds_read_b64_tr_b16 v[188:189], v219 offset:28672
ds_read_b64_tr_b16 v[190:191], v219 offset:30720
v_mfma_f32_16x16x32_bf16 a[20:23], v[168:171], v[72:75], a[20:23]
buffer_store_dwordx4 v[232:235], v14, s[16:19], s41 offen offset:512 sc1
v_mfma_f32_16x16x32_bf16 a[24:27], v[172:175], v[40:43], a[24:27]
s_add_u32 s40, s40, 1024
s_add_u32 s41, s41, 1024
v_mfma_f32_16x16x32_bf16 a[28:31], v[172:175], v[72:75], a[28:31]
s_waitcnt lgkmcnt(4)
v_mfma_f32_16x16x32_bf16 a[0:3], v[176:179], v[44:47], a[0:3]
v_mfma_f32_16x16x32_bf16 a[4:7], v[176:179], v[76:79], a[4:7]
v_mfma_f32_16x16x32_bf16 a[8:11], v[180:183], v[44:47], a[8:11]
v_mfma_f32_16x16x32_bf16 a[12:15], v[180:183], v[76:79], a[12:15]
s_waitcnt lgkmcnt(0)
v_mfma_f32_16x16x32_bf16 a[16:19], v[184:187], v[44:47], a[16:19]
v_mfma_f32_16x16x32_bf16 a[20:23], v[184:187], v[76:79], a[20:23]
v_mfma_f32_16x16x32_bf16 a[24:27], v[188:191], v[44:47], a[24:27]
v_mfma_f32_16x16x32_bf16 a[28:31], v[188:191], v[76:79], a[28:31]
s_nop 7
v_accvgpr_read_b32 v224, a0
v_accvgpr_read_b32 v225, a1
v_accvgpr_read_b32 v226, a2
v_accvgpr_read_b32 v227, a3
v_accvgpr_read_b32 v228, a8
v_accvgpr_read_b32 v229, a9
v_accvgpr_read_b32 v230, a10
v_accvgpr_read_b32 v231, a11
v_cvt_pk_bf16_f32 v224, v224, v225
v_cvt_pk_bf16_f32 v225, v226, v227
v_cvt_pk_bf16_f32 v226, v228, v229
v_cvt_pk_bf16_f32 v227, v230, v231
buffer_store_dwordx4 v[224:227], v14, s[16:19], s40 offen offset:0 sc1
v_accvgpr_read_b32 v232, a16
v_accvgpr_read_b32 v233, a17
v_accvgpr_read_b32 v234, a18
v_accvgpr_read_b32 v235, a19
v_accvgpr_read_b32 v236, a24
v_accvgpr_read_b32 v237, a25
v_accvgpr_read_b32 v238, a26
v_accvgpr_read_b32 v239, a27
v_cvt_pk_bf16_f32 v232, v232, v233
v_cvt_pk_bf16_f32 v233, v234, v235
v_cvt_pk_bf16_f32 v234, v236, v237
v_cvt_pk_bf16_f32 v235, v238, v239
buffer_store_dwordx4 v[232:235], v14, s[16:19], s40 offen offset:512 sc1
v_accvgpr_read_b32 v224, a4
v_accvgpr_read_b32 v225, a5
v_accvgpr_read_b32 v226, a6
v_accvgpr_read_b32 v227, a7
v_accvgpr_read_b32 v228, a12
v_accvgpr_read_b32 v229, a13
v_accvgpr_read_b32 v230, a14
v_accvgpr_read_b32 v231, a15
v_cvt_pk_bf16_f32 v224, v224, v225
v_cvt_pk_bf16_f32 v225, v226, v227
v_cvt_pk_bf16_f32 v226, v228, v229
v_cvt_pk_bf16_f32 v227, v230, v231
buffer_store_dwordx4 v[224:227], v14, s[16:19], s41 offen offset:0 sc1
v_accvgpr_read_b32 v232, a20
v_accvgpr_read_b32 v233, a21
v_accvgpr_read_b32 v234, a22
v_accvgpr_read_b32 v235, a23
v_accvgpr_read_b32 v236, a28
v_accvgpr_read_b32 v237, a29
v_accvgpr_read_b32 v238, a30
v_accvgpr_read_b32 v239, a31
v_cvt_pk_bf16_f32 v232, v232, v233
v_cvt_pk_bf16_f32 v233, v234, v235
v_cvt_pk_bf16_f32 v234, v236, v237
v_cvt_pk_bf16_f32 v235, v238, v239
buffer_store_dwordx4 v[232:235], v14, s[16:19], s41 offen offset:512 sc1
s_add_u32 s40, s40, 1024
s_add_u32 s41, s41, 1024
K2_opend:
s_waitcnt vmcnt(0)
s_barrier
s_lshl_b32 s4, s22, 7
v_mov_b32 v11, s4
v_mov_b32 v10, 1
s_cmp_lg_u32 s20, 0
s_cbranch_scc1 K2_noarr
v_cmp_eq_u32 vcc, 0, v1
s_and_saveexec_b64 s[4:5], vcc
buffer_atomic_add v10, v11, s[44:47], 0 offen sc1
s_mov_b64 exec, s[4:5]
K2_noarr:
v_lshrrev_b32 v6, 4, v1
s_lshl_b32 s43, s22, 4
s_add_u32 s43, s43, s21
v_and_b32 v10, 7, v6
s_lshl_b32 s6, s43, 3
v_add_u32 v10, s6, v10
s_movk_i32 s6, 896
v_mul_lo_u32 v10, v10, s6
v_lshrrev_b32 v12, 3, v6
v_and_b32 v12, 3, v12
v_lshrrev_b32 v13, 5, v6
v_lshlrev_b32 v7, 3, v12
v_lshl_add_u32 v7, v13, 6, v7
s_lshl_b32 s6, s20, 7
v_add3_u32 v2, v10, v7, s6
s_mul_i32 s6, s43, 7168
s_lshl_b32 s7, s20, 10
s_add_u32 s6, s6, s7
v_add_u32 v3, s6, v1
s_lshr_b32 s7, s43, 1
s_mul_i32 s7, s7, 14336
s_lshl_b32 s3, s20, 11
s_add_u32 s7, s7, s3
s_and_b32 s3, s43, 1
s_lshl_b32 s3, s3, 7
s_add_u32 s7, s7, s3
v_and_b32 v10, 7, v6
v_lshlrev_b32 v10, 4, v10
v_lshl_add_u32 v10, v12, 8, v10
v_lshl_add_u32 v10, v13, 10, v10
v_add_u32 v4, s7, v10
s_mov_b32 s8, s98
s_mov_b32 s9, s99
s_mov_b32 s10, 1835008
s_mov_b32 s11, 0x20000
s_add_u32 s12, s50, 77594624
s_addc_u32 s13, s51, 0
s_mov_b32 s14, 1835008
s_mov_b32 s15, 0x20000
s_add_u32 s52, s50, 79691776
s_addc_u32 s53, s51, 0
s_mov_b32 s54, 1835008
s_mov_b32 s55, 0x20000
buffer_load_dwordx2 v[144:145], v2, s[8:11], 0 offen offset:0
buffer_load_dwordx2 v[146:147], v2, s[8:11], 0 offen offset:32
buffer_load_dwordx2 v[148:149], v2, s[8:11], 0 offen offset:512
buffer_load_dwordx2 v[150:151], v2, s[8:11], 0 offen offset:544
s_cmp_lg_u32 s20, 0
s_cbranch_scc1 K2_rb_got
s_mov_b32 s4, 0
K2_rb_spin:
buffer_load_dword v13, v11, s[44:47], 0 offen sc1
s_waitcnt vmcnt(0)
K2_rb_chk:
v_readfirstlane_b32 s5, v13
s_nop 3
s_cmp_ge_u32 s5, 16
s_cbranch_scc1 K2_rb_got
s_add_u32 s4, s4, 1
s_cmp_lt_u32 s4, 0x40000
s_cbranch_scc0 K2_rb_got
s_sleep 2
s_branch K2_rb_spin
K2_rb_got:
s_barrier
s_mul_i32 s6, s43, 7168
s_lshl_b32 s7, s20, 10
s_add_u32 s6, s6, s7
buffer_load_dwordx4 v[16:19], v1, s[16:19], s6 offen sc1
s_add_u32 s6, s6, 1835008
buffer_load_dwordx4 v[24:27], v1, s[16:19], s6 offen sc1
s_add_u32 s6, s6, 1835008
buffer_load_dwordx4 v[32:35], v1, s[16:19], s6 offen sc1
s_add_u32 s6, s6, 1835008
buffer_load_dwordx4 v[40:43], v1, s[16:19], s6 offen sc1
s_add_u32 s6, s6, 1835008
buffer_load_dwordx4 v[48:51], v1, s[16:19], s6 offen sc1
s_add_u32 s6, s6, 1835008
buffer_load_dwordx4 v[56:59], v1, s[16:19], s6 offen sc1
s_add_u32 s6, s6, 1835008
buffer_load_dwordx4 v[64:67], v1, s[16:19], s6 offen sc1
s_add_u32 s6, s6, 1835008
buffer_load_dwordx4 v[72:75], v1, s[16:19], s6 offen sc1
s_add_u32 s6, s6, 1835008
buffer_load_dwordx4 v[80:83], v1, s[16:19], s6 offen sc1
s_add_u32 s6, s6, 1835008
buffer_load_dwordx4 v[88:91], v1, s[16:19], s6 offen sc1
s_add_u32 s6, s6, 1835008
buffer_load_dwordx4 v[96:99], v1, s[16:19], s6 offen sc1
s_add_u32 s6, s6, 1835008
buffer_load_dwordx4 v[104:107], v1, s[16:19], s6 offen sc1
s_add_u32 s6, s6, 1835008
buffer_load_dwordx4 v[112:115], v1, s[16:19], s6 offen sc1
s_add_u32 s6, s6, 1835008
buffer_load_dwordx4 v[120:123], v1, s[16:19], s6 offen sc1
s_add_u32 s6, s6, 1835008
buffer_load_dwordx4 v[128:131], v1, s[16:19], s6 offen sc1
s_add_u32 s6, s6, 1835008
buffer_load_dwordx4 v[136:139], v1, s[16:19], s6 offen sc1
s_add_u32 s6, s6, 1835008
s_mul_i32 s6, s43, 7168
s_lshl_b32 s7, s20, 10
s_add_u32 s6, s6, s7
s_add_u32 s6, s6, 4096
s_cmp_eq_u32 s20, 3
s_cselect_b32 s6, 0x7f000000, s6
buffer_load_dwordx4 v[20:23], v1, s[16:19], s6 offen sc1
s_add_u32 s6, s6, 1835008
buffer_load_dwordx4 v[28:31], v1, s[16:19], s6 offen sc1
s_add_u32 s6, s6, 1835008
buffer_load_dwordx4 v[36:39], v1, s[16:19], s6 offen sc1
s_add_u32 s6, s6, 1835008
buffer_load_dwordx4 v[44:47], v1, s[16:19], s6 offen sc1
s_add_u32 s6, s6, 1835008
buffer_load_dwordx4 v[52:55], v1, s[16:19], s6 offen sc1
s_add_u32 s6, s6, 1835008
buffer_load_dwordx4 v[60:63], v1, s[16:19], s6 offen sc1
s_add_u32 s6, s6, 1835008
buffer_load_dwordx4 v[68:71], v1, s[16:19], s6 offen sc1
s_add_u32 s6, s6, 1835008
buffer_load_dwordx4 v[76:79], v1, s[16:19], s6 offen sc1
s_add_u32 s6, s6, 1835008
buffer_load_dwordx4 v[84:87], v1, s[16:19], s6 offen sc1
s_add_u32 s6, s6, 1835008
buffer_load_dwordx4 v[92:95], v1, s[16:19], s6 offen sc1
s_add_u32 s6, s6, 1835008
buffer_load_dwordx4 v[100:103], v1, s[16:19], s6 offen sc1
s_add_u32 s6, s6, 1835008
buffer_load_dwordx4 v[108:111], v1, s[16:19], s6 offen sc1
s_add_u32 s6, s6, 1835008
buffer_load_dwordx4 v[116:119], v1, s[16:19], s6 offen sc1
s_add_u32 s6, s6, 1835008
buffer_load_dwordx4 v[124:127], v1, s[16:19], s6 offen sc1
s_add_u32 s6, s6, 1835008
buffer_load_dwordx4 v[132:135], v1, s[16:19], s6 offen sc1
s_add_u32 s6, s6, 1835008
buffer_load_dwordx4 v[140:143], v1, s[16:19], s6 offen sc1
s_add_u32 s6, s6, 1835008
s_waitcnt vmcnt(16)
v_lshlrev_b32 v160, 16, v16
v_and_b32 v161, 0xffff0000, v16
v_lshlrev_b32 v162, 16, v17
v_and_b32 v163, 0xffff0000, v17
v_lshlrev_b32 v164, 16, v18
v_and_b32 v165, 0xffff0000, v18
v_lshlrev_b32 v166, 16, v19
v_and_b32 v167, 0xffff0000, v19
v_lshlrev_b32 v176, 16, v24
v_and_b32 v177, 0xffff0000, v24
v_lshlrev_b32 v178, 16, v25
v_and_b32 v179, 0xffff0000, v25
v_lshlrev_b32 v180, 16, v26
v_and_b32 v181, 0xffff0000, v26
v_lshlrev_b32 v182, 16, v27
v_and_b32 v183, 0xffff0000, v27
v_lshlrev_b32 v10, 16, v32
v_and_b32 v12, 0xffff0000, v32
v_add_f32 v160, v160, v10
v_add_f32 v161, v161, v12
v_lshlrev_b32 v10, 16, v33
v_and_b32 v12, 0xffff0000, v33
v_add_f32 v162, v162, v10
v_add_f32 v163, v163, v12
v_lshlrev_b32 v10, 16, v34
v_and_b32 v12, 0xffff0000, v34
v_add_f32 v164, v164, v10
v_add_f32 v165, v165, v12
v_lshlrev_b32 v10, 16, v35
v_and_b32 v12, 0xffff0000, v35
v_add_f32 v166, v166, v10
v_add_f32 v167, v167, v12
v_lshlrev_b32 v10, 16, v40
v_and_b32 v12, 0xffff0000, v40
v_add_f32 v176, v176, v10
v_add_f32 v177, v177, v12
v_lshlrev_b32 v10, 16, v41
v_and_b32 v12, 0xffff0000, v41
v_add_f32 v178, v178, v10
v_add_f32 v179, v179, v12
v_lshlrev_b32 v10, 16, v42
v_and_b32 v12, 0xffff0000, v42
v_add_f32 v180, v180, v10
v_add_f32 v181, v181, v12
v_lshlrev_b32 v10, 16, v43
v_and_b32 v12, 0xffff0000, v43
v_add_f32 v182, v182, v10
v_add_f32 v183, v183, v12
v_lshlrev_b32 v10, 16, v48
v_and_b32 v12, 0xffff0000, v48
v_add_f32 v160, v160, v10
v_add_f32 v161, v161, v12
v_lshlrev_b32 v10, 16, v49
v_and_b32 v12, 0xffff0000, v49
v_add_f32 v162, v162, v10
v_add_f32 v163, v163, v12
v_lshlrev_b32 v10, 16, v50
v_and_b32 v12, 0xffff0000, v50
v_add_f32 v164, v164, v10
v_add_f32 v165, v165, v12
v_lshlrev_b32 v10, 16, v51
v_and_b32 v12, 0xffff0000, v51
v_add_f32 v166, v166, v10
v_add_f32 v167, v167, v12
v_lshlrev_b32 v10, 16, v56
v_and_b32 v12, 0xffff0000, v56
v_add_f32 v176, v176, v10
v_add_f32 v177, v177, v12
v_lshlrev_b32 v10, 16, v57
v_and_b32 v12, 0xffff0000, v57
v_add_f32 v178, v178, v10
v_add_f32 v179, v179, v12
v_lshlrev_b32 v10, 16, v58
v_and_b32 v12, 0xffff0000, v58
v_add_f32 v180, v180, v10
v_add_f32 v181, v181, v12
v_lshlrev_b32 v10, 16, v59
v_and_b32 v12, 0xffff0000, v59
v_add_f32 v182, v182, v10
v_add_f32 v183, v183, v12
v_lshlrev_b32 v10, 16, v64
v_and_b32 v12, 0xffff0000, v64
v_add_f32 v160, v160, v10
v_add_f32 v161, v161, v12
v_lshlrev_b32 v10, 16, v65
v_and_b32 v12, 0xffff0000, v65
v_add_f32 v162, v162, v10
v_add_f32 v163, v163, v12
v_lshlrev_b32 v10, 16, v66
v_and_b32 v12, 0xffff0000, v66
v_add_f32 v164, v164, v10
v_add_f32 v165, v165, v12
v_lshlrev_b32 v10, 16, v67
v_and_b32 v12, 0xffff0000, v67
v_add_f32 v166, v166, v10
v_add_f32 v167, v167, v12
v_lshlrev_b32 v10, 16, v72
v_and_b32 v12, 0xffff0000, v72
v_add_f32 v176, v176, v10
v_add_f32 v177, v177, v12
v_lshlrev_b32 v10, 16, v73
v_and_b32 v12, 0xffff0000, v73
v_add_f32 v178, v178, v10
v_add_f32 v179, v179, v12
v_lshlrev_b32 v10, 16, v74
v_and_b32 v12, 0xffff0000, v74
v_add_f32 v180, v180, v10
v_add_f32 v181, v181, v12
v_lshlrev_b32 v10, 16, v75
v_and_b32 v12, 0xffff0000, v75
v_add_f32 v182, v182, v10
v_add_f32 v183, v183, v12
v_lshlrev_b32 v10, 16, v80
v_and_b32 v12, 0xffff0000, v80
v_add_f32 v160, v160, v10
v_add_f32 v161, v161, v12
v_lshlrev_b32 v10, 16, v81
v_and_b32 v12, 0xffff0000, v81
v_add_f32 v162, v162, v10
v_add_f32 v163, v163, v12
v_lshlrev_b32 v10, 16, v82
v_and_b32 v12, 0xffff0000, v82
v_add_f32 v164, v164, v10
v_add_f32 v165, v165, v12
v_lshlrev_b32 v10, 16, v83
v_and_b32 v12, 0xffff0000, v83
v_add_f32 v166, v166, v10
v_add_f32 v167, v167, v12
v_lshlrev_b32 v10, 16, v88
v_and_b32 v12, 0xffff0000, v88
v_add_f32 v176, v176, v10
v_add_f32 v177, v177, v12
v_lshlrev_b32 v10, 16, v89
v_and_b32 v12, 0xffff0000, v89
v_add_f32 v178, v178, v10
v_add_f32 v179, v179, v12
v_lshlrev_b32 v10, 16, v90
v_and_b32 v12, 0xffff0000, v90
v_add_f32 v180, v180, v10
v_add_f32 v181, v181, v12
v_lshlrev_b32 v10, 16, v91
v_and_b32 v12, 0xffff0000, v91
v_add_f32 v182, v182, v10
v_add_f32 v183, v183, v12
v_lshlrev_b32 v10, 16, v96
v_and_b32 v12, 0xffff0000, v96
v_add_f32 v160, v160, v10
v_add_f32 v161, v161, v12
v_lshlrev_b32 v10, 16, v97
v_and_b32 v12, 0xffff0000, v97
v_add_f32 v162, v162, v10
v_add_f32 v163, v163, v12
v_lshlrev_b32 v10, 16, v98
v_and_b32 v12, 0xffff0000, v98
v_add_f32 v164, v164, v10
v_add_f32 v165, v165, v12
v_lshlrev_b32 v10, 16, v99
v_and_b32 v12, 0xffff0000, v99
v_add_f32 v166, v166, v10
v_add_f32 v167, v167, v12
v_lshlrev_b32 v10, 16, v104
v_and_b32 v12, 0xffff0000, v104
v_add_f32 v176, v176, v10
v_add_f32 v177, v177, v12
v_lshlrev_b32 v10, 16, v105
v_and_b32 v12, 0xffff0000, v105
v_add_f32 v178, v178, v10
v_add_f32 v179, v179, v12
v_lshlrev_b32 v10, 16, v106
v_and_b32 v12, 0xffff0000, v106
v_add_f32 v180, v180, v10
v_add_f32 v181, v181, v12
v_lshlrev_b32 v10, 16, v107
v_and_b32 v12, 0xffff0000, v107
v_add_f32 v182, v182, v10
v_add_f32 v183, v183, v12
v_lshlrev_b32 v10, 16, v112
v_and_b32 v12, 0xffff0000, v112
v_add_f32 v160, v160, v10
v_add_f32 v161, v161, v12
v_lshlrev_b32 v10, 16, v113
v_and_b32 v12, 0xffff0000, v113
v_add_f32 v162, v162, v10
v_add_f32 v163, v163, v12
v_lshlrev_b32 v10, 16, v114
v_and_b32 v12, 0xffff0000, v114
v_add_f32 v164, v164, v10
v_add_f32 v165, v165, v12
v_lshlrev_b32 v10, 16, v115
v_and_b32 v12, 0xffff0000, v115
v_add_f32 v166, v166, v10
v_add_f32 v167, v167, v12
v_lshlrev_b32 v10, 16, v120
v_and_b32 v12, 0xffff0000, v120
v_add_f32 v176, v176, v10
v_add_f32 v177, v177, v12
v_lshlrev_b32 v10, 16, v121
v_and_b32 v12, 0xffff0000, v121
v_add_f32 v178, v178, v10
v_add_f32 v179, v179, v12
v_lshlrev_b32 v10, 16, v122
v_and_b32 v12, 0xffff0000, v122
v_add_f32 v180, v180, v10
v_add_f32 v181, v181, v12
v_lshlrev_b32 v10, 16, v123
v_and_b32 v12, 0xffff0000, v123
v_add_f32 v182, v182, v10
v_add_f32 v183, v183, v12
v_lshlrev_b32 v10, 16, v128
v_and_b32 v12, 0xffff0000, v128
v_add_f32 v160, v160, v10
v_add_f32 v161, v161, v12
v_lshlrev_b32 v10, 16, v129
v_and_b32 v12, 0xffff0000, v129
v_add_f32 v162, v162, v10
v_add_f32 v163, v163, v12
v_lshlrev_b32 v10, 16, v130
v_and_b32 v12, 0xffff0000, v130
v_add_f32 v164, v164, v10
v_add_f32 v165, v165, v12
v_lshlrev_b32 v10, 16, v131
v_and_b32 v12, 0xffff0000, v131
v_add_f32 v166, v166, v10
v_add_f32 v167, v167, v12
v_lshlrev_b32 v10, 16, v136
v_and_b32 v12, 0xffff0000, v136
v_add_f32 v176, v176, v10
v_add_f32 v177, v177, v12
v_lshlrev_b32 v10, 16, v137
v_and_b32 v12, 0xffff0000, v137
v_add_f32 v178, v178, v10
v_add_f32 v179, v179, v12
v_lshlrev_b32 v10, 16, v138
v_and_b32 v12, 0xffff0000, v138
v_add_f32 v180, v180, v10
v_add_f32 v181, v181, v12
v_lshlrev_b32 v10, 16, v139
v_and_b32 v12, 0xffff0000, v139
v_add_f32 v182, v182, v10
v_add_f32 v183, v183, v12
s_waitcnt vmcnt(15)
v_lshlrev_b32 v192, 16, v20
v_and_b32 v193, 0xffff0000, v20
v_lshlrev_b32 v194, 16, v21
v_and_b32 v195, 0xffff0000, v21
v_lshlrev_b32 v196, 16, v22
v_and_b32 v197, 0xffff0000, v22
v_lshlrev_b32 v198, 16, v23
v_and_b32 v199, 0xffff0000, v23
s_waitcnt vmcnt(14)
v_lshlrev_b32 v208, 16, v28
v_and_b32 v209, 0xffff0000, v28
v_lshlrev_b32 v210, 16, v29
v_and_b32 v211, 0xffff0000, v29
v_lshlrev_b32 v212, 16, v30
v_and_b32 v213, 0xffff0000, v30
v_lshlrev_b32 v214, 16, v31
v_and_b32 v215, 0xffff0000, v31
s_waitcnt vmcnt(13)
v_lshlrev_b32 v10, 16, v36
v_and_b32 v12, 0xffff0000, v36
v_add_f32 v192, v192, v10
v_add_f32 v193, v193, v12
v_lshlrev_b32 v10, 16, v37
v_and_b32 v12, 0xffff0000, v37
v_add_f32 v194, v194, v10
v_add_f32 v195, v195, v12
v_lshlrev_b32 v10, 16, v38
v_and_b32 v12, 0xffff0000, v38
v_add_f32 v196, v196, v10
v_add_f32 v197, v197, v12
v_lshlrev_b32 v10, 16, v39
v_and_b32 v12, 0xffff0000, v39
v_add_f32 v198, v198, v10
v_add_f32 v199, v199, v12
s_waitcnt vmcnt(12)
v_lshlrev_b32 v10, 16, v44
v_and_b32 v12, 0xffff0000, v44
v_add_f32 v208, v208, v10
v_add_f32 v209, v209, v12
v_lshlrev_b32 v10, 16, v45
v_and_b32 v12, 0xffff0000, v45
v_add_f32 v210, v210, v10
v_add_f32 v211, v211, v12
v_lshlrev_b32 v10, 16, v46
v_and_b32 v12, 0xffff0000, v46
v_add_f32 v212, v212, v10
v_add_f32 v213, v213, v12
v_lshlrev_b32 v10, 16, v47
v_and_b32 v12, 0xffff0000, v47
v_add_f32 v214, v214, v10
v_add_f32 v215, v215, v12
s_waitcnt vmcnt(11)
v_lshlrev_b32 v10, 16, v52
v_and_b32 v12, 0xffff0000, v52
v_add_f32 v192, v192, v10
v_add_f32 v193, v193, v12
v_lshlrev_b32 v10, 16, v53
v_and_b32 v12, 0xffff0000, v53
v_add_f32 v194, v194, v10
v_add_f32 v195, v195, v12
v_lshlrev_b32 v10, 16, v54
v_and_b32 v12, 0xffff0000, v54
v_add_f32 v196, v196, v10
v_add_f32 v197, v197, v12
v_lshlrev_b32 v10, 16, v55
v_and_b32 v12, 0xffff0000, v55
v_add_f32 v198, v198, v10
v_add_f32 v199, v199, v12
s_waitcnt vmcnt(10)
v_lshlrev_b32 v10, 16, v60
v_and_b32 v12, 0xffff0000, v60
v_add_f32 v208, v208, v10
v_add_f32 v209, v209, v12
v_lshlrev_b32 v10, 16, v61
v_and_b32 v12, 0xffff0000, v61
v_add_f32 v210, v210, v10
v_add_f32 v211, v211, v12
v_lshlrev_b32 v10, 16, v62
v_and_b32 v12, 0xffff0000, v62
v_add_f32 v212, v212, v10
v_add_f32 v213, v213, v12
v_lshlrev_b32 v10, 16, v63
v_and_b32 v12, 0xffff0000, v63
v_add_f32 v214, v214, v10
v_add_f32 v215, v215, v12
s_waitcnt vmcnt(9)
v_lshlrev_b32 v10, 16, v68
v_and_b32 v12, 0xffff0000, v68
v_add_f32 v192, v192, v10
v_add_f32 v193, v193, v12
v_lshlrev_b32 v10, 16, v69
v_and_b32 v12, 0xffff0000, v69
v_add_f32 v194, v194, v10
v_add_f32 v195, v195, v12
v_lshlrev_b32 v10, 16, v70
v_and_b32 v12, 0xffff0000, v70
v_add_f32 v196, v196, v10
v_add_f32 v197, v197, v12
v_lshlrev_b32 v10, 16, v71
v_and_b32 v12, 0xffff0000, v71
v_add_f32 v198, v198, v10
v_add_f32 v199, v199, v12
s_waitcnt vmcnt(8)
v_lshlrev_b32 v10, 16, v76
v_and_b32 v12, 0xffff0000, v76
v_add_f32 v208, v208, v10
v_add_f32 v209, v209, v12
v_lshlrev_b32 v10, 16, v77
v_and_b32 v12, 0xffff0000, v77
v_add_f32 v210, v210, v10
v_add_f32 v211, v211, v12
v_lshlrev_b32 v10, 16, v78
v_and_b32 v12, 0xffff0000, v78
v_add_f32 v212, v212, v10
v_add_f32 v213, v213, v12
v_lshlrev_b32 v10, 16, v79
v_and_b32 v12, 0xffff0000, v79
v_add_f32 v214, v214, v10
v_add_f32 v215, v215, v12
s_waitcnt vmcnt(7)
v_lshlrev_b32 v10, 16, v84
v_and_b32 v12, 0xffff0000, v84
v_add_f32 v192, v192, v10
v_add_f32 v193, v193, v12
v_lshlrev_b32 v10, 16, v85
v_and_b32 v12, 0xffff0000, v85
v_add_f32 v194, v194, v10
v_add_f32 v195, v195, v12
v_lshlrev_b32 v10, 16, v86
v_and_b32 v12, 0xffff0000, v86
v_add_f32 v196, v196, v10
v_add_f32 v197, v197, v12
v_lshlrev_b32 v10, 16, v87
v_and_b32 v12, 0xffff0000, v87
v_add_f32 v198, v198, v10
v_add_f32 v199, v199, v12
s_waitcnt vmcnt(6)
v_lshlrev_b32 v10, 16, v92
v_and_b32 v12, 0xffff0000, v92
v_add_f32 v208, v208, v10
v_add_f32 v209, v209, v12
v_lshlrev_b32 v10, 16, v93
v_and_b32 v12, 0xffff0000, v93
v_add_f32 v210, v210, v10
v_add_f32 v211, v211, v12
v_lshlrev_b32 v10, 16, v94
v_and_b32 v12, 0xffff0000, v94
v_add_f32 v212, v212, v10
v_add_f32 v213, v213, v12
v_lshlrev_b32 v10, 16, v95
v_and_b32 v12, 0xffff0000, v95
v_add_f32 v214, v214, v10
v_add_f32 v215, v215, v12
s_waitcnt vmcnt(5)
v_lshlrev_b32 v10, 16, v100
v_and_b32 v12, 0xffff0000, v100
v_add_f32 v192, v192, v10
v_add_f32 v193, v193, v12
v_lshlrev_b32 v10, 16, v101
v_and_b32 v12, 0xffff0000, v101
v_add_f32 v194, v194, v10
v_add_f32 v195, v195, v12
v_lshlrev_b32 v10, 16, v102
v_and_b32 v12, 0xffff0000, v102
v_add_f32 v196, v196, v10
v_add_f32 v197, v197, v12
v_lshlrev_b32 v10, 16, v103
v_and_b32 v12, 0xffff0000, v103
v_add_f32 v198, v198, v10
v_add_f32 v199, v199, v12
s_waitcnt vmcnt(4)
v_lshlrev_b32 v10, 16, v108
v_and_b32 v12, 0xffff0000, v108
v_add_f32 v208, v208, v10
v_add_f32 v209, v209, v12
v_lshlrev_b32 v10, 16, v109
v_and_b32 v12, 0xffff0000, v109
v_add_f32 v210, v210, v10
v_add_f32 v211, v211, v12
v_lshlrev_b32 v10, 16, v110
v_and_b32 v12, 0xffff0000, v110
v_add_f32 v212, v212, v10
v_add_f32 v213, v213, v12
v_lshlrev_b32 v10, 16, v111
v_and_b32 v12, 0xffff0000, v111
v_add_f32 v214, v214, v10
v_add_f32 v215, v215, v12
s_waitcnt vmcnt(3)
v_lshlrev_b32 v10, 16, v116
v_and_b32 v12, 0xffff0000, v116
v_add_f32 v192, v192, v10
v_add_f32 v193, v193, v12
v_lshlrev_b32 v10, 16, v117
v_and_b32 v12, 0xffff0000, v117
v_add_f32 v194, v194, v10
v_add_f32 v195, v195, v12
v_lshlrev_b32 v10, 16, v118
v_and_b32 v12, 0xffff0000, v118
v_add_f32 v196, v196, v10
v_add_f32 v197, v197, v12
v_lshlrev_b32 v10, 16, v119
v_and_b32 v12, 0xffff0000, v119
v_add_f32 v198, v198, v10
v_add_f32 v199, v199, v12
s_waitcnt vmcnt(2)
v_lshlrev_b32 v10, 16, v124
v_and_b32 v12, 0xffff0000, v124
v_add_f32 v208, v208, v10
v_add_f32 v209, v209, v12
v_lshlrev_b32 v10, 16, v125
v_and_b32 v12, 0xffff0000, v125
v_add_f32 v210, v210, v10
v_add_f32 v211, v211, v12
v_lshlrev_b32 v10, 16, v126
v_and_b32 v12, 0xffff0000, v126
v_add_f32 v212, v212, v10
v_add_f32 v213, v213, v12
v_lshlrev_b32 v10, 16, v127
v_and_b32 v12, 0xffff0000, v127
v_add_f32 v214, v214, v10
v_add_f32 v215, v215, v12
s_waitcnt vmcnt(1)
v_lshlrev_b32 v10, 16, v132
v_and_b32 v12, 0xffff0000, v132
v_add_f32 v192, v192, v10
v_add_f32 v193, v193, v12
v_lshlrev_b32 v10, 16, v133
v_and_b32 v12, 0xffff0000, v133
v_add_f32 v194, v194, v10
v_add_f32 v195, v195, v12
v_lshlrev_b32 v10, 16, v134
v_and_b32 v12, 0xffff0000, v134
v_add_f32 v196, v196, v10
v_add_f32 v197, v197, v12
v_lshlrev_b32 v10, 16, v135
v_and_b32 v12, 0xffff0000, v135
v_add_f32 v198, v198, v10
v_add_f32 v199, v199, v12
s_waitcnt vmcnt(0)
v_lshlrev_b32 v10, 16, v140
v_and_b32 v12, 0xffff0000, v140
v_add_f32 v208, v208, v10
v_add_f32 v209, v209, v12
v_lshlrev_b32 v10, 16, v141
v_and_b32 v12, 0xffff0000, v141
v_add_f32 v210, v210, v10
v_add_f32 v211, v211, v12
v_lshlrev_b32 v10, 16, v142
v_and_b32 v12, 0xffff0000, v142
v_add_f32 v212, v212, v10
v_add_f32 v213, v213, v12
v_lshlrev_b32 v10, 16, v143
v_and_b32 v12, 0xffff0000, v143
v_add_f32 v214, v214, v10
v_add_f32 v215, v215, v12
v_add_f32 v160, v160, v176
v_add_f32 v161, v161, v177
v_add_f32 v162, v162, v178
v_add_f32 v163, v163, v179
v_add_f32 v164, v164, v180
v_add_f32 v165, v165, v181
v_add_f32 v166, v166, v182
v_add_f32 v167, v167, v183
v_cvt_pk_bf16_f32 v168, v160, v161
v_cvt_pk_bf16_f32 v169, v162, v163
v_cvt_pk_bf16_f32 v170, v164, v165
v_cvt_pk_bf16_f32 v171, v166, v167
v_lshlrev_b32 v160, 16, v168
v_and_b32 v161, 0xffff0000, v168
v_lshlrev_b32 v10, 16, v144
v_and_b32 v12, 0xffff0000, v144
v_add_f32 v160, v160, v10
v_add_f32 v161, v161, v12
v_lshlrev_b32 v162, 16, v169
v_and_b32 v163, 0xffff0000, v169
v_lshlrev_b32 v10, 16, v145
v_and_b32 v12, 0xffff0000, v145
v_add_f32 v162, v162, v10
v_add_f32 v163, v163, v12
v_lshlrev_b32 v164, 16, v170
v_and_b32 v165, 0xffff0000, v170
v_lshlrev_b32 v10, 16, v146
v_and_b32 v12, 0xffff0000, v146
v_add_f32 v164, v164, v10
v_add_f32 v165, v165, v12
v_lshlrev_b32 v166, 16, v171
v_and_b32 v167, 0xffff0000, v171
v_lshlrev_b32 v10, 16, v147
v_and_b32 v12, 0xffff0000, v147
v_add_f32 v166, v166, v10
v_add_f32 v167, v167, v12
v_cvt_pk_bf16_f32 v168, v160, v161
v_cvt_pk_bf16_f32 v169, v162, v163
v_cvt_pk_bf16_f32 v170, v164, v165
v_cvt_pk_bf16_f32 v171, v166, v167
v_add_f32 v192, v192, v208
v_add_f32 v193, v193, v209
v_add_f32 v194, v194, v210
v_add_f32 v195, v195, v211
v_add_f32 v196, v196, v212
v_add_f32 v197, v197, v213
v_add_f32 v198, v198, v214
v_add_f32 v199, v199, v215
v_cvt_pk_bf16_f32 v200, v192, v193
v_cvt_pk_bf16_f32 v201, v194, v195
v_cvt_pk_bf16_f32 v202, v196, v197
v_cvt_pk_bf16_f32 v203, v198, v199
v_lshlrev_b32 v192, 16, v200
v_and_b32 v193, 0xffff0000, v200
v_lshlrev_b32 v10, 16, v148
v_and_b32 v12, 0xffff0000, v148
v_add_f32 v192, v192, v10
v_add_f32 v193, v193, v12
v_lshlrev_b32 v194, 16, v201
v_and_b32 v195, 0xffff0000, v201
v_lshlrev_b32 v10, 16, v149
v_and_b32 v12, 0xffff0000, v149
v_add_f32 v194, v194, v10
v_add_f32 v195, v195, v12
v_lshlrev_b32 v196, 16, v202
v_and_b32 v197, 0xffff0000, v202
v_lshlrev_b32 v10, 16, v150
v_and_b32 v12, 0xffff0000, v150
v_add_f32 v196, v196, v10
v_add_f32 v197, v197, v12
v_lshlrev_b32 v198, 16, v203
v_and_b32 v199, 0xffff0000, v203
v_lshlrev_b32 v10, 16, v151
v_and_b32 v12, 0xffff0000, v151
v_add_f32 v198, v198, v10
v_add_f32 v199, v199, v12
v_cvt_pk_bf16_f32 v200, v192, v193
v_cvt_pk_bf16_f32 v201, v194, v195
v_cvt_pk_bf16_f32 v202, v196, v197
v_cvt_pk_bf16_f32 v203, v198, v199
s_movk_i32 s6, 4096
s_movk_i32 s7, 8192
s_cmp_eq_u32 s20, 3
s_cselect_b32 s6, 0x7f000000, s6
s_cselect_b32 s7, 0x7f000000, s7
s_cselect_b32 s3, 0, 1.0
buffer_store_dwordx4 v[168:171], v3, s[12:15], 0 offen sc1
buffer_store_dwordx4 v[200:203], v3, s[12:15], s6 offen sc1
v_lshlrev_b32 v160, 16, v168
v_and_b32 v161, 0xffff0000, v168
v_lshlrev_b32 v162, 16, v169
v_and_b32 v163, 0xffff0000, v169
v_lshlrev_b32 v164, 16, v170
v_and_b32 v165, 0xffff0000, v170
v_lshlrev_b32 v166, 16, v171
v_and_b32 v167, 0xffff0000, v171
v_lshlrev_b32 v192, 16, v200
v_and_b32 v193, 0xffff0000, v200
v_lshlrev_b32 v194, 16, v201
v_and_b32 v195, 0xffff0000, v201
v_lshlrev_b32 v196, 16, v202
v_and_b32 v197, 0xffff0000, v202
v_lshlrev_b32 v198, 16, v203
v_and_b32 v199, 0xffff0000, v203
v_mul_f32 v192, s3, v192
v_mul_f32 v193, s3, v193
v_mul_f32 v194, s3, v194
v_mul_f32 v195, s3, v195
v_mul_f32 v196, s3, v196
v_mul_f32 v197, s3, v197
v_mul_f32 v198, s3, v198
v_mul_f32 v199, s3, v199
v_add_f32 v224, v160, v161
v_mul_f32 v225, v160, v160
v_fmac_f32 v225, v161, v161
v_add_f32 v224, v224, v162
v_fmac_f32 v225, v162, v162
v_add_f32 v224, v224, v163
v_fmac_f32 v225, v163, v163
v_add_f32 v224, v224, v164
v_fmac_f32 v225, v164, v164
v_add_f32 v224, v224, v165
v_fmac_f32 v225, v165, v165
v_add_f32 v224, v224, v166
v_fmac_f32 v225, v166, v166
v_add_f32 v224, v224, v167
v_fmac_f32 v225, v167, v167
v_add_f32 v224, v224, v192
v_fmac_f32 v225, v192, v192
v_add_f32 v224, v224, v193
v_fmac_f32 v225, v193, v193
v_add_f32 v224, v224, v194
v_fmac_f32 v225, v194, v194
v_add_f32 v224, v224, v195
v_fmac_f32 v225, v195, v195
v_add_f32 v224, v224, v196
v_fmac_f32 v225, v196, v196
v_add_f32 v224, v224, v197
v_fmac_f32 v225, v197, v197
v_add_f32 v224, v224, v198
v_fmac_f32 v225, v198, v198
v_add_f32 v224, v224, v199
v_fmac_f32 v225, v199, v199
s_nop 1
v_add_f32_dpp v224, v224, v224 row_ror:8 row_mask:0xf bank_mask:0xf
v_add_f32_dpp v225, v225, v225 row_ror:8 row_mask:0xf bank_mask:0xf
v_mov_b32 v226, v224
v_mov_b32 v227, v225
s_nop 1
v_permlane16_swap_b32 v224, v226
v_permlane16_swap_b32 v225, v227
s_nop 1
v_add_f32 v224, v224, v226
v_add_f32 v225, v225, v227
v_mov_b32 v226, v224
v_mov_b32 v227, v225
s_nop 1
v_permlane32_swap_b32 v224, v226
v_permlane32_swap_b32 v225, v227
s_nop 1
v_add_f32 v224, v224, v226
v_add_f32 v225, v225, v227
v_and_b32 v10, 7, v6
v_lshlrev_b32 v10, 3, v10
v_add_u32 v10, 163328, v10
s_lshl_b32 s40, s20, 6
v_add_u32 v12, s40, v10
ds_write_b64 v12, v[224:225]
s_waitcnt lgkmcnt(0)
s_barrier
ds_read_b64 v[16:17], v10 offset:0
ds_read_b64 v[18:19], v10 offset:64
ds_read_b64 v[20:21], v10 offset:128
ds_read_b64 v[22:23], v10 offset:192
s_waitcnt lgkmcnt(0)
v_add_f32 v16, v16, v18
v_add_f32 v17, v17, v19
v_add_f32 v16, v16, v20
v_add_f32 v17, v17, v21
v_add_f32 v16, v16, v22
v_add_f32 v17, v17, v23
s_mov_b32 s40, 0x3b124925
s_mov_b32 s41, 0x3727c5ac
v_mul_f32 v16, s40, v16
v_mul_f32 v17, s40, v17
v_fma_f32 v17, -v16, v16, v17
v_max_f32 v17, 0, v17
v_add_f32 v17, s41, v17
v_rsq_f32 v17, v17
s_nop 0
v_sub_f32 v160, v160, v16
v_sub_f32 v161, v161, v16
v_sub_f32 v162, v162, v16
v_sub_f32 v163, v163, v16
v_sub_f32 v164, v164, v16
v_sub_f32 v165, v165, v16
v_sub_f32 v166, v166, v16
v_sub_f32 v167, v167, v16
v_mul_f32 v160, v160, v17
v_mul_f32 v161, v161, v17
v_mul_f32 v162, v162, v17
v_mul_f32 v163, v163, v17
v_mul_f32 v164, v164, v17
v_mul_f32 v165, v165, v17
v_mul_f32 v166, v166, v17
v_mul_f32 v167, v167, v17
v_cvt_pk_bf16_f32 v172, v160, v161
v_cvt_pk_bf16_f32 v173, v162, v163
v_cvt_pk_bf16_f32 v174, v164, v165
v_cvt_pk_bf16_f32 v175, v166, v167
v_sub_f32 v192, v192, v16
v_sub_f32 v193, v193, v16
v_sub_f32 v194, v194, v16
v_sub_f32 v195, v195, v16
v_sub_f32 v196, v196, v16
v_sub_f32 v197, v197, v16
v_sub_f32 v198, v198, v16
v_sub_f32 v199, v199, v16
v_mul_f32 v192, v192, v17
v_mul_f32 v193, v193, v17
v_mul_f32 v194, v194, v17
v_mul_f32 v195, v195, v17
v_mul_f32 v196, v196, v17
v_mul_f32 v197, v197, v17
v_mul_f32 v198, v198, v17
v_mul_f32 v199, v199, v17
v_cvt_pk_bf16_f32 v204, v192, v193
v_cvt_pk_bf16_f32 v205, v194, v195
v_cvt_pk_bf16_f32 v206, v196, v197
v_cvt_pk_bf16_f32 v207, v198, v199
buffer_store_dwordx4 v[172:175], v4, s[52:55], 0 offen sc1
buffer_store_dwordx4 v[204:207], v4, s[52:55], s7 offen sc1
s_mov_b32 s100, s22
s_mov_b32 s101, s21
s_cmp_ge_u32 s101, 14
s_cbranch_scc0 K2_ffn
s_add_u32 s92, s50, 125829120
s_addc_u32 s93, s51, 0
s_mov_b32 s94, 12288
s_mov_b32 s95, 0x20000
s_waitcnt vmcnt(0)
s_barrier
s_add_u32 s90, s100, 16
s_lshl_b32 s90, s90, 7
v_mov_b32 v11, s90
v_mov_b32 v10, 1
s_cmp_lg_u32 s20, 0
s_cbranch_scc1 K2R_pub2
v_cmp_eq_u32 vcc, 0, v1
s_and_saveexec_b64 s[90:91], vcc
buffer_atomic_add v10, v11, s[92:95], 0 offen sc1
s_mov_b64 exec, s[90:91]
K2R_pub2:
s_branch K2_tail
K2_ffn:
s_load_dwordx4 s[40:43], s[0:1], 56
s_load_dwordx2 s[48:49], s[0:1], 96
v_and_b32 v1, 63, v0
v_lshrrev_b32 v2, 6, v0
s_nop 0
v_readfirstlane_b32 s20, v2
s_mov_b32 s6, s100
s_mov_b32 s7, s101
s_lshr_b32 s21, s20, 1
s_and_b32 s22, s20, 1
s_lshl_b32 s28, s20, 12
v_lshrrev_b32 v2, 3, v1
s_movk_i32 s30, 3584
v_mul_lo_u32 v2, v2, s30
v_and_b32 v3, 7, v1
v_lshrrev_b32 v3, 1, v3
v_lshrrev_b32 v4, 4, v1
v_xor_b32 v3, v3, v4
v_lshlrev_b32 v3, 5, v3
v_and_b32 v4, 1, v1
v_lshlrev_b32 v4, 4, v4
v_add3_u32 v2, v2, v3, v4
v_add_u32 v12, 0, v2
v_add_u32 v13, 27648, v2
v_add_u32 v14, 55296, v2
v_add_u32 v15, 82944, v2
v_and_b32 v2, 15, v1
v_lshrrev_b32 v2, 2, v2
v_lshrrev_b32 v3, 4, v1
v_lshl_add_u32 v4, v3, 2, v2
v_lshlrev_b32 v4, 7, v4
v_lshrrev_b32 v2, 1, v2
v_lshl_add_u32 v2, v3, 1, v2
v_and_b32 v2, 3, v2
v_and_b32 v3, 3, v1
v_lshl_add_u32 v4, v3, 3, v4
s_lshl_b32 s30, s22, 13
v_add_u32 v4, s30, v4
v_xor_b32 v3, 0, v2
v_lshl_add_u32 v20, v3, 5, v4
v_xor_b32 v3, 1, v2
v_lshl_add_u32 v21, v3, 5, v4
v_xor_b32 v3, 2, v2
v_lshl_add_u32 v22, v3, 5, v4
v_xor_b32 v3, 3, v2
v_lshl_add_u32 v23, v3, 5, v4
v_lshlrev_b32 v2, 4, v1
s_mul_i32 s30, s20, 28672
v_add_u32 v8, s30, v2
v_mov_b32 v9, v8
v_add_u32 v10, 12288, v8
v_add_u32 v11, 12288, v8
s_lshl_b32 s30, s21, 13
v_add_u32 v16, s30, v2
v_add_u32 v17, 1024, v16
v_mov_b32 v7, v2
s_waitcnt lgkmcnt(0)
s_add_u32 s92, s48, 125829120
s_addc_u32 s93, s49, 0
s_mov_b32 s94, 12288
s_mov_b32 s95, 0x20000
s_mul_i32 s31, s6, 114688
s_add_u32 s33, s31, 79691776
s_add_u32 s8, s48, s33
s_addc_u32 s9, s49, 0
s_sub_u32 s10, 1835008, s31
s_mov_b32 s11, 0x20000
s_cmp_eq_u32 s22, 0
s_cselect_b32 s36, s40, s42
s_cselect_b32 s37, s41, s43
s_lshl_b32 s31, s7, 8
s_lshl_b32 s33, s21, 7
s_add_u32 s31, s31, s33
s_add_u32 s12, s36, s31
s_addc_u32 s13, s37, 0
s_sub_u32 s14, 1605632, s31
s_mov_b32 s15, 0x20000
s_add_u32 s16, s48, 81788928
s_addc_u32 s17, s49, 0
s_mov_b32 s18, 7340032
s_mov_b32 s19, 0x20000
v_add_u32 v2, 65536, v20
v_add_u32 v3, 65536, v21
v_add_u32 v4, 65536, v22
v_add_u32 v5, 65536, v23
v_add_u32 v18, 98304, v16
v_add_u32 v19, 98304, v17
s_lshl_b32 s29, s20, 12
s_add_u32 s29, s29, 98304
s_mov_b32 s23, 0
s_mov_b32 s24, 0
s_waitcnt vmcnt(0)
s_barrier
s_add_u32 s90, s100, 16
s_lshl_b32 s90, s90, 7
v_mov_b32 v25, s90
v_mov_b32 v24, 1
s_cmp_lg_u32 s20, 0
s_cbranch_scc1 K2R_pub
v_cmp_eq_u32 vcc, 0, v7
s_and_saveexec_b64 s[90:91], vcc
buffer_atomic_add v24, v25, s[92:95], 0 offen sc1
s_mov_b64 exec, s[90:91]
K2R_pub:
s_add_u32 m0, s28, 0
s_nop 0
buffer_load_dwordx4 v12, s[12:15], s23 offen offset:0 lds
buffer_load_dwordx4 v13, s[12:15], s23 offen offset:1024 lds
buffer_load_dwordx4 v14, s[12:15], s23 offen offset:2048 lds
buffer_load_dwordx4 v15, s[12:15], s23 offen offset:3072 lds
s_add_u32 s23, s23, 114688
s_add_u32 m0, s28, 16384
s_nop 0
buffer_load_dwordx4 v12, s[12:15], s23 offen offset:0 lds
buffer_load_dwordx4 v13, s[12:15], s23 offen offset:1024 lds
buffer_load_dwordx4 v14, s[12:15], s23 offen offset:2048 lds
buffer_load_dwordx4 v15, s[12:15], s23 offen offset:3072 lds
s_add_u32 s23, s23, 114688
s_add_u32 m0, s28, 32768
s_nop 0
buffer_load_dwordx4 v12, s[12:15], s23 offen offset:0 lds
buffer_load_dwordx4 v13, s[12:15], s23 offen offset:1024 lds
buffer_load_dwordx4 v14, s[12:15], s23 offen offset:2048 lds
buffer_load_dwordx4 v15, s[12:15], s23 offen offset:3072 lds
s_add_u32 s23, s23, 114688
s_add_u32 m0, s28, 49152
s_nop 0
buffer_load_dwordx4 v12, s[12:15], s23 offen offset:0 lds
buffer_load_dwordx4 v13, s[12:15], s23 offen offset:1024 lds
buffer_load_dwordx4 v14, s[12:15], s23 offen offset:2048 lds
buffer_load_dwordx4 v15, s[12:15], s23 offen offset:3072 lds
s_add_u32 s23, s23, 114688
s_add_u32 m0, s28, 65536
s_nop 0
buffer_load_dwordx4 v12, s[12:15], s23 offen offset:0 lds
buffer_load_dwordx4 v13, s[12:15], s23 offen offset:1024 lds
buffer_load_dwordx4 v14, s[12:15], s23 offen offset:2048 lds
buffer_load_dwordx4 v15, s[12:15], s23 offen offset:3072 lds
s_add_u32 s23, s23, 114688
s_add_u32 m0, s28, 81920
s_nop 0
buffer_load_dwordx4 v12, s[12:15], s23 offen offset:0 lds
buffer_load_dwordx4 v13, s[12:15], s23 offen offset:1024 lds
buffer_load_dwordx4 v14, s[12:15], s23 offen offset:2048 lds
buffer_load_dwordx4 v15, s[12:15], s23 offen offset:3072 lds
s_add_u32 s23, s23, 114688
v_mov_b32 v128, 0
v_mov_b32 v129, 0
v_mov_b32 v130, 0
v_mov_b32 v131, 0
v_mov_b32 v132, 0
v_mov_b32 v133, 0
v_mov_b32 v134, 0
v_mov_b32 v135, 0
v_mov_b32 v136, 0
v_mov_b32 v137, 0
v_mov_b32 v138, 0
v_mov_b32 v139, 0
v_mov_b32 v140, 0
v_mov_b32 v141, 0
v_mov_b32 v142, 0
v_mov_b32 v143, 0
v_mov_b32 v144, 0
v_mov_b32 v145, 0
v_mov_b32 v146, 0
v_mov_b32 v147, 0
v_mov_b32 v148, 0
v_mov_b32 v149, 0
v_mov_b32 v150, 0
v_mov_b32 v151, 0
v_mov_b32 v152, 0
v_mov_b32 v153, 0
v_mov_b32 v154, 0
v_mov_b32 v155, 0
v_mov_b32 v156, 0
v_mov_b32 v157, 0
v_mov_b32 v158, 0
v_mov_b32 v159, 0
v_mov_b32 v160, 0
v_mov_b32 v161, 0
v_mov_b32 v162, 0
v_mov_b32 v163, 0
v_mov_b32 v164, 0
v_mov_b32 v165, 0
v_mov_b32 v166, 0
v_mov_b32 v167, 0
v_mov_b32 v168, 0
v_mov_b32 v169, 0
v_mov_b32 v170, 0
v_mov_b32 v171, 0
v_mov_b32 v172, 0
v_mov_b32 v173, 0
v_mov_b32 v174, 0
v_mov_b32 v175, 0
v_mov_b32 v176, 0
v_mov_b32 v177, 0
v_mov_b32 v178, 0
v_mov_b32 v179, 0
v_mov_b32 v180, 0
v_mov_b32 v181, 0
v_mov_b32 v182, 0
v_mov_b32 v183, 0
v_mov_b32 v184, 0
v_mov_b32 v185, 0
v_mov_b32 v186, 0
v_mov_b32 v187, 0
v_mov_b32 v188, 0
v_mov_b32 v189, 0
v_mov_b32 v190, 0
v_mov_b32 v191, 0
v_mov_b32 v192, 0
v_mov_b32 v193, 0
v_mov_b32 v194, 0
v_mov_b32 v195, 0
v_mov_b32 v196, 0
v_mov_b32 v197, 0
v_mov_b32 v198, 0
v_mov_b32 v199, 0
v_mov_b32 v200, 0
v_mov_b32 v201, 0
v_mov_b32 v202, 0
v_mov_b32 v203, 0
v_mov_b32 v204, 0
v_mov_b32 v205, 0
v_mov_b32 v206, 0
v_mov_b32 v207, 0
v_mov_b32 v208, 0
v_mov_b32 v209, 0
v_mov_b32 v210, 0
v_mov_b32 v211, 0
v_mov_b32 v212, 0
v_mov_b32 v213, 0
v_mov_b32 v214, 0
v_mov_b32 v215, 0
v_mov_b32 v216, 0
v_mov_b32 v217, 0
v_mov_b32 v218, 0
v_mov_b32 v219, 0
v_mov_b32 v220, 0
v_mov_b32 v221, 0
v_mov_b32 v222, 0
v_mov_b32 v223, 0
v_mov_b32 v224, 0
v_mov_b32 v225, 0
v_mov_b32 v226, 0
v_mov_b32 v227, 0
v_mov_b32 v228, 0
v_mov_b32 v229, 0
v_mov_b32 v230, 0
v_mov_b32 v231, 0
v_mov_b32 v232, 0
v_mov_b32 v233, 0
v_mov_b32 v234, 0
v_mov_b32 v235, 0
v_mov_b32 v236, 0
v_mov_b32 v237, 0
v_mov_b32 v238, 0
v_mov_b32 v239, 0
v_mov_b32 v240, 0
v_mov_b32 v241, 0
v_mov_b32 v242, 0
v_mov_b32 v243, 0
v_mov_b32 v244, 0
v_mov_b32 v245, 0
v_mov_b32 v246, 0
v_mov_b32 v247, 0
v_mov_b32 v248, 0
v_mov_b32 v249, 0
v_mov_b32 v250, 0
v_mov_b32 v251, 0
v_mov_b32 v252, 0
v_mov_b32 v253, 0
v_mov_b32 v254, 0
v_mov_b32 v255, 0
s_cmp_lg_u32 s20, 0
s_cbranch_scc1 K2G_w_got
s_add_u32 s90, s100, 16
s_lshl_b32 s90, s90, 7
v_mov_b32 v25, s90
s_mov_b32 s91, 0
K2G_w_spin:
buffer_load_dword v24, v25, s[92:95], 0 offen sc1
s_waitcnt vmcnt(0)
v_readfirstlane_b32 s90, v24
s_nop 3
s_cmp_ge_u32 s90, 16
s_cbranch_scc1 K2G_w_got
s_add_u32 s91, s91, 1
s_cmp_lt_u32 s91, 0x40000
s_cbranch_scc0 K2G_w_got
s_sleep 2
s_branch K2G_w_spin
K2G_w_got:
s_barrier
s_add_u32 m0, s29, 0
s_nop 0
buffer_load_dwordx4 v8, s[8:11], s24 offen offset:0 sc1 lds
buffer_load_dwordx4 v9, s[8:11], s24 offen offset:1024 sc1 lds
s_add_u32 m0, s29, 0
s_nop 0
buffer_load_dwordx4 v10, s[8:11], s24 offen offset:2048 sc1 lds
buffer_load_dwordx4 v11, s[8:11], s24 offen offset:3072 sc1 lds
s_add_u32 s24, s24, 2048
s_add_u32 m0, s29, 16384
s_nop 0
buffer_load_dwordx4 v8, s[8:11], s24 offen offset:0 sc1 lds
buffer_load_dwordx4 v9, s[8:11], s24 offen offset:1024 sc1 lds
s_add_u32 m0, s29, 16384
s_nop 0
buffer_load_dwordx4 v10, s[8:11], s24 offen offset:2048 sc1 lds
buffer_load_dwordx4 v11, s[8:11], s24 offen offset:3072 sc1 lds
s_add_u32 s24, s24, 2048
s_add_u32 m0, s29, 32768
s_nop 0
buffer_load_dwordx4 v8, s[8:11], s24 offen offset:0 sc1 lds
buffer_load_dwordx4 v9, s[8:11], s24 offen offset:1024 sc1 lds
s_add_u32 m0, s29, 32768
s_nop 0
buffer_load_dwordx4 v10, s[8:11], s24 offen offset:2048 sc1 lds
buffer_load_dwordx4 v11, s[8:11], s24 offen offset:3072 sc1 lds
s_add_u32 s24, s24, 2048
s_add_u32 m0, s29, 49152
s_nop 0
buffer_load_dwordx4 v8, s[8:11], s24 offen offset:0 sc1 lds
buffer_load_dwordx4 v9, s[8:11], s24 offen offset:1024 sc1 lds
s_waitcnt vmcnt(10)
s_barrier
ds_read_b128 v[32:35], v18 offset:0
ds_read_b64_tr_b16 v[48:49], v20 offset:0
ds_read_b64_tr_b16 v[50:51], v20 offset:2048
ds_read_b64_tr_b16 v[52:53], v21 offset:0
ds_read_b64_tr_b16 v[54:55], v21 offset:2048
ds_read_b64_tr_b16 v[56:57], v22 offset:0
ds_read_b64_tr_b16 v[58:59], v22 offset:2048
ds_read_b64_tr_b16 v[60:61], v23 offset:0
ds_read_b64_tr_b16 v[62:63], v23 offset:2048
ds_read_b64_tr_b16 v[64:65], v20 offset:4096
ds_read_b64_tr_b16 v[66:67], v20 offset:6144
ds_read_b64_tr_b16 v[68:69], v21 offset:4096
ds_read_b64_tr_b16 v[70:71], v21 offset:6144
ds_read_b64_tr_b16 v[72:73], v22 offset:4096
ds_read_b64_tr_b16 v[74:75], v22 offset:6144
ds_read_b64_tr_b16 v[76:77], v23 offset:4096
ds_read_b64_tr_b16 v[78:79], v23 offset:6144
ds_read_b128 v[36:39], v18 offset:2048
ds_read_b128 v[40:43], v18 offset:4096
ds_read_b128 v[44:47], v18 offset:6144
s_waitcnt vmcnt(10) lgkmcnt(0)
s_barrier
v_mfma_f32_16x16x32_bf16 v[128:131], v[48:51], v[32:35], v[128:131]
s_add_u32 m0, s28, 0
ds_read_b128 v[80:83], v19 offset:0
s_nop 0
v_mfma_f32_16x16x32_bf16 v[132:135], v[52:55], v[32:35], v[132:135]
ds_read_b64_tr_b16 v[96:97], v20 offset:16384
v_mfma_f32_16x16x32_bf16 v[136:139], v[56:59], v[32:35], v[136:139]
ds_read_b64_tr_b16 v[98:99], v20 offset:18432
v_mfma_f32_16x16x32_bf16 v[140:143], v[60:63], v[32:35], v[140:143]
buffer_load_dwordx4 v12, s[12:15], s23 offen offset:0 lds
v_mfma_f32_16x16x32_bf16 v[144:147], v[64:67], v[32:35], v[144:147]
ds_read_b64_tr_b16 v[100:101], v21 offset:16384
v_mfma_f32_16x16x32_bf16 v[148:151], v[68:71], v[32:35], v[148:151]
ds_read_b64_tr_b16 v[102:103], v21 offset:18432
v_mfma_f32_16x16x32_bf16 v[152:155], v[72:75], v[32:35], v[152:155]
ds_read_b64_tr_b16 v[104:105], v22 offset:16384
v_mfma_f32_16x16x32_bf16 v[156:159], v[76:79], v[32:35], v[156:159]
ds_read_b64_tr_b16 v[106:107], v22 offset:18432
v_mfma_f32_16x16x32_bf16 v[160:163], v[48:51], v[36:39], v[160:163]
buffer_load_dwordx4 v13, s[12:15], s23 offen offset:1024 lds
v_mfma_f32_16x16x32_bf16 v[164:167], v[52:55], v[36:39], v[164:167]
ds_read_b64_tr_b16 v[108:109], v23 offset:16384
v_mfma_f32_16x16x32_bf16 v[168:171], v[56:59], v[36:39], v[168:171]
ds_read_b64_tr_b16 v[110:111], v23 offset:18432
v_mfma_f32_16x16x32_bf16 v[172:175], v[60:63], v[36:39], v[172:175]
ds_read_b64_tr_b16 v[112:113], v20 offset:20480
v_mfma_f32_16x16x32_bf16 v[176:179], v[64:67], v[36:39], v[176:179]
buffer_load_dwordx4 v14, s[12:15], s23 offen offset:2048 lds
v_mfma_f32_16x16x32_bf16 v[180:183], v[68:71], v[36:39], v[180:183]
ds_read_b64_tr_b16 v[114:115], v20 offset:22528
v_mfma_f32_16x16x32_bf16 v[184:187], v[72:75], v[36:39], v[184:187]
ds_read_b64_tr_b16 v[116:117], v21 offset:20480
v_mfma_f32_16x16x32_bf16 v[188:191], v[76:79], v[36:39], v[188:191]
ds_read_b64_tr_b16 v[118:119], v21 offset:22528
v_mfma_f32_16x16x32_bf16 v[192:195], v[48:51], v[40:43], v[192:195]
ds_read_b64_tr_b16 v[120:121], v22 offset:20480
buffer_load_dwordx4 v15, s[12:15], s23 offen offset:3072 lds
v_mfma_f32_16x16x32_bf16 v[196:199], v[52:55], v[40:43], v[196:199]
s_add_u32 s23, s23, 114688
ds_read_b64_tr_b16 v[122:123], v22 offset:22528
s_add_u32 m0, s29, 49152
v_mfma_f32_16x16x32_bf16 v[200:203], v[56:59], v[40:43], v[200:203]
s_nop 0
ds_read_b64_tr_b16 v[124:125], v23 offset:20480
v_mfma_f32_16x16x32_bf16 v[204:207], v[60:63], v[40:43], v[204:207]
ds_read_b64_tr_b16 v[126:127], v23 offset:22528
v_mfma_f32_16x16x32_bf16 v[208:211], v[64:67], v[40:43], v[208:211]
ds_read_b128 v[84:87], v19 offset:2048
buffer_load_dwordx4 v10, s[8:11], s24 offen offset:2048 sc1 lds
v_mfma_f32_16x16x32_bf16 v[212:215], v[68:71], v[40:43], v[212:215]
ds_read_b128 v[88:91], v19 offset:4096
v_mfma_f32_16x16x32_bf16 v[216:219], v[72:75], v[40:43], v[216:219]
ds_read_b128 v[92:95], v19 offset:6144
v_mfma_f32_16x16x32_bf16 v[220:223], v[76:79], v[40:43], v[220:223]
buffer_load_dwordx4 v11, s[8:11], s24 offen offset:3072 sc1 lds
v_mfma_f32_16x16x32_bf16 v[224:227], v[48:51], v[44:47], v[224:227]
s_add_u32 s24, s24, 2048
v_mfma_f32_16x16x32_bf16 v[228:231], v[52:55], v[44:47], v[228:231]
v_mfma_f32_16x16x32_bf16 v[232:235], v[56:59], v[44:47], v[232:235]
v_mfma_f32_16x16x32_bf16 v[236:239], v[60:63], v[44:47], v[236:239]
s_waitcnt vmcnt(12) lgkmcnt(0)
v_mfma_f32_16x16x32_bf16 v[240:243], v[64:67], v[44:47], v[240:243]
s_barrier
v_mfma_f32_16x16x32_bf16 v[244:247], v[68:71], v[44:47], v[244:247]
v_mfma_f32_16x16x32_bf16 v[248:251], v[72:75], v[44:47], v[248:251]
v_mfma_f32_16x16x32_bf16 v[252:255], v[76:79], v[44:47], v[252:255]
v_mfma_f32_16x16x32_bf16 v[128:131], v[96:99], v[80:83], v[128:131]
s_add_u32 m0, s28, 16384
ds_read_b128 v[32:35], v18 offset:16384
s_nop 0
v_mfma_f32_16x16x32_bf16 v[132:135], v[100:103], v[80:83], v[132:135]
ds_read_b64_tr_b16 v[48:49], v20 offset:32768
v_mfma_f32_16x16x32_bf16 v[136:139], v[104:107], v[80:83], v[136:139]
ds_read_b64_tr_b16 v[50:51], v20 offset:34816
v_mfma_f32_16x16x32_bf16 v[140:143], v[108:111], v[80:83], v[140:143]
buffer_load_dwordx4 v12, s[12:15], s23 offen offset:0 lds
v_mfma_f32_16x16x32_bf16 v[144:147], v[112:115], v[80:83], v[144:147]
ds_read_b64_tr_b16 v[52:53], v21 offset:32768
v_mfma_f32_16x16x32_bf16 v[148:151], v[116:119], v[80:83], v[148:151]
ds_read_b64_tr_b16 v[54:55], v21 offset:34816
v_mfma_f32_16x16x32_bf16 v[152:155], v[120:123], v[80:83], v[152:155]
ds_read_b64_tr_b16 v[56:57], v22 offset:32768
v_mfma_f32_16x16x32_bf16 v[156:159], v[124:127], v[80:83], v[156:159]
ds_read_b64_tr_b16 v[58:59], v22 offset:34816
v_mfma_f32_16x16x32_bf16 v[160:163], v[96:99], v[84:87], v[160:163]
buffer_load_dwordx4 v13, s[12:15], s23 offen offset:1024 lds
v_mfma_f32_16x16x32_bf16 v[164:167], v[100:103], v[84:87], v[164:167]
ds_read_b64_tr_b16 v[60:61], v23 offset:32768
v_mfma_f32_16x16x32_bf16 v[168:171], v[104:107], v[84:87], v[168:171]
ds_read_b64_tr_b16 v[62:63], v23 offset:34816
v_mfma_f32_16x16x32_bf16 v[172:175], v[108:111], v[84:87], v[172:175]
ds_read_b64_tr_b16 v[64:65], v20 offset:36864
v_mfma_f32_16x16x32_bf16 v[176:179], v[112:115], v[84:87], v[176:179]
buffer_load_dwordx4 v14, s[12:15], s23 offen offset:2048 lds
v_mfma_f32_16x16x32_bf16 v[180:183], v[116:119], v[84:87], v[180:183]
ds_read_b64_tr_b16 v[66:67], v20 offset:38912
v_mfma_f32_16x16x32_bf16 v[184:187], v[120:123], v[84:87], v[184:187]
ds_read_b64_tr_b16 v[68:69], v21 offset:36864
v_mfma_f32_16x16x32_bf16 v[188:191], v[124:127], v[84:87], v[188:191]
ds_read_b64_tr_b16 v[70:71], v21 offset:38912
v_mfma_f32_16x16x32_bf16 v[192:195], v[96:99], v[88:91], v[192:195]
ds_read_b64_tr_b16 v[72:73], v22 offset:36864
buffer_load_dwordx4 v15, s[12:15], s23 offen offset:3072 lds
v_mfma_f32_16x16x32_bf16 v[196:199], v[100:103], v[88:91], v[196:199]
s_add_u32 s23, s23, 114688
ds_read_b64_tr_b16 v[74:75], v22 offset:38912
s_add_u32 m0, s29, 0
v_mfma_f32_16x16x32_bf16 v[200:203], v[104:107], v[88:91], v[200:203]
s_nop 0
ds_read_b64_tr_b16 v[76:77], v23 offset:36864
v_mfma_f32_16x16x32_bf16 v[204:207], v[108:111], v[88:91], v[204:207]
ds_read_b64_tr_b16 v[78:79], v23 offset:38912
v_mfma_f32_16x16x32_bf16 v[208:211], v[112:115], v[88:91], v[208:211]
ds_read_b128 v[36:39], v18 offset:18432
buffer_load_dwordx4 v8, s[8:11], s24 offen offset:0 sc1 lds
v_mfma_f32_16x16x32_bf16 v[212:215], v[116:119], v[88:91], v[212:215]
ds_read_b128 v[40:43], v18 offset:20480
v_mfma_f32_16x16x32_bf16 v[216:219], v[120:123], v[88:91], v[216:219]
ds_read_b128 v[44:47], v18 offset:22528
v_mfma_f32_16x16x32_bf16 v[220:223], v[124:127], v[88:91], v[220:223]
buffer_load_dwordx4 v9, s[8:11], s24 offen offset:1024 sc1 lds
v_mfma_f32_16x16x32_bf16 v[224:227], v[96:99], v[92:95], v[224:227]
v_mfma_f32_16x16x32_bf16 v[228:231], v[100:103], v[92:95], v[228:231]
v_mfma_f32_16x16x32_bf16 v[232:235], v[104:107], v[92:95], v[232:235]
v_mfma_f32_16x16x32_bf16 v[236:239], v[108:111], v[92:95], v[236:239]
s_waitcnt vmcnt(18) lgkmcnt(0)
v_mfma_f32_16x16x32_bf16 v[240:243], v[112:115], v[92:95], v[240:243]
s_barrier
v_mfma_f32_16x16x32_bf16 v[244:247], v[116:119], v[92:95], v[244:247]
v_mfma_f32_16x16x32_bf16 v[248:251], v[120:123], v[92:95], v[248:251]
v_mfma_f32_16x16x32_bf16 v[252:255], v[124:127], v[92:95], v[252:255]
v_mfma_f32_16x16x32_bf16 v[128:131], v[48:51], v[32:35], v[128:131]
s_add_u32 m0, s28, 32768
ds_read_b128 v[80:83], v19 offset:16384
s_nop 0
v_mfma_f32_16x16x32_bf16 v[132:135], v[52:55], v[32:35], v[132:135]
ds_read_b64_tr_b16 v[96:97], v20 offset:49152
v_mfma_f32_16x16x32_bf16 v[136:139], v[56:59], v[32:35], v[136:139]
ds_read_b64_tr_b16 v[98:99], v20 offset:51200
v_mfma_f32_16x16x32_bf16 v[140:143], v[60:63], v[32:35], v[140:143]
buffer_load_dwordx4 v12, s[12:15], s23 offen offset:0 lds
v_mfma_f32_16x16x32_bf16 v[144:147], v[64:67], v[32:35], v[144:147]
ds_read_b64_tr_b16 v[100:101], v21 offset:49152
v_mfma_f32_16x16x32_bf16 v[148:151], v[68:71], v[32:35], v[148:151]
ds_read_b64_tr_b16 v[102:103], v21 offset:51200
v_mfma_f32_16x16x32_bf16 v[152:155], v[72:75], v[32:35], v[152:155]
ds_read_b64_tr_b16 v[104:105], v22 offset:49152
v_mfma_f32_16x16x32_bf16 v[156:159], v[76:79], v[32:35], v[156:159]
ds_read_b64_tr_b16 v[106:107], v22 offset:51200
v_mfma_f32_16x16x32_bf16 v[160:163], v[48:51], v[36:39], v[160:163]
buffer_load_dwordx4 v13, s[12:15], s23 offen offset:1024 lds
v_mfma_f32_16x16x32_bf16 v[164:167], v[52:55], v[36:39], v[164:167]
ds_read_b64_tr_b16 v[108:109], v23 offset:49152
v_mfma_f32_16x16x32_bf16 v[168:171], v[56:59], v[36:39], v[168:171]
ds_read_b64_tr_b16 v[110:111], v23 offset:51200
v_mfma_f32_16x16x32_bf16 v[172:175], v[60:63], v[36:39], v[172:175]
ds_read_b64_tr_b16 v[112:113], v20 offset:53248
v_mfma_f32_16x16x32_bf16 v[176:179], v[64:67], v[36:39], v[176:179]
buffer_load_dwordx4 v14, s[12:15], s23 offen offset:2048 lds
v_mfma_f32_16x16x32_bf16 v[180:183], v[68:71], v[36:39], v[180:183]
ds_read_b64_tr_b16 v[114:115], v20 offset:55296
v_mfma_f32_16x16x32_bf16 v[184:187], v[72:75], v[36:39], v[184:187]
ds_read_b64_tr_b16 v[116:117], v21 offset:53248
v_mfma_f32_16x16x32_bf16 v[188:191], v[76:79], v[36:39], v[188:191]
ds_read_b64_tr_b16 v[118:119], v21 offset:55296
v_mfma_f32_16x16x32_bf16 v[192:195], v[48:51], v[40:43], v[192:195]
ds_read_b64_tr_b16 v[120:121], v22 offset:53248
buffer_load_dwordx4 v15, s[12:15], s23 offen offset:3072 lds
v_mfma_f32_16x16x32_bf16 v[196:199], v[52:55], v[40:43], v[196:199]
s_add_u32 s23, s23, 114688
ds_read_b64_tr_b16 v[122:123], v22 offset:55296
s_add_u32 m0, s29, 0
v_mfma_f32_16x16x32_bf16 v[200:203], v[56:59], v[40:43], v[200:203]
s_nop 0
ds_read_b64_tr_b16 v[124:125], v23 offset:53248
v_mfma_f32_16x16x32_bf16 v[204:207], v[60:63], v[40:43], v[204:207]
ds_read_b64_tr_b16 v[126:127], v23 offset:55296
v_mfma_f32_16x16x32_bf16 v[208:211], v[64:67], v[40:43], v[208:211]
ds_read_b128 v[84:87], v19 offset:18432
buffer_load_dwordx4 v10, s[8:11], s24 offen offset:2048 sc1 lds
v_mfma_f32_16x16x32_bf16 v[212:215], v[68:71], v[40:43], v[212:215]
ds_read_b128 v[88:91], v19 offset:20480
v_mfma_f32_16x16x32_bf16 v[216:219], v[72:75], v[40:43], v[216:219]
ds_read_b128 v[92:95], v19 offset:22528
v_mfma_f32_16x16x32_bf16 v[220:223], v[76:79], v[40:43], v[220:223]
buffer_load_dwordx4 v11, s[8:11], s24 offen offset:3072 sc1 lds
v_mfma_f32_16x16x32_bf16 v[224:227], v[48:51], v[44:47], v[224:227]
s_add_u32 s24, s24, 2048
v_mfma_f32_16x16x32_bf16 v[228:231], v[52:55], v[44:47], v[228:231]
v_mfma_f32_16x16x32_bf16 v[232:235], v[56:59], v[44:47], v[232:235]
v_mfma_f32_16x16x32_bf16 v[236:239], v[60:63], v[44:47], v[236:239]
s_waitcnt vmcnt(20) lgkmcnt(0)
v_mfma_f32_16x16x32_bf16 v[240:243], v[64:67], v[44:47], v[240:243]
s_barrier
v_mfma_f32_16x16x32_bf16 v[244:247], v[68:71], v[44:47], v[244:247]
v_mfma_f32_16x16x32_bf16 v[248:251], v[72:75], v[44:47], v[248:251]
v_mfma_f32_16x16x32_bf16 v[252:255], v[76:79], v[44:47], v[252:255]
v_mfma_f32_16x16x32_bf16 v[128:131], v[96:99], v[80:83], v[128:131]
s_add_u32 m0, s28, 49152
ds_read_b128 v[32:35], v18 offset:32768
s_nop 0
v_mfma_f32_16x16x32_bf16 v[132:135], v[100:103], v[80:83], v[132:135]
ds_read_b64_tr_b16 v[48:49], v2 offset:0
v_mfma_f32_16x16x32_bf16 v[136:139], v[104:107], v[80:83], v[136:139]
ds_read_b64_tr_b16 v[50:51], v2 offset:2048
v_mfma_f32_16x16x32_bf16 v[140:143], v[108:111], v[80:83], v[140:143]
buffer_load_dwordx4 v12, s[12:15], s23 offen offset:0 lds
v_mfma_f32_16x16x32_bf16 v[144:147], v[112:115], v[80:83], v[144:147]
ds_read_b64_tr_b16 v[52:53], v3 offset:0
v_mfma_f32_16x16x32_bf16 v[148:151], v[116:119], v[80:83], v[148:151]
ds_read_b64_tr_b16 v[54:55], v3 offset:2048
v_mfma_f32_16x16x32_bf16 v[152:155], v[120:123], v[80:83], v[152:155]
ds_read_b64_tr_b16 v[56:57], v4 offset:0
v_mfma_f32_16x16x32_bf16 v[156:159], v[124:127], v[80:83], v[156:159]
ds_read_b64_tr_b16 v[58:59], v4 offset:2048
v_mfma_f32_16x16x32_bf16 v[160:163], v[96:99], v[84:87], v[160:163]
buffer_load_dwordx4 v13, s[12:15], s23 offen offset:1024 lds
v_mfma_f32_16x16x32_bf16 v[164:167], v[100:103], v[84:87], v[164:167]
ds_read_b64_tr_b16 v[60:61], v5 offset:0
v_mfma_f32_16x16x32_bf16 v[168:171], v[104:107], v[84:87], v[168:171]
ds_read_b64_tr_b16 v[62:63], v5 offset:2048
v_mfma_f32_16x16x32_bf16 v[172:175], v[108:111], v[84:87], v[172:175]
ds_read_b64_tr_b16 v[64:65], v2 offset:4096
v_mfma_f32_16x16x32_bf16 v[176:179], v[112:115], v[84:87], v[176:179]
buffer_load_dwordx4 v14, s[12:15], s23 offen offset:2048 lds
v_mfma_f32_16x16x32_bf16 v[180:183], v[116:119], v[84:87], v[180:183]
ds_read_b64_tr_b16 v[66:67], v2 offset:6144
v_mfma_f32_16x16x32_bf16 v[184:187], v[120:123], v[84:87], v[184:187]
ds_read_b64_tr_b16 v[68:69], v3 offset:4096
v_mfma_f32_16x16x32_bf16 v[188:191], v[124:127], v[84:87], v[188:191]
ds_read_b64_tr_b16 v[70:71], v3 offset:6144
v_mfma_f32_16x16x32_bf16 v[192:195], v[96:99], v[88:91], v[192:195]
ds_read_b64_tr_b16 v[72:73], v4 offset:4096
buffer_load_dwordx4 v15, s[12:15], s23 offen offset:3072 lds
v_mfma_f32_16x16x32_bf16 v[196:199], v[100:103], v[88:91], v[196:199]
s_add_u32 s23, s23, 114688
ds_read_b64_tr_b16 v[74:75], v4 offset:6144
s_add_u32 m0, s29, 16384
v_mfma_f32_16x16x32_bf16 v[200:203], v[104:107], v[88:91], v[200:203]
s_nop 0
ds_read_b64_tr_b16 v[76:77], v5 offset:4096
v_mfma_f32_16x16x32_bf16 v[204:207], v[108:111], v[88:91], v[204:207]
ds_read_b64_tr_b16 v[78:79], v5 offset:6144
v_mfma_f32_16x16x32_bf16 v[208:211], v[112:115], v[88:91], v[208:211]
ds_read_b128 v[36:39], v18 offset:34816
buffer_load_dwordx4 v8, s[8:11], s24 offen offset:0 sc1 lds
v_mfma_f32_16x16x32_bf16 v[212:215], v[116:119], v[88:91], v[212:215]
ds_read_b128 v[40:43], v18 offset:36864
v_mfma_f32_16x16x32_bf16 v[216:219], v[120:123], v[88:91], v[216:219]
ds_read_b128 v[44:47], v18 offset:38912
v_mfma_f32_16x16x32_bf16 v[220:223], v[124:127], v[88:91], v[220:223]
buffer_load_dwordx4 v9, s[8:11], s24 offen offset:1024 sc1 lds
v_mfma_f32_16x16x32_bf16 v[224:227], v[96:99], v[92:95], v[224:227]
v_mfma_f32_16x16x32_bf16 v[228:231], v[100:103], v[92:95], v[228:231]
v_mfma_f32_16x16x32_bf16 v[232:235], v[104:107], v[92:95], v[232:235]
v_mfma_f32_16x16x32_bf16 v[236:239], v[108:111], v[92:95], v[236:239]
s_waitcnt vmcnt(26) lgkmcnt(0)
v_mfma_f32_16x16x32_bf16 v[240:243], v[112:115], v[92:95], v[240:243]
s_barrier
v_mfma_f32_16x16x32_bf16 v[244:247], v[116:119], v[92:95], v[244:247]
v_mfma_f32_16x16x32_bf16 v[248:251], v[120:123], v[92:95], v[248:251]
v_mfma_f32_16x16x32_bf16 v[252:255], v[124:127], v[92:95], v[252:255]
v_mfma_f32_16x16x32_bf16 v[128:131], v[48:51], v[32:35], v[128:131]
s_add_u32 m0, s28, 65536
ds_read_b128 v[80:83], v19 offset:32768
s_nop 0
v_mfma_f32_16x16x32_bf16 v[132:135], v[52:55], v[32:35], v[132:135]
ds_read_b64_tr_b16 v[96:97], v2 offset:16384
v_mfma_f32_16x16x32_bf16 v[136:139], v[56:59], v[32:35], v[136:139]
ds_read_b64_tr_b16 v[98:99], v2 offset:18432
v_mfma_f32_16x16x32_bf16 v[140:143], v[60:63], v[32:35], v[140:143]
buffer_load_dwordx4 v12, s[12:15], s23 offen offset:0 lds
v_mfma_f32_16x16x32_bf16 v[144:147], v[64:67], v[32:35], v[144:147]
ds_read_b64_tr_b16 v[100:101], v3 offset:16384
v_mfma_f32_16x16x32_bf16 v[148:151], v[68:71], v[32:35], v[148:151]
ds_read_b64_tr_b16 v[102:103], v3 offset:18432
v_mfma_f32_16x16x32_bf16 v[152:155], v[72:75], v[32:35], v[152:155]
ds_read_b64_tr_b16 v[104:105], v4 offset:16384
v_mfma_f32_16x16x32_bf16 v[156:159], v[76:79], v[32:35], v[156:159]
ds_read_b64_tr_b16 v[106:107], v4 offset:18432
v_mfma_f32_16x16x32_bf16 v[160:163], v[48:51], v[36:39], v[160:163]
buffer_load_dwordx4 v13, s[12:15], s23 offen offset:1024 lds
v_mfma_f32_16x16x32_bf16 v[164:167], v[52:55], v[36:39], v[164:167]
ds_read_b64_tr_b16 v[108:109], v5 offset:16384
v_mfma_f32_16x16x32_bf16 v[168:171], v[56:59], v[36:39], v[168:171]
ds_read_b64_tr_b16 v[110:111], v5 offset:18432
v_mfma_f32_16x16x32_bf16 v[172:175], v[60:63], v[36:39], v[172:175]
ds_read_b64_tr_b16 v[112:113], v2 offset:20480
v_mfma_f32_16x16x32_bf16 v[176:179], v[64:67], v[36:39], v[176:179]
buffer_load_dwordx4 v14, s[12:15], s23 offen offset:2048 lds
v_mfma_f32_16x16x32_bf16 v[180:183], v[68:71], v[36:39], v[180:183]
ds_read_b64_tr_b16 v[114:115], v2 offset:22528
v_mfma_f32_16x16x32_bf16 v[184:187], v[72:75], v[36:39], v[184:187]
ds_read_b64_tr_b16 v[116:117], v3 offset:20480
v_mfma_f32_16x16x32_bf16 v[188:191], v[76:79], v[36:39], v[188:191]
ds_read_b64_tr_b16 v[118:119], v3 offset:22528
v_mfma_f32_16x16x32_bf16 v[192:195], v[48:51], v[40:43], v[192:195]
ds_read_b64_tr_b16 v[120:121], v4 offset:20480
buffer_load_dwordx4 v15, s[12:15], s23 offen offset:3072 lds
v_mfma_f32_16x16x32_bf16 v[196:199], v[52:55], v[40:43], v[196:199]
s_add_u32 s23, s23, 114688
ds_read_b64_tr_b16 v[122:123], v4 offset:22528
s_add_u32 m0, s29, 16384
v_mfma_f32_16x16x32_bf16 v[200:203], v[56:59], v[40:43], v[200:203]
s_nop 0
ds_read_b64_tr_b16 v[124:125], v5 offset:20480
v_mfma_f32_16x16x32_bf16 v[204:207], v[60:63], v[40:43], v[204:207]
ds_read_b64_tr_b16 v[126:127], v5 offset:22528
v_mfma_f32_16x16x32_bf16 v[208:211], v[64:67], v[40:43], v[208:211]
ds_read_b128 v[84:87], v19 offset:34816
buffer_load_dwordx4 v10, s[8:11], s24 offen offset:2048 sc1 lds
v_mfma_f32_16x16x32_bf16 v[212:215], v[68:71], v[40:43], v[212:215]
ds_read_b128 v[88:91], v19 offset:36864
v_mfma_f32_16x16x32_bf16 v[216:219], v[72:75], v[40:43], v[216:219]
ds_read_b128 v[92:95], v19 offset:38912
v_mfma_f32_16x16x32_bf16 v[220:223], v[76:79], v[40:43], v[220:223]
buffer_load_dwordx4 v11, s[8:11], s24 offen offset:3072 sc1 lds
v_mfma_f32_16x16x32_bf16 v[224:227], v[48:51], v[44:47], v[224:227]
s_add_u32 s24, s24, 2048
v_mfma_f32_16x16x32_bf16 v[228:231], v[52:55], v[44:47], v[228:231]
v_mfma_f32_16x16x32_bf16 v[232:235], v[56:59], v[44:47], v[232:235]
v_mfma_f32_16x16x32_bf16 v[236:239], v[60:63], v[44:47], v[236:239]
s_waitcnt vmcnt(24) lgkmcnt(0)
v_mfma_f32_16x16x32_bf16 v[240:243], v[64:67], v[44:47], v[240:243]
s_barrier
v_mfma_f32_16x16x32_bf16 v[244:247], v[68:71], v[44:47], v[244:247]
v_mfma_f32_16x16x32_bf16 v[248:251], v[72:75], v[44:47], v[248:251]
v_mfma_f32_16x16x32_bf16 v[252:255], v[76:79], v[44:47], v[252:255]
v_mfma_f32_16x16x32_bf16 v[128:131], v[96:99], v[80:83], v[128:131]
s_add_u32 m0, s28, 81920
ds_read_b128 v[32:35], v18 offset:49152
s_nop 0
v_mfma_f32_16x16x32_bf16 v[132:135], v[100:103], v[80:83], v[132:135]
ds_read_b64_tr_b16 v[48:49], v20 offset:0
v_mfma_f32_16x16x32_bf16 v[136:139], v[104:107], v[80:83], v[136:139]
ds_read_b64_tr_b16 v[50:51], v20 offset:2048
v_mfma_f32_16x16x32_bf16 v[140:143], v[108:111], v[80:83], v[140:143]
buffer_load_dwordx4 v12, s[12:15], s23 offen offset:0 lds
v_mfma_f32_16x16x32_bf16 v[144:147], v[112:115], v[80:83], v[144:147]
ds_read_b64_tr_b16 v[52:53], v21 offset:0
v_mfma_f32_16x16x32_bf16 v[148:151], v[116:119], v[80:83], v[148:151]
ds_read_b64_tr_b16 v[54:55], v21 offset:2048
v_mfma_f32_16x16x32_bf16 v[152:155], v[120:123], v[80:83], v[152:155]
ds_read_b64_tr_b16 v[56:57], v22 offset:0
v_mfma_f32_16x16x32_bf16 v[156:159], v[124:127], v[80:83], v[156:159]
ds_read_b64_tr_b16 v[58:59], v22 offset:2048
v_mfma_f32_16x16x32_bf16 v[160:163], v[96:99], v[84:87], v[160:163]
buffer_load_dwordx4 v13, s[12:15], s23 offen offset:1024 lds
v_mfma_f32_16x16x32_bf16 v[164:167], v[100:103], v[84:87], v[164:167]
ds_read_b64_tr_b16 v[60:61], v23 offset:0
v_mfma_f32_16x16x32_bf16 v[168:171], v[104:107], v[84:87], v[168:171]
ds_read_b64_tr_b16 v[62:63], v23 offset:2048
v_mfma_f32_16x16x32_bf16 v[172:175], v[108:111], v[84:87], v[172:175]
ds_read_b64_tr_b16 v[64:65], v20 offset:4096
v_mfma_f32_16x16x32_bf16 v[176:179], v[112:115], v[84:87], v[176:179]
buffer_load_dwordx4 v14, s[12:15], s23 offen offset:2048 lds
v_mfma_f32_16x16x32_bf16 v[180:183], v[116:119], v[84:87], v[180:183]
ds_read_b64_tr_b16 v[66:67], v20 offset:6144
v_mfma_f32_16x16x32_bf16 v[184:187], v[120:123], v[84:87], v[184:187]
ds_read_b64_tr_b16 v[68:69], v21 offset:4096
v_mfma_f32_16x16x32_bf16 v[188:191], v[124:127], v[84:87], v[188:191]
ds_read_b64_tr_b16 v[70:71], v21 offset:6144
v_mfma_f32_16x16x32_bf16 v[192:195], v[96:99], v[88:91], v[192:195]
ds_read_b64_tr_b16 v[72:73], v22 offset:4096
buffer_load_dwordx4 v15, s[12:15], s23 offen offset:3072 lds
v_mfma_f32_16x16x32_bf16 v[196:199], v[100:103], v[88:91], v[196:199]
s_add_u32 s23, s23, 114688
ds_read_b64_tr_b16 v[74:75], v22 offset:6144
s_add_u32 m0, s29, 32768
v_mfma_f32_16x16x32_bf16 v[200:203], v[104:107], v[88:91], v[200:203]
s_nop 0
ds_read_b64_tr_b16 v[76:77], v23 offset:4096
v_mfma_f32_16x16x32_bf16 v[204:207], v[108:111], v[88:91], v[204:207]
ds_read_b64_tr_b16 v[78:79], v23 offset:6144
v_mfma_f32_16x16x32_bf16 v[208:211], v[112:115], v[88:91], v[208:211]
ds_read_b128 v[36:39], v18 offset:51200
buffer_load_dwordx4 v8, s[8:11], s24 offen offset:0 sc1 lds
v_mfma_f32_16x16x32_bf16 v[212:215], v[116:119], v[88:91], v[212:215]
ds_read_b128 v[40:43], v18 offset:53248
v_mfma_f32_16x16x32_bf16 v[216:219], v[120:123], v[88:91], v[216:219]
ds_read_b128 v[44:47], v18 offset:55296
v_mfma_f32_16x16x32_bf16 v[220:223], v[124:127], v[88:91], v[220:223]
buffer_load_dwordx4 v9, s[8:11], s24 offen offset:1024 sc1 lds
v_mfma_f32_16x16x32_bf16 v[224:227], v[96:99], v[92:95], v[224:227]
v_mfma_f32_16x16x32_bf16 v[228:231], v[100:103], v[92:95], v[228:231]
v_mfma_f32_16x16x32_bf16 v[232:235], v[104:107], v[92:95], v[232:235]
v_mfma_f32_16x16x32_bf16 v[236:239], v[108:111], v[92:95], v[236:239]
s_waitcnt vmcnt(26) lgkmcnt(0)
v_mfma_f32_16x16x32_bf16 v[240:243], v[112:115], v[92:95], v[240:243]
s_barrier
v_mfma_f32_16x16x32_bf16 v[244:247], v[116:119], v[92:95], v[244:247]
v_mfma_f32_16x16x32_bf16 v[248:251], v[120:123], v[92:95], v[248:251]
v_mfma_f32_16x16x32_bf16 v[252:255], v[124:127], v[92:95], v[252:255]
v_mfma_f32_16x16x32_bf16 v[128:131], v[48:51], v[32:35], v[128:131]
s_add_u32 m0, s28, 0
ds_read_b128 v[80:83], v19 offset:49152
s_nop 0
v_mfma_f32_16x16x32_bf16 v[132:135], v[52:55], v[32:35], v[132:135]
ds_read_b64_tr_b16 v[96:97], v20 offset:16384
v_mfma_f32_16x16x32_bf16 v[136:139], v[56:59], v[32:35], v[136:139]
ds_read_b64_tr_b16 v[98:99], v20 offset:18432
v_mfma_f32_16x16x32_bf16 v[140:143], v[60:63], v[32:35], v[140:143]
buffer_load_dwordx4 v12, s[12:15], s23 offen offset:0 lds
v_mfma_f32_16x16x32_bf16 v[144:147], v[64:67], v[32:35], v[144:147]
ds_read_b64_tr_b16 v[100:101], v21 offset:16384
v_mfma_f32_16x16x32_bf16 v[148:151], v[68:71], v[32:35], v[148:151]
ds_read_b64_tr_b16 v[102:103], v21 offset:18432
v_mfma_f32_16x16x32_bf16 v[152:155], v[72:75], v[32:35], v[152:155]
ds_read_b64_tr_b16 v[104:105], v22 offset:16384
v_mfma_f32_16x16x32_bf16 v[156:159], v[76:79], v[32:35], v[156:159]
ds_read_b64_tr_b16 v[106:107], v22 offset:18432
v_mfma_f32_16x16x32_bf16 v[160:163], v[48:51], v[36:39], v[160:163]
buffer_load_dwordx4 v13, s[12:15], s23 offen offset:1024 lds
v_mfma_f32_16x16x32_bf16 v[164:167], v[52:55], v[36:39], v[164:167]
ds_read_b64_tr_b16 v[108:109], v23 offset:16384
v_mfma_f32_16x16x32_bf16 v[168:171], v[56:59], v[36:39], v[168:171]
ds_read_b64_tr_b16 v[110:111], v23 offset:18432
v_mfma_f32_16x16x32_bf16 v[172:175], v[60:63], v[36:39], v[172:175]
ds_read_b64_tr_b16 v[112:113], v20 offset:20480
v_mfma_f32_16x16x32_bf16 v[176:179], v[64:67], v[36:39], v[176:179]
buffer_load_dwordx4 v14, s[12:15], s23 offen offset:2048 lds
v_mfma_f32_16x16x32_bf16 v[180:183], v[68:71], v[36:39], v[180:183]
ds_read_b64_tr_b16 v[114:115], v20 offset:22528
v_mfma_f32_16x16x32_bf16 v[184:187], v[72:75], v[36:39], v[184:187]
ds_read_b64_tr_b16 v[116:117], v21 offset:20480
v_mfma_f32_16x16x32_bf16 v[188:191], v[76:79], v[36:39], v[188:191]
ds_read_b64_tr_b16 v[118:119], v21 offset:22528
v_mfma_f32_16x16x32_bf16 v[192:195], v[48:51], v[40:43], v[192:195]
ds_read_b64_tr_b16 v[120:121], v22 offset:20480
buffer_load_dwordx4 v15, s[12:15], s23 offen offset:3072 lds
v_mfma_f32_16x16x32_bf16 v[196:199], v[52:55], v[40:43], v[196:199]
s_add_u32 s23, s23, 114688
ds_read_b64_tr_b16 v[122:123], v22 offset:22528
s_add_u32 m0, s29, 32768
v_mfma_f32_16x16x32_bf16 v[200:203], v[56:59], v[40:43], v[200:203]
s_nop 0
ds_read_b64_tr_b16 v[124:125], v23 offset:20480
v_mfma_f32_16x16x32_bf16 v[204:207], v[60:63], v[40:43], v[204:207]
ds_read_b64_tr_b16 v[126:127], v23 offset:22528
v_mfma_f32_16x16x32_bf16 v[208:211], v[64:67], v[40:43], v[208:211]
ds_read_b128 v[84:87], v19 offset:51200
buffer_load_dwordx4 v10, s[8:11], s24 offen offset:2048 sc1 lds
v_mfma_f32_16x16x32_bf16 v[212:215], v[68:71], v[40:43], v[212:215]
ds_read_b128 v[88:91], v19 offset:53248
v_mfma_f32_16x16x32_bf16 v[216:219], v[72:75], v[40:43], v[216:219]
ds_read_b128 v[92:95], v19 offset:55296
v_mfma_f32_16x16x32_bf16 v[220:223], v[76:79], v[40:43], v[220:223]
buffer_load_dwordx4 v11, s[8:11], s24 offen offset:3072 sc1 lds
v_mfma_f32_16x16x32_bf16 v[224:227], v[48:51], v[44:47], v[224:227]
s_add_u32 s24, s24, 2048
v_mfma_f32_16x16x32_bf16 v[228:231], v[52:55], v[44:47], v[228:231]
v_mfma_f32_16x16x32_bf16 v[232:235], v[56:59], v[44:47], v[232:235]
v_mfma_f32_16x16x32_bf16 v[236:239], v[60:63], v[44:47], v[236:239]
s_waitcnt vmcnt(24) lgkmcnt(0)
v_mfma_f32_16x16x32_bf16 v[240:243], v[64:67], v[44:47], v[240:243]
s_barrier
v_mfma_f32_16x16x32_bf16 v[244:247], v[68:71], v[44:47], v[244:247]
v_mfma_f32_16x16x32_bf16 v[248:251], v[72:75], v[44:47], v[248:251]
v_mfma_f32_16x16x32_bf16 v[252:255], v[76:79], v[44:47], v[252:255]
v_mfma_f32_16x16x32_bf16 v[128:131], v[96:99], v[80:83], v[128:131]
s_add_u32 m0, s28, 16384
ds_read_b128 v[32:35], v18 offset:0
s_nop 0
v_mfma_f32_16x16x32_bf16 v[132:135], v[100:103], v[80:83], v[132:135]
ds_read_b64_tr_b16 v[48:49], v20 offset:32768
v_mfma_f32_16x16x32_bf16 v[136:139], v[104:107], v[80:83], v[136:139]
ds_read_b64_tr_b16 v[50:51], v20 offset:34816
v_mfma_f32_16x16x32_bf16 v[140:143], v[108:111], v[80:83], v[140:143]
buffer_load_dwordx4 v12, s[12:15], s23 offen offset:0 lds
v_mfma_f32_16x16x32_bf16 v[144:147], v[112:115], v[80:83], v[144:147]
ds_read_b64_tr_b16 v[52:53], v21 offset:32768
v_mfma_f32_16x16x32_bf16 v[148:151], v[116:119], v[80:83], v[148:151]
ds_read_b64_tr_b16 v[54:55], v21 offset:34816
v_mfma_f32_16x16x32_bf16 v[152:155], v[120:123], v[80:83], v[152:155]
ds_read_b64_tr_b16 v[56:57], v22 offset:32768
v_mfma_f32_16x16x32_bf16 v[156:159], v[124:127], v[80:83], v[156:159]
ds_read_b64_tr_b16 v[58:59], v22 offset:34816
v_mfma_f32_16x16x32_bf16 v[160:163], v[96:99], v[84:87], v[160:163]
ds_read_b64_tr_b16 v[60:61], v23 offset:32768
v_mfma_f32_16x16x32_bf16 v[164:167], v[100:103], v[84:87], v[164:167]
ds_read_b64_tr_b16 v[62:63], v23 offset:34816
v_mfma_f32_16x16x32_bf16 v[168:171], v[104:107], v[84:87], v[168:171]
buffer_load_dwordx4 v13, s[12:15], s23 offen offset:1024 lds
v_mfma_f32_16x16x32_bf16 v[172:175], v[108:111], v[84:87], v[172:175]
ds_read_b64_tr_b16 v[64:65], v20 offset:36864
v_mfma_f32_16x16x32_bf16 v[176:179], v[112:115], v[84:87], v[176:179]
ds_read_b64_tr_b16 v[66:67], v20 offset:38912
v_mfma_f32_16x16x32_bf16 v[180:183], v[116:119], v[84:87], v[180:183]
ds_read_b64_tr_b16 v[68:69], v21 offset:36864
v_mfma_f32_16x16x32_bf16 v[184:187], v[120:123], v[84:87], v[184:187]
ds_read_b64_tr_b16 v[70:71], v21 offset:38912
v_mfma_f32_16x16x32_bf16 v[188:191], v[124:127], v[84:87], v[188:191]
ds_read_b64_tr_b16 v[72:73], v22 offset:36864
v_mfma_f32_16x16x32_bf16 v[192:195], v[96:99], v[88:91], v[192:195]
buffer_load_dwordx4 v14, s[12:15], s23 offen offset:2048 lds
v_mfma_f32_16x16x32_bf16 v[196:199], v[100:103], v[88:91], v[196:199]
ds_read_b64_tr_b16 v[74:75], v22 offset:38912
v_mfma_f32_16x16x32_bf16 v[200:203], v[104:107], v[88:91], v[200:203]
ds_read_b64_tr_b16 v[76:77], v23 offset:36864
v_mfma_f32_16x16x32_bf16 v[204:207], v[108:111], v[88:91], v[204:207]
ds_read_b64_tr_b16 v[78:79], v23 offset:38912
v_mfma_f32_16x16x32_bf16 v[208:211], v[112:115], v[88:91], v[208:211]
ds_read_b128 v[36:39], v18 offset:2048
v_mfma_f32_16x16x32_bf16 v[212:215], v[116:119], v[88:91], v[212:215]
ds_read_b128 v[40:43], v18 offset:4096
v_mfma_f32_16x16x32_bf16 v[216:219], v[120:123], v[88:91], v[216:219]
buffer_load_dwordx4 v15, s[12:15], s23 offen offset:3072 lds
v_mfma_f32_16x16x32_bf16 v[220:223], v[124:127], v[88:91], v[220:223]
ds_read_b128 v[44:47], v18 offset:6144
v_mfma_f32_16x16x32_bf16 v[224:227], v[96:99], v[92:95], v[224:227]
s_add_u32 s23, s23, 114688
v_mfma_f32_16x16x32_bf16 v[228:231], v[100:103], v[92:95], v[228:231]
v_mfma_f32_16x16x32_bf16 v[232:235], v[104:107], v[92:95], v[232:235]
v_mfma_f32_16x16x32_bf16 v[236:239], v[108:111], v[92:95], v[236:239]
s_waitcnt vmcnt(24) lgkmcnt(0)
v_mfma_f32_16x16x32_bf16 v[240:243], v[112:115], v[92:95], v[240:243]
s_barrier
v_mfma_f32_16x16x32_bf16 v[244:247], v[116:119], v[92:95], v[244:247]
v_mfma_f32_16x16x32_bf16 v[248:251], v[120:123], v[92:95], v[248:251]
v_mfma_f32_16x16x32_bf16 v[252:255], v[124:127], v[92:95], v[252:255]
v_mfma_f32_16x16x32_bf16 v[128:131], v[48:51], v[32:35], v[128:131]
ds_read_b128 v[80:83], v19 offset:0
v_mfma_f32_16x16x32_bf16 v[132:135], v[52:55], v[32:35], v[132:135]
ds_read_b64_tr_b16 v[96:97], v20 offset:49152
v_mfma_f32_16x16x32_bf16 v[136:139], v[56:59], v[32:35], v[136:139]
ds_read_b64_tr_b16 v[98:99], v20 offset:51200
v_mfma_f32_16x16x32_bf16 v[140:143], v[60:63], v[32:35], v[140:143]
ds_read_b64_tr_b16 v[100:101], v21 offset:49152
v_mfma_f32_16x16x32_bf16 v[144:147], v[64:67], v[32:35], v[144:147]
ds_read_b64_tr_b16 v[102:103], v21 offset:51200
v_mfma_f32_16x16x32_bf16 v[148:151], v[68:71], v[32:35], v[148:151]
ds_read_b64_tr_b16 v[104:105], v22 offset:49152
v_mfma_f32_16x16x32_bf16 v[152:155], v[72:75], v[32:35], v[152:155]
ds_read_b64_tr_b16 v[106:107], v22 offset:51200
v_mfma_f32_16x16x32_bf16 v[156:159], v[76:79], v[32:35], v[156:159]
ds_read_b64_tr_b16 v[108:109], v23 offset:49152
v_mfma_f32_16x16x32_bf16 v[160:163], v[48:51], v[36:39], v[160:163]
ds_read_b64_tr_b16 v[110:111], v23 offset:51200
v_mfma_f32_16x16x32_bf16 v[164:167], v[52:55], v[36:39], v[164:167]
ds_read_b64_tr_b16 v[112:113], v20 offset:53248
v_mfma_f32_16x16x32_bf16 v[168:171], v[56:59], v[36:39], v[168:171]
ds_read_b64_tr_b16 v[114:115], v20 offset:55296
v_mfma_f32_16x16x32_bf16 v[172:175], v[60:63], v[36:39], v[172:175]
ds_read_b64_tr_b16 v[116:117], v21 offset:53248
v_mfma_f32_16x16x32_bf16 v[176:179], v[64:67], v[36:39], v[176:179]
ds_read_b64_tr_b16 v[118:119], v21 offset:55296
v_mfma_f32_16x16x32_bf16 v[180:183], v[68:71], v[36:39], v[180:183]
ds_read_b64_tr_b16 v[120:121], v22 offset:53248
v_mfma_f32_16x16x32_bf16 v[184:187], v[72:75], v[36:39], v[184:187]
ds_read_b64_tr_b16 v[122:123], v22 offset:55296
v_mfma_f32_16x16x32_bf16 v[188:191], v[76:79], v[36:39], v[188:191]
ds_read_b64_tr_b16 v[124:125], v23 offset:53248
v_mfma_f32_16x16x32_bf16 v[192:195], v[48:51], v[40:43], v[192:195]
ds_read_b64_tr_b16 v[126:127], v23 offset:55296
v_mfma_f32_16x16x32_bf16 v[196:199], v[52:55], v[40:43], v[196:199]
ds_read_b128 v[84:87], v19 offset:2048
v_mfma_f32_16x16x32_bf16 v[200:203], v[56:59], v[40:43], v[200:203]
ds_read_b128 v[88:91], v19 offset:4096
v_mfma_f32_16x16x32_bf16 v[204:207], v[60:63], v[40:43], v[204:207]
ds_read_b128 v[92:95], v19 offset:6144
v_mfma_f32_16x16x32_bf16 v[208:211], v[64:67], v[40:43], v[208:211]
v_mfma_f32_16x16x32_bf16 v[212:215], v[68:71], v[40:43], v[212:215]
v_mfma_f32_16x16x32_bf16 v[216:219], v[72:75], v[40:43], v[216:219]
v_mfma_f32_16x16x32_bf16 v[220:223], v[76:79], v[40:43], v[220:223]
v_mfma_f32_16x16x32_bf16 v[224:227], v[48:51], v[44:47], v[224:227]
v_mfma_f32_16x16x32_bf16 v[228:231], v[52:55], v[44:47], v[228:231]
v_mfma_f32_16x16x32_bf16 v[232:235], v[56:59], v[44:47], v[232:235]
v_mfma_f32_16x16x32_bf16 v[236:239], v[60:63], v[44:47], v[236:239]
s_waitcnt vmcnt(16) lgkmcnt(0)
v_mfma_f32_16x16x32_bf16 v[240:243], v[64:67], v[44:47], v[240:243]
s_barrier
v_mfma_f32_16x16x32_bf16 v[244:247], v[68:71], v[44:47], v[244:247]
v_mfma_f32_16x16x32_bf16 v[248:251], v[72:75], v[44:47], v[248:251]
v_mfma_f32_16x16x32_bf16 v[252:255], v[76:79], v[44:47], v[252:255]
v_mfma_f32_16x16x32_bf16 v[128:131], v[96:99], v[80:83], v[128:131]
ds_read_b128 v[32:35], v18 offset:16384
v_mfma_f32_16x16x32_bf16 v[132:135], v[100:103], v[80:83], v[132:135]
ds_read_b64_tr_b16 v[48:49], v2 offset:0
v_mfma_f32_16x16x32_bf16 v[136:139], v[104:107], v[80:83], v[136:139]
ds_read_b64_tr_b16 v[50:51], v2 offset:2048
v_mfma_f32_16x16x32_bf16 v[140:143], v[108:111], v[80:83], v[140:143]
ds_read_b64_tr_b16 v[52:53], v3 offset:0
v_mfma_f32_16x16x32_bf16 v[144:147], v[112:115], v[80:83], v[144:147]
ds_read_b64_tr_b16 v[54:55], v3 offset:2048
v_mfma_f32_16x16x32_bf16 v[148:151], v[116:119], v[80:83], v[148:151]
ds_read_b64_tr_b16 v[56:57], v4 offset:0
v_mfma_f32_16x16x32_bf16 v[152:155], v[120:123], v[80:83], v[152:155]
ds_read_b64_tr_b16 v[58:59], v4 offset:2048
v_mfma_f32_16x16x32_bf16 v[156:159], v[124:127], v[80:83], v[156:159]
ds_read_b64_tr_b16 v[60:61], v5 offset:0
v_mfma_f32_16x16x32_bf16 v[160:163], v[96:99], v[84:87], v[160:163]
ds_read_b64_tr_b16 v[62:63], v5 offset:2048
v_mfma_f32_16x16x32_bf16 v[164:167], v[100:103], v[84:87], v[164:167]
ds_read_b64_tr_b16 v[64:65], v2 offset:4096
v_mfma_f32_16x16x32_bf16 v[168:171], v[104:107], v[84:87], v[168:171]
ds_read_b64_tr_b16 v[66:67], v2 offset:6144
v_mfma_f32_16x16x32_bf16 v[172:175], v[108:111], v[84:87], v[172:175]
ds_read_b64_tr_b16 v[68:69], v3 offset:4096
v_mfma_f32_16x16x32_bf16 v[176:179], v[112:115], v[84:87], v[176:179]
ds_read_b64_tr_b16 v[70:71], v3 offset:6144
v_mfma_f32_16x16x32_bf16 v[180:183], v[116:119], v[84:87], v[180:183]
ds_read_b64_tr_b16 v[72:73], v4 offset:4096
v_mfma_f32_16x16x32_bf16 v[184:187], v[120:123], v[84:87], v[184:187]
ds_read_b64_tr_b16 v[74:75], v4 offset:6144
v_mfma_f32_16x16x32_bf16 v[188:191], v[124:127], v[84:87], v[188:191]
ds_read_b64_tr_b16 v[76:77], v5 offset:4096
v_mfma_f32_16x16x32_bf16 v[192:195], v[96:99], v[88:91], v[192:195]
ds_read_b64_tr_b16 v[78:79], v5 offset:6144
v_mfma_f32_16x16x32_bf16 v[196:199], v[100:103], v[88:91], v[196:199]
ds_read_b128 v[36:39], v18 offset:18432
v_mfma_f32_16x16x32_bf16 v[200:203], v[104:107], v[88:91], v[200:203]
ds_read_b128 v[40:43], v18 offset:20480
v_mfma_f32_16x16x32_bf16 v[204:207], v[108:111], v[88:91], v[204:207]
ds_read_b128 v[44:47], v18 offset:22528
v_mfma_f32_16x16x32_bf16 v[208:211], v[112:115], v[88:91], v[208:211]
v_mfma_f32_16x16x32_bf16 v[212:215], v[116:119], v[88:91], v[212:215]
v_mfma_f32_16x16x32_bf16 v[216:219], v[120:123], v[88:91], v[216:219]
v_mfma_f32_16x16x32_bf16 v[220:223], v[124:127], v[88:91], v[220:223]
v_mfma_f32_16x16x32_bf16 v[224:227], v[96:99], v[92:95], v[224:227]
v_mfma_f32_16x16x32_bf16 v[228:231], v[100:103], v[92:95], v[228:231]
v_mfma_f32_16x16x32_bf16 v[232:235], v[104:107], v[92:95], v[232:235]
v_mfma_f32_16x16x32_bf16 v[236:239], v[108:111], v[92:95], v[236:239]
s_waitcnt vmcnt(12) lgkmcnt(0)
v_mfma_f32_16x16x32_bf16 v[240:243], v[112:115], v[92:95], v[240:243]
s_barrier
v_mfma_f32_16x16x32_bf16 v[244:247], v[116:119], v[92:95], v[244:247]
v_mfma_f32_16x16x32_bf16 v[248:251], v[120:123], v[92:95], v[248:251]
v_mfma_f32_16x16x32_bf16 v[252:255], v[124:127], v[92:95], v[252:255]
v_mfma_f32_16x16x32_bf16 v[128:131], v[48:51], v[32:35], v[128:131]
ds_read_b128 v[80:83], v19 offset:16384
v_mfma_f32_16x16x32_bf16 v[132:135], v[52:55], v[32:35], v[132:135]
ds_read_b64_tr_b16 v[96:97], v2 offset:16384
v_mfma_f32_16x16x32_bf16 v[136:139], v[56:59], v[32:35], v[136:139]
ds_read_b64_tr_b16 v[98:99], v2 offset:18432
v_mfma_f32_16x16x32_bf16 v[140:143], v[60:63], v[32:35], v[140:143]
ds_read_b64_tr_b16 v[100:101], v3 offset:16384
v_mfma_f32_16x16x32_bf16 v[144:147], v[64:67], v[32:35], v[144:147]
ds_read_b64_tr_b16 v[102:103], v3 offset:18432
v_mfma_f32_16x16x32_bf16 v[148:151], v[68:71], v[32:35], v[148:151]
ds_read_b64_tr_b16 v[104:105], v4 offset:16384
v_mfma_f32_16x16x32_bf16 v[152:155], v[72:75], v[32:35], v[152:155]
ds_read_b64_tr_b16 v[106:107], v4 offset:18432
v_mfma_f32_16x16x32_bf16 v[156:159], v[76:79], v[32:35], v[156:159]
ds_read_b64_tr_b16 v[108:109], v5 offset:16384
v_mfma_f32_16x16x32_bf16 v[160:163], v[48:51], v[36:39], v[160:163]
ds_read_b64_tr_b16 v[110:111], v5 offset:18432
v_mfma_f32_16x16x32_bf16 v[164:167], v[52:55], v[36:39], v[164:167]
ds_read_b64_tr_b16 v[112:113], v2 offset:20480
v_mfma_f32_16x16x32_bf16 v[168:171], v[56:59], v[36:39], v[168:171]
ds_read_b64_tr_b16 v[114:115], v2 offset:22528
v_mfma_f32_16x16x32_bf16 v[172:175], v[60:63], v[36:39], v[172:175]
ds_read_b64_tr_b16 v[116:117], v3 offset:20480
v_mfma_f32_16x16x32_bf16 v[176:179], v[64:67], v[36:39], v[176:179]
ds_read_b64_tr_b16 v[118:119], v3 offset:22528
v_mfma_f32_16x16x32_bf16 v[180:183], v[68:71], v[36:39], v[180:183]
ds_read_b64_tr_b16 v[120:121], v4 offset:20480
v_mfma_f32_16x16x32_bf16 v[184:187], v[72:75], v[36:39], v[184:187]
ds_read_b64_tr_b16 v[122:123], v4 offset:22528
v_mfma_f32_16x16x32_bf16 v[188:191], v[76:79], v[36:39], v[188:191]
ds_read_b64_tr_b16 v[124:125], v5 offset:20480
v_mfma_f32_16x16x32_bf16 v[192:195], v[48:51], v[40:43], v[192:195]
ds_read_b64_tr_b16 v[126:127], v5 offset:22528
v_mfma_f32_16x16x32_bf16 v[196:199], v[52:55], v[40:43], v[196:199]
ds_read_b128 v[84:87], v19 offset:18432
v_mfma_f32_16x16x32_bf16 v[200:203], v[56:59], v[40:43], v[200:203]
ds_read_b128 v[88:91], v19 offset:20480
v_mfma_f32_16x16x32_bf16 v[204:207], v[60:63], v[40:43], v[204:207]
ds_read_b128 v[92:95], v19 offset:22528
v_mfma_f32_16x16x32_bf16 v[208:211], v[64:67], v[40:43], v[208:211]
v_mfma_f32_16x16x32_bf16 v[212:215], v[68:71], v[40:43], v[212:215]
v_mfma_f32_16x16x32_bf16 v[216:219], v[72:75], v[40:43], v[216:219]
v_mfma_f32_16x16x32_bf16 v[220:223], v[76:79], v[40:43], v[220:223]
v_mfma_f32_16x16x32_bf16 v[224:227], v[48:51], v[44:47], v[224:227]
v_mfma_f32_16x16x32_bf16 v[228:231], v[52:55], v[44:47], v[228:231]
v_mfma_f32_16x16x32_bf16 v[232:235], v[56:59], v[44:47], v[232:235]
v_mfma_f32_16x16x32_bf16 v[236:239], v[60:63], v[44:47], v[236:239]
s_waitcnt vmcnt(4) lgkmcnt(0)
v_mfma_f32_16x16x32_bf16 v[240:243], v[64:67], v[44:47], v[240:243]
s_barrier
v_mfma_f32_16x16x32_bf16 v[244:247], v[68:71], v[44:47], v[244:247]
v_mfma_f32_16x16x32_bf16 v[248:251], v[72:75], v[44:47], v[248:251]
v_mfma_f32_16x16x32_bf16 v[252:255], v[76:79], v[44:47], v[252:255]
v_mfma_f32_16x16x32_bf16 v[128:131], v[96:99], v[80:83], v[128:131]
ds_read_b128 v[32:35], v18 offset:32768
v_mfma_f32_16x16x32_bf16 v[132:135], v[100:103], v[80:83], v[132:135]
ds_read_b64_tr_b16 v[48:49], v20 offset:0
v_mfma_f32_16x16x32_bf16 v[136:139], v[104:107], v[80:83], v[136:139]
ds_read_b64_tr_b16 v[50:51], v20 offset:2048
v_mfma_f32_16x16x32_bf16 v[140:143], v[108:111], v[80:83], v[140:143]
ds_read_b64_tr_b16 v[52:53], v21 offset:0
v_mfma_f32_16x16x32_bf16 v[144:147], v[112:115], v[80:83], v[144:147]
ds_read_b64_tr_b16 v[54:55], v21 offset:2048
v_mfma_f32_16x16x32_bf16 v[148:151], v[116:119], v[80:83], v[148:151]
ds_read_b64_tr_b16 v[56:57], v22 offset:0
v_mfma_f32_16x16x32_bf16 v[152:155], v[120:123], v[80:83], v[152:155]
ds_read_b64_tr_b16 v[58:59], v22 offset:2048
v_mfma_f32_16x16x32_bf16 v[156:159], v[124:127], v[80:83], v[156:159]
ds_read_b64_tr_b16 v[60:61], v23 offset:0
v_mfma_f32_16x16x32_bf16 v[160:163], v[96:99], v[84:87], v[160:163]
ds_read_b64_tr_b16 v[62:63], v23 offset:2048
v_mfma_f32_16x16x32_bf16 v[164:167], v[100:103], v[84:87], v[164:167]
ds_read_b64_tr_b16 v[64:65], v20 offset:4096
v_mfma_f32_16x16x32_bf16 v[168:171], v[104:107], v[84:87], v[168:171]
ds_read_b64_tr_b16 v[66:67], v20 offset:6144
v_mfma_f32_16x16x32_bf16 v[172:175], v[108:111], v[84:87], v[172:175]
ds_read_b64_tr_b16 v[68:69], v21 offset:4096
v_mfma_f32_16x16x32_bf16 v[176:179], v[112:115], v[84:87], v[176:179]
ds_read_b64_tr_b16 v[70:71], v21 offset:6144
v_mfma_f32_16x16x32_bf16 v[180:183], v[116:119], v[84:87], v[180:183]
ds_read_b64_tr_b16 v[72:73], v22 offset:4096
v_mfma_f32_16x16x32_bf16 v[184:187], v[120:123], v[84:87], v[184:187]
ds_read_b64_tr_b16 v[74:75], v22 offset:6144
v_mfma_f32_16x16x32_bf16 v[188:191], v[124:127], v[84:87], v[188:191]
ds_read_b64_tr_b16 v[76:77], v23 offset:4096
v_mfma_f32_16x16x32_bf16 v[192:195], v[96:99], v[88:91], v[192:195]
ds_read_b64_tr_b16 v[78:79], v23 offset:6144
v_mfma_f32_16x16x32_bf16 v[196:199], v[100:103], v[88:91], v[196:199]
ds_read_b128 v[36:39], v18 offset:34816
v_mfma_f32_16x16x32_bf16 v[200:203], v[104:107], v[88:91], v[200:203]
ds_read_b128 v[40:43], v18 offset:36864
v_mfma_f32_16x16x32_bf16 v[204:207], v[108:111], v[88:91], v[204:207]
ds_read_b128 v[44:47], v18 offset:38912
v_mfma_f32_16x16x32_bf16 v[208:211], v[112:115], v[88:91], v[208:211]
v_mfma_f32_16x16x32_bf16 v[212:215], v[116:119], v[88:91], v[212:215]
v_mfma_f32_16x16x32_bf16 v[216:219], v[120:123], v[88:91], v[216:219]
v_mfma_f32_16x16x32_bf16 v[220:223], v[124:127], v[88:91], v[220:223]
v_mfma_f32_16x16x32_bf16 v[224:227], v[96:99], v[92:95], v[224:227]
v_mfma_f32_16x16x32_bf16 v[228:231], v[100:103], v[92:95], v[228:231]
v_mfma_f32_16x16x32_bf16 v[232:235], v[104:107], v[92:95], v[232:235]
v_mfma_f32_16x16x32_bf16 v[236:239], v[108:111], v[92:95], v[236:239]
s_waitcnt vmcnt(0) lgkmcnt(0)
v_mfma_f32_16x16x32_bf16 v[240:243], v[112:115], v[92:95], v[240:243]
s_barrier
v_mfma_f32_16x16x32_bf16 v[244:247], v[116:119], v[92:95], v[244:247]
v_mfma_f32_16x16x32_bf16 v[248:251], v[120:123], v[92:95], v[248:251]
v_mfma_f32_16x16x32_bf16 v[252:255], v[124:127], v[92:95], v[252:255]
v_mfma_f32_16x16x32_bf16 v[128:131], v[48:51], v[32:35], v[128:131]
ds_read_b128 v[80:83], v19 offset:32768
v_mfma_f32_16x16x32_bf16 v[132:135], v[52:55], v[32:35], v[132:135]
ds_read_b64_tr_b16 v[96:97], v20 offset:16384
v_mfma_f32_16x16x32_bf16 v[136:139], v[56:59], v[32:35], v[136:139]
ds_read_b64_tr_b16 v[98:99], v20 offset:18432
v_mfma_f32_16x16x32_bf16 v[140:143], v[60:63], v[32:35], v[140:143]
ds_read_b64_tr_b16 v[100:101], v21 offset:16384
v_mfma_f32_16x16x32_bf16 v[144:147], v[64:67], v[32:35], v[144:147]
ds_read_b64_tr_b16 v[102:103], v21 offset:18432
v_mfma_f32_16x16x32_bf16 v[148:151], v[68:71], v[32:35], v[148:151]
ds_read_b64_tr_b16 v[104:105], v22 offset:16384
v_mfma_f32_16x16x32_bf16 v[152:155], v[72:75], v[32:35], v[152:155]
ds_read_b64_tr_b16 v[106:107], v22 offset:18432
v_mfma_f32_16x16x32_bf16 v[156:159], v[76:79], v[32:35], v[156:159]
ds_read_b64_tr_b16 v[108:109], v23 offset:16384
v_mfma_f32_16x16x32_bf16 v[160:163], v[48:51], v[36:39], v[160:163]
ds_read_b64_tr_b16 v[110:111], v23 offset:18432
v_mfma_f32_16x16x32_bf16 v[164:167], v[52:55], v[36:39], v[164:167]
ds_read_b64_tr_b16 v[112:113], v20 offset:20480
v_mfma_f32_16x16x32_bf16 v[168:171], v[56:59], v[36:39], v[168:171]
ds_read_b64_tr_b16 v[114:115], v20 offset:22528
v_mfma_f32_16x16x32_bf16 v[172:175], v[60:63], v[36:39], v[172:175]
ds_read_b64_tr_b16 v[116:117], v21 offset:20480
v_mfma_f32_16x16x32_bf16 v[176:179], v[64:67], v[36:39], v[176:179]
ds_read_b64_tr_b16 v[118:119], v21 offset:22528
v_mfma_f32_16x16x32_bf16 v[180:183], v[68:71], v[36:39], v[180:183]
ds_read_b64_tr_b16 v[120:121], v22 offset:20480
v_mfma_f32_16x16x32_bf16 v[184:187], v[72:75], v[36:39], v[184:187]
ds_read_b64_tr_b16 v[122:123], v22 offset:22528
v_mfma_f32_16x16x32_bf16 v[188:191], v[76:79], v[36:39], v[188:191]
ds_read_b64_tr_b16 v[124:125], v23 offset:20480
v_mfma_f32_16x16x32_bf16 v[192:195], v[48:51], v[40:43], v[192:195]
ds_read_b64_tr_b16 v[126:127], v23 offset:22528
v_mfma_f32_16x16x32_bf16 v[196:199], v[52:55], v[40:43], v[196:199]
ds_read_b128 v[84:87], v19 offset:34816
v_mfma_f32_16x16x32_bf16 v[200:203], v[56:59], v[40:43], v[200:203]
ds_read_b128 v[88:91], v19 offset:36864
v_mfma_f32_16x16x32_bf16 v[204:207], v[60:63], v[40:43], v[204:207]
ds_read_b128 v[92:95], v19 offset:38912
v_mfma_f32_16x16x32_bf16 v[208:211], v[64:67], v[40:43], v[208:211]
v_mfma_f32_16x16x32_bf16 v[212:215], v[68:71], v[40:43], v[212:215]
v_mfma_f32_16x16x32_bf16 v[216:219], v[72:75], v[40:43], v[216:219]
v_mfma_f32_16x16x32_bf16 v[220:223], v[76:79], v[40:43], v[220:223]
v_mfma_f32_16x16x32_bf16 v[224:227], v[48:51], v[44:47], v[224:227]
v_mfma_f32_16x16x32_bf16 v[228:231], v[52:55], v[44:47], v[228:231]
v_mfma_f32_16x16x32_bf16 v[232:235], v[56:59], v[44:47], v[232:235]
v_mfma_f32_16x16x32_bf16 v[236:239], v[60:63], v[44:47], v[236:239]
s_waitcnt vmcnt(0) lgkmcnt(0)
v_mfma_f32_16x16x32_bf16 v[240:243], v[64:67], v[44:47], v[240:243]
s_barrier
v_mfma_f32_16x16x32_bf16 v[244:247], v[68:71], v[44:47], v[244:247]
v_mfma_f32_16x16x32_bf16 v[248:251], v[72:75], v[44:47], v[248:251]
v_mfma_f32_16x16x32_bf16 v[252:255], v[76:79], v[44:47], v[252:255]
v_mfma_f32_16x16x32_bf16 v[128:131], v[96:99], v[80:83], v[128:131]
v_mfma_f32_16x16x32_bf16 v[132:135], v[100:103], v[80:83], v[132:135]
v_mfma_f32_16x16x32_bf16 v[136:139], v[104:107], v[80:83], v[136:139]
v_mfma_f32_16x16x32_bf16 v[140:143], v[108:111], v[80:83], v[140:143]
v_mfma_f32_16x16x32_bf16 v[144:147], v[112:115], v[80:83], v[144:147]
v_mfma_f32_16x16x32_bf16 v[148:151], v[116:119], v[80:83], v[148:151]
v_mfma_f32_16x16x32_bf16 v[152:155], v[120:123], v[80:83], v[152:155]
v_mfma_f32_16x16x32_bf16 v[156:159], v[124:127], v[80:83], v[156:159]
v_mfma_f32_16x16x32_bf16 v[160:163], v[96:99], v[84:87], v[160:163]
v_mfma_f32_16x16x32_bf16 v[164:167], v[100:103], v[84:87], v[164:167]
v_mfma_f32_16x16x32_bf16 v[168:171], v[104:107], v[84:87], v[168:171]
v_mfma_f32_16x16x32_bf16 v[172:175], v[108:111], v[84:87], v[172:175]
v_mfma_f32_16x16x32_bf16 v[176:179], v[112:115], v[84:87], v[176:179]
v_mfma_f32_16x16x32_bf16 v[180:183], v[116:119], v[84:87], v[180:183]
v_mfma_f32_16x16x32_bf16 v[184:187], v[120:123], v[84:87], v[184:187]
v_mfma_f32_16x16x32_bf16 v[188:191], v[124:127], v[84:87], v[188:191]
v_mfma_f32_16x16x32_bf16 v[192:195], v[96:99], v[88:91], v[192:195]
v_mfma_f32_16x16x32_bf16 v[196:199], v[100:103], v[88:91], v[196:199]
v_mfma_f32_16x16x32_bf16 v[200:203], v[104:107], v[88:91], v[200:203]
v_mfma_f32_16x16x32_bf16 v[204:207], v[108:111], v[88:91], v[204:207]
v_mfma_f32_16x16x32_bf16 v[208:211], v[112:115], v[88:91], v[208:211]
v_mfma_f32_16x16x32_bf16 v[212:215], v[116:119], v[88:91], v[212:215]
v_mfma_f32_16x16x32_bf16 v[216:219], v[120:123], v[88:91], v[216:219]
v_mfma_f32_16x16x32_bf16 v[220:223], v[124:127], v[88:91], v[220:223]
v_mfma_f32_16x16x32_bf16 v[224:227], v[96:99], v[92:95], v[224:227]
v_mfma_f32_16x16x32_bf16 v[228:231], v[100:103], v[92:95], v[228:231]
v_mfma_f32_16x16x32_bf16 v[232:235], v[104:107], v[92:95], v[232:235]
v_mfma_f32_16x16x32_bf16 v[236:239], v[108:111], v[92:95], v[236:239]
v_mfma_f32_16x16x32_bf16 v[240:243], v[112:115], v[92:95], v[240:243]
v_mfma_f32_16x16x32_bf16 v[244:247], v[116:119], v[92:95], v[244:247]
v_mfma_f32_16x16x32_bf16 v[248:251], v[120:123], v[92:95], v[248:251]
v_mfma_f32_16x16x32_bf16 v[252:255], v[124:127], v[92:95], v[252:255]
s_lshl_b32 s30, s6, 3
s_lshl_b32 s31, s21, 2
s_add_u32 s30, s30, s31
s_mul_i32 s30, s30, 57344
s_lshl_b32 s31, s7, 12
s_add_u32 s30, s30, s31
s_lshl_b32 s31, s22, 11
s_add_u32 s30, s30, s31
s_nop 7
v_max_f32 v128, 0, v128
v_max_f32 v129, 0, v129
v_max_f32 v130, 0, v130
v_max_f32 v131, 0, v131
v_max_f32 v132, 0, v132
v_max_f32 v133, 0, v133
v_max_f32 v134, 0, v134
v_max_f32 v135, 0, v135
v_pk_mul_f32 v[128:129], v[128:129], v[144:145]
v_pk_mul_f32 v[130:131], v[130:131], v[146:147]
v_pk_mul_f32 v[132:133], v[132:133], v[148:149]
v_pk_mul_f32 v[134:135], v[134:135], v[150:151]
v_cvt_pk_bf16_f32 v32, v128, v129
v_cvt_pk_bf16_f32 v33, v130, v131
v_cvt_pk_bf16_f32 v34, v132, v133
v_cvt_pk_bf16_f32 v35, v134, v135
buffer_store_dwordx4 v[32:35], v7, s[16:19], s30 offen offset:0 sc1
v_max_f32 v136, 0, v136
v_max_f32 v137, 0, v137
v_max_f32 v138, 0, v138
v_max_f32 v139, 0, v139
v_max_f32 v140, 0, v140
v_max_f32 v141, 0, v141
v_max_f32 v142, 0, v142
v_max_f32 v143, 0, v143
v_pk_mul_f32 v[136:137], v[136:137], v[152:153]
v_pk_mul_f32 v[138:139], v[138:139], v[154:155]
v_pk_mul_f32 v[140:141], v[140:141], v[156:157]
v_pk_mul_f32 v[142:143], v[142:143], v[158:159]
v_cvt_pk_bf16_f32 v36, v136, v137
v_cvt_pk_bf16_f32 v37, v138, v139
v_cvt_pk_bf16_f32 v38, v140, v141
v_cvt_pk_bf16_f32 v39, v142, v143
buffer_store_dwordx4 v[36:39], v7, s[16:19], s30 offen offset:1024 sc1
s_add_u32 s30, s30, 57344
v_max_f32 v160, 0, v160
v_max_f32 v161, 0, v161
v_max_f32 v162, 0, v162
v_max_f32 v163, 0, v163
v_max_f32 v164, 0, v164
v_max_f32 v165, 0, v165
v_max_f32 v166, 0, v166
v_max_f32 v167, 0, v167
v_pk_mul_f32 v[160:161], v[160:161], v[176:177]
v_pk_mul_f32 v[162:163], v[162:163], v[178:179]
v_pk_mul_f32 v[164:165], v[164:165], v[180:181]
v_pk_mul_f32 v[166:167], v[166:167], v[182:183]
v_cvt_pk_bf16_f32 v40, v160, v161
v_cvt_pk_bf16_f32 v41, v162, v163
v_cvt_pk_bf16_f32 v42, v164, v165
v_cvt_pk_bf16_f32 v43, v166, v167
buffer_store_dwordx4 v[40:43], v7, s[16:19], s30 offen offset:0 sc1
v_max_f32 v168, 0, v168
v_max_f32 v169, 0, v169
v_max_f32 v170, 0, v170
v_max_f32 v171, 0, v171
v_max_f32 v172, 0, v172
v_max_f32 v173, 0, v173
v_max_f32 v174, 0, v174
v_max_f32 v175, 0, v175
v_pk_mul_f32 v[168:169], v[168:169], v[184:185]
v_pk_mul_f32 v[170:171], v[170:171], v[186:187]
v_pk_mul_f32 v[172:173], v[172:173], v[188:189]
v_pk_mul_f32 v[174:175], v[174:175], v[190:191]
v_cvt_pk_bf16_f32 v44, v168, v169
v_cvt_pk_bf16_f32 v45, v170, v171
v_cvt_pk_bf16_f32 v46, v172, v173
v_cvt_pk_bf16_f32 v47, v174, v175
buffer_store_dwordx4 v[44:47], v7, s[16:19], s30 offen offset:1024 sc1
s_add_u32 s30, s30, 57344
v_max_f32 v192, 0, v192
v_max_f32 v193, 0, v193
v_max_f32 v194, 0, v194
v_max_f32 v195, 0, v195
v_max_f32 v196, 0, v196
v_max_f32 v197, 0, v197
v_max_f32 v198, 0, v198
v_max_f32 v199, 0, v199
v_pk_mul_f32 v[192:193], v[192:193], v[208:209]
v_pk_mul_f32 v[194:195], v[194:195], v[210:211]
v_pk_mul_f32 v[196:197], v[196:197], v[212:213]
v_pk_mul_f32 v[198:199], v[198:199], v[214:215]
v_cvt_pk_bf16_f32 v32, v192, v193
v_cvt_pk_bf16_f32 v33, v194, v195
v_cvt_pk_bf16_f32 v34, v196, v197
v_cvt_pk_bf16_f32 v35, v198, v199
buffer_store_dwordx4 v[32:35], v7, s[16:19], s30 offen offset:0 sc1
v_max_f32 v200, 0, v200
v_max_f32 v201, 0, v201
v_max_f32 v202, 0, v202
v_max_f32 v203, 0, v203
v_max_f32 v204, 0, v204
v_max_f32 v205, 0, v205
v_max_f32 v206, 0, v206
v_max_f32 v207, 0, v207
v_pk_mul_f32 v[200:201], v[200:201], v[216:217]
v_pk_mul_f32 v[202:203], v[202:203], v[218:219]
v_pk_mul_f32 v[204:205], v[204:205], v[220:221]
v_pk_mul_f32 v[206:207], v[206:207], v[222:223]
v_cvt_pk_bf16_f32 v36, v200, v201
v_cvt_pk_bf16_f32 v37, v202, v203
v_cvt_pk_bf16_f32 v38, v204, v205
v_cvt_pk_bf16_f32 v39, v206, v207
buffer_store_dwordx4 v[36:39], v7, s[16:19], s30 offen offset:1024 sc1
s_add_u32 s30, s30, 57344
v_max_f32 v224, 0, v224
v_max_f32 v225, 0, v225
v_max_f32 v226, 0, v226
v_max_f32 v227, 0, v227
v_max_f32 v228, 0, v228
v_max_f32 v229, 0, v229
v_max_f32 v230, 0, v230
v_max_f32 v231, 0, v231
v_pk_mul_f32 v[224:225], v[224:225], v[240:241]
v_pk_mul_f32 v[226:227], v[226:227], v[242:243]
v_pk_mul_f32 v[228:229], v[228:229], v[244:245]
v_pk_mul_f32 v[230:231], v[230:231], v[246:247]
v_cvt_pk_bf16_f32 v40, v224, v225
v_cvt_pk_bf16_f32 v41, v226, v227
v_cvt_pk_bf16_f32 v42, v228, v229
v_cvt_pk_bf16_f32 v43, v230, v231
buffer_store_dwordx4 v[40:43], v7, s[16:19], s30 offen offset:0 sc1
v_max_f32 v232, 0, v232
v_max_f32 v233, 0, v233
v_max_f32 v234, 0, v234
v_max_f32 v235, 0, v235
v_max_f32 v236, 0, v236
v_max_f32 v237, 0, v237
v_max_f32 v238, 0, v238
v_max_f32 v239, 0, v239
v_pk_mul_f32 v[232:233], v[232:233], v[248:249]
v_pk_mul_f32 v[234:235], v[234:235], v[250:251]
v_pk_mul_f32 v[236:237], v[236:237], v[252:253]
v_pk_mul_f32 v[238:239], v[238:239], v[254:255]
v_cvt_pk_bf16_f32 v44, v232, v233
v_cvt_pk_bf16_f32 v45, v234, v235
v_cvt_pk_bf16_f32 v46, v236, v237
v_cvt_pk_bf16_f32 v47, v238, v239
buffer_store_dwordx4 v[44:47], v7, s[16:19], s30 offen offset:1024 sc1
s_add_u32 s30, s30, 57344
s_load_dwordx2 s[40:41], s[0:1], 72
s_load_dwordx2 s[44:45], s[0:1], 80
s_load_dwordx2 s[46:47], s[0:1], 96
v_and_b32 v1, 63, v0
v_lshrrev_b32 v3, 6, v0
v_lshlrev_b32 v2, 4, v1
s_nop 0
v_readfirstlane_b32 s20, v3
s_lshl_b32 s27, s100, 1
s_add_u32 s3, s27, 1
s_sub_u32 s4, s101, 7
s_cmp_ge_u32 s101, 7
s_cselect_b32 s27, s3, s27
s_cselect_b32 s28, s4, s101
v_lshrrev_b32 v3, 3, v1
s_movk_i32 s26, 896
v_mul_lo_u32 v3, v3, s26
v_and_b32 v4, 7, v1
v_lshrrev_b32 v4, 1, v4
v_lshrrev_b32 v5, 4, v1
v_xor_b32 v4, v4, v5
v_lshlrev_b32 v4, 5, v4
v_and_b32 v5, 1, v1
v_lshlrev_b32 v5, 4, v5
v_add3_u32 v3, v3, v4, v5
s_lshl_b32 s26, s28, 7
v_add_u32 v3, s26, v3
v_add_u32 v8, 0, v3
v_add_u32 v9, 6144, v3
v_add_u32 v10, 12288, v3
v_add_u32 v11, 18432, v3
v_add_u32 v12, 0, v2
v_add_u32 v13, 57344, v2
v_add_u32 v14, 114688, v2
v_add_u32 v15, 172032, v2
v_and_b32 v3, 15, v1
v_lshrrev_b32 v3, 2, v3
v_lshrrev_b32 v4, 4, v1
v_lshl_add_u32 v5, v4, 2, v3
v_lshlrev_b32 v5, 7, v5
v_lshrrev_b32 v3, 1, v3
v_lshl_add_u32 v3, v4, 1, v3
v_and_b32 v3, 3, v3
v_and_b32 v4, 3, v1
v_lshl_add_u32 v5, v4, 3, v5
s_lshl_b32 s25, s20, 14
v_add_u32 v5, s25, v5
v_xor_b32 v4, 0, v3
v_lshl_add_u32 v16, v4, 5, v5
v_xor_b32 v4, 1, v3
v_lshl_add_u32 v17, v4, 5, v5
v_xor_b32 v4, 2, v3
v_lshl_add_u32 v18, v4, 5, v5
v_xor_b32 v4, 3, v3
v_lshl_add_u32 v19, v4, 5, v5
v_and_b32 v4, 15, v1
s_lshl_b32 s26, s27, 6
s_lshl_b32 s29, s20, 4
s_add_u32 s26, s26, s29
v_add_u32 v4, s26, v4
s_movk_i32 s26, 896
v_mul_lo_u32 v4, v4, s26
v_lshrrev_b32 v5, 4, v1
v_lshlrev_b32 v5, 3, v5
s_lshl_b32 s26, s28, 7
v_add3_u32 v20, v4, v5, s26
v_and_b32 v4, 15, v1
v_lshrrev_b32 v5, 3, v4
v_mul_u32_u24 v5, 7168, v5
v_and_b32 v4, 7, v4
v_lshrrev_b32 v6, 4, v1
v_lshl_add_u32 v4, v6, 3, v4
v_lshl_add_u32 v21, v4, 4, v5
s_waitcnt lgkmcnt(0)
s_mov_b32 s8, s40
s_mov_b32 s9, s41
s_mov_b32 s10, 1605632
s_mov_b32 s11, 0x20000
s_mul_i32 s26, s20, 14
s_mul_i32 s21, s26, 28672
s_lshl_b32 s22, s26, 10
s_mul_i32 s26, s27, 229376
s_add_u32 s22, s22, s26
s_waitcnt vmcnt(0)
s_barrier
s_add_u32 s90, s100, 32
s_lshl_b32 s90, s90, 7
v_mov_b32 v25, s90
v_mov_b32 v24, 1
s_cmp_lg_u32 s20, 0
s_cbranch_scc1 K2G_pub
v_cmp_eq_u32 vcc, 0, v7
s_and_saveexec_b64 s[90:91], vcc
buffer_atomic_add v24, v25, s[92:95], 0 offen sc1
s_mov_b64 exec, s[90:91]
K2G_pub:
s_add_u32 m0, s25, 0
s_nop 0
buffer_load_dwordx4 v8, s[8:11], s21 offen lds
buffer_load_dwordx4 v9, s[8:11], s21 offen offset:1024 lds
buffer_load_dwordx4 v10, s[8:11], s21 offen offset:2048 lds
buffer_load_dwordx4 v11, s[8:11], s21 offen offset:3072 lds
s_add_u32 s21, s21, 28672
s_add_u32 m0, s25, 4096
s_nop 0
buffer_load_dwordx4 v8, s[8:11], s21 offen lds
buffer_load_dwordx4 v9, s[8:11], s21 offen offset:1024 lds
buffer_load_dwordx4 v10, s[8:11], s21 offen offset:2048 lds
buffer_load_dwordx4 v11, s[8:11], s21 offen offset:3072 lds
s_add_u32 s21, s21, 28672
s_add_u32 m0, s25, 8192
s_nop 0
buffer_load_dwordx4 v8, s[8:11], s21 offen lds
buffer_load_dwordx4 v9, s[8:11], s21 offen offset:1024 lds
buffer_load_dwordx4 v10, s[8:11], s21 offen offset:2048 lds
buffer_load_dwordx4 v11, s[8:11], s21 offen offset:3072 lds
s_add_u32 s21, s21, 28672
v_accvgpr_write_b32 a0, 0
v_accvgpr_write_b32 a1, 0
v_accvgpr_write_b32 a2, 0
v_accvgpr_write_b32 a3, 0
v_accvgpr_write_b32 a4, 0
v_accvgpr_write_b32 a5, 0
v_accvgpr_write_b32 a6, 0
v_accvgpr_write_b32 a7, 0
v_accvgpr_write_b32 a8, 0
v_accvgpr_write_b32 a9, 0
v_accvgpr_write_b32 a10, 0
v_accvgpr_write_b32 a11, 0
v_accvgpr_write_b32 a12, 0
v_accvgpr_write_b32 a13, 0
v_accvgpr_write_b32 a14, 0
v_accvgpr_write_b32 a15, 0
v_accvgpr_write_b32 a16, 0
v_accvgpr_write_b32 a17, 0
v_accvgpr_write_b32 a18, 0
v_accvgpr_write_b32 a19, 0
v_accvgpr_write_b32 a20, 0
v_accvgpr_write_b32 a21, 0
v_accvgpr_write_b32 a22, 0
v_accvgpr_write_b32 a23, 0
v_accvgpr_write_b32 a24, 0
v_accvgpr_write_b32 a25, 0
v_accvgpr_write_b32 a26, 0
v_accvgpr_write_b32 a27, 0
v_accvgpr_write_b32 a28, 0
v_accvgpr_write_b32 a29, 0
v_accvgpr_write_b32 a30, 0
v_accvgpr_write_b32 a31, 0
v_accvgpr_write_b32 a32, 0
v_accvgpr_write_b32 a33, 0
v_accvgpr_write_b32 a34, 0
v_accvgpr_write_b32 a35, 0
v_accvgpr_write_b32 a36, 0
v_accvgpr_write_b32 a37, 0
v_accvgpr_write_b32 a38, 0
v_accvgpr_write_b32 a39, 0
v_accvgpr_write_b32 a40, 0
v_accvgpr_write_b32 a41, 0
v_accvgpr_write_b32 a42, 0
v_accvgpr_write_b32 a43, 0
v_accvgpr_write_b32 a44, 0
v_accvgpr_write_b32 a45, 0
v_accvgpr_write_b32 a46, 0
v_accvgpr_write_b32 a47, 0
v_accvgpr_write_b32 a48, 0
v_accvgpr_write_b32 a49, 0
v_accvgpr_write_b32 a50, 0
v_accvgpr_write_b32 a51, 0
v_accvgpr_write_b32 a52, 0
v_accvgpr_write_b32 a53, 0
v_accvgpr_write_b32 a54, 0
v_accvgpr_write_b32 a55, 0
v_accvgpr_write_b32 a56, 0
v_accvgpr_write_b32 a57, 0
v_accvgpr_write_b32 a58, 0
v_accvgpr_write_b32 a59, 0
v_accvgpr_write_b32 a60, 0
v_accvgpr_write_b32 a61, 0
v_accvgpr_write_b32 a62, 0
v_accvgpr_write_b32 a63, 0
s_add_u32 s12, s46, 81788928
s_addc_u32 s13, s47, 0
s_mov_b32 s14, 7340032
s_mov_b32 s15, 0x20000
s_add_u32 s16, s46, 77594624
s_addc_u32 s17, s47, 0
s_mov_b32 s18, 1835008
s_mov_b32 s19, 0x20000
s_mov_b32 s36, s44
s_mov_b32 s37, s45
s_mov_b32 s38, 1835008
s_mov_b32 s39, 0x20000
s_lshl_b32 s26, s27, 3
s_lshl_b32 s29, s20, 1
s_add_u32 s26, s26, s29
s_mul_i32 s26, s26, 7168
s_lshl_b32 s29, s28, 10
s_add_u32 s26, s26, s29
buffer_load_dwordx2 v[128:129], v21, s[16:19], s26 offen offset:0 sc1
buffer_load_dwordx2 v[130:131], v21, s[16:19], s26 offen offset:8 sc1
buffer_load_dwordx2 v[132:133], v21, s[16:19], s26 offen offset:512 sc1
buffer_load_dwordx2 v[134:135], v21, s[16:19], s26 offen offset:520 sc1
s_cmp_lg_u32 s20, 0
s_cbranch_scc1 K2D_w_got
s_add_u32 s90, s100, 32
s_lshl_b32 s90, s90, 7
v_mov_b32 v25, s90
s_mov_b32 s91, 0
K2D_w_spin:
buffer_load_dword v24, v25, s[92:95], 0 offen sc1
s_waitcnt vmcnt(0)
v_readfirstlane_b32 s90, v24
s_nop 3
s_cmp_ge_u32 s90, 14
s_cbranch_scc1 K2D_w_got
s_add_u32 s91, s91, 1
s_cmp_lt_u32 s91, 0x40000
s_cbranch_scc0 K2D_w_got
s_sleep 2
s_branch K2D_w_spin
K2D_w_got:
s_barrier
buffer_load_dwordx4 v[32:35], v12, s[12:15], s22 offen sc1
buffer_load_dwordx4 v[36:39], v13, s[12:15], s22 offen sc1
buffer_load_dwordx4 v[40:43], v14, s[12:15], s22 offen sc1
buffer_load_dwordx4 v[44:47], v15, s[12:15], s22 offen sc1
s_add_u32 s22, s22, 1024
buffer_load_dwordx4 v[48:51], v12, s[12:15], s22 offen sc1
buffer_load_dwordx4 v[52:55], v13, s[12:15], s22 offen sc1
buffer_load_dwordx4 v[56:59], v14, s[12:15], s22 offen sc1
buffer_load_dwordx4 v[60:63], v15, s[12:15], s22 offen sc1
s_add_u32 s22, s22, 1024
buffer_load_dwordx4 v[64:67], v12, s[12:15], s22 offen sc1
buffer_load_dwordx4 v[68:71], v13, s[12:15], s22 offen sc1
buffer_load_dwordx4 v[72:75], v14, s[12:15], s22 offen sc1
buffer_load_dwordx4 v[76:79], v15, s[12:15], s22 offen sc1
s_add_u32 s22, s22, 1024
s_waitcnt vmcnt(24)
ds_read_b64_tr_b16 v[96:97], v16 offset:0
ds_read_b64_tr_b16 v[98:99], v16 offset:2048
ds_read_b64_tr_b16 v[100:101], v17 offset:0
ds_read_b64_tr_b16 v[102:103], v17 offset:2048
ds_read_b64_tr_b16 v[104:105], v18 offset:0
ds_read_b64_tr_b16 v[106:107], v18 offset:2048
ds_read_b64_tr_b16 v[108:109], v19 offset:0
ds_read_b64_tr_b16 v[110:111], v19 offset:2048
s_waitcnt vmcnt(8) lgkmcnt(0)
v_mfma_f32_16x16x32_bf16 a[0:3], v[96:99], v[32:35], a[0:3]
s_add_u32 m0, s25, 12288
ds_read_b64_tr_b16 v[112:113], v16 offset:4096
s_nop 0
v_mfma_f32_16x16x32_bf16 a[4:7], v[96:99], v[36:39], a[4:7]
ds_read_b64_tr_b16 v[114:115], v16 offset:6144
v_mfma_f32_16x16x32_bf16 a[8:11], v[96:99], v[40:43], a[8:11]
ds_read_b64_tr_b16 v[116:117], v17 offset:4096
v_mfma_f32_16x16x32_bf16 a[12:15], v[96:99], v[44:47], a[12:15]
ds_read_b64_tr_b16 v[118:119], v17 offset:6144
v_mfma_f32_16x16x32_bf16 a[16:19], v[100:103], v[32:35], a[16:19]
ds_read_b64_tr_b16 v[120:121], v18 offset:4096
v_mfma_f32_16x16x32_bf16 a[20:23], v[100:103], v[36:39], a[20:23]
ds_read_b64_tr_b16 v[122:123], v18 offset:6144
v_mfma_f32_16x16x32_bf16 a[24:27], v[100:103], v[40:43], a[24:27]
ds_read_b64_tr_b16 v[124:125], v19 offset:4096
v_mfma_f32_16x16x32_bf16 a[28:31], v[100:103], v[44:47], a[28:31]
ds_read_b64_tr_b16 v[126:127], v19 offset:6144
v_mfma_f32_16x16x32_bf16 a[32:35], v[104:107], v[32:35], a[32:35]
buffer_load_dwordx4 v8, s[8:11], s21 offen lds
v_mfma_f32_16x16x32_bf16 a[36:39], v[104:107], v[36:39], a[36:39]
buffer_load_dwordx4 v9, s[8:11], s21 offen offset:1024 lds
v_mfma_f32_16x16x32_bf16 a[40:43], v[104:107], v[40:43], a[40:43]
buffer_load_dwordx4 v10, s[8:11], s21 offen offset:2048 lds
v_mfma_f32_16x16x32_bf16 a[44:47], v[104:107], v[44:47], a[44:47]
buffer_load_dwordx4 v11, s[8:11], s21 offen offset:3072 lds
v_mfma_f32_16x16x32_bf16 a[48:51], v[108:111], v[32:35], a[48:51]
s_add_u32 s21, s21, 28672
buffer_load_dwordx4 v[80:83], v12, s[12:15], s22 offen sc1
v_mfma_f32_16x16x32_bf16 a[52:55], v[108:111], v[36:39], a[52:55]
buffer_load_dwordx4 v[84:87], v13, s[12:15], s22 offen sc1
v_mfma_f32_16x16x32_bf16 a[56:59], v[108:111], v[40:43], a[56:59]
buffer_load_dwordx4 v[88:91], v14, s[12:15], s22 offen sc1
v_mfma_f32_16x16x32_bf16 a[60:63], v[108:111], v[44:47], a[60:63]
buffer_load_dwordx4 v[92:95], v15, s[12:15], s22 offen sc1
s_add_u32 s22, s22, 1024
s_waitcnt vmcnt(12) lgkmcnt(0)
v_mfma_f32_16x16x32_bf16 a[0:3], v[112:115], v[48:51], a[0:3]
s_add_u32 m0, s25, 0
ds_read_b64_tr_b16 v[96:97], v16 offset:8192
s_nop 0
v_mfma_f32_16x16x32_bf16 a[4:7], v[112:115], v[52:55], a[4:7]
ds_read_b64_tr_b16 v[98:99], v16 offset:10240
v_mfma_f32_16x16x32_bf16 a[8:11], v[112:115], v[56:59], a[8:11]
ds_read_b64_tr_b16 v[100:101], v17 offset:8192
v_mfma_f32_16x16x32_bf16 a[12:15], v[112:115], v[60:63], a[12:15]
ds_read_b64_tr_b16 v[102:103], v17 offset:10240
v_mfma_f32_16x16x32_bf16 a[16:19], v[116:119], v[48:51], a[16:19]
ds_read_b64_tr_b16 v[104:105], v18 offset:8192
v_mfma_f32_16x16x32_bf16 a[20:23], v[116:119], v[52:55], a[20:23]
ds_read_b64_tr_b16 v[106:107], v18 offset:10240
v_mfma_f32_16x16x32_bf16 a[24:27], v[116:119], v[56:59], a[24:27]
ds_read_b64_tr_b16 v[108:109], v19 offset:8192
v_mfma_f32_16x16x32_bf16 a[28:31], v[116:119], v[60:63], a[28:31]
ds_read_b64_tr_b16 v[110:111], v19 offset:10240
v_mfma_f32_16x16x32_bf16 a[32:35], v[120:123], v[48:51], a[32:35]
buffer_load_dwordx4 v8, s[8:11], s21 offen lds
v_mfma_f32_16x16x32_bf16 a[36:39], v[120:123], v[52:55], a[36:39]
buffer_load_dwordx4 v9, s[8:11], s21 offen offset:1024 lds
v_mfma_f32_16x16x32_bf16 a[40:43], v[120:123], v[56:59], a[40:43]
buffer_load_dwordx4 v10, s[8:11], s21 offen offset:2048 lds
v_mfma_f32_16x16x32_bf16 a[44:47], v[120:123], v[60:63], a[44:47]
buffer_load_dwordx4 v11, s[8:11], s21 offen offset:3072 lds
v_mfma_f32_16x16x32_bf16 a[48:51], v[124:127], v[48:51], a[48:51]
s_add_u32 s21, s21, 28672
buffer_load_dwordx4 v[32:35], v12, s[12:15], s22 offen sc1
v_mfma_f32_16x16x32_bf16 a[52:55], v[124:127], v[52:55], a[52:55]
buffer_load_dwordx4 v[36:39], v13, s[12:15], s22 offen sc1
v_mfma_f32_16x16x32_bf16 a[56:59], v[124:127], v[56:59], a[56:59]
buffer_load_dwordx4 v[40:43], v14, s[12:15], s22 offen sc1
v_mfma_f32_16x16x32_bf16 a[60:63], v[124:127], v[60:63], a[60:63]
buffer_load_dwordx4 v[44:47], v15, s[12:15], s22 offen sc1
s_add_u32 s22, s22, 1024
s_waitcnt vmcnt(12) lgkmcnt(0)
v_mfma_f32_16x16x32_bf16 a[0:3], v[96:99], v[64:67], a[0:3]
s_add_u32 m0, s25, 4096
ds_read_b64_tr_b16 v[112:113], v16 offset:12288
s_nop 0
v_mfma_f32_16x16x32_bf16 a[4:7], v[96:99], v[68:71], a[4:7]
ds_read_b64_tr_b16 v[114:115], v16 offset:14336
v_mfma_f32_16x16x32_bf16 a[8:11], v[96:99], v[72:75], a[8:11]
ds_read_b64_tr_b16 v[116:117], v17 offset:12288
v_mfma_f32_16x16x32_bf16 a[12:15], v[96:99], v[76:79], a[12:15]
ds_read_b64_tr_b16 v[118:119], v17 offset:14336
v_mfma_f32_16x16x32_bf16 a[16:19], v[100:103], v[64:67], a[16:19]
ds_read_b64_tr_b16 v[120:121], v18 offset:12288
v_mfma_f32_16x16x32_bf16 a[20:23], v[100:103], v[68:71], a[20:23]
ds_read_b64_tr_b16 v[122:123], v18 offset:14336
v_mfma_f32_16x16x32_bf16 a[24:27], v[100:103], v[72:75], a[24:27]
ds_read_b64_tr_b16 v[124:125], v19 offset:12288
v_mfma_f32_16x16x32_bf16 a[28:31], v[100:103], v[76:79], a[28:31]
ds_read_b64_tr_b16 v[126:127], v19 offset:14336
v_mfma_f32_16x16x32_bf16 a[32:35], v[104:107], v[64:67], a[32:35]
buffer_load_dwordx4 v8, s[8:11], s21 offen lds
v_mfma_f32_16x16x32_bf16 a[36:39], v[104:107], v[68:71], a[36:39]
buffer_load_dwordx4 v9, s[8:11], s21 offen offset:1024 lds
v_mfma_f32_16x16x32_bf16 a[40:43], v[104:107], v[72:75], a[40:43]
buffer_load_dwordx4 v10, s[8:11], s21 offen offset:2048 lds
v_mfma_f32_16x16x32_bf16 a[44:47], v[104:107], v[76:79], a[44:47]
buffer_load_dwordx4 v11, s[8:11], s21 offen offset:3072 lds
v_mfma_f32_16x16x32_bf16 a[48:51], v[108:111], v[64:67], a[48:51]
s_add_u32 s21, s21, 28672
buffer_load_dwordx4 v[48:51], v12, s[12:15], s22 offen sc1
v_mfma_f32_16x16x32_bf16 a[52:55], v[108:111], v[68:71], a[52:55]
buffer_load_dwordx4 v[52:55], v13, s[12:15], s22 offen sc1
v_mfma_f32_16x16x32_bf16 a[56:59], v[108:111], v[72:75], a[56:59]
buffer_load_dwordx4 v[56:59], v14, s[12:15], s22 offen sc1
v_mfma_f32_16x16x32_bf16 a[60:63], v[108:111], v[76:79], a[60:63]
buffer_load_dwordx4 v[60:63], v15, s[12:15], s22 offen sc1
s_add_u32 s22, s22, 1024
s_waitcnt vmcnt(12) lgkmcnt(0)
v_mfma_f32_16x16x32_bf16 a[0:3], v[112:115], v[80:83], a[0:3]
s_add_u32 m0, s25, 8192
ds_read_b64_tr_b16 v[96:97], v16 offset:0
s_nop 0
v_mfma_f32_16x16x32_bf16 a[4:7], v[112:115], v[84:87], a[4:7]
ds_read_b64_tr_b16 v[98:99], v16 offset:2048
v_mfma_f32_16x16x32_bf16 a[8:11], v[112:115], v[88:91], a[8:11]
ds_read_b64_tr_b16 v[100:101], v17 offset:0
v_mfma_f32_16x16x32_bf16 a[12:15], v[112:115], v[92:95], a[12:15]
ds_read_b64_tr_b16 v[102:103], v17 offset:2048
v_mfma_f32_16x16x32_bf16 a[16:19], v[116:119], v[80:83], a[16:19]
ds_read_b64_tr_b16 v[104:105], v18 offset:0
v_mfma_f32_16x16x32_bf16 a[20:23], v[116:119], v[84:87], a[20:23]
ds_read_b64_tr_b16 v[106:107], v18 offset:2048
v_mfma_f32_16x16x32_bf16 a[24:27], v[116:119], v[88:91], a[24:27]
ds_read_b64_tr_b16 v[108:109], v19 offset:0
v_mfma_f32_16x16x32_bf16 a[28:31], v[116:119], v[92:95], a[28:31]
ds_read_b64_tr_b16 v[110:111], v19 offset:2048
v_mfma_f32_16x16x32_bf16 a[32:35], v[120:123], v[80:83], a[32:35]
buffer_load_dwordx4 v8, s[8:11], s21 offen lds
v_mfma_f32_16x16x32_bf16 a[36:39], v[120:123], v[84:87], a[36:39]
buffer_load_dwordx4 v9, s[8:11], s21 offen offset:1024 lds
v_mfma_f32_16x16x32_bf16 a[40:43], v[120:123], v[88:91], a[40:43]
buffer_load_dwordx4 v10, s[8:11], s21 offen offset:2048 lds
v_mfma_f32_16x16x32_bf16 a[44:47], v[120:123], v[92:95], a[44:47]
buffer_load_dwordx4 v11, s[8:11], s21 offen offset:3072 lds
v_mfma_f32_16x16x32_bf16 a[48:51], v[124:127], v[80:83], a[48:51]
s_add_u32 s21, s21, 28672
buffer_load_dwordx4 v[64:67], v12, s[12:15], s22 offen sc1
v_mfma_f32_16x16x32_bf16 a[52:55], v[124:127], v[84:87], a[52:55]
buffer_load_dwordx4 v[68:71], v13, s[12:15], s22 offen sc1
v_mfma_f32_16x16x32_bf16 a[56:59], v[124:127], v[88:91], a[56:59]
buffer_load_dwordx4 v[72:75], v14, s[12:15], s22 offen sc1
v_mfma_f32_16x16x32_bf16 a[60:63], v[124:127], v[92:95], a[60:63]
buffer_load_dwordx4 v[76:79], v15, s[12:15], s22 offen sc1
s_add_u32 s22, s22, 1024
s_waitcnt vmcnt(12) lgkmcnt(0)
v_mfma_f32_16x16x32_bf16 a[0:3], v[96:99], v[32:35], a[0:3]
s_add_u32 m0, s25, 12288
ds_read_b64_tr_b16 v[112:113], v16 offset:4096
s_nop 0
v_mfma_f32_16x16x32_bf16 a[4:7], v[96:99], v[36:39], a[4:7]
ds_read_b64_tr_b16 v[114:115], v16 offset:6144
v_mfma_f32_16x16x32_bf16 a[8:11], v[96:99], v[40:43], a[8:11]
ds_read_b64_tr_b16 v[116:117], v17 offset:4096
v_mfma_f32_16x16x32_bf16 a[12:15], v[96:99], v[44:47], a[12:15]
ds_read_b64_tr_b16 v[118:119], v17 offset:6144
v_mfma_f32_16x16x32_bf16 a[16:19], v[100:103], v[32:35], a[16:19]
ds_read_b64_tr_b16 v[120:121], v18 offset:4096
v_mfma_f32_16x16x32_bf16 a[20:23], v[100:103], v[36:39], a[20:23]
ds_read_b64_tr_b16 v[122:123], v18 offset:6144
v_mfma_f32_16x16x32_bf16 a[24:27], v[100:103], v[40:43], a[24:27]
ds_read_b64_tr_b16 v[124:125], v19 offset:4096
v_mfma_f32_16x16x32_bf16 a[28:31], v[100:103], v[44:47], a[28:31]
ds_read_b64_tr_b16 v[126:127], v19 offset:6144
v_mfma_f32_16x16x32_bf16 a[32:35], v[104:107], v[32:35], a[32:35]
buffer_load_dwordx4 v8, s[8:11], s21 offen lds
v_mfma_f32_16x16x32_bf16 a[36:39], v[104:107], v[36:39], a[36:39]
buffer_load_dwordx4 v9, s[8:11], s21 offen offset:1024 lds
v_mfma_f32_16x16x32_bf16 a[40:43], v[104:107], v[40:43], a[40:43]
buffer_load_dwordx4 v10, s[8:11], s21 offen offset:2048 lds
v_mfma_f32_16x16x32_bf16 a[44:47], v[104:107], v[44:47], a[44:47]
buffer_load_dwordx4 v11, s[8:11], s21 offen offset:3072 lds
v_mfma_f32_16x16x32_bf16 a[48:51], v[108:111], v[32:35], a[48:51]
s_add_u32 s21, s21, 28672
buffer_load_dwordx4 v[80:83], v12, s[12:15], s22 offen sc1
v_mfma_f32_16x16x32_bf16 a[52:55], v[108:111], v[36:39], a[52:55]
buffer_load_dwordx4 v[84:87], v13, s[12:15], s22 offen sc1
v_mfma_f32_16x16x32_bf16 a[56:59], v[108:111], v[40:43], a[56:59]
buffer_load_dwordx4 v[88:91], v14, s[12:15], s22 offen sc1
v_mfma_f32_16x16x32_bf16 a[60:63], v[108:111], v[44:47], a[60:63]
buffer_load_dwordx4 v[92:95], v15, s[12:15], s22 offen sc1
s_add_u32 s22, s22, 1024
s_waitcnt vmcnt(12) lgkmcnt(0)
v_mfma_f32_16x16x32_bf16 a[0:3], v[112:115], v[48:51], a[0:3]
s_add_u32 m0, s25, 0
ds_read_b64_tr_b16 v[96:97], v16 offset:8192
s_nop 0
v_mfma_f32_16x16x32_bf16 a[4:7], v[112:115], v[52:55], a[4:7]
ds_read_b64_tr_b16 v[98:99], v16 offset:10240
v_mfma_f32_16x16x32_bf16 a[8:11], v[112:115], v[56:59], a[8:11]
ds_read_b64_tr_b16 v[100:101], v17 offset:8192
v_mfma_f32_16x16x32_bf16 a[12:15], v[112:115], v[60:63], a[12:15]
ds_read_b64_tr_b16 v[102:103], v17 offset:10240
v_mfma_f32_16x16x32_bf16 a[16:19], v[116:119], v[48:51], a[16:19]
ds_read_b64_tr_b16 v[104:105], v18 offset:8192
v_mfma_f32_16x16x32_bf16 a[20:23], v[116:119], v[52:55], a[20:23]
ds_read_b64_tr_b16 v[106:107], v18 offset:10240
v_mfma_f32_16x16x32_bf16 a[24:27], v[116:119], v[56:59], a[24:27]
ds_read_b64_tr_b16 v[108:109], v19 offset:8192
v_mfma_f32_16x16x32_bf16 a[28:31], v[116:119], v[60:63], a[28:31]
ds_read_b64_tr_b16 v[110:111], v19 offset:10240
v_mfma_f32_16x16x32_bf16 a[32:35], v[120:123], v[48:51], a[32:35]
buffer_load_dwordx4 v8, s[8:11], s21 offen lds
v_mfma_f32_16x16x32_bf16 a[36:39], v[120:123], v[52:55], a[36:39]
buffer_load_dwordx4 v9, s[8:11], s21 offen offset:1024 lds
v_mfma_f32_16x16x32_bf16 a[40:43], v[120:123], v[56:59], a[40:43]
buffer_load_dwordx4 v10, s[8:11], s21 offen offset:2048 lds
v_mfma_f32_16x16x32_bf16 a[44:47], v[120:123], v[60:63], a[44:47]
buffer_load_dwordx4 v11, s[8:11], s21 offen offset:3072 lds
v_mfma_f32_16x16x32_bf16 a[48:51], v[124:127], v[48:51], a[48:51]
s_add_u32 s21, s21, 28672
buffer_load_dwordx4 v[32:35], v12, s[12:15], s22 offen sc1
v_mfma_f32_16x16x32_bf16 a[52:55], v[124:127], v[52:55], a[52:55]
buffer_load_dwordx4 v[36:39], v13, s[12:15], s22 offen sc1
v_mfma_f32_16x16x32_bf16 a[56:59], v[124:127], v[56:59], a[56:59]
buffer_load_dwordx4 v[40:43], v14, s[12:15], s22 offen sc1
v_mfma_f32_16x16x32_bf16 a[60:63], v[124:127], v[60:63], a[60:63]
buffer_load_dwordx4 v[44:47], v15, s[12:15], s22 offen sc1
s_add_u32 s22, s22, 1024
s_waitcnt vmcnt(12) lgkmcnt(0)
v_mfma_f32_16x16x32_bf16 a[0:3], v[96:99], v[64:67], a[0:3]
s_add_u32 m0, s25, 4096
ds_read_b64_tr_b16 v[112:113], v16 offset:12288
s_nop 0
v_mfma_f32_16x16x32_bf16 a[4:7], v[96:99], v[68:71], a[4:7]
ds_read_b64_tr_b16 v[114:115], v16 offset:14336
v_mfma_f32_16x16x32_bf16 a[8:11], v[96:99], v[72:75], a[8:11]
ds_read_b64_tr_b16 v[116:117], v17 offset:12288
v_mfma_f32_16x16x32_bf16 a[12:15], v[96:99], v[76:79], a[12:15]
ds_read_b64_tr_b16 v[118:119], v17 offset:14336
v_mfma_f32_16x16x32_bf16 a[16:19], v[100:103], v[64:67], a[16:19]
ds_read_b64_tr_b16 v[120:121], v18 offset:12288
v_mfma_f32_16x16x32_bf16 a[20:23], v[100:103], v[68:71], a[20:23]
ds_read_b64_tr_b16 v[122:123], v18 offset:14336
v_mfma_f32_16x16x32_bf16 a[24:27], v[100:103], v[72:75], a[24:27]
ds_read_b64_tr_b16 v[124:125], v19 offset:12288
v_mfma_f32_16x16x32_bf16 a[28:31], v[100:103], v[76:79], a[28:31]
ds_read_b64_tr_b16 v[126:127], v19 offset:14336
v_mfma_f32_16x16x32_bf16 a[32:35], v[104:107], v[64:67], a[32:35]
buffer_load_dwordx4 v8, s[8:11], s21 offen lds
v_mfma_f32_16x16x32_bf16 a[36:39], v[104:107], v[68:71], a[36:39]
buffer_load_dwordx4 v9, s[8:11], s21 offen offset:1024 lds
v_mfma_f32_16x16x32_bf16 a[40:43], v[104:107], v[72:75], a[40:43]
buffer_load_dwordx4 v10, s[8:11], s21 offen offset:2048 lds
v_mfma_f32_16x16x32_bf16 a[44:47], v[104:107], v[76:79], a[44:47]
buffer_load_dwordx4 v11, s[8:11], s21 offen offset:3072 lds
v_mfma_f32_16x16x32_bf16 a[48:51], v[108:111], v[64:67], a[48:51]
s_add_u32 s21, s21, 28672
buffer_load_dwordx4 v[48:51], v12, s[12:15], s22 offen sc1
v_mfma_f32_16x16x32_bf16 a[52:55], v[108:111], v[68:71], a[52:55]
buffer_load_dwordx4 v[52:55], v13, s[12:15], s22 offen sc1
v_mfma_f32_16x16x32_bf16 a[56:59], v[108:111], v[72:75], a[56:59]
buffer_load_dwordx4 v[56:59], v14, s[12:15], s22 offen sc1
v_mfma_f32_16x16x32_bf16 a[60:63], v[108:111], v[76:79], a[60:63]
buffer_load_dwordx4 v[60:63], v15, s[12:15], s22 offen sc1
s_add_u32 s22, s22, 1024
s_waitcnt vmcnt(12) lgkmcnt(0)
v_mfma_f32_16x16x32_bf16 a[0:3], v[112:115], v[80:83], a[0:3]
s_add_u32 m0, s25, 8192
ds_read_b64_tr_b16 v[96:97], v16 offset:0
s_nop 0
v_mfma_f32_16x16x32_bf16 a[4:7], v[112:115], v[84:87], a[4:7]
ds_read_b64_tr_b16 v[98:99], v16 offset:2048
v_mfma_f32_16x16x32_bf16 a[8:11], v[112:115], v[88:91], a[8:11]
ds_read_b64_tr_b16 v[100:101], v17 offset:0
v_mfma_f32_16x16x32_bf16 a[12:15], v[112:115], v[92:95], a[12:15]
ds_read_b64_tr_b16 v[102:103], v17 offset:2048
v_mfma_f32_16x16x32_bf16 a[16:19], v[116:119], v[80:83], a[16:19]
ds_read_b64_tr_b16 v[104:105], v18 offset:0
v_mfma_f32_16x16x32_bf16 a[20:23], v[116:119], v[84:87], a[20:23]
ds_read_b64_tr_b16 v[106:107], v18 offset:2048
v_mfma_f32_16x16x32_bf16 a[24:27], v[116:119], v[88:91], a[24:27]
ds_read_b64_tr_b16 v[108:109], v19 offset:0
v_mfma_f32_16x16x32_bf16 a[28:31], v[116:119], v[92:95], a[28:31]
ds_read_b64_tr_b16 v[110:111], v19 offset:2048
v_mfma_f32_16x16x32_bf16 a[32:35], v[120:123], v[80:83], a[32:35]
buffer_load_dwordx4 v8, s[8:11], s21 offen lds
v_mfma_f32_16x16x32_bf16 a[36:39], v[120:123], v[84:87], a[36:39]
buffer_load_dwordx4 v9, s[8:11], s21 offen offset:1024 lds
v_mfma_f32_16x16x32_bf16 a[40:43], v[120:123], v[88:91], a[40:43]
buffer_load_dwordx4 v10, s[8:11], s21 offen offset:2048 lds
v_mfma_f32_16x16x32_bf16 a[44:47], v[120:123], v[92:95], a[44:47]
buffer_load_dwordx4 v11, s[8:11], s21 offen offset:3072 lds
v_mfma_f32_16x16x32_bf16 a[48:51], v[124:127], v[80:83], a[48:51]
s_add_u32 s21, s21, 28672
buffer_load_dwordx4 v[64:67], v12, s[12:15], s22 offen sc1
v_mfma_f32_16x16x32_bf16 a[52:55], v[124:127], v[84:87], a[52:55]
buffer_load_dwordx4 v[68:71], v13, s[12:15], s22 offen sc1
v_mfma_f32_16x16x32_bf16 a[56:59], v[124:127], v[88:91], a[56:59]
buffer_load_dwordx4 v[72:75], v14, s[12:15], s22 offen sc1
v_mfma_f32_16x16x32_bf16 a[60:63], v[124:127], v[92:95], a[60:63]
buffer_load_dwordx4 v[76:79], v15, s[12:15], s22 offen sc1
s_add_u32 s22, s22, 1024
s_waitcnt vmcnt(12) lgkmcnt(0)
v_mfma_f32_16x16x32_bf16 a[0:3], v[96:99], v[32:35], a[0:3]
s_add_u32 m0, s25, 12288
ds_read_b64_tr_b16 v[112:113], v16 offset:4096
s_nop 0
v_mfma_f32_16x16x32_bf16 a[4:7], v[96:99], v[36:39], a[4:7]
ds_read_b64_tr_b16 v[114:115], v16 offset:6144
v_mfma_f32_16x16x32_bf16 a[8:11], v[96:99], v[40:43], a[8:11]
ds_read_b64_tr_b16 v[116:117], v17 offset:4096
v_mfma_f32_16x16x32_bf16 a[12:15], v[96:99], v[44:47], a[12:15]
ds_read_b64_tr_b16 v[118:119], v17 offset:6144
v_mfma_f32_16x16x32_bf16 a[16:19], v[100:103], v[32:35], a[16:19]
ds_read_b64_tr_b16 v[120:121], v18 offset:4096
v_mfma_f32_16x16x32_bf16 a[20:23], v[100:103], v[36:39], a[20:23]
ds_read_b64_tr_b16 v[122:123], v18 offset:6144
v_mfma_f32_16x16x32_bf16 a[24:27], v[100:103], v[40:43], a[24:27]
ds_read_b64_tr_b16 v[124:125], v19 offset:4096
v_mfma_f32_16x16x32_bf16 a[28:31], v[100:103], v[44:47], a[28:31]
ds_read_b64_tr_b16 v[126:127], v19 offset:6144
v_mfma_f32_16x16x32_bf16 a[32:35], v[104:107], v[32:35], a[32:35]
buffer_load_dwordx4 v8, s[8:11], s21 offen lds
v_mfma_f32_16x16x32_bf16 a[36:39], v[104:107], v[36:39], a[36:39]
buffer_load_dwordx4 v9, s[8:11], s21 offen offset:1024 lds
v_mfma_f32_16x16x32_bf16 a[40:43], v[104:107], v[40:43], a[40:43]
buffer_load_dwordx4 v10, s[8:11], s21 offen offset:2048 lds
v_mfma_f32_16x16x32_bf16 a[44:47], v[104:107], v[44:47], a[44:47]
buffer_load_dwordx4 v11, s[8:11], s21 offen offset:3072 lds
v_mfma_f32_16x16x32_bf16 a[48:51], v[108:111], v[32:35], a[48:51]
s_add_u32 s21, s21, 28672
buffer_load_dwordx4 v[80:83], v12, s[12:15], s22 offen sc1
v_mfma_f32_16x16x32_bf16 a[52:55], v[108:111], v[36:39], a[52:55]
buffer_load_dwordx4 v[84:87], v13, s[12:15], s22 offen sc1
v_mfma_f32_16x16x32_bf16 a[56:59], v[108:111], v[40:43], a[56:59]
buffer_load_dwordx4 v[88:91], v14, s[12:15], s22 offen sc1
v_mfma_f32_16x16x32_bf16 a[60:63], v[108:111], v[44:47], a[60:63]
buffer_load_dwordx4 v[92:95], v15, s[12:15], s22 offen sc1
s_add_u32 s22, s22, 1024
s_waitcnt vmcnt(12) lgkmcnt(0)
v_mfma_f32_16x16x32_bf16 a[0:3], v[112:115], v[48:51], a[0:3]
s_add_u32 m0, s25, 0
ds_read_b64_tr_b16 v[96:97], v16 offset:8192
s_nop 0
v_mfma_f32_16x16x32_bf16 a[4:7], v[112:115], v[52:55], a[4:7]
ds_read_b64_tr_b16 v[98:99], v16 offset:10240
v_mfma_f32_16x16x32_bf16 a[8:11], v[112:115], v[56:59], a[8:11]
ds_read_b64_tr_b16 v[100:101], v17 offset:8192
v_mfma_f32_16x16x32_bf16 a[12:15], v[112:115], v[60:63], a[12:15]
ds_read_b64_tr_b16 v[102:103], v17 offset:10240
v_mfma_f32_16x16x32_bf16 a[16:19], v[116:119], v[48:51], a[16:19]
ds_read_b64_tr_b16 v[104:105], v18 offset:8192
v_mfma_f32_16x16x32_bf16 a[20:23], v[116:119], v[52:55], a[20:23]
ds_read_b64_tr_b16 v[106:107], v18 offset:10240
v_mfma_f32_16x16x32_bf16 a[24:27], v[116:119], v[56:59], a[24:27]
ds_read_b64_tr_b16 v[108:109], v19 offset:8192
v_mfma_f32_16x16x32_bf16 a[28:31], v[116:119], v[60:63], a[28:31]
ds_read_b64_tr_b16 v[110:111], v19 offset:10240
v_mfma_f32_16x16x32_bf16 a[32:35], v[120:123], v[48:51], a[32:35]
buffer_load_dwordx4 v8, s[8:11], s21 offen lds
v_mfma_f32_16x16x32_bf16 a[36:39], v[120:123], v[52:55], a[36:39]
buffer_load_dwordx4 v9, s[8:11], s21 offen offset:1024 lds
v_mfma_f32_16x16x32_bf16 a[40:43], v[120:123], v[56:59], a[40:43]
buffer_load_dwordx4 v10, s[8:11], s21 offen offset:2048 lds
v_mfma_f32_16x16x32_bf16 a[44:47], v[120:123], v[60:63], a[44:47]
buffer_load_dwordx4 v11, s[8:11], s21 offen offset:3072 lds
v_mfma_f32_16x16x32_bf16 a[48:51], v[124:127], v[48:51], a[48:51]
s_add_u32 s21, s21, 28672
buffer_load_dwordx4 v[32:35], v12, s[12:15], s22 offen sc1
v_mfma_f32_16x16x32_bf16 a[52:55], v[124:127], v[52:55], a[52:55]
buffer_load_dwordx4 v[36:39], v13, s[12:15], s22 offen sc1
v_mfma_f32_16x16x32_bf16 a[56:59], v[124:127], v[56:59], a[56:59]
buffer_load_dwordx4 v[40:43], v14, s[12:15], s22 offen sc1
v_mfma_f32_16x16x32_bf16 a[60:63], v[124:127], v[60:63], a[60:63]
buffer_load_dwordx4 v[44:47], v15, s[12:15], s22 offen sc1
s_add_u32 s22, s22, 1024
s_waitcnt vmcnt(12) lgkmcnt(0)
v_mfma_f32_16x16x32_bf16 a[0:3], v[96:99], v[64:67], a[0:3]
s_add_u32 m0, s25, 4096
ds_read_b64_tr_b16 v[112:113], v16 offset:12288
s_nop 0
v_mfma_f32_16x16x32_bf16 a[4:7], v[96:99], v[68:71], a[4:7]
ds_read_b64_tr_b16 v[114:115], v16 offset:14336
v_mfma_f32_16x16x32_bf16 a[8:11], v[96:99], v[72:75], a[8:11]
ds_read_b64_tr_b16 v[116:117], v17 offset:12288
v_mfma_f32_16x16x32_bf16 a[12:15], v[96:99], v[76:79], a[12:15]
ds_read_b64_tr_b16 v[118:119], v17 offset:14336
v_mfma_f32_16x16x32_bf16 a[16:19], v[100:103], v[64:67], a[16:19]
ds_read_b64_tr_b16 v[120:121], v18 offset:12288
v_mfma_f32_16x16x32_bf16 a[20:23], v[100:103], v[68:71], a[20:23]
ds_read_b64_tr_b16 v[122:123], v18 offset:14336
v_mfma_f32_16x16x32_bf16 a[24:27], v[100:103], v[72:75], a[24:27]
ds_read_b64_tr_b16 v[124:125], v19 offset:12288
v_mfma_f32_16x16x32_bf16 a[28:31], v[100:103], v[76:79], a[28:31]
ds_read_b64_tr_b16 v[126:127], v19 offset:14336
v_mfma_f32_16x16x32_bf16 a[32:35], v[104:107], v[64:67], a[32:35]
buffer_load_dwordx4 v8, s[8:11], s21 offen lds
v_mfma_f32_16x16x32_bf16 a[36:39], v[104:107], v[68:71], a[36:39]
buffer_load_dwordx4 v9, s[8:11], s21 offen offset:1024 lds
v_mfma_f32_16x16x32_bf16 a[40:43], v[104:107], v[72:75], a[40:43]
buffer_load_dwordx4 v10, s[8:11], s21 offen offset:2048 lds
v_mfma_f32_16x16x32_bf16 a[44:47], v[104:107], v[76:79], a[44:47]
buffer_load_dwordx4 v11, s[8:11], s21 offen offset:3072 lds
v_mfma_f32_16x16x32_bf16 a[48:51], v[108:111], v[64:67], a[48:51]
s_add_u32 s21, s21, 28672
buffer_load_dwordx4 v[48:51], v12, s[12:15], s22 offen sc1
v_mfma_f32_16x16x32_bf16 a[52:55], v[108:111], v[68:71], a[52:55]
buffer_load_dwordx4 v[52:55], v13, s[12:15], s22 offen sc1
v_mfma_f32_16x16x32_bf16 a[56:59], v[108:111], v[72:75], a[56:59]
buffer_load_dwordx4 v[56:59], v14, s[12:15], s22 offen sc1
v_mfma_f32_16x16x32_bf16 a[60:63], v[108:111], v[76:79], a[60:63]
buffer_load_dwordx4 v[60:63], v15, s[12:15], s22 offen sc1
s_add_u32 s22, s22, 1024
s_waitcnt vmcnt(12) lgkmcnt(0)
v_mfma_f32_16x16x32_bf16 a[0:3], v[112:115], v[80:83], a[0:3]
ds_read_b64_tr_b16 v[96:97], v16 offset:0
v_mfma_f32_16x16x32_bf16 a[4:7], v[112:115], v[84:87], a[4:7]
ds_read_b64_tr_b16 v[98:99], v16 offset:2048
v_mfma_f32_16x16x32_bf16 a[8:11], v[112:115], v[88:91], a[8:11]
ds_read_b64_tr_b16 v[100:101], v17 offset:0
v_mfma_f32_16x16x32_bf16 a[12:15], v[112:115], v[92:95], a[12:15]
ds_read_b64_tr_b16 v[102:103], v17 offset:2048
v_mfma_f32_16x16x32_bf16 a[16:19], v[116:119], v[80:83], a[16:19]
ds_read_b64_tr_b16 v[104:105], v18 offset:0
v_mfma_f32_16x16x32_bf16 a[20:23], v[116:119], v[84:87], a[20:23]
ds_read_b64_tr_b16 v[106:107], v18 offset:2048
v_mfma_f32_16x16x32_bf16 a[24:27], v[116:119], v[88:91], a[24:27]
ds_read_b64_tr_b16 v[108:109], v19 offset:0
v_mfma_f32_16x16x32_bf16 a[28:31], v[116:119], v[92:95], a[28:31]
ds_read_b64_tr_b16 v[110:111], v19 offset:2048
v_mfma_f32_16x16x32_bf16 a[32:35], v[120:123], v[80:83], a[32:35]
v_mfma_f32_16x16x32_bf16 a[36:39], v[120:123], v[84:87], a[36:39]
v_mfma_f32_16x16x32_bf16 a[40:43], v[120:123], v[88:91], a[40:43]
v_mfma_f32_16x16x32_bf16 a[44:47], v[120:123], v[92:95], a[44:47]
v_mfma_f32_16x16x32_bf16 a[48:51], v[124:127], v[80:83], a[48:51]
v_mfma_f32_16x16x32_bf16 a[52:55], v[124:127], v[84:87], a[52:55]
v_mfma_f32_16x16x32_bf16 a[56:59], v[124:127], v[88:91], a[56:59]
v_mfma_f32_16x16x32_bf16 a[60:63], v[124:127], v[92:95], a[60:63]
s_waitcnt vmcnt(4) lgkmcnt(0)
v_mfma_f32_16x16x32_bf16 a[0:3], v[96:99], v[32:35], a[0:3]
ds_read_b64_tr_b16 v[112:113], v16 offset:4096
v_mfma_f32_16x16x32_bf16 a[4:7], v[96:99], v[36:39], a[4:7]
ds_read_b64_tr_b16 v[114:115], v16 offset:6144
v_mfma_f32_16x16x32_bf16 a[8:11], v[96:99], v[40:43], a[8:11]
ds_read_b64_tr_b16 v[116:117], v17 offset:4096
v_mfma_f32_16x16x32_bf16 a[12:15], v[96:99], v[44:47], a[12:15]
ds_read_b64_tr_b16 v[118:119], v17 offset:6144
v_mfma_f32_16x16x32_bf16 a[16:19], v[100:103], v[32:35], a[16:19]
ds_read_b64_tr_b16 v[120:121], v18 offset:4096
v_mfma_f32_16x16x32_bf16 a[20:23], v[100:103], v[36:39], a[20:23]
ds_read_b64_tr_b16 v[122:123], v18 offset:6144
v_mfma_f32_16x16x32_bf16 a[24:27], v[100:103], v[40:43], a[24:27]
ds_read_b64_tr_b16 v[124:125], v19 offset:4096
v_mfma_f32_16x16x32_bf16 a[28:31], v[100:103], v[44:47], a[28:31]
ds_read_b64_tr_b16 v[126:127], v19 offset:6144
v_mfma_f32_16x16x32_bf16 a[32:35], v[104:107], v[32:35], a[32:35]
v_mfma_f32_16x16x32_bf16 a[36:39], v[104:107], v[36:39], a[36:39]
v_mfma_f32_16x16x32_bf16 a[40:43], v[104:107], v[40:43], a[40:43]
v_mfma_f32_16x16x32_bf16 a[44:47], v[104:107], v[44:47], a[44:47]
v_mfma_f32_16x16x32_bf16 a[48:51], v[108:111], v[32:35], a[48:51]
v_mfma_f32_16x16x32_bf16 a[52:55], v[108:111], v[36:39], a[52:55]
v_mfma_f32_16x16x32_bf16 a[56:59], v[108:111], v[40:43], a[56:59]
v_mfma_f32_16x16x32_bf16 a[60:63], v[108:111], v[44:47], a[60:63]
s_waitcnt vmcnt(0) lgkmcnt(0)
v_mfma_f32_16x16x32_bf16 a[0:3], v[112:115], v[48:51], a[0:3]
v_mfma_f32_16x16x32_bf16 a[4:7], v[112:115], v[52:55], a[4:7]
v_mfma_f32_16x16x32_bf16 a[8:11], v[112:115], v[56:59], a[8:11]
v_mfma_f32_16x16x32_bf16 a[12:15], v[112:115], v[60:63], a[12:15]
v_mfma_f32_16x16x32_bf16 a[16:19], v[116:119], v[48:51], a[16:19]
v_mfma_f32_16x16x32_bf16 a[20:23], v[116:119], v[52:55], a[20:23]
v_mfma_f32_16x16x32_bf16 a[24:27], v[116:119], v[56:59], a[24:27]
v_mfma_f32_16x16x32_bf16 a[28:31], v[116:119], v[60:63], a[28:31]
v_mfma_f32_16x16x32_bf16 a[32:35], v[120:123], v[48:51], a[32:35]
v_mfma_f32_16x16x32_bf16 a[36:39], v[120:123], v[52:55], a[36:39]
v_mfma_f32_16x16x32_bf16 a[40:43], v[120:123], v[56:59], a[40:43]
v_mfma_f32_16x16x32_bf16 a[44:47], v[120:123], v[60:63], a[44:47]
v_mfma_f32_16x16x32_bf16 a[48:51], v[124:127], v[48:51], a[48:51]
v_mfma_f32_16x16x32_bf16 a[52:55], v[124:127], v[52:55], a[52:55]
v_mfma_f32_16x16x32_bf16 a[56:59], v[124:127], v[56:59], a[56:59]
v_mfma_f32_16x16x32_bf16 a[60:63], v[124:127], v[60:63], a[60:63]
s_waitcnt vmcnt(0) lgkmcnt(0)
s_barrier
v_add_u32 v3, s25, v2
s_nop 7
ds_write_b128 v3, a[0:3] offset:0
ds_write_b128 v3, a[4:7] offset:1024
ds_write_b128 v3, a[8:11] offset:2048
ds_write_b128 v3, a[12:15] offset:3072
ds_write_b128 v3, a[16:19] offset:4096
ds_write_b128 v3, a[20:23] offset:5120
ds_write_b128 v3, a[24:27] offset:6144
ds_write_b128 v3, a[28:31] offset:7168
ds_write_b128 v3, a[32:35] offset:8192
ds_write_b128 v3, a[36:39] offset:9216
ds_write_b128 v3, a[40:43] offset:10240
ds_write_b128 v3, a[44:47] offset:11264
ds_write_b128 v3, a[48:51] offset:12288
ds_write_b128 v3, a[52:55] offset:13312
ds_write_b128 v3, a[56:59] offset:14336
ds_write_b128 v3, a[60:63] offset:15360
s_waitcnt lgkmcnt(0)
s_barrier
s_lshl_b32 s26, s20, 10
v_add_u32 v3, s26, v2
ds_read_b128 v[32:35], v3 offset:0
ds_read_b128 v[36:39], v3 offset:16384
ds_read_b128 v[40:43], v3 offset:32768
ds_read_b128 v[44:47], v3 offset:49152
ds_read_b128 v[48:51], v3 offset:4096
ds_read_b128 v[52:55], v3 offset:20480
ds_read_b128 v[56:59], v3 offset:36864
ds_read_b128 v[60:63], v3 offset:53248
ds_read_b128 v[64:67], v3 offset:8192
ds_read_b128 v[68:71], v3 offset:24576
ds_read_b128 v[72:75], v3 offset:40960
ds_read_b128 v[76:79], v3 offset:57344
ds_read_b128 v[80:83], v3 offset:12288
ds_read_b128 v[84:87], v3 offset:28672
ds_read_b128 v[88:91], v3 offset:45056
ds_read_b128 v[92:95], v3 offset:61440
s_waitcnt lgkmcnt(0)
v_add_f32 v32, v32, v36
v_add_f32 v40, v40, v44
v_add_f32 v32, v32, v40
v_add_f32 v33, v33, v37
v_add_f32 v41, v41, v45
v_add_f32 v33, v33, v41
v_add_f32 v34, v34, v38
v_add_f32 v42, v42, v46
v_add_f32 v34, v34, v42
v_add_f32 v35, v35, v39
v_add_f32 v43, v43, v47
v_add_f32 v35, v35, v43
v_cvt_pk_bf16_f32 v36, v32, v33
v_cvt_pk_bf16_f32 v37, v34, v35
v_lshlrev_b32 v40, 16, v36
v_and_b32 v41, 0xffff0000, v36
v_lshlrev_b32 v42, 16, v128
v_and_b32 v43, 0xffff0000, v128
v_add_f32 v40, v40, v42
v_add_f32 v41, v41, v43
v_cvt_pk_bf16_f32 v44, v40, v41
v_lshlrev_b32 v40, 16, v37
v_and_b32 v41, 0xffff0000, v37
v_lshlrev_b32 v42, 16, v129
v_and_b32 v43, 0xffff0000, v129
v_add_f32 v40, v40, v42
v_add_f32 v41, v41, v43
v_cvt_pk_bf16_f32 v45, v40, v41
buffer_store_dwordx2 v[44:45], v20, s[36:39], 0 offen offset:0
v_add_f32 v48, v48, v52
v_add_f32 v56, v56, v60
v_add_f32 v48, v48, v56
v_add_f32 v49, v49, v53
v_add_f32 v57, v57, v61
v_add_f32 v49, v49, v57
v_add_f32 v50, v50, v54
v_add_f32 v58, v58, v62
v_add_f32 v50, v50, v58
v_add_f32 v51, v51, v55
v_add_f32 v59, v59, v63
v_add_f32 v51, v51, v59
v_cvt_pk_bf16_f32 v52, v48, v49
v_cvt_pk_bf16_f32 v53, v50, v51
v_lshlrev_b32 v56, 16, v52
v_and_b32 v57, 0xffff0000, v52
v_lshlrev_b32 v58, 16, v130
v_and_b32 v59, 0xffff0000, v130
v_add_f32 v56, v56, v58
v_add_f32 v57, v57, v59
v_cvt_pk_bf16_f32 v60, v56, v57
v_lshlrev_b32 v56, 16, v53
v_and_b32 v57, 0xffff0000, v53
v_lshlrev_b32 v58, 16, v131
v_and_b32 v59, 0xffff0000, v131
v_add_f32 v56, v56, v58
v_add_f32 v57, v57, v59
v_cvt_pk_bf16_f32 v61, v56, v57
buffer_store_dwordx2 v[60:61], v20, s[36:39], 0 offen offset:32
v_add_f32 v64, v64, v68
v_add_f32 v72, v72, v76
v_add_f32 v64, v64, v72
v_add_f32 v65, v65, v69
v_add_f32 v73, v73, v77
v_add_f32 v65, v65, v73
v_add_f32 v66, v66, v70
v_add_f32 v74, v74, v78
v_add_f32 v66, v66, v74
v_add_f32 v67, v67, v71
v_add_f32 v75, v75, v79
v_add_f32 v67, v67, v75
v_cvt_pk_bf16_f32 v68, v64, v65
v_cvt_pk_bf16_f32 v69, v66, v67
v_lshlrev_b32 v72, 16, v68
v_and_b32 v73, 0xffff0000, v68
v_lshlrev_b32 v74, 16, v132
v_and_b32 v75, 0xffff0000, v132
v_add_f32 v72, v72, v74
v_add_f32 v73, v73, v75
v_cvt_pk_bf16_f32 v76, v72, v73
v_lshlrev_b32 v72, 16, v69
v_and_b32 v73, 0xffff0000, v69
v_lshlrev_b32 v74, 16, v133
v_and_b32 v75, 0xffff0000, v133
v_add_f32 v72, v72, v74
v_add_f32 v73, v73, v75
v_cvt_pk_bf16_f32 v77, v72, v73
buffer_store_dwordx2 v[76:77], v20, s[36:39], 0 offen offset:64
v_add_f32 v80, v80, v84
v_add_f32 v88, v88, v92
v_add_f32 v80, v80, v88
v_add_f32 v81, v81, v85
v_add_f32 v89, v89, v93
v_add_f32 v81, v81, v89
v_add_f32 v82, v82, v86
v_add_f32 v90, v90, v94
v_add_f32 v82, v82, v90
v_add_f32 v83, v83, v87
v_add_f32 v91, v91, v95
v_add_f32 v83, v83, v91
v_cvt_pk_bf16_f32 v84, v80, v81
v_cvt_pk_bf16_f32 v85, v82, v83
v_lshlrev_b32 v88, 16, v84
v_and_b32 v89, 0xffff0000, v84
v_lshlrev_b32 v90, 16, v134
v_and_b32 v91, 0xffff0000, v134
v_add_f32 v88, v88, v90
v_add_f32 v89, v89, v91
v_cvt_pk_bf16_f32 v92, v88, v89
v_lshlrev_b32 v88, 16, v85
v_and_b32 v89, 0xffff0000, v85
v_lshlrev_b32 v90, 16, v135
v_and_b32 v91, 0xffff0000, v135
v_add_f32 v88, v88, v90
v_add_f32 v89, v89, v91
v_cvt_pk_bf16_f32 v93, v88, v89
buffer_store_dwordx2 v[92:93], v20, s[36:39], 0 offen offset:96
K2_tail:
K2_end:
s_endpgm
K2_slow0:
s_nop 15
v_mov_b32 v6, v12
v_mov_b32 v7, v13
s_nop 1
v_permlane16_swap_b32 v12, v6
v_permlane16_swap_b32 v13, v7
s_nop 1
v_max_f32 v12, v12, v6
v_max_f32 v13, v13, v7
v_mov_b32 v6, v12
v_mov_b32 v7, v13
s_nop 1
v_permlane32_swap_b32 v12, v6
v_permlane32_swap_b32 v13, v7
s_nop 1
v_max_f32 v12, v12, v6
v_max_f32 v13, v13, v7
v_max_f32 v12, 0, v12
v_max_f32 v13, 0, v13
v_sub_f32 v16, v16, v12
v_sub_f32 v17, v17, v12
v_sub_f32 v18, v18, v12
v_sub_f32 v19, v19, v12
v_sub_f32 v24, v24, v12
v_sub_f32 v25, v25, v12
v_sub_f32 v26, v26, v12
v_sub_f32 v27, v27, v12
v_sub_f32 v32, v32, v12
v_sub_f32 v33, v33, v12
v_sub_f32 v34, v34, v12
v_sub_f32 v35, v35, v12
v_sub_f32 v40, v40, v12
v_sub_f32 v41, v41, v12
v_sub_f32 v42, v42, v12
v_sub_f32 v43, v43, v12
v_sub_f32 v96, v96, v12
v_sub_f32 v97, v97, v12
v_sub_f32 v98, v98, v12
v_sub_f32 v99, v99, v12
v_sub_f32 v20, v20, v13
v_sub_f32 v21, v21, v13
v_sub_f32 v22, v22, v13
v_sub_f32 v23, v23, v13
v_sub_f32 v28, v28, v13
v_sub_f32 v29, v29, v13
v_sub_f32 v30, v30, v13
v_sub_f32 v31, v31, v13
v_sub_f32 v36, v36, v13
v_sub_f32 v37, v37, v13
v_sub_f32 v38, v38, v13
v_sub_f32 v39, v39, v13
v_sub_f32 v44, v44, v13
v_sub_f32 v45, v45, v13
v_sub_f32 v46, v46, v13
v_sub_f32 v47, v47, v13
v_sub_f32 v100, v100, v13
v_sub_f32 v101, v101, v13
v_sub_f32 v102, v102, v13
v_sub_f32 v103, v103, v13
v_sub_f32 v6, 0, v12
v_exp_f32 v6, v6
v_sub_f32 v7, 0, v13
v_exp_f32 v7, v7
s_nop 0
v_mul_f32 v104, v104, v6
v_mul_f32 v105, v105, v6
v_mul_f32 v106, v106, v6
v_mul_f32 v107, v107, v6
v_mul_f32 v108, v108, v7
v_mul_f32 v109, v109, v7
v_mul_f32 v110, v110, v7
v_mul_f32 v111, v111, v7
v_accvgpr_read_b32 v224, a0
v_accvgpr_read_b32 v225, a1
v_accvgpr_read_b32 v226, a2
v_accvgpr_read_b32 v227, a3
v_mul_f32 v224, v224, v6
v_mul_f32 v225, v225, v6
v_mul_f32 v226, v226, v6
v_mul_f32 v227, v227, v6
v_accvgpr_write_b32 a0, v224
v_accvgpr_write_b32 a1, v225
v_accvgpr_write_b32 a2, v226
v_accvgpr_write_b32 a3, v227
v_accvgpr_read_b32 v228, a4
v_accvgpr_read_b32 v229, a5
v_accvgpr_read_b32 v230, a6
v_accvgpr_read_b32 v231, a7
v_mul_f32 v228, v228, v7
v_mul_f32 v229, v229, v7
v_mul_f32 v230, v230, v7
v_mul_f32 v231, v231, v7
v_accvgpr_write_b32 a4, v228
v_accvgpr_write_b32 a5, v229
v_accvgpr_write_b32 a6, v230
v_accvgpr_write_b32 a7, v231
v_accvgpr_read_b32 v232, a8
v_accvgpr_read_b32 v233, a9
v_accvgpr_read_b32 v234, a10
v_accvgpr_read_b32 v235, a11
v_mul_f32 v232, v232, v6
v_mul_f32 v233, v233, v6
v_mul_f32 v234, v234, v6
v_mul_f32 v235, v235, v6
v_accvgpr_write_b32 a8, v232
v_accvgpr_write_b32 a9, v233
v_accvgpr_write_b32 a10, v234
v_accvgpr_write_b32 a11, v235
v_accvgpr_read_b32 v236, a12
v_accvgpr_read_b32 v237, a13
v_accvgpr_read_b32 v238, a14
v_accvgpr_read_b32 v239, a15
v_mul_f32 v236, v236, v7
v_mul_f32 v237, v237, v7
v_mul_f32 v238, v238, v7
v_mul_f32 v239, v239, v7
v_accvgpr_write_b32 a12, v236
v_accvgpr_write_b32 a13, v237
v_accvgpr_write_b32 a14, v238
v_accvgpr_write_b32 a15, v239
v_accvgpr_read_b32 v224, a16
v_accvgpr_read_b32 v225, a17
v_accvgpr_read_b32 v226, a18
v_accvgpr_read_b32 v227, a19
v_mul_f32 v224, v224, v6
v_mul_f32 v225, v225, v6
v_mul_f32 v226, v226, v6
v_mul_f32 v227, v227, v6
v_accvgpr_write_b32 a16, v224
v_accvgpr_write_b32 a17, v225
v_accvgpr_write_b32 a18, v226
v_accvgpr_write_b32 a19, v227
v_accvgpr_read_b32 v228, a20
v_accvgpr_read_b32 v229, a21
v_accvgpr_read_b32 v230, a22
v_accvgpr_read_b32 v231, a23
v_mul_f32 v228, v228, v7
v_mul_f32 v229, v229, v7
v_mul_f32 v230, v230, v7
v_mul_f32 v231, v231, v7
v_accvgpr_write_b32 a20, v228
v_accvgpr_write_b32 a21, v229
v_accvgpr_write_b32 a22, v230
v_accvgpr_write_b32 a23, v231
v_accvgpr_read_b32 v232, a24
v_accvgpr_read_b32 v233, a25
v_accvgpr_read_b32 v234, a26
v_accvgpr_read_b32 v235, a27
v_mul_f32 v232, v232, v6
v_mul_f32 v233, v233, v6
v_mul_f32 v234, v234, v6
v_mul_f32 v235, v235, v6
v_accvgpr_write_b32 a24, v232
v_accvgpr_write_b32 a25, v233
v_accvgpr_write_b32 a26, v234
v_accvgpr_write_b32 a27, v235
v_accvgpr_read_b32 v236, a28
v_accvgpr_read_b32 v237, a29
v_accvgpr_read_b32 v238, a30
v_accvgpr_read_b32 v239, a31
v_mul_f32 v236, v236, v7
v_mul_f32 v237, v237, v7
v_mul_f32 v238, v238, v7
v_mul_f32 v239, v239, v7
v_accvgpr_write_b32 a28, v236
v_accvgpr_write_b32 a29, v237
v_accvgpr_write_b32 a30, v238
v_accvgpr_write_b32 a31, v239
v_accvgpr_read_b32 v224, a32
v_accvgpr_read_b32 v225, a33
v_accvgpr_read_b32 v226, a34
v_accvgpr_read_b32 v227, a35
v_mul_f32 v224, v224, v6
v_mul_f32 v225, v225, v6
v_mul_f32 v226, v226, v6
v_mul_f32 v227, v227, v6
v_accvgpr_write_b32 a32, v224
v_accvgpr_write_b32 a33, v225
v_accvgpr_write_b32 a34, v226
v_accvgpr_write_b32 a35, v227
v_accvgpr_read_b32 v228, a36
v_accvgpr_read_b32 v229, a37
v_accvgpr_read_b32 v230, a38
v_accvgpr_read_b32 v231, a39
v_mul_f32 v228, v228, v7
v_mul_f32 v229, v229, v7
v_mul_f32 v230, v230, v7
v_mul_f32 v231, v231, v7
v_accvgpr_write_b32 a36, v228
v_accvgpr_write_b32 a37, v229
v_accvgpr_write_b32 a38, v230
v_accvgpr_write_b32 a39, v231
v_accvgpr_read_b32 v232, a40
v_accvgpr_read_b32 v233, a41
v_accvgpr_read_b32 v234, a42
v_accvgpr_read_b32 v235, a43
v_mul_f32 v232, v232, v6
v_mul_f32 v233, v233, v6
v_mul_f32 v234, v234, v6
v_mul_f32 v235, v235, v6
v_accvgpr_write_b32 a40, v232
v_accvgpr_write_b32 a41, v233
v_accvgpr_write_b32 a42, v234
v_accvgpr_write_b32 a43, v235
v_accvgpr_read_b32 v236, a44
v_accvgpr_read_b32 v237, a45
v_accvgpr_read_b32 v238, a46
v_accvgpr_read_b32 v239, a47
v_mul_f32 v236, v236, v7
v_mul_f32 v237, v237, v7
v_mul_f32 v238, v238, v7
v_mul_f32 v239, v239, v7
v_accvgpr_write_b32 a44, v236
v_accvgpr_write_b32 a45, v237
v_accvgpr_write_b32 a46, v238
v_accvgpr_write_b32 a47, v239
v_accvgpr_read_b32 v224, a48
v_accvgpr_read_b32 v225, a49
v_accvgpr_read_b32 v226, a50
v_accvgpr_read_b32 v227, a51
v_mul_f32 v224, v224, v6
v_mul_f32 v225, v225, v6
v_mul_f32 v226, v226, v6
v_mul_f32 v227, v227, v6
v_accvgpr_write_b32 a48, v224
v_accvgpr_write_b32 a49, v225
v_accvgpr_write_b32 a50, v226
v_accvgpr_write_b32 a51, v227
v_accvgpr_read_b32 v228, a52
v_accvgpr_read_b32 v229, a53
v_accvgpr_read_b32 v230, a54
v_accvgpr_read_b32 v231, a55
v_mul_f32 v228, v228, v7
v_mul_f32 v229, v229, v7
v_mul_f32 v230, v230, v7
v_mul_f32 v231, v231, v7
v_accvgpr_write_b32 a52, v228
v_accvgpr_write_b32 a53, v229
v_accvgpr_write_b32 a54, v230
v_accvgpr_write_b32 a55, v231
v_accvgpr_read_b32 v232, a56
v_accvgpr_read_b32 v233, a57
v_accvgpr_read_b32 v234, a58
v_accvgpr_read_b32 v235, a59
v_mul_f32 v232, v232, v6
v_mul_f32 v233, v233, v6
v_mul_f32 v234, v234, v6
v_mul_f32 v235, v235, v6
v_accvgpr_write_b32 a56, v232
v_accvgpr_write_b32 a57, v233
v_accvgpr_write_b32 a58, v234
v_accvgpr_write_b32 a59, v235
v_accvgpr_read_b32 v236, a60
v_accvgpr_read_b32 v237, a61
v_accvgpr_read_b32 v238, a62
v_accvgpr_read_b32 v239, a63
v_mul_f32 v236, v236, v7
v_mul_f32 v237, v237, v7
v_mul_f32 v238, v238, v7
v_mul_f32 v239, v239, v7
v_accvgpr_write_b32 a60, v236
v_accvgpr_write_b32 a61, v237
v_accvgpr_write_b32 a62, v238
v_accvgpr_write_b32 a63, v239
v_accvgpr_read_b32 v224, a64
v_accvgpr_read_b32 v225, a65
v_accvgpr_read_b32 v226, a66
v_accvgpr_read_b32 v227, a67
v_mul_f32 v224, v224, v6
v_mul_f32 v225, v225, v6
v_mul_f32 v226, v226, v6
v_mul_f32 v227, v227, v6
v_accvgpr_write_b32 a64, v224
v_accvgpr_write_b32 a65, v225
v_accvgpr_write_b32 a66, v226
v_accvgpr_write_b32 a67, v227
v_accvgpr_read_b32 v228, a68
v_accvgpr_read_b32 v229, a69
v_accvgpr_read_b32 v230, a70
v_accvgpr_read_b32 v231, a71
v_mul_f32 v228, v228, v7
v_mul_f32 v229, v229, v7
v_mul_f32 v230, v230, v7
v_mul_f32 v231, v231, v7
v_accvgpr_write_b32 a68, v228
v_accvgpr_write_b32 a69, v229
v_accvgpr_write_b32 a70, v230
v_accvgpr_write_b32 a71, v231
v_accvgpr_read_b32 v232, a72
v_accvgpr_read_b32 v233, a73
v_accvgpr_read_b32 v234, a74
v_accvgpr_read_b32 v235, a75
v_mul_f32 v232, v232, v6
v_mul_f32 v233, v233, v6
v_mul_f32 v234, v234, v6
v_mul_f32 v235, v235, v6
v_accvgpr_write_b32 a72, v232
v_accvgpr_write_b32 a73, v233
v_accvgpr_write_b32 a74, v234
v_accvgpr_write_b32 a75, v235
v_accvgpr_read_b32 v236, a76
v_accvgpr_read_b32 v237, a77
v_accvgpr_read_b32 v238, a78
v_accvgpr_read_b32 v239, a79
v_mul_f32 v236, v236, v7
v_mul_f32 v237, v237, v7
v_mul_f32 v238, v238, v7
v_mul_f32 v239, v239, v7
v_accvgpr_write_b32 a76, v236
v_accvgpr_write_b32 a77, v237
v_accvgpr_write_b32 a78, v238
v_accvgpr_write_b32 a79, v239
v_accvgpr_read_b32 v224, a80
v_accvgpr_read_b32 v225, a81
v_accvgpr_read_b32 v226, a82
v_accvgpr_read_b32 v227, a83
v_mul_f32 v224, v224, v6
v_mul_f32 v225, v225, v6
v_mul_f32 v226, v226, v6
v_mul_f32 v227, v227, v6
v_accvgpr_write_b32 a80, v224
v_accvgpr_write_b32 a81, v225
v_accvgpr_write_b32 a82, v226
v_accvgpr_write_b32 a83, v227
v_accvgpr_read_b32 v228, a84
v_accvgpr_read_b32 v229, a85
v_accvgpr_read_b32 v230, a86
v_accvgpr_read_b32 v231, a87
v_mul_f32 v228, v228, v7
v_mul_f32 v229, v229, v7
v_mul_f32 v230, v230, v7
v_mul_f32 v231, v231, v7
v_accvgpr_write_b32 a84, v228
v_accvgpr_write_b32 a85, v229
v_accvgpr_write_b32 a86, v230
v_accvgpr_write_b32 a87, v231
v_accvgpr_read_b32 v232, a88
v_accvgpr_read_b32 v233, a89
v_accvgpr_read_b32 v234, a90
v_accvgpr_read_b32 v235, a91
v_mul_f32 v232, v232, v6
v_mul_f32 v233, v233, v6
v_mul_f32 v234, v234, v6
v_mul_f32 v235, v235, v6
v_accvgpr_write_b32 a88, v232
v_accvgpr_write_b32 a89, v233
v_accvgpr_write_b32 a90, v234
v_accvgpr_write_b32 a91, v235
v_accvgpr_read_b32 v236, a92
v_accvgpr_read_b32 v237, a93
v_accvgpr_read_b32 v238, a94
v_accvgpr_read_b32 v239, a95
v_mul_f32 v236, v236, v7
v_mul_f32 v237, v237, v7
v_mul_f32 v238, v238, v7
v_mul_f32 v239, v239, v7
v_accvgpr_write_b32 a92, v236
v_accvgpr_write_b32 a93, v237
v_accvgpr_write_b32 a94, v238
v_accvgpr_write_b32 a95, v239
v_accvgpr_read_b32 v224, a96
v_accvgpr_read_b32 v225, a97
v_accvgpr_read_b32 v226, a98
v_accvgpr_read_b32 v227, a99
v_mul_f32 v224, v224, v6
v_mul_f32 v225, v225, v6
v_mul_f32 v226, v226, v6
v_mul_f32 v227, v227, v6
v_accvgpr_write_b32 a96, v224
v_accvgpr_write_b32 a97, v225
v_accvgpr_write_b32 a98, v226
v_accvgpr_write_b32 a99, v227
v_accvgpr_read_b32 v228, a100
v_accvgpr_read_b32 v229, a101
v_accvgpr_read_b32 v230, a102
v_accvgpr_read_b32 v231, a103
v_mul_f32 v228, v228, v7
v_mul_f32 v229, v229, v7
v_mul_f32 v230, v230, v7
v_mul_f32 v231, v231, v7
v_accvgpr_write_b32 a100, v228
v_accvgpr_write_b32 a101, v229
v_accvgpr_write_b32 a102, v230
v_accvgpr_write_b32 a103, v231
v_accvgpr_read_b32 v232, a104
v_accvgpr_read_b32 v233, a105
v_accvgpr_read_b32 v234, a106
v_accvgpr_read_b32 v235, a107
v_mul_f32 v232, v232, v6
v_mul_f32 v233, v233, v6
v_mul_f32 v234, v234, v6
v_mul_f32 v235, v235, v6
v_accvgpr_write_b32 a104, v232
v_accvgpr_write_b32 a105, v233
v_accvgpr_write_b32 a106, v234
v_accvgpr_write_b32 a107, v235
v_accvgpr_read_b32 v236, a108
v_accvgpr_read_b32 v237, a109
v_accvgpr_read_b32 v238, a110
v_accvgpr_read_b32 v239, a111
v_mul_f32 v236, v236, v7
v_mul_f32 v237, v237, v7
v_mul_f32 v238, v238, v7
v_mul_f32 v239, v239, v7
v_accvgpr_write_b32 a108, v236
v_accvgpr_write_b32 a109, v237
v_accvgpr_write_b32 a110, v238
v_accvgpr_write_b32 a111, v239
v_accvgpr_read_b32 v224, a112
v_accvgpr_read_b32 v225, a113
v_accvgpr_read_b32 v226, a114
v_accvgpr_read_b32 v227, a115
v_mul_f32 v224, v224, v6
v_mul_f32 v225, v225, v6
v_mul_f32 v226, v226, v6
v_mul_f32 v227, v227, v6
v_accvgpr_write_b32 a112, v224
v_accvgpr_write_b32 a113, v225
v_accvgpr_write_b32 a114, v226
v_accvgpr_write_b32 a115, v227
v_accvgpr_read_b32 v228, a116
v_accvgpr_read_b32 v229, a117
v_accvgpr_read_b32 v230, a118
v_accvgpr_read_b32 v231, a119
v_mul_f32 v228, v228, v7
v_mul_f32 v229, v229, v7
v_mul_f32 v230, v230, v7
v_mul_f32 v231, v231, v7
v_accvgpr_write_b32 a116, v228
v_accvgpr_write_b32 a117, v229
v_accvgpr_write_b32 a118, v230
v_accvgpr_write_b32 a119, v231
v_accvgpr_read_b32 v232, a120
v_accvgpr_read_b32 v233, a121
v_accvgpr_read_b32 v234, a122
v_accvgpr_read_b32 v235, a123
v_mul_f32 v232, v232, v6
v_mul_f32 v233, v233, v6
v_mul_f32 v234, v234, v6
v_mul_f32 v235, v235, v6
v_accvgpr_write_b32 a120, v232
v_accvgpr_write_b32 a121, v233
v_accvgpr_write_b32 a122, v234
v_accvgpr_write_b32 a123, v235
v_accvgpr_read_b32 v236, a124
v_accvgpr_read_b32 v237, a125
v_accvgpr_read_b32 v238, a126
v_accvgpr_read_b32 v239, a127
v_mul_f32 v236, v236, v7
v_mul_f32 v237, v237, v7
v_mul_f32 v238, v238, v7
v_mul_f32 v239, v239, v7
v_accvgpr_write_b32 a124, v236
v_accvgpr_write_b32 a125, v237
v_accvgpr_write_b32 a126, v238
v_accvgpr_write_b32 a127, v239
s_nop 1
s_setpc_b64 s[96:97]
K2_slow1:
s_nop 15
v_mov_b32 v6, v12
v_mov_b32 v7, v13
s_nop 1
v_permlane16_swap_b32 v12, v6
v_permlane16_swap_b32 v13, v7
s_nop 1
v_max_f32 v12, v12, v6
v_max_f32 v13, v13, v7
v_mov_b32 v6, v12
v_mov_b32 v7, v13
s_nop 1
v_permlane32_swap_b32 v12, v6
v_permlane32_swap_b32 v13, v7
s_nop 1
v_max_f32 v12, v12, v6
v_max_f32 v13, v13, v7
v_max_f32 v12, 0, v12
v_max_f32 v13, 0, v13
v_sub_f32 v48, v48, v12
v_sub_f32 v49, v49, v12
v_sub_f32 v50, v50, v12
v_sub_f32 v51, v51, v12
v_sub_f32 v56, v56, v12
v_sub_f32 v57, v57, v12
v_sub_f32 v58, v58, v12
v_sub_f32 v59, v59, v12
v_sub_f32 v64, v64, v12
v_sub_f32 v65, v65, v12
v_sub_f32 v66, v66, v12
v_sub_f32 v67, v67, v12
v_sub_f32 v72, v72, v12
v_sub_f32 v73, v73, v12
v_sub_f32 v74, v74, v12
v_sub_f32 v75, v75, v12
v_sub_f32 v96, v96, v12
v_sub_f32 v97, v97, v12
v_sub_f32 v98, v98, v12
v_sub_f32 v99, v99, v12
v_sub_f32 v52, v52, v13
v_sub_f32 v53, v53, v13
v_sub_f32 v54, v54, v13
v_sub_f32 v55, v55, v13
v_sub_f32 v60, v60, v13
v_sub_f32 v61, v61, v13
v_sub_f32 v62, v62, v13
v_sub_f32 v63, v63, v13
v_sub_f32 v68, v68, v13
v_sub_f32 v69, v69, v13
v_sub_f32 v70, v70, v13
v_sub_f32 v71, v71, v13
v_sub_f32 v76, v76, v13
v_sub_f32 v77, v77, v13
v_sub_f32 v78, v78, v13
v_sub_f32 v79, v79, v13
v_sub_f32 v100, v100, v13
v_sub_f32 v101, v101, v13
v_sub_f32 v102, v102, v13
v_sub_f32 v103, v103, v13
v_sub_f32 v6, 0, v12
v_exp_f32 v6, v6
v_sub_f32 v7, 0, v13
v_exp_f32 v7, v7
s_nop 0
v_mul_f32 v104, v104, v6
v_mul_f32 v105, v105, v6
v_mul_f32 v106, v106, v6
v_mul_f32 v107, v107, v6
v_mul_f32 v108, v108, v7
v_mul_f32 v109, v109, v7
v_mul_f32 v110, v110, v7
v_mul_f32 v111, v111, v7
v_accvgpr_read_b32 v224, a0
v_accvgpr_read_b32 v225, a1
v_accvgpr_read_b32 v226, a2
v_accvgpr_read_b32 v227, a3
v_mul_f32 v224, v224, v6
v_mul_f32 v225, v225, v6
v_mul_f32 v226, v226, v6
v_mul_f32 v227, v227, v6
v_accvgpr_write_b32 a0, v224
v_accvgpr_write_b32 a1, v225
v_accvgpr_write_b32 a2, v226
v_accvgpr_write_b32 a3, v227
v_accvgpr_read_b32 v228, a4
v_accvgpr_read_b32 v229, a5
v_accvgpr_read_b32 v230, a6
v_accvgpr_read_b32 v231, a7
v_mul_f32 v228, v228, v7
v_mul_f32 v229, v229, v7
v_mul_f32 v230, v230, v7
v_mul_f32 v231, v231, v7
v_accvgpr_write_b32 a4, v228
v_accvgpr_write_b32 a5, v229
v_accvgpr_write_b32 a6, v230
v_accvgpr_write_b32 a7, v231
v_accvgpr_read_b32 v232, a8
v_accvgpr_read_b32 v233, a9
v_accvgpr_read_b32 v234, a10
v_accvgpr_read_b32 v235, a11
v_mul_f32 v232, v232, v6
v_mul_f32 v233, v233, v6
v_mul_f32 v234, v234, v6
v_mul_f32 v235, v235, v6
v_accvgpr_write_b32 a8, v232
v_accvgpr_write_b32 a9, v233
v_accvgpr_write_b32 a10, v234
v_accvgpr_write_b32 a11, v235
v_accvgpr_read_b32 v236, a12
v_accvgpr_read_b32 v237, a13
v_accvgpr_read_b32 v238, a14
v_accvgpr_read_b32 v239, a15
v_mul_f32 v236, v236, v7
v_mul_f32 v237, v237, v7
v_mul_f32 v238, v238, v7
v_mul_f32 v239, v239, v7
v_accvgpr_write_b32 a12, v236
v_accvgpr_write_b32 a13, v237
v_accvgpr_write_b32 a14, v238
v_accvgpr_write_b32 a15, v239
v_accvgpr_read_b32 v224, a16
v_accvgpr_read_b32 v225, a17
v_accvgpr_read_b32 v226, a18
v_accvgpr_read_b32 v227, a19
v_mul_f32 v224, v224, v6
v_mul_f32 v225, v225, v6
v_mul_f32 v226, v226, v6
v_mul_f32 v227, v227, v6
v_accvgpr_write_b32 a16, v224
v_accvgpr_write_b32 a17, v225
v_accvgpr_write_b32 a18, v226
v_accvgpr_write_b32 a19, v227
v_accvgpr_read_b32 v228, a20
v_accvgpr_read_b32 v229, a21
v_accvgpr_read_b32 v230, a22
v_accvgpr_read_b32 v231, a23
v_mul_f32 v228, v228, v7
v_mul_f32 v229, v229, v7
v_mul_f32 v230, v230, v7
v_mul_f32 v231, v231, v7
v_accvgpr_write_b32 a20, v228
v_accvgpr_write_b32 a21, v229
v_accvgpr_write_b32 a22, v230
v_accvgpr_write_b32 a23, v231
v_accvgpr_read_b32 v232, a24
v_accvgpr_read_b32 v233, a25
v_accvgpr_read_b32 v234, a26
v_accvgpr_read_b32 v235, a27
v_mul_f32 v232, v232, v6
v_mul_f32 v233, v233, v6
v_mul_f32 v234, v234, v6
v_mul_f32 v235, v235, v6
v_accvgpr_write_b32 a24, v232
v_accvgpr_write_b32 a25, v233
v_accvgpr_write_b32 a26, v234
v_accvgpr_write_b32 a27, v235
v_accvgpr_read_b32 v236, a28
v_accvgpr_read_b32 v237, a29
v_accvgpr_read_b32 v238, a30
v_accvgpr_read_b32 v239, a31
v_mul_f32 v236, v236, v7
v_mul_f32 v237, v237, v7
v_mul_f32 v238, v238, v7
v_mul_f32 v239, v239, v7
v_accvgpr_write_b32 a28, v236
v_accvgpr_write_b32 a29, v237
v_accvgpr_write_b32 a30, v238
v_accvgpr_write_b32 a31, v239
v_accvgpr_read_b32 v224, a32
v_accvgpr_read_b32 v225, a33
v_accvgpr_read_b32 v226, a34
v_accvgpr_read_b32 v227, a35
v_mul_f32 v224, v224, v6
v_mul_f32 v225, v225, v6
v_mul_f32 v226, v226, v6
v_mul_f32 v227, v227, v6
v_accvgpr_write_b32 a32, v224
v_accvgpr_write_b32 a33, v225
v_accvgpr_write_b32 a34, v226
v_accvgpr_write_b32 a35, v227
v_accvgpr_read_b32 v228, a36
v_accvgpr_read_b32 v229, a37
v_accvgpr_read_b32 v230, a38
v_accvgpr_read_b32 v231, a39
v_mul_f32 v228, v228, v7
v_mul_f32 v229, v229, v7
v_mul_f32 v230, v230, v7
v_mul_f32 v231, v231, v7
v_accvgpr_write_b32 a36, v228
v_accvgpr_write_b32 a37, v229
v_accvgpr_write_b32 a38, v230
v_accvgpr_write_b32 a39, v231
v_accvgpr_read_b32 v232, a40
v_accvgpr_read_b32 v233, a41
v_accvgpr_read_b32 v234, a42
v_accvgpr_read_b32 v235, a43
v_mul_f32 v232, v232, v6
v_mul_f32 v233, v233, v6
v_mul_f32 v234, v234, v6
v_mul_f32 v235, v235, v6
v_accvgpr_write_b32 a40, v232
v_accvgpr_write_b32 a41, v233
v_accvgpr_write_b32 a42, v234
v_accvgpr_write_b32 a43, v235
v_accvgpr_read_b32 v236, a44
v_accvgpr_read_b32 v237, a45
v_accvgpr_read_b32 v238, a46
v_accvgpr_read_b32 v239, a47
v_mul_f32 v236, v236, v7
v_mul_f32 v237, v237, v7
v_mul_f32 v238, v238, v7
v_mul_f32 v239, v239, v7
v_accvgpr_write_b32 a44, v236
v_accvgpr_write_b32 a45, v237
v_accvgpr_write_b32 a46, v238
v_accvgpr_write_b32 a47, v239
v_accvgpr_read_b32 v224, a48
v_accvgpr_read_b32 v225, a49
v_accvgpr_read_b32 v226, a50
v_accvgpr_read_b32 v227, a51
v_mul_f32 v224, v224, v6
v_mul_f32 v225, v225, v6
v_mul_f32 v226, v226, v6
v_mul_f32 v227, v227, v6
v_accvgpr_write_b32 a48, v224
v_accvgpr_write_b32 a49, v225
v_accvgpr_write_b32 a50, v226
v_accvgpr_write_b32 a51, v227
v_accvgpr_read_b32 v228, a52
v_accvgpr_read_b32 v229, a53
v_accvgpr_read_b32 v230, a54
v_accvgpr_read_b32 v231, a55
v_mul_f32 v228, v228, v7
v_mul_f32 v229, v229, v7
v_mul_f32 v230, v230, v7
v_mul_f32 v231, v231, v7
v_accvgpr_write_b32 a52, v228
v_accvgpr_write_b32 a53, v229
v_accvgpr_write_b32 a54, v230
v_accvgpr_write_b32 a55, v231
v_accvgpr_read_b32 v232, a56
v_accvgpr_read_b32 v233, a57
v_accvgpr_read_b32 v234, a58
v_accvgpr_read_b32 v235, a59
v_mul_f32 v232, v232, v6
v_mul_f32 v233, v233, v6
v_mul_f32 v234, v234, v6
v_mul_f32 v235, v235, v6
v_accvgpr_write_b32 a56, v232
v_accvgpr_write_b32 a57, v233
v_accvgpr_write_b32 a58, v234
v_accvgpr_write_b32 a59, v235
v_accvgpr_read_b32 v236, a60
v_accvgpr_read_b32 v237, a61
v_accvgpr_read_b32 v238, a62
v_accvgpr_read_b32 v239, a63
v_mul_f32 v236, v236, v7
v_mul_f32 v237, v237, v7
v_mul_f32 v238, v238, v7
v_mul_f32 v239, v239, v7
v_accvgpr_write_b32 a60, v236
v_accvgpr_write_b32 a61, v237
v_accvgpr_write_b32 a62, v238
v_accvgpr_write_b32 a63, v239
v_accvgpr_read_b32 v224, a64
v_accvgpr_read_b32 v225, a65
v_accvgpr_read_b32 v226, a66
v_accvgpr_read_b32 v227, a67
v_mul_f32 v224, v224, v6
v_mul_f32 v225, v225, v6
v_mul_f32 v226, v226, v6
v_mul_f32 v227, v227, v6
v_accvgpr_write_b32 a64, v224
v_accvgpr_write_b32 a65, v225
v_accvgpr_write_b32 a66, v226
v_accvgpr_write_b32 a67, v227
v_accvgpr_read_b32 v228, a68
v_accvgpr_read_b32 v229, a69
v_accvgpr_read_b32 v230, a70
v_accvgpr_read_b32 v231, a71
v_mul_f32 v228, v228, v7
v_mul_f32 v229, v229, v7
v_mul_f32 v230, v230, v7
v_mul_f32 v231, v231, v7
v_accvgpr_write_b32 a68, v228
v_accvgpr_write_b32 a69, v229
v_accvgpr_write_b32 a70, v230
v_accvgpr_write_b32 a71, v231
v_accvgpr_read_b32 v232, a72
v_accvgpr_read_b32 v233, a73
v_accvgpr_read_b32 v234, a74
v_accvgpr_read_b32 v235, a75
v_mul_f32 v232, v232, v6
v_mul_f32 v233, v233, v6
v_mul_f32 v234, v234, v6
v_mul_f32 v235, v235, v6
v_accvgpr_write_b32 a72, v232
v_accvgpr_write_b32 a73, v233
v_accvgpr_write_b32 a74, v234
v_accvgpr_write_b32 a75, v235
v_accvgpr_read_b32 v236, a76
v_accvgpr_read_b32 v237, a77
v_accvgpr_read_b32 v238, a78
v_accvgpr_read_b32 v239, a79
v_mul_f32 v236, v236, v7
v_mul_f32 v237, v237, v7
v_mul_f32 v238, v238, v7
v_mul_f32 v239, v239, v7
v_accvgpr_write_b32 a76, v236
v_accvgpr_write_b32 a77, v237
v_accvgpr_write_b32 a78, v238
v_accvgpr_write_b32 a79, v239
v_accvgpr_read_b32 v224, a80
v_accvgpr_read_b32 v225, a81
v_accvgpr_read_b32 v226, a82
v_accvgpr_read_b32 v227, a83
v_mul_f32 v224, v224, v6
v_mul_f32 v225, v225, v6
v_mul_f32 v226, v226, v6
v_mul_f32 v227, v227, v6
v_accvgpr_write_b32 a80, v224
v_accvgpr_write_b32 a81, v225
v_accvgpr_write_b32 a82, v226
v_accvgpr_write_b32 a83, v227
v_accvgpr_read_b32 v228, a84
v_accvgpr_read_b32 v229, a85
v_accvgpr_read_b32 v230, a86
v_accvgpr_read_b32 v231, a87
v_mul_f32 v228, v228, v7
v_mul_f32 v229, v229, v7
v_mul_f32 v230, v230, v7
v_mul_f32 v231, v231, v7
v_accvgpr_write_b32 a84, v228
v_accvgpr_write_b32 a85, v229
v_accvgpr_write_b32 a86, v230
v_accvgpr_write_b32 a87, v231
v_accvgpr_read_b32 v232, a88
v_accvgpr_read_b32 v233, a89
v_accvgpr_read_b32 v234, a90
v_accvgpr_read_b32 v235, a91
v_mul_f32 v232, v232, v6
v_mul_f32 v233, v233, v6
v_mul_f32 v234, v234, v6
v_mul_f32 v235, v235, v6
v_accvgpr_write_b32 a88, v232
v_accvgpr_write_b32 a89, v233
v_accvgpr_write_b32 a90, v234
v_accvgpr_write_b32 a91, v235
v_accvgpr_read_b32 v236, a92
v_accvgpr_read_b32 v237, a93
v_accvgpr_read_b32 v238, a94
v_accvgpr_read_b32 v239, a95
v_mul_f32 v236, v236, v7
v_mul_f32 v237, v237, v7
v_mul_f32 v238, v238, v7
v_mul_f32 v239, v239, v7
v_accvgpr_write_b32 a92, v236
v_accvgpr_write_b32 a93, v237
v_accvgpr_write_b32 a94, v238
v_accvgpr_write_b32 a95, v239
v_accvgpr_read_b32 v224, a96
v_accvgpr_read_b32 v225, a97
v_accvgpr_read_b32 v226, a98
v_accvgpr_read_b32 v227, a99
v_mul_f32 v224, v224, v6
v_mul_f32 v225, v225, v6
v_mul_f32 v226, v226, v6
v_mul_f32 v227, v227, v6
v_accvgpr_write_b32 a96, v224
v_accvgpr_write_b32 a97, v225
v_accvgpr_write_b32 a98, v226
v_accvgpr_write_b32 a99, v227
v_accvgpr_read_b32 v228, a100
v_accvgpr_read_b32 v229, a101
v_accvgpr_read_b32 v230, a102
v_accvgpr_read_b32 v231, a103
v_mul_f32 v228, v228, v7
v_mul_f32 v229, v229, v7
v_mul_f32 v230, v230, v7
v_mul_f32 v231, v231, v7
v_accvgpr_write_b32 a100, v228
v_accvgpr_write_b32 a101, v229
v_accvgpr_write_b32 a102, v230
v_accvgpr_write_b32 a103, v231
v_accvgpr_read_b32 v232, a104
v_accvgpr_read_b32 v233, a105
v_accvgpr_read_b32 v234, a106
v_accvgpr_read_b32 v235, a107
v_mul_f32 v232, v232, v6
v_mul_f32 v233, v233, v6
v_mul_f32 v234, v234, v6
v_mul_f32 v235, v235, v6
v_accvgpr_write_b32 a104, v232
v_accvgpr_write_b32 a105, v233
v_accvgpr_write_b32 a106, v234
v_accvgpr_write_b32 a107, v235
v_accvgpr_read_b32 v236, a108
v_accvgpr_read_b32 v237, a109
v_accvgpr_read_b32 v238, a110
v_accvgpr_read_b32 v239, a111
v_mul_f32 v236, v236, v7
v_mul_f32 v237, v237, v7
v_mul_f32 v238, v238, v7
v_mul_f32 v239, v239, v7
v_accvgpr_write_b32 a108, v236
v_accvgpr_write_b32 a109, v237
v_accvgpr_write_b32 a110, v238
v_accvgpr_write_b32 a111, v239
v_accvgpr_read_b32 v224, a112
v_accvgpr_read_b32 v225, a113
v_accvgpr_read_b32 v226, a114
v_accvgpr_read_b32 v227, a115
v_mul_f32 v224, v224, v6
v_mul_f32 v225, v225, v6
v_mul_f32 v226, v226, v6
v_mul_f32 v227, v227, v6
v_accvgpr_write_b32 a112, v224
v_accvgpr_write_b32 a113, v225
v_accvgpr_write_b32 a114, v226
v_accvgpr_write_b32 a115, v227
v_accvgpr_read_b32 v228, a116
v_accvgpr_read_b32 v229, a117
v_accvgpr_read_b32 v230, a118
v_accvgpr_read_b32 v231, a119
v_mul_f32 v228, v228, v7
v_mul_f32 v229, v229, v7
v_mul_f32 v230, v230, v7
v_mul_f32 v231, v231, v7
v_accvgpr_write_b32 a116, v228
v_accvgpr_write_b32 a117, v229
v_accvgpr_write_b32 a118, v230
v_accvgpr_write_b32 a119, v231
v_accvgpr_read_b32 v232, a120
v_accvgpr_read_b32 v233, a121
v_accvgpr_read_b32 v234, a122
v_accvgpr_read_b32 v235, a123
v_mul_f32 v232, v232, v6
v_mul_f32 v233, v233, v6
v_mul_f32 v234, v234, v6
v_mul_f32 v235, v235, v6
v_accvgpr_write_b32 a120, v232
v_accvgpr_write_b32 a121, v233
v_accvgpr_write_b32 a122, v234
v_accvgpr_write_b32 a123, v235
v_accvgpr_read_b32 v236, a124
v_accvgpr_read_b32 v237, a125
v_accvgpr_read_b32 v238, a126
v_accvgpr_read_b32 v239, a127
v_mul_f32 v236, v236, v7
v_mul_f32 v237, v237, v7
v_mul_f32 v238, v238, v7
v_mul_f32 v239, v239, v7
v_accvgpr_write_b32 a124, v236
v_accvgpr_write_b32 a125, v237
v_accvgpr_write_b32 a126, v238
v_accvgpr_write_b32 a127, v239
s_nop 1
s_setpc_b64 s[96:97]
KALL_code_end:
.section .rodata,"a"
.p2align 6
.amdhsa_kernel sequential_preLN__compressed_kv_cla__glu_gated_reglu__prompt_kernel
  .amdhsa_next_free_vgpr 512
  .amdhsa_next_free_sgpr 102
  .amdhsa_accum_offset 256
  .amdhsa_group_segment_fixed_size 0
  .amdhsa_kernarg_size 104
  .amdhsa_user_sgpr_count 2
  .amdhsa_user_sgpr_kernarg_segment_ptr 1
  .amdhsa_system_sgpr_workgroup_id_x 1
  .amdhsa_float_denorm_mode_32 3
.end_amdhsa_kernel
```
